```python
import torch

def _softmax(x, axis=-1):
    return torch.softmax(x, dim=axis)
def _gelu(x):
    return torch.nn.functional.gelu(x, approximate="tanh")
def _silu(x):
    return torch.nn.functional.silu(x)
def _sigmoid(x):
    return torch.sigmoid(x)
def _layernorm(x, axis=-1, eps=1e-5):
    m = x.mean(dim=axis, keepdim=True)
    v = x.var(dim=axis, keepdim=True, unbiased=False)
    return (x - m) / torch.sqrt(v + eps)
def _scatter_add(tgt, idx, src, axis=0):
    return tgt.clone().index_add_(axis, idx, src)
def _segment_sum(src, seg, n):
    out = torch.zeros((n,) + src.shape[1:], dtype=src.dtype)
    return out.index_add_(0, seg, src)
def _pad(x, pw):
    flat = tuple(v for pair in reversed(pw) for v in pair)
    return torch.nn.functional.pad(x, flat)

kernel_name = 'standalone__detection_seg_fpn_lateral__vision'

def setup_inputs():

    _w = (lambda a: (lambda t: t.to(torch.bfloat16) if t.is_floating_point() else t)(torch.as_tensor(a)))
    H = W = (384 // 2) * 2
    C = 384
    k = 1
    return {
        "c_fine": _w((lambda *s: torch.randn(*s, dtype=torch.bfloat16) * 0.05)(1, H, W, C)),
        "p_coarse": _w((lambda *s: torch.randn(*s, dtype=torch.bfloat16) * 0.05)(1, H // 2, W // 2, C)),
        "w_lat": _w((lambda *s: torch.randn(*s, dtype=torch.bfloat16) * 0.05)(C, C)),
        "w_out": _w((lambda *s: torch.randn(*s, dtype=torch.bfloat16) * 0.05)(k, k, C, C)),
    }

def reference(c_fine, p_coarse, w_lat, w_out):
    B, H, W, C = c_fine.shape
    k = 1
    lat = torch.einsum("bhwc,cd->bhwd", c_fine, w_lat)
    up = (lambda x, n, axis: torch.repeat_interleave(x, n, dim=axis))((lambda x, n, axis: torch.repeat_interleave(x, n, dim=axis))(p_coarse, 2, axis=1), 2, axis=2)
    m = lat + up
    pad = k // 2
    mp = _pad(m, ((0, 0), (pad, pad), (pad, pad), (0, 0)))
    o = None
    for di in range(k):
        for dj in range(k):
            t = torch.einsum("bhwc,cd->bhwd", mp[:, di:di + H, dj:dj + W, :], w_out[di, dj])
            o = t if o is None else o + t
    return o
```

```asm
; @launch grid=(256,1,1) block=(256,1,1) lds=163840
.amdgcn_target "amdgcn-amd-amdhsa--gfx950"
.text
.globl standalone__detection_seg_fpn_lateral__vision_kernel
.p2align 8
.type standalone__detection_seg_fpn_lateral__vision_kernel,@function
standalone__detection_seg_fpn_lateral__vision_kernel:
    s_load_dwordx8 s[4:11], s[0:1], 0
    s_getpc_b64 s[18:19]
L_pc:
    s_cmp_ge_u32 s2, 256
    s_cbranch_scc1 L_end
    s_and_b32 s57, s2, 0x30
    s_cbranch_scc1 L_nocpf
    s_and_b32 s57, s2, 8
    s_lshl_b32 s57, s57, 12
    v_lshl_add_u32 v1, v0, 7, s57
    v_min_u32 v1, L_end-L_pc, v1
    global_load_dword v96, v1, s[18:19]
L_nocpf:
    v_lshrrev_b32 v1, 6, v0
    v_and_b32 v0, 63, v0
    v_readfirstlane_b32 s48, v1
    v_lshrrev_b32 v3, 4, v0
    v_lshlrev_b32 v85, 7, v0
    s_lshr_b32 s68, s2, 3
    s_lshl_b32 s68, s68, 2
    s_add_u32 s68, s68, s48
    s_mul_i32 s68, s68, 2304
    s_mul_i32 s49, s48, 3072
    s_mul_i32 s57, s48, 516
    v_mad_u32_u24 v80, v3, 43, s57
    v_lshl_add_u32 v81, v0, 4, s49
    v_lshrrev_b32 v1, 3, v80
    v_and_b32 v1, 0xf0, v1
    v_xor_b32 v244, v1, v81
    v_mad_u32_u24 v232, v1, 48, v244
    v_add_u32 v80, 172, v80
    v_lshrrev_b32 v1, 3, v80
    v_and_b32 v1, 0xf0, v1
    v_xor_b32 v245, v1, v81
    v_mad_u32_u24 v233, v1, 48, v245
    v_add_u32 v80, 172, v80
    v_lshrrev_b32 v1, 3, v80
    v_and_b32 v1, 0xf0, v1
    v_xor_b32 v246, v1, v81
    v_mad_u32_u24 v234, v1, 48, v246
    s_lshr_b32 s57, s2, 4
    s_lshl_b32 s60, s57, 2
    s_bfe_u32 s57, s2, 131073
    s_add_u32 s60, s60, s57
    s_and_b32 s57, s2, 9
    s_cselect_b32 s60, 99, s60
    s_bitcmp1_b32 s2, 3
    s_cselect_b32 s61, 2, 1
    s_cmp_lt_u32 s60, 24
    s_cselect_b32 s61, 0, s61
    s_mov_b32 s34, 294912
    s_mov_b32 s35, 0x20000
    s_mov_b32 s26, 28311552
    s_mov_b32 s27, 0x20000
    s_waitcnt lgkmcnt(0)
    s_mov_b64 s[32:33], s[10:11]
    s_mov_b64 exec, 0x3ffff
    buffer_load_dword v97, v85, s[32:35], s68 offen
    s_mov_b64 exec, -1
    s_mov_b64 s[24:25], s[6:7]
    s_load_dwordx4 s[12:15], s[0:1], 32
    s_load_dwordx2 s[16:17], s[0:1], 48
    s_cmp_eq_u32 s61, 1
    s_cbranch_scc1 L_pre_done
    s_cmp_eq_u32 s61, 2
    s_cbranch_scc1 L_pre_2
    s_mov_b32 s28, s8
    s_mov_b32 s29, s9
    s_mov_b32 s30, 294912
    s_mov_b32 s31, 0x20000
    s_mul_i32 s57, s60, 12288
    s_add_u32 s75, s57, 0
    s_add_u32 m0, s49, 110592
    s_nop 0
    buffer_load_dwordx4 v244, s[28:31], s75 offen lds
    buffer_load_dwordx4 v245, s[28:31], s75 offen offset:1024 lds
    buffer_load_dwordx4 v246, s[28:31], s75 offen offset:2048 lds
    s_branch L_pre_done
L_pre_2:
    s_add_u32 s76, s2, 0
    s_and_b32 s76, s76, 255
    s_add_u32 s76, s76, 0
    s_mul_i32 s76, s76, 12288
    s_add_u32 m0, s49, 110592
    s_nop 0
    buffer_load_dwordx4 v244, s[24:27], s76 offen nt lds
    buffer_load_dwordx4 v245, s[24:27], s76 offen offset:1024 nt lds
    buffer_load_dwordx4 v246, s[24:27], s76 offen offset:2048 nt lds
    s_add_u32 s77, s2, 43
    s_and_b32 s77, s77, 255
    s_add_u32 s77, s77, 256
    s_mul_i32 s77, s77, 12288
    s_add_u32 m0, s49, 122880
    s_nop 0
    buffer_load_dwordx4 v244, s[24:27], s77 offen nt lds
    buffer_load_dwordx4 v245, s[24:27], s77 offen offset:1024 nt lds
    buffer_load_dwordx4 v246, s[24:27], s77 offen offset:2048 nt lds
    s_add_u32 s74, s2, 86
    s_and_b32 s74, s74, 255
    s_add_u32 s74, s74, 512
    s_mul_i32 s74, s74, 12288
    s_add_u32 m0, s49, 135168
    s_nop 0
    buffer_load_dwordx4 v244, s[24:27], s74 offen nt lds
    buffer_load_dwordx4 v245, s[24:27], s74 offen offset:1024 nt lds
    buffer_load_dwordx4 v246, s[24:27], s74 offen offset:2048 nt lds
    s_add_u32 s75, s2, 129
    s_and_b32 s75, s75, 255
    s_add_u32 s75, s75, 768
    s_mul_i32 s75, s75, 12288
    s_add_u32 m0, s49, 24576
    s_nop 0
    buffer_load_dwordx4 v244, s[24:27], s75 offen nt lds
    buffer_load_dwordx4 v245, s[24:27], s75 offen offset:1024 nt lds
    buffer_load_dwordx4 v246, s[24:27], s75 offen offset:2048 nt lds
    s_add_u32 s76, s2, 172
    s_and_b32 s76, s76, 255
    s_add_u32 s76, s76, 1024
    s_mul_i32 s76, s76, 12288
    s_add_u32 m0, s49, 36864
    s_nop 0
    buffer_load_dwordx4 v244, s[24:27], s76 offen nt lds
    buffer_load_dwordx4 v245, s[24:27], s76 offen offset:1024 nt lds
    buffer_load_dwordx4 v246, s[24:27], s76 offen offset:2048 nt lds
    s_add_u32 s77, s2, 215
    s_and_b32 s77, s77, 255
    s_add_u32 s77, s77, 1280
    s_mul_i32 s77, s77, 12288
    s_add_u32 m0, s49, 98304
    s_nop 0
    buffer_load_dwordx4 v244, s[24:27], s77 offen nt lds
    buffer_load_dwordx4 v245, s[24:27], s77 offen offset:1024 nt lds
    buffer_load_dwordx4 v246, s[24:27], s77 offen offset:2048 nt lds
L_pre_done:
    s_mul_i32 s57, s48, 192
    s_and_b32 s58, s48, 1
    s_lshl_b32 s50, s58, 6
    s_add_u32 s50, s50, s57
    s_xor_b32 s58, s58, 1
    s_lshl_b32 s51, s58, 7
    s_add_u32 s51, s51, s57
    v_lshrrev_b32 v76, 3, v0
    v_and_b32 v77, 7, v0
    v_lshrrev_b32 v78, 2, v0
    v_and_b32 v79, 3, v0
    v_and_b32 v1, 4, v78
    v_xor_b32 v1, v1, v77
    v_mul_u32_u24 v247, 768, v76
    v_lshl_add_u32 v247, v1, 4, v247
    v_add_u32 v247, s50, v247
    v_mul_u32_u24 v248, 768, v78
    v_lshl_add_u32 v248, v79, 4, v248
    v_add_u32 v248, s51, v248
    s_mul_i32 s70, s48, 12288
    s_add_u32 s70, s70, 49152
    s_lshl_b32 s71, s48, 12
    s_add_u32 s71, s71, 147456
    s_add_u32 m0, s70, 0
    s_mov_b32 s74, 0
    buffer_load_dwordx4 v247, s[32:35], s74 offen lds
    s_mov_b32 s75, 5120
    buffer_load_dwordx4 v247, s[32:35], s75 offen offset:1024 lds
    s_mov_b32 s76, 10240
    buffer_load_dwordx4 v247, s[32:35], s76 offen offset:2048 lds
    s_mov_b32 s77, 15360
    buffer_load_dwordx4 v247, s[32:35], s77 offen offset:3072 lds
    s_add_u32 m0, s71, 0
    s_mov_b32 s74, 0
    buffer_load_dwordx4 v248, s[32:35], s74 offen lds
    s_mov_b32 s75, 11264
    buffer_load_dwordx4 v248, s[32:35], s75 offen offset:1024 lds
    s_add_u32 m0, s70, 4096
    s_mov_b32 s76, 24576
    buffer_load_dwordx4 v247, s[32:35], s76 offen lds
    s_mov_b32 s77, 29696
    buffer_load_dwordx4 v247, s[32:35], s77 offen offset:1024 lds
    s_mov_b32 s74, 34816
    buffer_load_dwordx4 v247, s[32:35], s74 offen offset:2048 lds
    s_mov_b32 s75, 39936
    buffer_load_dwordx4 v247, s[32:35], s75 offen offset:3072 lds
    s_add_u32 m0, s71, 2048
    s_mov_b32 s76, 24576
    buffer_load_dwordx4 v248, s[32:35], s76 offen lds
    s_mov_b32 s77, 35840
    buffer_load_dwordx4 v248, s[32:35], s77 offen offset:1024 lds
    s_add_u32 m0, s70, 8192
    s_mov_b32 s74, 49152
    buffer_load_dwordx4 v247, s[32:35], s74 offen lds
    s_mov_b32 s75, 54272
    buffer_load_dwordx4 v247, s[32:35], s75 offen offset:1024 lds
    s_mov_b32 s76, 59392
    buffer_load_dwordx4 v247, s[32:35], s76 offen offset:2048 lds
    s_mov_b32 s77, 64512
    buffer_load_dwordx4 v247, s[32:35], s77 offen offset:3072 lds
    v_and_b32 v2, 15, v0
    s_mov_b32 s20, s4
    s_mov_b32 s21, s5
    s_mov_b32 s22, 113246208
    s_mov_b32 s23, 0x20000
    s_mul_hi_u32 s57, s2, 0x15555556
    s_mul_i32 s57, s57, 294912
    s_mul_i32 s78, s2, 24576
    s_add_u32 s78, s78, s57
    s_add_u32 s67, s2, 43
    s_and_b32 s67, s67, 255
    s_add_u32 s87, s67, 256
    s_mul_hi_u32 s57, s87, 0x15555556
    s_mul_i32 s57, s57, 294912
    s_mul_i32 s79, s87, 24576
    s_add_u32 s79, s79, s57
    s_bfe_u32 s85, s2, 196612
    s_add_u32 s85, s85, 1
    s_mul_i32 s68, s85, 43
    s_add_u32 s68, s68, s2
    s_and_b32 s68, s68, 255
    s_lshl_b32 s58, s85, 8
    s_add_u32 s68, s68, s58
    s_mul_hi_u32 s57, s68, 0x15555556
    s_mul_i32 s57, s57, 294912
    s_mul_i32 s84, s68, 24576
    s_add_u32 s84, s84, s57
    s_cmp_eq_u32 s61, 2
    s_cselect_b32 s85, 59, s85
    v_and_b32 v1, 3, v78
    v_lshl_add_u32 v80, v3, 3, v1
    v_and_b32 v1, 2, v1
    v_lshl_add_u32 v1, v1, 1, v79
    v_lshlrev_b32 v1, 4, v1
    v_lshl_add_u32 v249, v80, 7, v1
    v_add_u32 v249, s70, v249
    v_xor_b32 v250, 64, v249
    v_lshlrev_b32 v1, 4, v79
    v_lshl_add_u32 v251, v80, 6, v1
    v_add_u32 v251, s71, v251
    v_xor_b32 v1, v2, v3
    v_lshlrev_b32 v1, 4, v1
    v_mul_u32_u24 v80, 768, v2
    v_add_u32 v228, v80, v1
    v_xor_b32 v229, 64, v228
    v_xor_b32 v230, 128, v228
    v_xor_b32 v231, 192, v228
    s_mov_b32 s57, 73728
    s_cmp_eq_u32 s61, 1
    s_cselect_b32 s57, 163840, s57
    v_add_u32 v240, s57, v228
    v_add_u32 v241, s57, v229
    v_add_u32 v242, s57, v230
    v_add_u32 v243, s57, v231
    s_mov_b32 s57, s50
    s_and_b32 s58, s57, 0xc0
    s_andn2_b32 s57, s57, 0xff
    s_add_u32 s57, s57, 98304
    v_xor_b32 v235, s58, v228
    v_add_u32 v235, s57, v235
    s_add_u32 s57, s50, 64
    s_and_b32 s58, s57, 0xc0
    s_andn2_b32 s57, s57, 0xff
    s_add_u32 s57, s57, 98304
    v_xor_b32 v236, s58, v228
    v_add_u32 v236, s57, v236
    s_mov_b32 s57, s51
    s_and_b32 s58, s57, 0xc0
    s_andn2_b32 s57, s57, 0xff
    s_add_u32 s57, s57, 98304
    v_xor_b32 v237, s58, v228
    v_add_u32 v237, s57, v237
    s_add_u32 s57, s49, 98304
    v_lshlrev_b32 v1, 4, v0
    v_add_u32 v238, s57, v1
    s_mul_i32 s57, s48, 73728
    v_add_u32 v252, s57, v1
    s_lshr_b32 s58, s2, 4
    s_lshl_b32 s58, s58, 2
    s_add_u32 s58, s58, s48
    s_mul_i32 s58, s58, 4608
    v_add_u32 v253, s58, v85
    s_cmp_eq_u32 s61, 2
    s_cselect_b32 s62, 2147483648, 0
    s_cselect_b32 s63, 90112, s49
    s_cselect_b32 s64, 163840, s49
    s_mov_b32 s58, 1
    s_waitcnt lgkmcnt(0)
    s_mov_b32 s36, s12
    s_mov_b32 s37, s13
    s_mov_b32 s38, 113246208
    s_mov_b32 s39, 0x20000
    s_mov_b32 s40, s16
    s_mov_b32 s41, s17
    s_mov_b32 s42, 294912
    s_mov_b32 s43, 0x20000
    s_mov_b32 s44, s14
    s_mov_b32 s45, s15
    s_mov_b32 s46, 256
    s_mov_b32 s47, 0x20000
    s_mov_b32 s59, 0xffff0000
    s_mov_b32 s19, 1
    s_cmp_eq_u32 s58, 1
    s_cselect_b32 s81, s78, 2147483648
    s_cselect_b32 s82, s49, 163840
    s_mov_b32 s54, 0
    s_getreg_b32 s57, hwreg(HW_REG_XCC_ID)
    s_bitcmp0_b32 s57, 0
    s_cselect_b64 vcc, -1, 0
    s_cmp_eq_u32 s61, 0
    s_cselect_b64 vcc, 0, vcc
    s_mov_b32 s65, 1
    s_mov_b32 s83, 0
    s_brev_b32 s56, 1
    s_mov_b32 s97, s78
    s_waitcnt vmcnt(10)
    s_barrier
    ds_read_b64_tr_b16 a[16:17], v251 offset:0
    ds_read_b64_tr_b16 a[18:19], v251 offset:256
    ds_read_b64_tr_b16 a[20:21], v251 offset:8
    ds_read_b64_tr_b16 a[22:23], v251 offset:264
    ds_read_b64_tr_b16 a[0:1], v249 offset:0
    ds_read_b64_tr_b16 a[2:3], v249 offset:512
    ds_read_b64_tr_b16 a[4:5], v249 offset:8
    ds_read_b64_tr_b16 a[6:7], v249 offset:520
    ds_read_b64_tr_b16 a[8:9], v250 offset:0
    ds_read_b64_tr_b16 a[10:11], v250 offset:512
    ds_read_b64_tr_b16 a[12:13], v250 offset:8
    ds_read_b64_tr_b16 a[14:15], v250 offset:520
    ds_read_b128 v[4:7], v240 offset:36864
    ds_read_b128 v[8:11], v240 offset:49152
    ds_read_b128 v[12:15], v240 offset:61440
    s_waitcnt lgkmcnt(11)
    s_add_u32 m0, s71, 0
    s_mov_b32 s74, 49152
    buffer_load_dwordx4 v248, s[32:35], s74 offen lds
    s_mov_b32 s75, 60416
    buffer_load_dwordx4 v248, s[32:35], s75 offen offset:1024 lds
    s_waitcnt lgkmcnt(0)
    s_add_u32 m0, s70, 0
    s_mov_b32 s76, 73728
    buffer_load_dwordx4 v247, s[32:35], s76 offen lds
    s_mov_b32 s77, 78848
    buffer_load_dwordx4 v247, s[32:35], s77 offen offset:1024 lds
    s_mov_b32 s74, 83968
    buffer_load_dwordx4 v247, s[32:35], s74 offen offset:2048 lds
    s_mov_b32 s75, 89088
    buffer_load_dwordx4 v247, s[32:35], s75 offen offset:3072 lds
    s_waitcnt vmcnt(10)
    ds_read_b64_tr_b16 a[40:41], v251 offset:2048
    ds_read_b64_tr_b16 a[42:43], v251 offset:2304
    v_mfma_f32_16x16x32_bf16 v[148:151], a[0:3], v[4:7], 0
    ds_read_b64_tr_b16 a[44:45], v251 offset:2056
    ds_read_b64_tr_b16 a[46:47], v251 offset:2312
    v_mfma_f32_16x16x32_bf16 v[172:175], a[0:3], v[8:11], 0
    ds_read_b64_tr_b16 a[24:25], v249 offset:4096
    ds_read_b64_tr_b16 a[26:27], v249 offset:4608
    v_mfma_f32_16x16x32_bf16 v[52:55], a[0:3], v[12:15], 0
    ds_read_b64_tr_b16 a[28:29], v249 offset:4104
    ds_read_b64_tr_b16 a[30:31], v249 offset:4616
    v_mfma_f32_16x16x32_bf16 v[152:155], a[4:7], v[4:7], 0
    ds_read_b64_tr_b16 a[32:33], v250 offset:4096
    ds_read_b64_tr_b16 a[34:35], v250 offset:4608
    v_mfma_f32_16x16x32_bf16 v[176:179], a[4:7], v[8:11], 0
    ds_read_b64_tr_b16 a[36:37], v250 offset:4104
    ds_read_b64_tr_b16 a[38:39], v250 offset:4616
    v_mfma_f32_16x16x32_bf16 v[56:59], a[4:7], v[12:15], 0
    ds_read_b128 v[16:19], v241 offset:36864
    ds_read_b128 v[20:23], v241 offset:49152
    s_waitcnt lgkmcnt(10)
    s_add_u32 m0, s71, 2048
    s_mov_b32 s76, 73728
    buffer_load_dwordx4 v248, s[32:35], s76 offen lds
    v_mfma_f32_16x16x32_bf16 v[156:159], a[8:11], v[4:7], 0
    ds_read_b128 v[24:27], v241 offset:61440
    v_mfma_f32_16x16x32_bf16 v[180:183], a[8:11], v[8:11], 0
    s_mov_b32 s77, 84992
    buffer_load_dwordx4 v248, s[32:35], s77 offen offset:1024 lds
    v_mfma_f32_16x16x32_bf16 v[60:63], a[8:11], v[12:15], 0
    v_mfma_f32_16x16x32_bf16 v[160:163], a[12:15], v[4:7], 0
    v_mfma_f32_16x16x32_bf16 v[184:187], a[12:15], v[8:11], 0
    v_mfma_f32_16x16x32_bf16 v[64:67], a[12:15], v[12:15], 0
    s_waitcnt lgkmcnt(0)
    s_add_u32 m0, s70, 4096
    s_mov_b32 s74, 98304
    buffer_load_dwordx4 v247, s[32:35], s74 offen lds
    v_mfma_f32_16x16x32_bf16 v[164:167], a[16:19], v[4:7], 0
    s_mov_b32 s75, 103424
    buffer_load_dwordx4 v247, s[32:35], s75 offen offset:1024 lds
    v_mfma_f32_16x16x32_bf16 v[188:191], a[16:19], v[8:11], 0
    s_mov_b32 s76, 108544
    buffer_load_dwordx4 v247, s[32:35], s76 offen offset:2048 lds
    v_mfma_f32_16x16x32_bf16 v[68:71], a[16:19], v[12:15], 0
    s_mov_b32 s77, 113664
    buffer_load_dwordx4 v247, s[32:35], s77 offen offset:3072 lds
    v_mfma_f32_16x16x32_bf16 v[168:171], a[20:23], v[4:7], 0
    v_mfma_f32_16x16x32_bf16 v[192:195], a[20:23], v[8:11], 0
    v_mfma_f32_16x16x32_bf16 v[72:75], a[20:23], v[12:15], 0
    s_waitcnt vmcnt(10)
    ds_read_b64_tr_b16 a[64:65], v251 offset:0
    ds_read_b64_tr_b16 a[66:67], v251 offset:256
    v_mfma_f32_16x16x32_bf16 v[148:151], a[24:27], v[16:19], v[148:151]
    ds_read_b64_tr_b16 a[68:69], v251 offset:8
    ds_read_b64_tr_b16 a[70:71], v251 offset:264
    v_mfma_f32_16x16x32_bf16 v[172:175], a[24:27], v[20:23], v[172:175]
    ds_read_b64_tr_b16 a[48:49], v249 offset:8192
    ds_read_b64_tr_b16 a[50:51], v249 offset:8704
    v_mfma_f32_16x16x32_bf16 v[52:55], a[24:27], v[24:27], v[52:55]
    ds_read_b64_tr_b16 a[52:53], v249 offset:8200
    ds_read_b64_tr_b16 a[54:55], v249 offset:8712
    v_mfma_f32_16x16x32_bf16 v[152:155], a[28:31], v[16:19], v[152:155]
    ds_read_b64_tr_b16 a[56:57], v250 offset:8192
    ds_read_b64_tr_b16 a[58:59], v250 offset:8704
    v_mfma_f32_16x16x32_bf16 v[176:179], a[28:31], v[20:23], v[176:179]
    ds_read_b64_tr_b16 a[60:61], v250 offset:8200
    ds_read_b64_tr_b16 a[62:63], v250 offset:8712
    v_mfma_f32_16x16x32_bf16 v[56:59], a[28:31], v[24:27], v[56:59]
    ds_read_b128 v[28:31], v242 offset:36864
    ds_read_b128 v[32:35], v242 offset:49152
    s_waitcnt lgkmcnt(10)
    s_add_u32 m0, s71, 0
    s_mov_b32 s74, 98304
    buffer_load_dwordx4 v248, s[32:35], s74 offen lds
    v_mfma_f32_16x16x32_bf16 v[156:159], a[32:35], v[16:19], v[156:159]
    ds_read_b128 v[36:39], v242 offset:61440
    v_mfma_f32_16x16x32_bf16 v[180:183], a[32:35], v[20:23], v[180:183]
    s_mov_b32 s75, 109568
    buffer_load_dwordx4 v248, s[32:35], s75 offen offset:1024 lds
    v_mfma_f32_16x16x32_bf16 v[60:63], a[32:35], v[24:27], v[60:63]
    v_mfma_f32_16x16x32_bf16 v[160:163], a[36:39], v[16:19], v[160:163]
    v_mfma_f32_16x16x32_bf16 v[184:187], a[36:39], v[20:23], v[184:187]
    v_mfma_f32_16x16x32_bf16 v[64:67], a[36:39], v[24:27], v[64:67]
    s_waitcnt lgkmcnt(0)
    s_add_u32 m0, s70, 8192
    s_mov_b32 s76, 122880
    buffer_load_dwordx4 v247, s[32:35], s76 offen lds
    v_mfma_f32_16x16x32_bf16 v[164:167], a[40:43], v[16:19], v[164:167]
    s_mov_b32 s77, 128000
    buffer_load_dwordx4 v247, s[32:35], s77 offen offset:1024 lds
    v_mfma_f32_16x16x32_bf16 v[188:191], a[40:43], v[20:23], v[188:191]
    s_mov_b32 s74, 133120
    buffer_load_dwordx4 v247, s[32:35], s74 offen offset:2048 lds
    v_mfma_f32_16x16x32_bf16 v[68:71], a[40:43], v[24:27], v[68:71]
    s_mov_b32 s75, 138240
    buffer_load_dwordx4 v247, s[32:35], s75 offen offset:3072 lds
    v_mfma_f32_16x16x32_bf16 v[168:171], a[44:47], v[16:19], v[168:171]
    v_mfma_f32_16x16x32_bf16 v[192:195], a[44:47], v[20:23], v[192:195]
    v_mfma_f32_16x16x32_bf16 v[72:75], a[44:47], v[24:27], v[72:75]
    s_waitcnt vmcnt(10)
    ds_read_b64_tr_b16 a[88:89], v251 offset:2048
    ds_read_b64_tr_b16 a[90:91], v251 offset:2304
    v_mfma_f32_16x16x32_bf16 v[148:151], a[48:51], v[28:31], v[148:151]
    ds_read_b64_tr_b16 a[92:93], v251 offset:2056
    ds_read_b64_tr_b16 a[94:95], v251 offset:2312
    v_mfma_f32_16x16x32_bf16 v[172:175], a[48:51], v[32:35], v[172:175]
    ds_read_b64_tr_b16 a[72:73], v249 offset:0
    ds_read_b64_tr_b16 a[74:75], v249 offset:512
    v_mfma_f32_16x16x32_bf16 v[52:55], a[48:51], v[36:39], v[52:55]
    ds_read_b64_tr_b16 a[76:77], v249 offset:8
    ds_read_b64_tr_b16 a[78:79], v249 offset:520
    v_mfma_f32_16x16x32_bf16 v[152:155], a[52:55], v[28:31], v[152:155]
    ds_read_b64_tr_b16 a[80:81], v250 offset:0
    ds_read_b64_tr_b16 a[82:83], v250 offset:512
    v_mfma_f32_16x16x32_bf16 v[176:179], a[52:55], v[32:35], v[176:179]
    ds_read_b64_tr_b16 a[84:85], v250 offset:8
    ds_read_b64_tr_b16 a[86:87], v250 offset:520
    v_mfma_f32_16x16x32_bf16 v[56:59], a[52:55], v[36:39], v[56:59]
    ds_read_b128 v[40:43], v243 offset:36864
    ds_read_b128 v[44:47], v243 offset:49152
    s_waitcnt lgkmcnt(10)
    s_add_u32 m0, s71, 2048
    s_mov_b32 s76, 122880
    buffer_load_dwordx4 v248, s[32:35], s76 offen lds
    v_mfma_f32_16x16x32_bf16 v[156:159], a[56:59], v[28:31], v[156:159]
    ds_read_b128 v[48:51], v243 offset:61440
    v_mfma_f32_16x16x32_bf16 v[180:183], a[56:59], v[32:35], v[180:183]
    s_mov_b32 s77, 134144
    buffer_load_dwordx4 v248, s[32:35], s77 offen offset:1024 lds
    v_mfma_f32_16x16x32_bf16 v[60:63], a[56:59], v[36:39], v[60:63]
    v_mfma_f32_16x16x32_bf16 v[160:163], a[60:63], v[28:31], v[160:163]
    v_mfma_f32_16x16x32_bf16 v[184:187], a[60:63], v[32:35], v[184:187]
    v_mfma_f32_16x16x32_bf16 v[64:67], a[60:63], v[36:39], v[64:67]
    s_waitcnt lgkmcnt(0)
    s_add_u32 m0, s70, 0
    s_mov_b32 s74, 147456
    buffer_load_dwordx4 v247, s[32:35], s74 offen lds
    v_mfma_f32_16x16x32_bf16 v[164:167], a[64:67], v[28:31], v[164:167]
    s_mov_b32 s75, 152576
    buffer_load_dwordx4 v247, s[32:35], s75 offen offset:1024 lds
    v_mfma_f32_16x16x32_bf16 v[188:191], a[64:67], v[32:35], v[188:191]
    s_mov_b32 s76, 157696
    buffer_load_dwordx4 v247, s[32:35], s76 offen offset:2048 lds
    v_mfma_f32_16x16x32_bf16 v[68:71], a[64:67], v[36:39], v[68:71]
    s_mov_b32 s77, 162816
    buffer_load_dwordx4 v247, s[32:35], s77 offen offset:3072 lds
    v_mfma_f32_16x16x32_bf16 v[168:171], a[68:71], v[28:31], v[168:171]
    v_mfma_f32_16x16x32_bf16 v[192:195], a[68:71], v[32:35], v[192:195]
    v_mfma_f32_16x16x32_bf16 v[72:75], a[68:71], v[36:39], v[72:75]
    s_waitcnt vmcnt(10)
    ds_read_b64_tr_b16 a[112:113], v251 offset:0
    ds_read_b64_tr_b16 a[114:115], v251 offset:256
    v_mfma_f32_16x16x32_bf16 v[148:151], a[72:75], v[40:43], v[148:151]
    ds_read_b64_tr_b16 a[116:117], v251 offset:8
    ds_read_b64_tr_b16 a[118:119], v251 offset:264
    v_mfma_f32_16x16x32_bf16 v[172:175], a[72:75], v[44:47], v[172:175]
    ds_read_b64_tr_b16 a[96:97], v249 offset:4096
    ds_read_b64_tr_b16 a[98:99], v249 offset:4608
    v_mfma_f32_16x16x32_bf16 v[52:55], a[72:75], v[48:51], v[52:55]
    ds_read_b64_tr_b16 a[100:101], v249 offset:4104
    ds_read_b64_tr_b16 a[102:103], v249 offset:4616
    v_mfma_f32_16x16x32_bf16 v[152:155], a[76:79], v[40:43], v[152:155]
    ds_read_b64_tr_b16 a[104:105], v250 offset:4096
    ds_read_b64_tr_b16 a[106:107], v250 offset:4608
    v_mfma_f32_16x16x32_bf16 v[176:179], a[76:79], v[44:47], v[176:179]
    ds_read_b64_tr_b16 a[108:109], v250 offset:4104
    ds_read_b64_tr_b16 a[110:111], v250 offset:4616
    v_mfma_f32_16x16x32_bf16 v[56:59], a[76:79], v[48:51], v[56:59]
    ds_read_b128 v[4:7], v240 offset:37120
    ds_read_b128 v[8:11], v240 offset:49408
    s_waitcnt lgkmcnt(10)
    s_add_u32 m0, s71, 0
    s_mov_b32 s74, 147456
    buffer_load_dwordx4 v248, s[32:35], s74 offen lds
    v_mfma_f32_16x16x32_bf16 v[156:159], a[80:83], v[40:43], v[156:159]
    ds_read_b128 v[12:15], v240 offset:61696
    v_mfma_f32_16x16x32_bf16 v[180:183], a[80:83], v[44:47], v[180:183]
    s_mov_b32 s75, 158720
    buffer_load_dwordx4 v248, s[32:35], s75 offen offset:1024 lds
    v_mfma_f32_16x16x32_bf16 v[60:63], a[80:83], v[48:51], v[60:63]
    v_mfma_f32_16x16x32_bf16 v[160:163], a[84:87], v[40:43], v[160:163]
    v_mfma_f32_16x16x32_bf16 v[184:187], a[84:87], v[44:47], v[184:187]
    v_mfma_f32_16x16x32_bf16 v[64:67], a[84:87], v[48:51], v[64:67]
    s_waitcnt lgkmcnt(0)
    s_add_u32 m0, s70, 4096
    s_mov_b32 s76, 172032
    buffer_load_dwordx4 v247, s[32:35], s76 offen lds
    v_mfma_f32_16x16x32_bf16 v[164:167], a[88:91], v[40:43], v[164:167]
    s_mov_b32 s77, 177152
    buffer_load_dwordx4 v247, s[32:35], s77 offen offset:1024 lds
    v_mfma_f32_16x16x32_bf16 v[188:191], a[88:91], v[44:47], v[188:191]
    s_mov_b32 s74, 182272
    buffer_load_dwordx4 v247, s[32:35], s74 offen offset:2048 lds
    v_mfma_f32_16x16x32_bf16 v[68:71], a[88:91], v[48:51], v[68:71]
    s_mov_b32 s75, 187392
    buffer_load_dwordx4 v247, s[32:35], s75 offen offset:3072 lds
    v_mfma_f32_16x16x32_bf16 v[168:171], a[92:95], v[40:43], v[168:171]
    v_mfma_f32_16x16x32_bf16 v[192:195], a[92:95], v[44:47], v[192:195]
    v_mfma_f32_16x16x32_bf16 v[72:75], a[92:95], v[48:51], v[72:75]
    s_waitcnt vmcnt(10)
    ds_read_b64_tr_b16 a[136:137], v251 offset:2048
    ds_read_b64_tr_b16 a[138:139], v251 offset:2304
    v_mfma_f32_16x16x32_bf16 v[148:151], a[96:99], v[4:7], v[148:151]
    ds_read_b64_tr_b16 a[140:141], v251 offset:2056
    ds_read_b64_tr_b16 a[142:143], v251 offset:2312
    v_mfma_f32_16x16x32_bf16 v[172:175], a[96:99], v[8:11], v[172:175]
    ds_read_b64_tr_b16 a[120:121], v249 offset:8192
    ds_read_b64_tr_b16 a[122:123], v249 offset:8704
    v_mfma_f32_16x16x32_bf16 v[52:55], a[96:99], v[12:15], v[52:55]
    ds_read_b64_tr_b16 a[124:125], v249 offset:8200
    ds_read_b64_tr_b16 a[126:127], v249 offset:8712
    v_mfma_f32_16x16x32_bf16 v[152:155], a[100:103], v[4:7], v[152:155]
    ds_read_b64_tr_b16 a[128:129], v250 offset:8192
    ds_read_b64_tr_b16 a[130:131], v250 offset:8704
    v_mfma_f32_16x16x32_bf16 v[176:179], a[100:103], v[8:11], v[176:179]
    ds_read_b64_tr_b16 a[132:133], v250 offset:8200
    ds_read_b64_tr_b16 a[134:135], v250 offset:8712
    v_mfma_f32_16x16x32_bf16 v[56:59], a[100:103], v[12:15], v[56:59]
    ds_read_b128 v[16:19], v241 offset:37120
    ds_read_b128 v[20:23], v241 offset:49408
    s_waitcnt lgkmcnt(10)
    s_add_u32 m0, s71, 2048
    s_mov_b32 s76, 172032
    buffer_load_dwordx4 v248, s[32:35], s76 offen lds
    v_mfma_f32_16x16x32_bf16 v[156:159], a[104:107], v[4:7], v[156:159]
    ds_read_b128 v[24:27], v241 offset:61696
    v_mfma_f32_16x16x32_bf16 v[180:183], a[104:107], v[8:11], v[180:183]
    s_mov_b32 s77, 183296
    buffer_load_dwordx4 v248, s[32:35], s77 offen offset:1024 lds
    v_mfma_f32_16x16x32_bf16 v[60:63], a[104:107], v[12:15], v[60:63]
    v_mfma_f32_16x16x32_bf16 v[160:163], a[108:111], v[4:7], v[160:163]
    v_mfma_f32_16x16x32_bf16 v[184:187], a[108:111], v[8:11], v[184:187]
    v_mfma_f32_16x16x32_bf16 v[64:67], a[108:111], v[12:15], v[64:67]
    s_waitcnt lgkmcnt(0)
    s_add_u32 m0, s70, 8192
    s_mov_b32 s74, 196608
    buffer_load_dwordx4 v247, s[32:35], s74 offen lds
    v_mfma_f32_16x16x32_bf16 v[164:167], a[112:115], v[4:7], v[164:167]
    s_mov_b32 s75, 201728
    buffer_load_dwordx4 v247, s[32:35], s75 offen offset:1024 lds
    v_mfma_f32_16x16x32_bf16 v[188:191], a[112:115], v[8:11], v[188:191]
    s_mov_b32 s76, 206848
    buffer_load_dwordx4 v247, s[32:35], s76 offen offset:2048 lds
    v_mfma_f32_16x16x32_bf16 v[68:71], a[112:115], v[12:15], v[68:71]
    s_mov_b32 s77, 211968
    buffer_load_dwordx4 v247, s[32:35], s77 offen offset:3072 lds
    v_mfma_f32_16x16x32_bf16 v[168:171], a[116:119], v[4:7], v[168:171]
    v_mfma_f32_16x16x32_bf16 v[192:195], a[116:119], v[8:11], v[192:195]
    v_mfma_f32_16x16x32_bf16 v[72:75], a[116:119], v[12:15], v[72:75]
    s_waitcnt vmcnt(10)
    ds_read_b64_tr_b16 a[160:161], v251 offset:0
    ds_read_b64_tr_b16 a[162:163], v251 offset:256
    v_mfma_f32_16x16x32_bf16 v[148:151], a[120:123], v[16:19], v[148:151]
    ds_read_b64_tr_b16 a[164:165], v251 offset:8
    ds_read_b64_tr_b16 a[166:167], v251 offset:264
    v_mfma_f32_16x16x32_bf16 v[172:175], a[120:123], v[20:23], v[172:175]
    ds_read_b64_tr_b16 a[144:145], v249 offset:0
    ds_read_b64_tr_b16 a[146:147], v249 offset:512
    v_mfma_f32_16x16x32_bf16 v[52:55], a[120:123], v[24:27], v[52:55]
    ds_read_b64_tr_b16 a[148:149], v249 offset:8
    ds_read_b64_tr_b16 a[150:151], v249 offset:520
    v_mfma_f32_16x16x32_bf16 v[152:155], a[124:127], v[16:19], v[152:155]
    ds_read_b64_tr_b16 a[152:153], v250 offset:0
    ds_read_b64_tr_b16 a[154:155], v250 offset:512
    v_mfma_f32_16x16x32_bf16 v[176:179], a[124:127], v[20:23], v[176:179]
    ds_read_b64_tr_b16 a[156:157], v250 offset:8
    ds_read_b64_tr_b16 a[158:159], v250 offset:520
    v_mfma_f32_16x16x32_bf16 v[56:59], a[124:127], v[24:27], v[56:59]
    ds_read_b128 v[28:31], v242 offset:37120
    ds_read_b128 v[32:35], v242 offset:49408
    s_waitcnt lgkmcnt(10)
    s_add_u32 m0, s71, 0
    s_mov_b32 s74, 196608
    buffer_load_dwordx4 v248, s[32:35], s74 offen lds
    v_mfma_f32_16x16x32_bf16 v[156:159], a[128:131], v[16:19], v[156:159]
    ds_read_b128 v[36:39], v242 offset:61696
    v_mfma_f32_16x16x32_bf16 v[180:183], a[128:131], v[20:23], v[180:183]
    s_mov_b32 s75, 207872
    buffer_load_dwordx4 v248, s[32:35], s75 offen offset:1024 lds
    v_mfma_f32_16x16x32_bf16 v[60:63], a[128:131], v[24:27], v[60:63]
    v_mfma_f32_16x16x32_bf16 v[160:163], a[132:135], v[16:19], v[160:163]
    v_mfma_f32_16x16x32_bf16 v[184:187], a[132:135], v[20:23], v[184:187]
    v_mfma_f32_16x16x32_bf16 v[64:67], a[132:135], v[24:27], v[64:67]
    s_waitcnt lgkmcnt(0)
    s_add_u32 m0, s70, 0
    s_mov_b32 s76, 221184
    buffer_load_dwordx4 v247, s[32:35], s76 offen lds
    v_mfma_f32_16x16x32_bf16 v[164:167], a[136:139], v[16:19], v[164:167]
    s_mov_b32 s77, 226304
    buffer_load_dwordx4 v247, s[32:35], s77 offen offset:1024 lds
    v_mfma_f32_16x16x32_bf16 v[188:191], a[136:139], v[20:23], v[188:191]
    s_mov_b32 s74, 231424
    buffer_load_dwordx4 v247, s[32:35], s74 offen offset:2048 lds
    v_mfma_f32_16x16x32_bf16 v[68:71], a[136:139], v[24:27], v[68:71]
    s_mov_b32 s75, 236544
    buffer_load_dwordx4 v247, s[32:35], s75 offen offset:3072 lds
    v_mfma_f32_16x16x32_bf16 v[168:171], a[140:143], v[16:19], v[168:171]
    v_mfma_f32_16x16x32_bf16 v[192:195], a[140:143], v[20:23], v[192:195]
    v_mfma_f32_16x16x32_bf16 v[72:75], a[140:143], v[24:27], v[72:75]
    s_waitcnt vmcnt(10)
    ds_read_b64_tr_b16 a[184:185], v251 offset:2048
    ds_read_b64_tr_b16 a[186:187], v251 offset:2304
    v_mfma_f32_16x16x32_bf16 v[148:151], a[144:147], v[28:31], v[148:151]
    ds_read_b64_tr_b16 a[188:189], v251 offset:2056
    ds_read_b64_tr_b16 a[190:191], v251 offset:2312
    v_mfma_f32_16x16x32_bf16 v[172:175], a[144:147], v[32:35], v[172:175]
    ds_read_b64_tr_b16 a[168:169], v249 offset:4096
    ds_read_b64_tr_b16 a[170:171], v249 offset:4608
    v_mfma_f32_16x16x32_bf16 v[52:55], a[144:147], v[36:39], v[52:55]
    ds_read_b64_tr_b16 a[172:173], v249 offset:4104
    ds_read_b64_tr_b16 a[174:175], v249 offset:4616
    v_mfma_f32_16x16x32_bf16 v[152:155], a[148:151], v[28:31], v[152:155]
    ds_read_b64_tr_b16 a[176:177], v250 offset:4096
    ds_read_b64_tr_b16 a[178:179], v250 offset:4608
    v_mfma_f32_16x16x32_bf16 v[176:179], a[148:151], v[32:35], v[176:179]
    ds_read_b64_tr_b16 a[180:181], v250 offset:4104
    ds_read_b64_tr_b16 a[182:183], v250 offset:4616
    v_mfma_f32_16x16x32_bf16 v[56:59], a[148:151], v[36:39], v[56:59]
    ds_read_b128 v[40:43], v243 offset:37120
    ds_read_b128 v[44:47], v243 offset:49408
    s_waitcnt lgkmcnt(10)
    s_add_u32 m0, s71, 2048
    s_mov_b32 s76, 221184
    buffer_load_dwordx4 v248, s[32:35], s76 offen lds
    v_mfma_f32_16x16x32_bf16 v[156:159], a[152:155], v[28:31], v[156:159]
    ds_read_b128 v[48:51], v243 offset:61696
    v_mfma_f32_16x16x32_bf16 v[180:183], a[152:155], v[32:35], v[180:183]
    s_mov_b32 s77, 232448
    buffer_load_dwordx4 v248, s[32:35], s77 offen offset:1024 lds
    v_mfma_f32_16x16x32_bf16 v[60:63], a[152:155], v[36:39], v[60:63]
    v_mfma_f32_16x16x32_bf16 v[160:163], a[156:159], v[28:31], v[160:163]
    v_mfma_f32_16x16x32_bf16 v[184:187], a[156:159], v[32:35], v[184:187]
    v_mfma_f32_16x16x32_bf16 v[64:67], a[156:159], v[36:39], v[64:67]
    s_waitcnt lgkmcnt(0)
    s_add_u32 m0, s70, 4096
    s_mov_b32 s74, 245760
    buffer_load_dwordx4 v247, s[32:35], s74 offen lds
    v_mfma_f32_16x16x32_bf16 v[164:167], a[160:163], v[28:31], v[164:167]
    s_mov_b32 s75, 250880
    buffer_load_dwordx4 v247, s[32:35], s75 offen offset:1024 lds
    v_mfma_f32_16x16x32_bf16 v[188:191], a[160:163], v[32:35], v[188:191]
    s_mov_b32 s76, 256000
    buffer_load_dwordx4 v247, s[32:35], s76 offen offset:2048 lds
    v_mfma_f32_16x16x32_bf16 v[68:71], a[160:163], v[36:39], v[68:71]
    s_mov_b32 s77, 261120
    buffer_load_dwordx4 v247, s[32:35], s77 offen offset:3072 lds
    v_mfma_f32_16x16x32_bf16 v[168:171], a[164:167], v[28:31], v[168:171]
    v_mfma_f32_16x16x32_bf16 v[192:195], a[164:167], v[32:35], v[192:195]
    v_mfma_f32_16x16x32_bf16 v[72:75], a[164:167], v[36:39], v[72:75]
    s_waitcnt vmcnt(10)
    ds_read_b64_tr_b16 a[208:209], v251 offset:0
    ds_read_b64_tr_b16 a[210:211], v251 offset:256
    v_mfma_f32_16x16x32_bf16 v[148:151], a[168:171], v[40:43], v[148:151]
    ds_read_b64_tr_b16 a[212:213], v251 offset:8
    ds_read_b64_tr_b16 a[214:215], v251 offset:264
    v_mfma_f32_16x16x32_bf16 v[172:175], a[168:171], v[44:47], v[172:175]
    ds_read_b64_tr_b16 a[192:193], v249 offset:8192
    ds_read_b64_tr_b16 a[194:195], v249 offset:8704
    v_mfma_f32_16x16x32_bf16 v[52:55], a[168:171], v[48:51], v[52:55]
    ds_read_b64_tr_b16 a[196:197], v249 offset:8200
    ds_read_b64_tr_b16 a[198:199], v249 offset:8712
    v_mfma_f32_16x16x32_bf16 v[152:155], a[172:175], v[40:43], v[152:155]
    ds_read_b64_tr_b16 a[200:201], v250 offset:8192
    ds_read_b64_tr_b16 a[202:203], v250 offset:8704
    v_mfma_f32_16x16x32_bf16 v[176:179], a[172:175], v[44:47], v[176:179]
    ds_read_b64_tr_b16 a[204:205], v250 offset:8200
    ds_read_b64_tr_b16 a[206:207], v250 offset:8712
    v_mfma_f32_16x16x32_bf16 v[56:59], a[172:175], v[48:51], v[56:59]
    ds_read_b128 v[4:7], v240 offset:37376
    ds_read_b128 v[8:11], v240 offset:49664
    s_waitcnt lgkmcnt(10)
    s_add_u32 m0, s71, 0
    s_mov_b32 s74, 245760
    buffer_load_dwordx4 v248, s[32:35], s74 offen lds
    v_mfma_f32_16x16x32_bf16 v[156:159], a[176:179], v[40:43], v[156:159]
    ds_read_b128 v[12:15], v240 offset:61952
    v_mfma_f32_16x16x32_bf16 v[180:183], a[176:179], v[44:47], v[180:183]
    s_mov_b32 s75, 257024
    buffer_load_dwordx4 v248, s[32:35], s75 offen offset:1024 lds
    v_mfma_f32_16x16x32_bf16 v[60:63], a[176:179], v[48:51], v[60:63]
    v_mfma_f32_16x16x32_bf16 v[160:163], a[180:183], v[40:43], v[160:163]
    v_mfma_f32_16x16x32_bf16 v[184:187], a[180:183], v[44:47], v[184:187]
    v_mfma_f32_16x16x32_bf16 v[64:67], a[180:183], v[48:51], v[64:67]
    s_waitcnt lgkmcnt(0)
    s_add_u32 m0, s70, 8192
    s_mov_b32 s76, 270336
    buffer_load_dwordx4 v247, s[32:35], s76 offen lds
    v_mfma_f32_16x16x32_bf16 v[164:167], a[184:187], v[40:43], v[164:167]
    s_mov_b32 s77, 275456
    buffer_load_dwordx4 v247, s[32:35], s77 offen offset:1024 lds
    v_mfma_f32_16x16x32_bf16 v[188:191], a[184:187], v[44:47], v[188:191]
    s_mov_b32 s74, 280576
    buffer_load_dwordx4 v247, s[32:35], s74 offen offset:2048 lds
    v_mfma_f32_16x16x32_bf16 v[68:71], a[184:187], v[48:51], v[68:71]
    s_mov_b32 s75, 285696
    buffer_load_dwordx4 v247, s[32:35], s75 offen offset:3072 lds
    v_mfma_f32_16x16x32_bf16 v[168:171], a[188:191], v[40:43], v[168:171]
    v_mfma_f32_16x16x32_bf16 v[192:195], a[188:191], v[44:47], v[192:195]
    v_mfma_f32_16x16x32_bf16 v[72:75], a[188:191], v[48:51], v[72:75]
    s_waitcnt vmcnt(10)
    ds_read_b64_tr_b16 a[232:233], v251 offset:2048
    ds_read_b64_tr_b16 a[234:235], v251 offset:2304
    v_mfma_f32_16x16x32_bf16 v[148:151], a[192:195], v[4:7], v[148:151]
    ds_read_b64_tr_b16 a[236:237], v251 offset:2056
    ds_read_b64_tr_b16 a[238:239], v251 offset:2312
    v_mfma_f32_16x16x32_bf16 v[172:175], a[192:195], v[8:11], v[172:175]
    ds_read_b64_tr_b16 a[216:217], v249 offset:0
    ds_read_b64_tr_b16 a[218:219], v249 offset:512
    v_mfma_f32_16x16x32_bf16 v[52:55], a[192:195], v[12:15], v[52:55]
    ds_read_b64_tr_b16 a[220:221], v249 offset:8
    ds_read_b64_tr_b16 a[222:223], v249 offset:520
    v_mfma_f32_16x16x32_bf16 v[152:155], a[196:199], v[4:7], v[152:155]
    ds_read_b64_tr_b16 a[224:225], v250 offset:0
    ds_read_b64_tr_b16 a[226:227], v250 offset:512
    v_mfma_f32_16x16x32_bf16 v[176:179], a[196:199], v[8:11], v[176:179]
    ds_read_b64_tr_b16 a[228:229], v250 offset:8
    ds_read_b64_tr_b16 a[230:231], v250 offset:520
    v_mfma_f32_16x16x32_bf16 v[56:59], a[196:199], v[12:15], v[56:59]
    ds_read_b128 v[16:19], v241 offset:37376
    ds_read_b128 v[20:23], v241 offset:49664
    s_waitcnt lgkmcnt(10)
    s_add_u32 m0, s71, 2048
    s_mov_b32 s76, 270336
    buffer_load_dwordx4 v248, s[32:35], s76 offen lds
    v_mfma_f32_16x16x32_bf16 v[156:159], a[200:203], v[4:7], v[156:159]
    ds_read_b128 v[24:27], v241 offset:61952
    v_mfma_f32_16x16x32_bf16 v[180:183], a[200:203], v[8:11], v[180:183]
    s_mov_b32 s77, 281600
    buffer_load_dwordx4 v248, s[32:35], s77 offen offset:1024 lds
    v_mfma_f32_16x16x32_bf16 v[60:63], a[200:203], v[12:15], v[60:63]
    s_add_u32 s74, s2, 0
    s_and_b32 s74, s74, 255
    s_add_u32 s74, s74, 0
    v_mfma_f32_16x16x32_bf16 v[160:163], a[204:207], v[4:7], v[160:163]
    s_mul_i32 s74, s74, 12288
    s_or_b32 s74, s74, s62
    s_add_u32 m0, s63, 122880
    v_mfma_f32_16x16x32_bf16 v[184:187], a[204:207], v[8:11], v[184:187]
    buffer_load_dwordx4 v244, s[24:27], s74 offen nt lds
    v_mfma_f32_16x16x32_bf16 v[64:67], a[204:207], v[12:15], v[64:67]
    s_waitcnt lgkmcnt(0)
    buffer_load_dwordx4 v245, s[24:27], s74 offen offset:1024 nt lds
    v_mfma_f32_16x16x32_bf16 v[164:167], a[208:211], v[4:7], v[164:167]
    buffer_load_dwordx4 v246, s[24:27], s74 offen offset:2048 nt lds
    v_mfma_f32_16x16x32_bf16 v[188:191], a[208:211], v[8:11], v[188:191]
    s_add_u32 s75, s2, 43
    s_and_b32 s75, s75, 255
    s_add_u32 s75, s75, 256
    s_mul_i32 s75, s75, 12288
    s_or_b32 s75, s75, s62
    s_add_u32 m0, s63, 135168
    v_mfma_f32_16x16x32_bf16 v[68:71], a[208:211], v[12:15], v[68:71]
    buffer_load_dwordx4 v244, s[24:27], s75 offen nt lds
    v_mfma_f32_16x16x32_bf16 v[168:171], a[212:215], v[4:7], v[168:171]
    buffer_load_dwordx4 v245, s[24:27], s75 offen offset:1024 nt lds
    v_mfma_f32_16x16x32_bf16 v[192:195], a[212:215], v[8:11], v[192:195]
    buffer_load_dwordx4 v246, s[24:27], s75 offen offset:2048 nt lds
    v_mfma_f32_16x16x32_bf16 v[72:75], a[212:215], v[12:15], v[72:75]
    s_waitcnt vmcnt(12)
    ds_read_b64_tr_b16 v[196:197], v251 offset:0
    ds_read_b64_tr_b16 v[198:199], v251 offset:256
    v_mfma_f32_16x16x32_bf16 v[148:151], a[216:219], v[16:19], v[148:151]
    ds_read_b64_tr_b16 v[200:201], v251 offset:8
    ds_read_b64_tr_b16 v[202:203], v251 offset:264
    v_mfma_f32_16x16x32_bf16 v[172:175], a[216:219], v[20:23], v[172:175]
    ds_read_b64_tr_b16 a[240:241], v249 offset:4096
    ds_read_b64_tr_b16 a[242:243], v249 offset:4608
    v_mfma_f32_16x16x32_bf16 v[52:55], a[216:219], v[24:27], v[52:55]
    ds_read_b64_tr_b16 a[244:245], v249 offset:4104
    ds_read_b64_tr_b16 a[246:247], v249 offset:4616
    v_mfma_f32_16x16x32_bf16 v[152:155], a[220:223], v[16:19], v[152:155]
    ds_read_b64_tr_b16 a[248:249], v250 offset:4096
    ds_read_b64_tr_b16 a[250:251], v250 offset:4608
    v_mfma_f32_16x16x32_bf16 v[176:179], a[220:223], v[20:23], v[176:179]
    ds_read_b64_tr_b16 a[252:253], v250 offset:4104
    ds_read_b64_tr_b16 a[254:255], v250 offset:4616
    v_mfma_f32_16x16x32_bf16 v[56:59], a[220:223], v[24:27], v[56:59]
    ds_read_b128 v[28:31], v242 offset:37376
    ds_read_b128 v[32:35], v242 offset:49664
    s_add_u32 s76, s2, 86
    s_and_b32 s76, s76, 255
    v_mfma_f32_16x16x32_bf16 v[156:159], a[224:227], v[16:19], v[156:159]
    ds_read_b128 v[36:39], v242 offset:61952
    s_add_u32 s76, s76, 512
    s_mul_i32 s76, s76, 12288
    v_mfma_f32_16x16x32_bf16 v[180:183], a[224:227], v[20:23], v[180:183]
    s_or_b32 s76, s76, s62
    s_add_u32 m0, s64, 12288
    v_mfma_f32_16x16x32_bf16 v[60:63], a[224:227], v[24:27], v[60:63]
    buffer_load_dwordx4 v244, s[24:27], s76 offen nt lds
    v_mfma_f32_16x16x32_bf16 v[160:163], a[228:231], v[16:19], v[160:163]
    buffer_load_dwordx4 v245, s[24:27], s76 offen offset:1024 nt lds
    v_mfma_f32_16x16x32_bf16 v[184:187], a[228:231], v[20:23], v[184:187]
    buffer_load_dwordx4 v246, s[24:27], s76 offen offset:2048 nt lds
    v_mfma_f32_16x16x32_bf16 v[64:67], a[228:231], v[24:27], v[64:67]
    s_waitcnt lgkmcnt(0)
    s_add_u32 s77, s2, 129
    s_and_b32 s77, s77, 255
    v_mfma_f32_16x16x32_bf16 v[164:167], a[232:235], v[16:19], v[164:167]
    s_add_u32 s77, s77, 768
    s_mul_i32 s77, s77, 12288
    v_mfma_f32_16x16x32_bf16 v[188:191], a[232:235], v[20:23], v[188:191]
    s_or_b32 s77, s77, s62
    s_add_u32 m0, s64, 24576
    v_mfma_f32_16x16x32_bf16 v[68:71], a[232:235], v[24:27], v[68:71]
    buffer_load_dwordx4 v244, s[24:27], s77 offen nt lds
    v_mfma_f32_16x16x32_bf16 v[168:171], a[236:239], v[16:19], v[168:171]
    buffer_load_dwordx4 v245, s[24:27], s77 offen offset:1024 nt lds
    v_mfma_f32_16x16x32_bf16 v[192:195], a[236:239], v[20:23], v[192:195]
    buffer_load_dwordx4 v246, s[24:27], s77 offen offset:2048 nt lds
    v_mfma_f32_16x16x32_bf16 v[72:75], a[236:239], v[24:27], v[72:75]
    s_waitcnt vmcnt(12)
    ds_read_b64_tr_b16 v[220:221], v251 offset:2048
    ds_read_b64_tr_b16 v[222:223], v251 offset:2304
    v_mfma_f32_16x16x32_bf16 v[148:151], a[240:243], v[28:31], v[148:151]
    ds_read_b64_tr_b16 v[224:225], v251 offset:2056
    ds_read_b64_tr_b16 v[226:227], v251 offset:2312
    v_mfma_f32_16x16x32_bf16 v[172:175], a[240:243], v[32:35], v[172:175]
    ds_read_b64_tr_b16 v[204:205], v249 offset:8192
    ds_read_b64_tr_b16 v[206:207], v249 offset:8704
    v_mfma_f32_16x16x32_bf16 v[52:55], a[240:243], v[36:39], v[52:55]
    ds_read_b64_tr_b16 v[208:209], v249 offset:8200
    ds_read_b64_tr_b16 v[210:211], v249 offset:8712
    v_mfma_f32_16x16x32_bf16 v[152:155], a[244:247], v[28:31], v[152:155]
    ds_read_b64_tr_b16 v[212:213], v250 offset:8192
    ds_read_b64_tr_b16 v[214:215], v250 offset:8704
    v_mfma_f32_16x16x32_bf16 v[176:179], a[244:247], v[32:35], v[176:179]
    ds_read_b64_tr_b16 v[216:217], v250 offset:8200
    ds_read_b64_tr_b16 v[218:219], v250 offset:8712
    v_mfma_f32_16x16x32_bf16 v[56:59], a[244:247], v[36:39], v[56:59]
    ds_read_b128 v[40:43], v243 offset:37376
    ds_read_b128 v[44:47], v243 offset:49664
    s_add_u32 s74, s2, 172
    s_and_b32 s74, s74, 255
    v_mfma_f32_16x16x32_bf16 v[156:159], a[248:251], v[28:31], v[156:159]
    ds_read_b128 v[48:51], v243 offset:61952
    s_add_u32 s74, s74, 1024
    s_mul_i32 s74, s74, 12288
    v_mfma_f32_16x16x32_bf16 v[180:183], a[248:251], v[32:35], v[180:183]
    s_or_b32 s74, s74, s62
    s_add_u32 m0, s64, 36864
    v_mfma_f32_16x16x32_bf16 v[60:63], a[248:251], v[36:39], v[60:63]
    buffer_load_dwordx4 v244, s[24:27], s74 offen nt lds
    v_mfma_f32_16x16x32_bf16 v[160:163], a[252:255], v[28:31], v[160:163]
    buffer_load_dwordx4 v245, s[24:27], s74 offen offset:1024 nt lds
    v_mfma_f32_16x16x32_bf16 v[184:187], a[252:255], v[32:35], v[184:187]
    buffer_load_dwordx4 v246, s[24:27], s74 offen offset:2048 nt lds
    v_mfma_f32_16x16x32_bf16 v[64:67], a[252:255], v[36:39], v[64:67]
    s_waitcnt lgkmcnt(0)
    s_add_u32 s75, s2, 215
    s_and_b32 s75, s75, 255
    v_mfma_f32_16x16x32_bf16 v[164:167], v[196:199], v[28:31], v[164:167]
    s_add_u32 s75, s75, 1280
    s_mul_i32 s75, s75, 12288
    v_mfma_f32_16x16x32_bf16 v[188:191], v[196:199], v[32:35], v[188:191]
    s_or_b32 s75, s75, s62
    s_add_u32 m0, s63, 98304
    v_mfma_f32_16x16x32_bf16 v[68:71], v[196:199], v[36:39], v[68:71]
    buffer_load_dwordx4 v244, s[24:27], s75 offen nt lds
    v_mfma_f32_16x16x32_bf16 v[168:171], v[200:203], v[28:31], v[168:171]
    buffer_load_dwordx4 v245, s[24:27], s75 offen offset:1024 nt lds
    v_mfma_f32_16x16x32_bf16 v[192:195], v[200:203], v[32:35], v[192:195]
    buffer_load_dwordx4 v246, s[24:27], s75 offen offset:2048 nt lds
    v_mfma_f32_16x16x32_bf16 v[72:75], v[200:203], v[36:39], v[72:75]
    v_mfma_f32_16x16x32_bf16 v[148:151], v[204:207], v[40:43], v[148:151]
    v_mfma_f32_16x16x32_bf16 v[172:175], v[204:207], v[44:47], v[172:175]
    s_cmp_lg_u32 s61, 2
    s_cbranch_scc1 L_nb
    s_barrier
    ds_read_b128 v[4:7], v228 offset:24576
    ds_read_b128 v[8:11], v228 offset:36864
    ds_read_b128 v[12:15], v240 offset:24576
    ds_read_b128 v[16:19], v229 offset:24576
    ds_read_b128 v[20:23], v229 offset:36864
    ds_read_b128 v[24:27], v241 offset:24576
L_nb:
    v_mfma_f32_16x16x32_bf16 v[52:55], v[204:207], v[48:51], v[52:55]
    v_mfma_f32_16x16x32_bf16 v[152:155], v[208:211], v[40:43], v[152:155]
    v_mfma_f32_16x16x32_bf16 v[176:179], v[208:211], v[44:47], v[176:179]
    v_mfma_f32_16x16x32_bf16 v[56:59], v[208:211], v[48:51], v[56:59]
    v_mfma_f32_16x16x32_bf16 v[156:159], v[212:215], v[40:43], v[156:159]
    v_mfma_f32_16x16x32_bf16 v[180:183], v[212:215], v[44:47], v[180:183]
    v_mfma_f32_16x16x32_bf16 v[60:63], v[212:215], v[48:51], v[60:63]
    v_mfma_f32_16x16x32_bf16 v[160:163], v[216:219], v[40:43], v[160:163]
    v_mfma_f32_16x16x32_bf16 v[184:187], v[216:219], v[44:47], v[184:187]
    v_mfma_f32_16x16x32_bf16 v[64:67], v[216:219], v[48:51], v[64:67]
    v_mfma_f32_16x16x32_bf16 v[164:167], v[220:223], v[40:43], v[164:167]
    v_mfma_f32_16x16x32_bf16 v[188:191], v[220:223], v[44:47], v[188:191]
    v_mfma_f32_16x16x32_bf16 v[68:71], v[220:223], v[48:51], v[68:71]
    v_mfma_f32_16x16x32_bf16 v[168:171], v[224:227], v[40:43], v[168:171]
    v_mfma_f32_16x16x32_bf16 v[192:195], v[224:227], v[44:47], v[192:195]
    v_mfma_f32_16x16x32_bf16 v[72:75], v[224:227], v[48:51], v[72:75]
    s_cmp_eq_u32 s61, 2
    s_cbranch_scc1 L_pass2t
    s_cmp_eq_u32 s61, 0
    s_cbranch_scc1 L_prod
    v_add_u32 v240, 73728, v228
    v_add_u32 v241, 73728, v229
    v_add_u32 v242, 73728, v230
    v_add_u32 v243, 73728, v231
    s_waitcnt vmcnt(9)
L_prod_ret:
    s_barrier
    ds_read_b128 v[4:7], v240 offset:49152
    ds_read_b128 v[8:11], v240 offset:61440
    ds_read_b128 v[12:15], v228 offset:12288
    ds_read_b128 v[16:19], v241 offset:49152
    ds_read_b128 v[20:23], v241 offset:61440
    ds_read_b128 v[24:27], v229 offset:12288
    s_waitcnt lgkmcnt(0)
    v_mfma_f32_16x16x32_bf16 v[148:151], a[0:3], v[4:7], 0
    v_mfma_f32_16x16x32_bf16 v[148:151], a[24:27], v[16:19], v[148:151]
    v_mfma_f32_16x16x32_bf16 v[172:175], a[0:3], v[8:11], 0
    ds_read_b128 v[28:31], v242 offset:49152
    v_mfma_f32_16x16x32_bf16 v[172:175], a[24:27], v[20:23], v[172:175]
    v_mfma_f32_16x16x32_bf16 v[52:55], a[0:3], v[12:15], 0
    v_mfma_f32_16x16x32_bf16 v[52:55], a[24:27], v[24:27], v[52:55]
    v_mfma_f32_16x16x32_bf16 v[152:155], a[4:7], v[4:7], 0
    ds_read_b128 v[32:35], v242 offset:61440
    s_add_u32 s76, s84, 0
    s_add_u32 m0, s49, 49152
    v_mfma_f32_16x16x32_bf16 v[152:155], a[28:31], v[16:19], v[152:155]
    buffer_load_dwordx4 v232, s[20:23], s76 offen nt lds
    v_mfma_f32_16x16x32_bf16 v[176:179], a[4:7], v[8:11], 0
    v_mfma_f32_16x16x32_bf16 v[176:179], a[28:31], v[20:23], v[176:179]
    v_mfma_f32_16x16x32_bf16 v[56:59], a[4:7], v[12:15], 0
    ds_read_b128 v[36:39], v230 offset:12288
    buffer_load_dwordx4 v233, s[20:23], s76 offen offset:1024 nt lds
    v_mfma_f32_16x16x32_bf16 v[56:59], a[28:31], v[24:27], v[56:59]
    v_mfma_f32_16x16x32_bf16 v[156:159], a[8:11], v[4:7], 0
    v_mfma_f32_16x16x32_bf16 v[156:159], a[32:35], v[16:19], v[156:159]
    buffer_load_dwordx4 v234, s[20:23], s76 offen offset:2048 nt lds
    v_mfma_f32_16x16x32_bf16 v[180:183], a[8:11], v[8:11], 0
    ds_read_b128 v[40:43], v243 offset:49152
    v_mfma_f32_16x16x32_bf16 v[180:183], a[32:35], v[20:23], v[180:183]
    v_mfma_f32_16x16x32_bf16 v[60:63], a[8:11], v[12:15], 0
    v_mfma_f32_16x16x32_bf16 v[60:63], a[32:35], v[24:27], v[60:63]
    v_mfma_f32_16x16x32_bf16 v[160:163], a[12:15], v[4:7], 0
    ds_read_b128 v[44:47], v243 offset:61440
    v_mfma_f32_16x16x32_bf16 v[160:163], a[36:39], v[16:19], v[160:163]
    v_mfma_f32_16x16x32_bf16 v[184:187], a[12:15], v[8:11], 0
    v_mfma_f32_16x16x32_bf16 v[184:187], a[36:39], v[20:23], v[184:187]
    v_mfma_f32_16x16x32_bf16 v[64:67], a[12:15], v[12:15], 0
    ds_read_b128 v[48:51], v231 offset:12288
    v_mfma_f32_16x16x32_bf16 v[64:67], a[36:39], v[24:27], v[64:67]
    v_mfma_f32_16x16x32_bf16 v[164:167], a[16:19], v[4:7], 0
    v_mfma_f32_16x16x32_bf16 v[164:167], a[40:43], v[16:19], v[164:167]
    v_mfma_f32_16x16x32_bf16 v[188:191], a[16:19], v[8:11], 0
    v_mfma_f32_16x16x32_bf16 v[188:191], a[40:43], v[20:23], v[188:191]
    v_mfma_f32_16x16x32_bf16 v[68:71], a[16:19], v[12:15], 0
    v_mfma_f32_16x16x32_bf16 v[68:71], a[40:43], v[24:27], v[68:71]
    v_mfma_f32_16x16x32_bf16 v[168:171], a[20:23], v[4:7], 0
    s_add_u32 s77, s84, 768
    s_add_u32 m0, s49, 61440
    v_mfma_f32_16x16x32_bf16 v[168:171], a[44:47], v[16:19], v[168:171]
    buffer_load_dwordx4 v232, s[20:23], s77 offen nt lds
    v_mfma_f32_16x16x32_bf16 v[192:195], a[20:23], v[8:11], 0
    v_mfma_f32_16x16x32_bf16 v[192:195], a[44:47], v[20:23], v[192:195]
    v_mfma_f32_16x16x32_bf16 v[72:75], a[20:23], v[12:15], 0
    buffer_load_dwordx4 v233, s[20:23], s77 offen offset:1024 nt lds
    v_mfma_f32_16x16x32_bf16 v[72:75], a[44:47], v[24:27], v[72:75]
    s_waitcnt lgkmcnt(0)
    v_mfma_f32_16x16x32_bf16 v[148:151], a[48:51], v[28:31], v[148:151]
    v_mfma_f32_16x16x32_bf16 v[148:151], a[72:75], v[40:43], v[148:151]
    buffer_load_dwordx4 v234, s[20:23], s77 offen offset:2048 nt lds
    v_mfma_f32_16x16x32_bf16 v[172:175], a[48:51], v[32:35], v[172:175]
    ds_read_b128 v[4:7], v240 offset:49408
    v_mfma_f32_16x16x32_bf16 v[172:175], a[72:75], v[44:47], v[172:175]
    v_mfma_f32_16x16x32_bf16 v[52:55], a[48:51], v[36:39], v[52:55]
    v_mfma_f32_16x16x32_bf16 v[52:55], a[72:75], v[48:51], v[52:55]
    v_mfma_f32_16x16x32_bf16 v[152:155], a[52:55], v[28:31], v[152:155]
    ds_read_b128 v[8:11], v240 offset:61696
    v_mfma_f32_16x16x32_bf16 v[152:155], a[76:79], v[40:43], v[152:155]
    v_mfma_f32_16x16x32_bf16 v[176:179], a[52:55], v[32:35], v[176:179]
    v_mfma_f32_16x16x32_bf16 v[176:179], a[76:79], v[44:47], v[176:179]
    v_mfma_f32_16x16x32_bf16 v[56:59], a[52:55], v[36:39], v[56:59]
    ds_read_b128 v[12:15], v228 offset:12544
    v_mfma_f32_16x16x32_bf16 v[56:59], a[76:79], v[48:51], v[56:59]
    s_cmp_lg_u32 s61, 0
    s_cbranch_scc1 L_pub_done
    s_waitcnt vmcnt(6)
    s_barrier
    s_cmp_lg_u32 s48, 0
    s_cbranch_scc1 L_pub_done
    v_mov_b32 v254, 1
    v_lshlrev_b32 v255, 6, v0
    s_mov_b64 exec, 15
    buffer_atomic_add v254, v255, s[44:47], 0 offen sc1
    s_mov_b64 exec, -1
L_pub_done:
    v_mfma_f32_16x16x32_bf16 v[156:159], a[56:59], v[28:31], v[156:159]
    v_mfma_f32_16x16x32_bf16 v[156:159], a[80:83], v[40:43], v[156:159]
    v_mfma_f32_16x16x32_bf16 v[180:183], a[56:59], v[32:35], v[180:183]
    ds_read_b128 v[16:19], v241 offset:49408
    v_mfma_f32_16x16x32_bf16 v[180:183], a[80:83], v[44:47], v[180:183]
    v_mfma_f32_16x16x32_bf16 v[60:63], a[56:59], v[36:39], v[60:63]
    v_mfma_f32_16x16x32_bf16 v[60:63], a[80:83], v[48:51], v[60:63]
    v_mfma_f32_16x16x32_bf16 v[160:163], a[60:63], v[28:31], v[160:163]
    ds_read_b128 v[20:23], v241 offset:61696
    v_mfma_f32_16x16x32_bf16 v[160:163], a[84:87], v[40:43], v[160:163]
    v_mfma_f32_16x16x32_bf16 v[184:187], a[60:63], v[32:35], v[184:187]
    v_mfma_f32_16x16x32_bf16 v[184:187], a[84:87], v[44:47], v[184:187]
    v_mfma_f32_16x16x32_bf16 v[64:67], a[60:63], v[36:39], v[64:67]
    ds_read_b128 v[24:27], v229 offset:12544
    v_mfma_f32_16x16x32_bf16 v[64:67], a[84:87], v[48:51], v[64:67]
    v_mfma_f32_16x16x32_bf16 v[164:167], a[64:67], v[28:31], v[164:167]
    v_mfma_f32_16x16x32_bf16 v[164:167], a[88:91], v[40:43], v[164:167]
    v_mfma_f32_16x16x32_bf16 v[188:191], a[64:67], v[32:35], v[188:191]
    v_mfma_f32_16x16x32_bf16 v[188:191], a[88:91], v[44:47], v[188:191]
    v_mfma_f32_16x16x32_bf16 v[68:71], a[64:67], v[36:39], v[68:71]
    v_mfma_f32_16x16x32_bf16 v[68:71], a[88:91], v[48:51], v[68:71]
    v_mfma_f32_16x16x32_bf16 v[168:171], a[68:71], v[28:31], v[168:171]
    v_mfma_f32_16x16x32_bf16 v[168:171], a[92:95], v[40:43], v[168:171]
    v_mfma_f32_16x16x32_bf16 v[192:195], a[68:71], v[32:35], v[192:195]
    v_mfma_f32_16x16x32_bf16 v[192:195], a[92:95], v[44:47], v[192:195]
    v_mfma_f32_16x16x32_bf16 v[72:75], a[68:71], v[36:39], v[72:75]
    v_mfma_f32_16x16x32_bf16 v[72:75], a[92:95], v[48:51], v[72:75]
    s_waitcnt lgkmcnt(0)
    v_mfma_f32_16x16x32_bf16 v[148:151], a[96:99], v[4:7], v[148:151]
    v_mfma_f32_16x16x32_bf16 v[148:151], a[120:123], v[16:19], v[148:151]
    v_mfma_f32_16x16x32_bf16 v[172:175], a[96:99], v[8:11], v[172:175]
    ds_read_b128 v[28:31], v242 offset:49408
    v_mfma_f32_16x16x32_bf16 v[172:175], a[120:123], v[20:23], v[172:175]
    v_mfma_f32_16x16x32_bf16 v[52:55], a[96:99], v[12:15], v[52:55]
    v_mfma_f32_16x16x32_bf16 v[52:55], a[120:123], v[24:27], v[52:55]
    v_mfma_f32_16x16x32_bf16 v[152:155], a[100:103], v[4:7], v[152:155]
    ds_read_b128 v[32:35], v242 offset:61696
    v_mfma_f32_16x16x32_bf16 v[152:155], a[124:127], v[16:19], v[152:155]
    v_mfma_f32_16x16x32_bf16 v[176:179], a[100:103], v[8:11], v[176:179]
    v_mfma_f32_16x16x32_bf16 v[176:179], a[124:127], v[20:23], v[176:179]
    v_mfma_f32_16x16x32_bf16 v[56:59], a[100:103], v[12:15], v[56:59]
    ds_read_b128 v[36:39], v230 offset:12544
    v_mfma_f32_16x16x32_bf16 v[56:59], a[124:127], v[24:27], v[56:59]
    v_mfma_f32_16x16x32_bf16 v[156:159], a[104:107], v[4:7], v[156:159]
    v_mfma_f32_16x16x32_bf16 v[156:159], a[128:131], v[16:19], v[156:159]
    v_mfma_f32_16x16x32_bf16 v[180:183], a[104:107], v[8:11], v[180:183]
    ds_read_b128 v[40:43], v243 offset:49408
    v_mfma_f32_16x16x32_bf16 v[180:183], a[128:131], v[20:23], v[180:183]
    v_mfma_f32_16x16x32_bf16 v[60:63], a[104:107], v[12:15], v[60:63]
    v_mfma_f32_16x16x32_bf16 v[60:63], a[128:131], v[24:27], v[60:63]
    v_mfma_f32_16x16x32_bf16 v[160:163], a[108:111], v[4:7], v[160:163]
    ds_read_b128 v[44:47], v243 offset:61696
    v_mfma_f32_16x16x32_bf16 v[160:163], a[132:135], v[16:19], v[160:163]
    v_mfma_f32_16x16x32_bf16 v[184:187], a[108:111], v[8:11], v[184:187]
    v_mfma_f32_16x16x32_bf16 v[184:187], a[132:135], v[20:23], v[184:187]
    v_mfma_f32_16x16x32_bf16 v[64:67], a[108:111], v[12:15], v[64:67]
    ds_read_b128 v[48:51], v231 offset:12544
    v_mfma_f32_16x16x32_bf16 v[64:67], a[132:135], v[24:27], v[64:67]
    v_mfma_f32_16x16x32_bf16 v[164:167], a[112:115], v[4:7], v[164:167]
    v_mfma_f32_16x16x32_bf16 v[164:167], a[136:139], v[16:19], v[164:167]
    v_mfma_f32_16x16x32_bf16 v[188:191], a[112:115], v[8:11], v[188:191]
    v_mfma_f32_16x16x32_bf16 v[188:191], a[136:139], v[20:23], v[188:191]
    v_mfma_f32_16x16x32_bf16 v[68:71], a[112:115], v[12:15], v[68:71]
    v_mfma_f32_16x16x32_bf16 v[68:71], a[136:139], v[24:27], v[68:71]
    v_mfma_f32_16x16x32_bf16 v[168:171], a[116:119], v[4:7], v[168:171]
    v_mfma_f32_16x16x32_bf16 v[168:171], a[140:143], v[16:19], v[168:171]
    v_mfma_f32_16x16x32_bf16 v[192:195], a[116:119], v[8:11], v[192:195]
    v_mfma_f32_16x16x32_bf16 v[192:195], a[140:143], v[20:23], v[192:195]
    v_mfma_f32_16x16x32_bf16 v[72:75], a[116:119], v[12:15], v[72:75]
    v_mfma_f32_16x16x32_bf16 v[72:75], a[140:143], v[24:27], v[72:75]
    s_waitcnt lgkmcnt(0)
    v_mfma_f32_16x16x32_bf16 v[148:151], a[144:147], v[28:31], v[148:151]
    v_mfma_f32_16x16x32_bf16 v[148:151], a[168:171], v[40:43], v[148:151]
    v_mfma_f32_16x16x32_bf16 v[172:175], a[144:147], v[32:35], v[172:175]
    ds_read_b128 v[4:7], v240 offset:49664
    v_mfma_f32_16x16x32_bf16 v[172:175], a[168:171], v[44:47], v[172:175]
    v_mfma_f32_16x16x32_bf16 v[52:55], a[144:147], v[36:39], v[52:55]
    v_mfma_f32_16x16x32_bf16 v[52:55], a[168:171], v[48:51], v[52:55]
    v_mfma_f32_16x16x32_bf16 v[152:155], a[148:151], v[28:31], v[152:155]
    ds_read_b128 v[8:11], v240 offset:61952
    v_mfma_f32_16x16x32_bf16 v[152:155], a[172:175], v[40:43], v[152:155]
    v_mfma_f32_16x16x32_bf16 v[176:179], a[148:151], v[32:35], v[176:179]
    v_mfma_f32_16x16x32_bf16 v[176:179], a[172:175], v[44:47], v[176:179]
    v_mfma_f32_16x16x32_bf16 v[56:59], a[148:151], v[36:39], v[56:59]
    ds_read_b128 v[12:15], v228 offset:12800
    v_mfma_f32_16x16x32_bf16 v[56:59], a[172:175], v[48:51], v[56:59]
    v_mfma_f32_16x16x32_bf16 v[156:159], a[152:155], v[28:31], v[156:159]
    v_mfma_f32_16x16x32_bf16 v[156:159], a[176:179], v[40:43], v[156:159]
    v_mfma_f32_16x16x32_bf16 v[180:183], a[152:155], v[32:35], v[180:183]
    ds_read_b128 v[16:19], v241 offset:49664
    v_mfma_f32_16x16x32_bf16 v[180:183], a[176:179], v[44:47], v[180:183]
    v_mfma_f32_16x16x32_bf16 v[60:63], a[152:155], v[36:39], v[60:63]
    v_mfma_f32_16x16x32_bf16 v[60:63], a[176:179], v[48:51], v[60:63]
    v_mfma_f32_16x16x32_bf16 v[160:163], a[156:159], v[28:31], v[160:163]
    ds_read_b128 v[20:23], v241 offset:61952
    v_mfma_f32_16x16x32_bf16 v[160:163], a[180:183], v[40:43], v[160:163]
    v_mfma_f32_16x16x32_bf16 v[184:187], a[156:159], v[32:35], v[184:187]
    v_mfma_f32_16x16x32_bf16 v[184:187], a[180:183], v[44:47], v[184:187]
    v_mfma_f32_16x16x32_bf16 v[64:67], a[156:159], v[36:39], v[64:67]
    ds_read_b128 v[24:27], v229 offset:12800
    v_mfma_f32_16x16x32_bf16 v[64:67], a[180:183], v[48:51], v[64:67]
    v_mfma_f32_16x16x32_bf16 v[164:167], a[160:163], v[28:31], v[164:167]
    v_mfma_f32_16x16x32_bf16 v[164:167], a[184:187], v[40:43], v[164:167]
    v_mfma_f32_16x16x32_bf16 v[188:191], a[160:163], v[32:35], v[188:191]
    v_mfma_f32_16x16x32_bf16 v[188:191], a[184:187], v[44:47], v[188:191]
    v_mfma_f32_16x16x32_bf16 v[68:71], a[160:163], v[36:39], v[68:71]
    v_mfma_f32_16x16x32_bf16 v[68:71], a[184:187], v[48:51], v[68:71]
    v_mfma_f32_16x16x32_bf16 v[168:171], a[164:167], v[28:31], v[168:171]
    v_mfma_f32_16x16x32_bf16 v[168:171], a[188:191], v[40:43], v[168:171]
    v_mfma_f32_16x16x32_bf16 v[192:195], a[164:167], v[32:35], v[192:195]
    v_mfma_f32_16x16x32_bf16 v[192:195], a[188:191], v[44:47], v[192:195]
    v_mfma_f32_16x16x32_bf16 v[72:75], a[164:167], v[36:39], v[72:75]
    v_mfma_f32_16x16x32_bf16 v[72:75], a[188:191], v[48:51], v[72:75]
    s_waitcnt lgkmcnt(0)
    v_mfma_f32_16x16x32_bf16 v[148:151], a[192:195], v[4:7], v[148:151]
    v_mfma_f32_16x16x32_bf16 v[148:151], a[216:219], v[16:19], v[148:151]
    v_mfma_f32_16x16x32_bf16 v[172:175], a[192:195], v[8:11], v[172:175]
    ds_read_b128 v[28:31], v242 offset:49664
    v_mfma_f32_16x16x32_bf16 v[172:175], a[216:219], v[20:23], v[172:175]
    v_mfma_f32_16x16x32_bf16 v[52:55], a[192:195], v[12:15], v[52:55]
    v_mfma_f32_16x16x32_bf16 v[52:55], a[216:219], v[24:27], v[52:55]
    v_mfma_f32_16x16x32_bf16 v[152:155], a[196:199], v[4:7], v[152:155]
    ds_read_b128 v[32:35], v242 offset:61952
    v_mfma_f32_16x16x32_bf16 v[152:155], a[220:223], v[16:19], v[152:155]
    v_mfma_f32_16x16x32_bf16 v[176:179], a[196:199], v[8:11], v[176:179]
    v_mfma_f32_16x16x32_bf16 v[176:179], a[220:223], v[20:23], v[176:179]
    v_mfma_f32_16x16x32_bf16 v[56:59], a[196:199], v[12:15], v[56:59]
    ds_read_b128 v[36:39], v230 offset:12800
    v_mfma_f32_16x16x32_bf16 v[56:59], a[220:223], v[24:27], v[56:59]
    v_mfma_f32_16x16x32_bf16 v[156:159], a[200:203], v[4:7], v[156:159]
    v_mfma_f32_16x16x32_bf16 v[156:159], a[224:227], v[16:19], v[156:159]
    v_mfma_f32_16x16x32_bf16 v[180:183], a[200:203], v[8:11], v[180:183]
    ds_read_b128 v[40:43], v243 offset:49664
    v_mfma_f32_16x16x32_bf16 v[180:183], a[224:227], v[20:23], v[180:183]
    v_mfma_f32_16x16x32_bf16 v[60:63], a[200:203], v[12:15], v[60:63]
    v_mfma_f32_16x16x32_bf16 v[60:63], a[224:227], v[24:27], v[60:63]
    v_mfma_f32_16x16x32_bf16 v[160:163], a[204:207], v[4:7], v[160:163]
    ds_read_b128 v[44:47], v243 offset:61952
    v_mfma_f32_16x16x32_bf16 v[160:163], a[228:231], v[16:19], v[160:163]
    v_mfma_f32_16x16x32_bf16 v[184:187], a[204:207], v[8:11], v[184:187]
    v_mfma_f32_16x16x32_bf16 v[184:187], a[228:231], v[20:23], v[184:187]
    v_mfma_f32_16x16x32_bf16 v[64:67], a[204:207], v[12:15], v[64:67]
    ds_read_b128 v[48:51], v231 offset:12800
    v_mfma_f32_16x16x32_bf16 v[64:67], a[228:231], v[24:27], v[64:67]
    v_mfma_f32_16x16x32_bf16 v[164:167], a[208:211], v[4:7], v[164:167]
    v_mfma_f32_16x16x32_bf16 v[164:167], a[232:235], v[16:19], v[164:167]
    v_mfma_f32_16x16x32_bf16 v[188:191], a[208:211], v[8:11], v[188:191]
    v_mfma_f32_16x16x32_bf16 v[188:191], a[232:235], v[20:23], v[188:191]
    v_mfma_f32_16x16x32_bf16 v[68:71], a[208:211], v[12:15], v[68:71]
    v_mfma_f32_16x16x32_bf16 v[68:71], a[232:235], v[24:27], v[68:71]
    v_mfma_f32_16x16x32_bf16 v[168:171], a[212:215], v[4:7], v[168:171]
    v_mfma_f32_16x16x32_bf16 v[168:171], a[236:239], v[16:19], v[168:171]
    v_mfma_f32_16x16x32_bf16 v[192:195], a[212:215], v[8:11], v[192:195]
    v_mfma_f32_16x16x32_bf16 v[192:195], a[236:239], v[20:23], v[192:195]
    v_mfma_f32_16x16x32_bf16 v[72:75], a[212:215], v[12:15], v[72:75]
    v_mfma_f32_16x16x32_bf16 v[72:75], a[236:239], v[24:27], v[72:75]
    s_waitcnt vmcnt(6) lgkmcnt(0)
    s_barrier
    v_mfma_f32_16x16x32_bf16 v[148:151], a[240:243], v[28:31], v[148:151]
    v_mfma_f32_16x16x32_bf16 v[148:151], v[204:207], v[40:43], v[148:151]
    v_mfma_f32_16x16x32_bf16 v[172:175], a[240:243], v[32:35], v[172:175]
    ds_read_b128 v[4:7], v228 offset:24576
    v_mfma_f32_16x16x32_bf16 v[172:175], v[204:207], v[44:47], v[172:175]
    v_mfma_f32_16x16x32_bf16 v[52:55], a[240:243], v[36:39], v[52:55]
    v_mfma_f32_16x16x32_bf16 v[52:55], v[204:207], v[48:51], v[52:55]
    v_mfma_f32_16x16x32_bf16 v[152:155], a[244:247], v[28:31], v[152:155]
    ds_read_b128 v[8:11], v228 offset:36864
    v_mfma_f32_16x16x32_bf16 v[152:155], v[208:211], v[40:43], v[152:155]
    v_mfma_f32_16x16x32_bf16 v[176:179], a[244:247], v[32:35], v[176:179]
    v_mfma_f32_16x16x32_bf16 v[176:179], v[208:211], v[44:47], v[176:179]
    v_mfma_f32_16x16x32_bf16 v[56:59], a[244:247], v[36:39], v[56:59]
    ds_read_b128 v[12:15], v240 offset:24576
    v_mfma_f32_16x16x32_bf16 v[56:59], v[208:211], v[48:51], v[56:59]
    v_mfma_f32_16x16x32_bf16 v[156:159], a[248:251], v[28:31], v[156:159]
    v_mfma_f32_16x16x32_bf16 v[156:159], v[212:215], v[40:43], v[156:159]
    v_mfma_f32_16x16x32_bf16 v[180:183], a[248:251], v[32:35], v[180:183]
    ds_read_b128 v[16:19], v229 offset:24576
    v_mfma_f32_16x16x32_bf16 v[180:183], v[212:215], v[44:47], v[180:183]
    v_mfma_f32_16x16x32_bf16 v[60:63], a[248:251], v[36:39], v[60:63]
    v_mfma_f32_16x16x32_bf16 v[60:63], v[212:215], v[48:51], v[60:63]
    v_mfma_f32_16x16x32_bf16 v[160:163], a[252:255], v[28:31], v[160:163]
    ds_read_b128 v[20:23], v229 offset:36864
    v_mfma_f32_16x16x32_bf16 v[160:163], v[216:219], v[40:43], v[160:163]
    v_mfma_f32_16x16x32_bf16 v[184:187], a[252:255], v[32:35], v[184:187]
    v_mfma_f32_16x16x32_bf16 v[184:187], v[216:219], v[44:47], v[184:187]
    v_mfma_f32_16x16x32_bf16 v[64:67], a[252:255], v[36:39], v[64:67]
    ds_read_b128 v[24:27], v241 offset:24576
    v_mfma_f32_16x16x32_bf16 v[64:67], v[216:219], v[48:51], v[64:67]
    v_mfma_f32_16x16x32_bf16 v[164:167], v[196:199], v[28:31], v[164:167]
    v_mfma_f32_16x16x32_bf16 v[164:167], v[220:223], v[40:43], v[164:167]
    v_mfma_f32_16x16x32_bf16 v[188:191], v[196:199], v[32:35], v[188:191]
    v_mfma_f32_16x16x32_bf16 v[188:191], v[220:223], v[44:47], v[188:191]
    v_mfma_f32_16x16x32_bf16 v[68:71], v[196:199], v[36:39], v[68:71]
    v_mfma_f32_16x16x32_bf16 v[68:71], v[220:223], v[48:51], v[68:71]
    v_mfma_f32_16x16x32_bf16 v[168:171], v[200:203], v[28:31], v[168:171]
    v_mfma_f32_16x16x32_bf16 v[168:171], v[224:227], v[40:43], v[168:171]
    v_mfma_f32_16x16x32_bf16 v[192:195], v[200:203], v[32:35], v[192:195]
    v_mfma_f32_16x16x32_bf16 v[192:195], v[224:227], v[44:47], v[192:195]
    v_mfma_f32_16x16x32_bf16 v[72:75], v[200:203], v[36:39], v[72:75]
    v_mfma_f32_16x16x32_bf16 v[72:75], v[224:227], v[48:51], v[72:75]
    s_waitcnt lgkmcnt(0)
    v_cvt_pk_bf16_f32 v76, v148, v149
    v_cvt_pk_bf16_f32 v77, v150, v151
    v_mfma_f32_16x16x32_bf16 v[148:151], a[0:3], v[4:7], 0
    s_add_u32 s74, s2, 258
    s_and_b32 s74, s74, 255
    v_mfma_f32_16x16x32_bf16 v[148:151], a[24:27], v[16:19], v[148:151]
    v_cvt_pk_bf16_f32 v88, v172, v173
    v_cvt_pk_bf16_f32 v89, v174, v175
    s_add_u32 s74, s74, 1536
    s_mul_i32 s74, s74, 12288
    v_mfma_f32_16x16x32_bf16 v[172:175], a[0:3], v[8:11], 0
    ds_read_b128 v[28:31], v230 offset:24576
    s_add_u32 m0, s49, 110592
    v_mfma_f32_16x16x32_bf16 v[172:175], a[24:27], v[20:23], v[172:175]
    v_cvt_pk_bf16_f32 v100, v52, v53
    v_cvt_pk_bf16_f32 v101, v54, v55
    buffer_load_dwordx4 v244, s[24:27], s74 offen nt lds
    v_mfma_f32_16x16x32_bf16 v[52:55], a[0:3], v[12:15], 0
    v_mfma_f32_16x16x32_bf16 v[52:55], a[24:27], v[24:27], v[52:55]
    v_cvt_pk_bf16_f32 v78, v152, v153
    v_cvt_pk_bf16_f32 v79, v154, v155
    v_mfma_f32_16x16x32_bf16 v[152:155], a[4:7], v[4:7], 0
    ds_read_b128 v[32:35], v230 offset:36864
    buffer_load_dwordx4 v245, s[24:27], s74 offen offset:1024 nt lds
    v_mfma_f32_16x16x32_bf16 v[152:155], a[28:31], v[16:19], v[152:155]
    v_cvt_pk_bf16_f32 v90, v176, v177
    v_cvt_pk_bf16_f32 v91, v178, v179
    v_mfma_f32_16x16x32_bf16 v[176:179], a[4:7], v[8:11], 0
    v_mfma_f32_16x16x32_bf16 v[176:179], a[28:31], v[20:23], v[176:179]
    v_cvt_pk_bf16_f32 v102, v56, v57
    v_cvt_pk_bf16_f32 v103, v58, v59
    buffer_load_dwordx4 v246, s[24:27], s74 offen offset:2048 nt lds
    v_mfma_f32_16x16x32_bf16 v[56:59], a[4:7], v[12:15], 0
    ds_read_b128 v[36:39], v242 offset:24576
    v_mfma_f32_16x16x32_bf16 v[56:59], a[28:31], v[24:27], v[56:59]
    v_cvt_pk_bf16_f32 v80, v156, v157
    v_cvt_pk_bf16_f32 v81, v158, v159
    v_mfma_f32_16x16x32_bf16 v[156:159], a[8:11], v[4:7], 0
    v_mfma_f32_16x16x32_bf16 v[156:159], a[32:35], v[16:19], v[156:159]
    v_cvt_pk_bf16_f32 v92, v180, v181
    v_cvt_pk_bf16_f32 v93, v182, v183
    v_mfma_f32_16x16x32_bf16 v[180:183], a[8:11], v[8:11], 0
    ds_read_b128 v[40:43], v231 offset:24576
    v_mfma_f32_16x16x32_bf16 v[180:183], a[32:35], v[20:23], v[180:183]
    v_cvt_pk_bf16_f32 v104, v60, v61
    v_cvt_pk_bf16_f32 v105, v62, v63
    v_mfma_f32_16x16x32_bf16 v[60:63], a[8:11], v[12:15], 0
    v_mfma_f32_16x16x32_bf16 v[60:63], a[32:35], v[24:27], v[60:63]
    v_cvt_pk_bf16_f32 v82, v160, v161
    v_cvt_pk_bf16_f32 v83, v162, v163
    v_mfma_f32_16x16x32_bf16 v[160:163], a[12:15], v[4:7], 0
    ds_read_b128 v[44:47], v231 offset:36864
    v_mfma_f32_16x16x32_bf16 v[160:163], a[36:39], v[16:19], v[160:163]
    v_cvt_pk_bf16_f32 v94, v184, v185
    v_cvt_pk_bf16_f32 v95, v186, v187
    v_mfma_f32_16x16x32_bf16 v[184:187], a[12:15], v[8:11], 0
    v_mfma_f32_16x16x32_bf16 v[184:187], a[36:39], v[20:23], v[184:187]
    v_cvt_pk_bf16_f32 v106, v64, v65
    v_cvt_pk_bf16_f32 v107, v66, v67
    v_mfma_f32_16x16x32_bf16 v[64:67], a[12:15], v[12:15], 0
    ds_read_b128 v[48:51], v243 offset:24576
    v_mfma_f32_16x16x32_bf16 v[64:67], a[36:39], v[24:27], v[64:67]
    v_cvt_pk_bf16_f32 v84, v164, v165
    v_cvt_pk_bf16_f32 v85, v166, v167
    v_mfma_f32_16x16x32_bf16 v[164:167], a[16:19], v[4:7], 0
    s_add_u32 s75, s2, 301
    s_and_b32 s75, s75, 255
    v_mfma_f32_16x16x32_bf16 v[164:167], a[40:43], v[16:19], v[164:167]
    v_cvt_pk_bf16_f32 v96, v188, v189
    v_cvt_pk_bf16_f32 v97, v190, v191
    s_add_u32 s75, s75, 1792
    s_mul_i32 s75, s75, 12288
    v_mfma_f32_16x16x32_bf16 v[188:191], a[16:19], v[8:11], 0
    s_add_u32 m0, s49, 122880
    v_mfma_f32_16x16x32_bf16 v[188:191], a[40:43], v[20:23], v[188:191]
    v_cvt_pk_bf16_f32 v108, v68, v69
    v_cvt_pk_bf16_f32 v109, v70, v71
    buffer_load_dwordx4 v244, s[24:27], s75 offen nt lds
    v_mfma_f32_16x16x32_bf16 v[68:71], a[16:19], v[12:15], 0
    v_mfma_f32_16x16x32_bf16 v[68:71], a[40:43], v[24:27], v[68:71]
    v_cvt_pk_bf16_f32 v86, v168, v169
    v_cvt_pk_bf16_f32 v87, v170, v171
    v_mfma_f32_16x16x32_bf16 v[168:171], a[20:23], v[4:7], 0
    buffer_load_dwordx4 v245, s[24:27], s75 offen offset:1024 nt lds
    v_mfma_f32_16x16x32_bf16 v[168:171], a[44:47], v[16:19], v[168:171]
    v_cvt_pk_bf16_f32 v98, v192, v193
    v_cvt_pk_bf16_f32 v99, v194, v195
    v_mfma_f32_16x16x32_bf16 v[192:195], a[20:23], v[8:11], 0
    v_mfma_f32_16x16x32_bf16 v[192:195], a[44:47], v[20:23], v[192:195]
    v_cvt_pk_bf16_f32 v110, v72, v73
    v_cvt_pk_bf16_f32 v111, v74, v75
    buffer_load_dwordx4 v246, s[24:27], s75 offen offset:2048 nt lds
    v_mfma_f32_16x16x32_bf16 v[72:75], a[20:23], v[12:15], 0
    v_mfma_f32_16x16x32_bf16 v[72:75], a[44:47], v[24:27], v[72:75]
    s_waitcnt lgkmcnt(0)
    v_mfma_f32_16x16x32_bf16 v[148:151], a[48:51], v[28:31], v[148:151]
    v_mfma_f32_16x16x32_bf16 v[148:151], a[72:75], v[40:43], v[148:151]
    v_mfma_f32_16x16x32_bf16 v[172:175], a[48:51], v[32:35], v[172:175]
    ds_read_b128 v[4:7], v228 offset:24832
    v_mfma_f32_16x16x32_bf16 v[172:175], a[72:75], v[44:47], v[172:175]
    v_mfma_f32_16x16x32_bf16 v[52:55], a[48:51], v[36:39], v[52:55]
    v_mfma_f32_16x16x32_bf16 v[52:55], a[72:75], v[48:51], v[52:55]
    v_mfma_f32_16x16x32_bf16 v[152:155], a[52:55], v[28:31], v[152:155]
    ds_read_b128 v[8:11], v228 offset:37120
    v_mfma_f32_16x16x32_bf16 v[152:155], a[76:79], v[40:43], v[152:155]
    v_mfma_f32_16x16x32_bf16 v[176:179], a[52:55], v[32:35], v[176:179]
    v_mfma_f32_16x16x32_bf16 v[176:179], a[76:79], v[44:47], v[176:179]
    v_mfma_f32_16x16x32_bf16 v[56:59], a[52:55], v[36:39], v[56:59]
    ds_read_b128 v[12:15], v240 offset:24832
    v_mfma_f32_16x16x32_bf16 v[56:59], a[76:79], v[48:51], v[56:59]
    v_mfma_f32_16x16x32_bf16 v[156:159], a[56:59], v[28:31], v[156:159]
    s_add_u32 s76, s2, 344
    s_and_b32 s76, s76, 255
    v_mfma_f32_16x16x32_bf16 v[156:159], a[80:83], v[40:43], v[156:159]
    s_add_u32 s76, s76, 2048
    s_mul_i32 s76, s76, 12288
    v_mfma_f32_16x16x32_bf16 v[180:183], a[56:59], v[32:35], v[180:183]
    ds_read_b128 v[16:19], v229 offset:24832
    s_add_u32 m0, s49, 135168
    v_mfma_f32_16x16x32_bf16 v[180:183], a[80:83], v[44:47], v[180:183]
    buffer_load_dwordx4 v244, s[24:27], s76 offen nt lds
    v_mfma_f32_16x16x32_bf16 v[60:63], a[56:59], v[36:39], v[60:63]
    v_mfma_f32_16x16x32_bf16 v[60:63], a[80:83], v[48:51], v[60:63]
    v_mfma_f32_16x16x32_bf16 v[160:163], a[60:63], v[28:31], v[160:163]
    ds_read_b128 v[20:23], v229 offset:37120
    buffer_load_dwordx4 v245, s[24:27], s76 offen offset:1024 nt lds
    v_mfma_f32_16x16x32_bf16 v[160:163], a[84:87], v[40:43], v[160:163]
    v_mfma_f32_16x16x32_bf16 v[184:187], a[60:63], v[32:35], v[184:187]
    v_mfma_f32_16x16x32_bf16 v[184:187], a[84:87], v[44:47], v[184:187]
    buffer_load_dwordx4 v246, s[24:27], s76 offen offset:2048 nt lds
    v_mfma_f32_16x16x32_bf16 v[64:67], a[60:63], v[36:39], v[64:67]
    ds_read_b128 v[24:27], v241 offset:24832
    v_mfma_f32_16x16x32_bf16 v[64:67], a[84:87], v[48:51], v[64:67]
    v_mfma_f32_16x16x32_bf16 v[164:167], a[64:67], v[28:31], v[164:167]
    v_mfma_f32_16x16x32_bf16 v[164:167], a[88:91], v[40:43], v[164:167]
    v_mfma_f32_16x16x32_bf16 v[188:191], a[64:67], v[32:35], v[188:191]
    v_mfma_f32_16x16x32_bf16 v[188:191], a[88:91], v[44:47], v[188:191]
    v_mfma_f32_16x16x32_bf16 v[68:71], a[64:67], v[36:39], v[68:71]
    v_mfma_f32_16x16x32_bf16 v[68:71], a[88:91], v[48:51], v[68:71]
    v_mfma_f32_16x16x32_bf16 v[168:171], a[68:71], v[28:31], v[168:171]
    v_mfma_f32_16x16x32_bf16 v[168:171], a[92:95], v[40:43], v[168:171]
    v_mfma_f32_16x16x32_bf16 v[192:195], a[68:71], v[32:35], v[192:195]
    v_mfma_f32_16x16x32_bf16 v[192:195], a[92:95], v[44:47], v[192:195]
    v_mfma_f32_16x16x32_bf16 v[72:75], a[68:71], v[36:39], v[72:75]
    v_mfma_f32_16x16x32_bf16 v[72:75], a[92:95], v[48:51], v[72:75]
    s_waitcnt lgkmcnt(0)
    v_mfma_f32_16x16x32_bf16 v[148:151], a[96:99], v[4:7], v[148:151]
    s_add_u32 s77, s78, 0
    s_add_u32 m0, s49, 0
    v_mfma_f32_16x16x32_bf16 v[148:151], a[120:123], v[16:19], v[148:151]
    buffer_load_dwordx4 v232, s[20:23], s77 offen nt lds
    v_mfma_f32_16x16x32_bf16 v[172:175], a[96:99], v[8:11], v[172:175]
    ds_read_b128 v[28:31], v230 offset:24832
    v_mfma_f32_16x16x32_bf16 v[172:175], a[120:123], v[20:23], v[172:175]
    v_mfma_f32_16x16x32_bf16 v[52:55], a[96:99], v[12:15], v[52:55]
    buffer_load_dwordx4 v233, s[20:23], s77 offen offset:1024 nt lds
    v_mfma_f32_16x16x32_bf16 v[52:55], a[120:123], v[24:27], v[52:55]
    v_mfma_f32_16x16x32_bf16 v[152:155], a[100:103], v[4:7], v[152:155]
    ds_read_b128 v[32:35], v230 offset:37120
    v_mfma_f32_16x16x32_bf16 v[152:155], a[124:127], v[16:19], v[152:155]
    buffer_load_dwordx4 v234, s[20:23], s77 offen offset:2048 nt lds
    v_mfma_f32_16x16x32_bf16 v[176:179], a[100:103], v[8:11], v[176:179]
    v_mfma_f32_16x16x32_bf16 v[176:179], a[124:127], v[20:23], v[176:179]
    v_mfma_f32_16x16x32_bf16 v[56:59], a[100:103], v[12:15], v[56:59]
    ds_read_b128 v[36:39], v242 offset:24832
    v_mfma_f32_16x16x32_bf16 v[56:59], a[124:127], v[24:27], v[56:59]
    v_mfma_f32_16x16x32_bf16 v[156:159], a[104:107], v[4:7], v[156:159]
    v_mfma_f32_16x16x32_bf16 v[156:159], a[128:131], v[16:19], v[156:159]
    v_mfma_f32_16x16x32_bf16 v[180:183], a[104:107], v[8:11], v[180:183]
    ds_read_b128 v[40:43], v231 offset:24832
    v_mfma_f32_16x16x32_bf16 v[180:183], a[128:131], v[20:23], v[180:183]
    v_mfma_f32_16x16x32_bf16 v[60:63], a[104:107], v[12:15], v[60:63]
    v_mfma_f32_16x16x32_bf16 v[60:63], a[128:131], v[24:27], v[60:63]
    v_mfma_f32_16x16x32_bf16 v[160:163], a[108:111], v[4:7], v[160:163]
    ds_read_b128 v[44:47], v231 offset:37120
    v_mfma_f32_16x16x32_bf16 v[160:163], a[132:135], v[16:19], v[160:163]
    v_mfma_f32_16x16x32_bf16 v[184:187], a[108:111], v[8:11], v[184:187]
    v_mfma_f32_16x16x32_bf16 v[184:187], a[132:135], v[20:23], v[184:187]
    v_mfma_f32_16x16x32_bf16 v[64:67], a[108:111], v[12:15], v[64:67]
    ds_read_b128 v[48:51], v243 offset:24832
    v_mfma_f32_16x16x32_bf16 v[64:67], a[132:135], v[24:27], v[64:67]
    v_mfma_f32_16x16x32_bf16 v[164:167], a[112:115], v[4:7], v[164:167]
    s_add_u32 s74, s78, 768
    s_add_u32 m0, s49, 12288
    v_mfma_f32_16x16x32_bf16 v[164:167], a[136:139], v[16:19], v[164:167]
    buffer_load_dwordx4 v232, s[20:23], s74 offen nt lds
    v_mfma_f32_16x16x32_bf16 v[188:191], a[112:115], v[8:11], v[188:191]
    v_mfma_f32_16x16x32_bf16 v[188:191], a[136:139], v[20:23], v[188:191]
    v_mfma_f32_16x16x32_bf16 v[68:71], a[112:115], v[12:15], v[68:71]
    buffer_load_dwordx4 v233, s[20:23], s74 offen offset:1024 nt lds
    v_mfma_f32_16x16x32_bf16 v[68:71], a[136:139], v[24:27], v[68:71]
    v_mfma_f32_16x16x32_bf16 v[168:171], a[116:119], v[4:7], v[168:171]
    v_mfma_f32_16x16x32_bf16 v[168:171], a[140:143], v[16:19], v[168:171]
    buffer_load_dwordx4 v234, s[20:23], s74 offen offset:2048 nt lds
    v_mfma_f32_16x16x32_bf16 v[192:195], a[116:119], v[8:11], v[192:195]
    v_mfma_f32_16x16x32_bf16 v[192:195], a[140:143], v[20:23], v[192:195]
    v_mfma_f32_16x16x32_bf16 v[72:75], a[116:119], v[12:15], v[72:75]
    v_mfma_f32_16x16x32_bf16 v[72:75], a[140:143], v[24:27], v[72:75]
    s_waitcnt lgkmcnt(0)
    v_mfma_f32_16x16x32_bf16 v[148:151], a[144:147], v[28:31], v[148:151]
    v_mfma_f32_16x16x32_bf16 v[148:151], a[168:171], v[40:43], v[148:151]
    v_mfma_f32_16x16x32_bf16 v[172:175], a[144:147], v[32:35], v[172:175]
    ds_read_b128 v[4:7], v228 offset:25088
    v_mfma_f32_16x16x32_bf16 v[172:175], a[168:171], v[44:47], v[172:175]
    v_mfma_f32_16x16x32_bf16 v[52:55], a[144:147], v[36:39], v[52:55]
    v_mfma_f32_16x16x32_bf16 v[52:55], a[168:171], v[48:51], v[52:55]
    v_mfma_f32_16x16x32_bf16 v[152:155], a[148:151], v[28:31], v[152:155]
    ds_read_b128 v[8:11], v228 offset:37376
    v_mfma_f32_16x16x32_bf16 v[152:155], a[172:175], v[40:43], v[152:155]
    v_mfma_f32_16x16x32_bf16 v[176:179], a[148:151], v[32:35], v[176:179]
    v_mfma_f32_16x16x32_bf16 v[176:179], a[172:175], v[44:47], v[176:179]
    v_mfma_f32_16x16x32_bf16 v[56:59], a[148:151], v[36:39], v[56:59]
    ds_read_b128 v[12:15], v240 offset:25088
    v_mfma_f32_16x16x32_bf16 v[56:59], a[172:175], v[48:51], v[56:59]
    v_mfma_f32_16x16x32_bf16 v[156:159], a[152:155], v[28:31], v[156:159]
    s_add_u32 s75, s84, 294912
    s_add_u32 m0, s49, 73728
    v_mfma_f32_16x16x32_bf16 v[156:159], a[176:179], v[40:43], v[156:159]
    buffer_load_dwordx4 v232, s[20:23], s75 offen nt lds
    v_mfma_f32_16x16x32_bf16 v[180:183], a[152:155], v[32:35], v[180:183]
    ds_read_b128 v[16:19], v229 offset:25088
    v_mfma_f32_16x16x32_bf16 v[180:183], a[176:179], v[44:47], v[180:183]
    v_mfma_f32_16x16x32_bf16 v[60:63], a[152:155], v[36:39], v[60:63]
    buffer_load_dwordx4 v233, s[20:23], s75 offen offset:1024 nt lds
    v_mfma_f32_16x16x32_bf16 v[60:63], a[176:179], v[48:51], v[60:63]
    v_mfma_f32_16x16x32_bf16 v[160:163], a[156:159], v[28:31], v[160:163]
    ds_read_b128 v[20:23], v229 offset:37376
    v_mfma_f32_16x16x32_bf16 v[160:163], a[180:183], v[40:43], v[160:163]
    buffer_load_dwordx4 v234, s[20:23], s75 offen offset:2048 nt lds
    v_mfma_f32_16x16x32_bf16 v[184:187], a[156:159], v[32:35], v[184:187]
    v_mfma_f32_16x16x32_bf16 v[184:187], a[180:183], v[44:47], v[184:187]
    v_mfma_f32_16x16x32_bf16 v[64:67], a[156:159], v[36:39], v[64:67]
    ds_read_b128 v[24:27], v241 offset:25088
    v_mfma_f32_16x16x32_bf16 v[64:67], a[180:183], v[48:51], v[64:67]
    v_mfma_f32_16x16x32_bf16 v[164:167], a[160:163], v[28:31], v[164:167]
    v_mfma_f32_16x16x32_bf16 v[164:167], a[184:187], v[40:43], v[164:167]
    v_mfma_f32_16x16x32_bf16 v[188:191], a[160:163], v[32:35], v[188:191]
    v_mfma_f32_16x16x32_bf16 v[188:191], a[184:187], v[44:47], v[188:191]
    v_mfma_f32_16x16x32_bf16 v[68:71], a[160:163], v[36:39], v[68:71]
    v_mfma_f32_16x16x32_bf16 v[68:71], a[184:187], v[48:51], v[68:71]
    v_mfma_f32_16x16x32_bf16 v[168:171], a[164:167], v[28:31], v[168:171]
    v_mfma_f32_16x16x32_bf16 v[168:171], a[188:191], v[40:43], v[168:171]
    v_mfma_f32_16x16x32_bf16 v[192:195], a[164:167], v[32:35], v[192:195]
    v_mfma_f32_16x16x32_bf16 v[192:195], a[188:191], v[44:47], v[192:195]
    v_mfma_f32_16x16x32_bf16 v[72:75], a[164:167], v[36:39], v[72:75]
    v_mfma_f32_16x16x32_bf16 v[72:75], a[188:191], v[48:51], v[72:75]
    s_waitcnt lgkmcnt(0)
    v_mfma_f32_16x16x32_bf16 v[148:151], a[192:195], v[4:7], v[148:151]
    s_add_u32 s76, s84, 295680
    s_add_u32 m0, s49, 86016
    s_load_dword s72, s[14:15], 0
    v_mfma_f32_16x16x32_bf16 v[148:151], a[216:219], v[16:19], v[148:151]
    buffer_load_dwordx4 v232, s[20:23], s76 offen nt lds
    v_mfma_f32_16x16x32_bf16 v[172:175], a[192:195], v[8:11], v[172:175]
    ds_read_b128 v[28:31], v230 offset:25088
    v_mfma_f32_16x16x32_bf16 v[172:175], a[216:219], v[20:23], v[172:175]
    v_mfma_f32_16x16x32_bf16 v[52:55], a[192:195], v[12:15], v[52:55]
    buffer_load_dwordx4 v233, s[20:23], s76 offen offset:1024 nt lds
    v_mfma_f32_16x16x32_bf16 v[52:55], a[216:219], v[24:27], v[52:55]
    v_mfma_f32_16x16x32_bf16 v[152:155], a[196:199], v[4:7], v[152:155]
    ds_read_b128 v[32:35], v230 offset:37376
    v_mfma_f32_16x16x32_bf16 v[152:155], a[220:223], v[16:19], v[152:155]
    buffer_load_dwordx4 v234, s[20:23], s76 offen offset:2048 nt lds
    v_mfma_f32_16x16x32_bf16 v[176:179], a[196:199], v[8:11], v[176:179]
    v_mfma_f32_16x16x32_bf16 v[176:179], a[220:223], v[20:23], v[176:179]
    v_mfma_f32_16x16x32_bf16 v[56:59], a[196:199], v[12:15], v[56:59]
    ds_read_b128 v[36:39], v242 offset:25088
    v_mfma_f32_16x16x32_bf16 v[56:59], a[220:223], v[24:27], v[56:59]
    v_mfma_f32_16x16x32_bf16 v[156:159], a[200:203], v[4:7], v[156:159]
    v_mfma_f32_16x16x32_bf16 v[156:159], a[224:227], v[16:19], v[156:159]
    v_mfma_f32_16x16x32_bf16 v[180:183], a[200:203], v[8:11], v[180:183]
    ds_read_b128 v[40:43], v231 offset:25088
    v_mfma_f32_16x16x32_bf16 v[180:183], a[224:227], v[20:23], v[180:183]
    v_mfma_f32_16x16x32_bf16 v[60:63], a[200:203], v[12:15], v[60:63]
    v_mfma_f32_16x16x32_bf16 v[60:63], a[224:227], v[24:27], v[60:63]
    v_mfma_f32_16x16x32_bf16 v[160:163], a[204:207], v[4:7], v[160:163]
    ds_read_b128 v[44:47], v231 offset:37376
    v_mfma_f32_16x16x32_bf16 v[160:163], a[228:231], v[16:19], v[160:163]
    v_mfma_f32_16x16x32_bf16 v[184:187], a[204:207], v[8:11], v[184:187]
    v_mfma_f32_16x16x32_bf16 v[184:187], a[228:231], v[20:23], v[184:187]
    v_mfma_f32_16x16x32_bf16 v[64:67], a[204:207], v[12:15], v[64:67]
    ds_read_b128 v[48:51], v243 offset:25088
    v_mfma_f32_16x16x32_bf16 v[64:67], a[228:231], v[24:27], v[64:67]
    v_mfma_f32_16x16x32_bf16 v[164:167], a[208:211], v[4:7], v[164:167]
    v_mfma_f32_16x16x32_bf16 v[164:167], a[232:235], v[16:19], v[164:167]
    v_mfma_f32_16x16x32_bf16 v[188:191], a[208:211], v[8:11], v[188:191]
    v_mfma_f32_16x16x32_bf16 v[188:191], a[232:235], v[20:23], v[188:191]
    v_mfma_f32_16x16x32_bf16 v[68:71], a[208:211], v[12:15], v[68:71]
    v_mfma_f32_16x16x32_bf16 v[68:71], a[232:235], v[24:27], v[68:71]
    v_mfma_f32_16x16x32_bf16 v[168:171], a[212:215], v[4:7], v[168:171]
    v_mfma_f32_16x16x32_bf16 v[168:171], a[236:239], v[16:19], v[168:171]
    v_mfma_f32_16x16x32_bf16 v[192:195], a[212:215], v[8:11], v[192:195]
    v_mfma_f32_16x16x32_bf16 v[192:195], a[236:239], v[20:23], v[192:195]
    v_mfma_f32_16x16x32_bf16 v[72:75], a[212:215], v[12:15], v[72:75]
    s_waitcnt lgkmcnt(0)
    s_cmp_ge_u32 s72, 24
    s_cbranch_scc0 L_nopfw
    s_mov_b32 exec_hi, 15
    buffer_load_dword v254, v253, s[40:43], 0 offen sc1
    s_mov_b64 exec, -1
L_nopfw:
    v_mfma_f32_16x16x32_bf16 v[72:75], a[236:239], v[24:27], v[72:75]
    s_waitcnt vmcnt(12) lgkmcnt(0)
    s_barrier
    v_mfma_f32_16x16x32_bf16 v[148:151], a[240:243], v[28:31], v[148:151]
    v_mfma_f32_16x16x32_bf16 v[148:151], v[204:207], v[40:43], v[148:151]
    v_mfma_f32_16x16x32_bf16 v[172:175], a[240:243], v[32:35], v[172:175]
    ds_read_b128 v[4:7], v240 offset:36864
    v_mfma_f32_16x16x32_bf16 v[172:175], v[204:207], v[44:47], v[172:175]
    v_mfma_f32_16x16x32_bf16 v[52:55], a[240:243], v[36:39], v[52:55]
    v_mfma_f32_16x16x32_bf16 v[52:55], v[204:207], v[48:51], v[52:55]
    v_mfma_f32_16x16x32_bf16 v[152:155], a[244:247], v[28:31], v[152:155]
    ds_read_b128 v[8:11], v240 offset:49152
    v_mfma_f32_16x16x32_bf16 v[152:155], v[208:211], v[40:43], v[152:155]
    v_mfma_f32_16x16x32_bf16 v[176:179], a[244:247], v[32:35], v[176:179]
    v_mfma_f32_16x16x32_bf16 v[176:179], v[208:211], v[44:47], v[176:179]
    v_mfma_f32_16x16x32_bf16 v[56:59], a[244:247], v[36:39], v[56:59]
    ds_read_b128 v[12:15], v240 offset:61440
    v_mfma_f32_16x16x32_bf16 v[56:59], v[208:211], v[48:51], v[56:59]
    v_mfma_f32_16x16x32_bf16 v[156:159], a[248:251], v[28:31], v[156:159]
    v_mfma_f32_16x16x32_bf16 v[156:159], v[212:215], v[40:43], v[156:159]
    v_mfma_f32_16x16x32_bf16 v[180:183], a[248:251], v[32:35], v[180:183]
    ds_read_b128 v[16:19], v241 offset:36864
    v_mfma_f32_16x16x32_bf16 v[180:183], v[212:215], v[44:47], v[180:183]
    v_mfma_f32_16x16x32_bf16 v[60:63], a[248:251], v[36:39], v[60:63]
    v_mfma_f32_16x16x32_bf16 v[60:63], v[212:215], v[48:51], v[60:63]
    v_mfma_f32_16x16x32_bf16 v[160:163], a[252:255], v[28:31], v[160:163]
    ds_read_b128 v[20:23], v241 offset:49152
    v_mfma_f32_16x16x32_bf16 v[160:163], v[216:219], v[40:43], v[160:163]
    v_mfma_f32_16x16x32_bf16 v[184:187], a[252:255], v[32:35], v[184:187]
    v_mfma_f32_16x16x32_bf16 v[184:187], v[216:219], v[44:47], v[184:187]
    v_mfma_f32_16x16x32_bf16 v[64:67], a[252:255], v[36:39], v[64:67]
    ds_read_b128 v[24:27], v241 offset:61440
    v_mfma_f32_16x16x32_bf16 v[64:67], v[216:219], v[48:51], v[64:67]
    v_mfma_f32_16x16x32_bf16 v[164:167], v[196:199], v[28:31], v[164:167]
    v_mfma_f32_16x16x32_bf16 v[164:167], v[220:223], v[40:43], v[164:167]
    v_mfma_f32_16x16x32_bf16 v[188:191], v[196:199], v[32:35], v[188:191]
    v_mfma_f32_16x16x32_bf16 v[188:191], v[220:223], v[44:47], v[188:191]
    v_mfma_f32_16x16x32_bf16 v[68:71], v[196:199], v[36:39], v[68:71]
    v_mfma_f32_16x16x32_bf16 v[68:71], v[220:223], v[48:51], v[68:71]
    v_mfma_f32_16x16x32_bf16 v[168:171], v[200:203], v[28:31], v[168:171]
    v_mfma_f32_16x16x32_bf16 v[168:171], v[224:227], v[40:43], v[168:171]
    v_mfma_f32_16x16x32_bf16 v[192:195], v[200:203], v[32:35], v[192:195]
    v_mfma_f32_16x16x32_bf16 v[192:195], v[224:227], v[44:47], v[192:195]
    v_mfma_f32_16x16x32_bf16 v[72:75], v[200:203], v[36:39], v[72:75]
    v_mfma_f32_16x16x32_bf16 v[72:75], v[224:227], v[48:51], v[72:75]
    s_branch L_p2done
L_pass2t:
    s_waitcnt lgkmcnt(0)
    v_cvt_pk_bf16_f32 v76, v148, v149
    v_cvt_pk_bf16_f32 v77, v150, v151
    v_mfma_f32_16x16x32_bf16 v[148:151], a[0:3], v[4:7], 0
    s_add_u32 s77, s2, 258
    s_and_b32 s77, s77, 255
    v_mfma_f32_16x16x32_bf16 v[148:151], a[24:27], v[16:19], v[148:151]
    v_cvt_pk_bf16_f32 v88, v172, v173
    v_cvt_pk_bf16_f32 v89, v174, v175
    s_add_u32 s77, s77, 1536
    s_mul_i32 s77, s77, 12288
    v_mfma_f32_16x16x32_bf16 v[172:175], a[0:3], v[8:11], 0
    ds_read_b128 v[28:31], v230 offset:24576
    s_add_u32 m0, s49, 110592
    v_mfma_f32_16x16x32_bf16 v[172:175], a[24:27], v[20:23], v[172:175]
    v_cvt_pk_bf16_f32 v100, v52, v53
    v_cvt_pk_bf16_f32 v101, v54, v55
    buffer_load_dwordx4 v244, s[24:27], s77 offen nt lds
    v_mfma_f32_16x16x32_bf16 v[52:55], a[0:3], v[12:15], 0
    v_mfma_f32_16x16x32_bf16 v[52:55], a[24:27], v[24:27], v[52:55]
    v_cvt_pk_bf16_f32 v78, v152, v153
    v_cvt_pk_bf16_f32 v79, v154, v155
    v_mfma_f32_16x16x32_bf16 v[152:155], a[4:7], v[4:7], 0
    ds_read_b128 v[32:35], v230 offset:36864
    buffer_load_dwordx4 v245, s[24:27], s77 offen offset:1024 nt lds
    v_mfma_f32_16x16x32_bf16 v[152:155], a[28:31], v[16:19], v[152:155]
    v_cvt_pk_bf16_f32 v90, v176, v177
    v_cvt_pk_bf16_f32 v91, v178, v179
    v_mfma_f32_16x16x32_bf16 v[176:179], a[4:7], v[8:11], 0
    v_mfma_f32_16x16x32_bf16 v[176:179], a[28:31], v[20:23], v[176:179]
    v_cvt_pk_bf16_f32 v102, v56, v57
    v_cvt_pk_bf16_f32 v103, v58, v59
    buffer_load_dwordx4 v246, s[24:27], s77 offen offset:2048 nt lds
    v_mfma_f32_16x16x32_bf16 v[56:59], a[4:7], v[12:15], 0
    ds_read_b128 v[36:39], v242 offset:24576
    v_mfma_f32_16x16x32_bf16 v[56:59], a[28:31], v[24:27], v[56:59]
    v_cvt_pk_bf16_f32 v80, v156, v157
    v_cvt_pk_bf16_f32 v81, v158, v159
    v_mfma_f32_16x16x32_bf16 v[156:159], a[8:11], v[4:7], 0
    v_mfma_f32_16x16x32_bf16 v[156:159], a[32:35], v[16:19], v[156:159]
    v_cvt_pk_bf16_f32 v92, v180, v181
    v_cvt_pk_bf16_f32 v93, v182, v183
    v_mfma_f32_16x16x32_bf16 v[180:183], a[8:11], v[8:11], 0
    ds_read_b128 v[40:43], v231 offset:24576
    v_mfma_f32_16x16x32_bf16 v[180:183], a[32:35], v[20:23], v[180:183]
    v_cvt_pk_bf16_f32 v104, v60, v61
    v_cvt_pk_bf16_f32 v105, v62, v63
    v_mfma_f32_16x16x32_bf16 v[60:63], a[8:11], v[12:15], 0
    v_mfma_f32_16x16x32_bf16 v[60:63], a[32:35], v[24:27], v[60:63]
    v_cvt_pk_bf16_f32 v82, v160, v161
    v_cvt_pk_bf16_f32 v83, v162, v163
    v_mfma_f32_16x16x32_bf16 v[160:163], a[12:15], v[4:7], 0
    ds_read_b128 v[44:47], v231 offset:36864
    v_mfma_f32_16x16x32_bf16 v[160:163], a[36:39], v[16:19], v[160:163]
    v_cvt_pk_bf16_f32 v94, v184, v185
    v_cvt_pk_bf16_f32 v95, v186, v187
    v_mfma_f32_16x16x32_bf16 v[184:187], a[12:15], v[8:11], 0
    s_add_u32 s74, s2, 301
    s_and_b32 s74, s74, 255
    v_mfma_f32_16x16x32_bf16 v[184:187], a[36:39], v[20:23], v[184:187]
    v_cvt_pk_bf16_f32 v106, v64, v65
    v_cvt_pk_bf16_f32 v107, v66, v67
    s_add_u32 s74, s74, 1792
    s_mul_i32 s74, s74, 12288
    v_mfma_f32_16x16x32_bf16 v[64:67], a[12:15], v[12:15], 0
    ds_read_b128 v[48:51], v243 offset:24576
    s_add_u32 m0, s49, 122880
    v_mfma_f32_16x16x32_bf16 v[64:67], a[36:39], v[24:27], v[64:67]
    v_cvt_pk_bf16_f32 v84, v164, v165
    v_cvt_pk_bf16_f32 v85, v166, v167
    buffer_load_dwordx4 v244, s[24:27], s74 offen nt lds
    v_mfma_f32_16x16x32_bf16 v[164:167], a[16:19], v[4:7], 0
    v_mfma_f32_16x16x32_bf16 v[164:167], a[40:43], v[16:19], v[164:167]
    v_cvt_pk_bf16_f32 v96, v188, v189
    v_cvt_pk_bf16_f32 v97, v190, v191
    v_mfma_f32_16x16x32_bf16 v[188:191], a[16:19], v[8:11], 0
    buffer_load_dwordx4 v245, s[24:27], s74 offen offset:1024 nt lds
    v_mfma_f32_16x16x32_bf16 v[188:191], a[40:43], v[20:23], v[188:191]
    v_cvt_pk_bf16_f32 v108, v68, v69
    v_cvt_pk_bf16_f32 v109, v70, v71
    v_mfma_f32_16x16x32_bf16 v[68:71], a[16:19], v[12:15], 0
    v_mfma_f32_16x16x32_bf16 v[68:71], a[40:43], v[24:27], v[68:71]
    v_cvt_pk_bf16_f32 v86, v168, v169
    v_cvt_pk_bf16_f32 v87, v170, v171
    buffer_load_dwordx4 v246, s[24:27], s74 offen offset:2048 nt lds
    v_mfma_f32_16x16x32_bf16 v[168:171], a[20:23], v[4:7], 0
    v_mfma_f32_16x16x32_bf16 v[168:171], a[44:47], v[16:19], v[168:171]
    v_cvt_pk_bf16_f32 v98, v192, v193
    v_cvt_pk_bf16_f32 v99, v194, v195
    v_mfma_f32_16x16x32_bf16 v[192:195], a[20:23], v[8:11], 0
    v_mfma_f32_16x16x32_bf16 v[192:195], a[44:47], v[20:23], v[192:195]
    v_cvt_pk_bf16_f32 v110, v72, v73
    v_cvt_pk_bf16_f32 v111, v74, v75
    v_mfma_f32_16x16x32_bf16 v[72:75], a[20:23], v[12:15], 0
    v_mfma_f32_16x16x32_bf16 v[72:75], a[44:47], v[24:27], v[72:75]
    s_waitcnt lgkmcnt(0)
    v_mfma_f32_16x16x32_bf16 v[148:151], a[48:51], v[28:31], v[148:151]
    v_mfma_f32_16x16x32_bf16 v[148:151], a[72:75], v[40:43], v[148:151]
    v_mfma_f32_16x16x32_bf16 v[172:175], a[48:51], v[32:35], v[172:175]
    ds_read_b128 v[4:7], v228 offset:24832
    v_mfma_f32_16x16x32_bf16 v[172:175], a[72:75], v[44:47], v[172:175]
    v_mfma_f32_16x16x32_bf16 v[52:55], a[48:51], v[36:39], v[52:55]
    s_add_u32 s75, s2, 344
    s_and_b32 s75, s75, 255
    v_mfma_f32_16x16x32_bf16 v[52:55], a[72:75], v[48:51], v[52:55]
    s_add_u32 s75, s75, 2048
    s_mul_i32 s75, s75, 12288
    v_mfma_f32_16x16x32_bf16 v[152:155], a[52:55], v[28:31], v[152:155]
    ds_read_b128 v[8:11], v228 offset:37120
    s_add_u32 m0, s49, 135168
    v_mfma_f32_16x16x32_bf16 v[152:155], a[76:79], v[40:43], v[152:155]
    buffer_load_dwordx4 v244, s[24:27], s75 offen nt lds
    v_mfma_f32_16x16x32_bf16 v[176:179], a[52:55], v[32:35], v[176:179]
    v_mfma_f32_16x16x32_bf16 v[176:179], a[76:79], v[44:47], v[176:179]
    v_mfma_f32_16x16x32_bf16 v[56:59], a[52:55], v[36:39], v[56:59]
    ds_read_b128 v[12:15], v240 offset:24832
    buffer_load_dwordx4 v245, s[24:27], s75 offen offset:1024 nt lds
    v_mfma_f32_16x16x32_bf16 v[56:59], a[76:79], v[48:51], v[56:59]
    v_mfma_f32_16x16x32_bf16 v[156:159], a[56:59], v[28:31], v[156:159]
    v_mfma_f32_16x16x32_bf16 v[156:159], a[80:83], v[40:43], v[156:159]
    buffer_load_dwordx4 v246, s[24:27], s75 offen offset:2048 nt lds
    v_mfma_f32_16x16x32_bf16 v[180:183], a[56:59], v[32:35], v[180:183]
    ds_read_b128 v[16:19], v229 offset:24832
    v_mfma_f32_16x16x32_bf16 v[180:183], a[80:83], v[44:47], v[180:183]
    v_mfma_f32_16x16x32_bf16 v[60:63], a[56:59], v[36:39], v[60:63]
    v_mfma_f32_16x16x32_bf16 v[60:63], a[80:83], v[48:51], v[60:63]
    v_mfma_f32_16x16x32_bf16 v[160:163], a[60:63], v[28:31], v[160:163]
    ds_read_b128 v[20:23], v229 offset:37120
    v_mfma_f32_16x16x32_bf16 v[160:163], a[84:87], v[40:43], v[160:163]
    v_mfma_f32_16x16x32_bf16 v[184:187], a[60:63], v[32:35], v[184:187]
    v_mfma_f32_16x16x32_bf16 v[184:187], a[84:87], v[44:47], v[184:187]
    v_mfma_f32_16x16x32_bf16 v[64:67], a[60:63], v[36:39], v[64:67]
    ds_read_b128 v[24:27], v241 offset:24832
    v_mfma_f32_16x16x32_bf16 v[64:67], a[84:87], v[48:51], v[64:67]
    v_mfma_f32_16x16x32_bf16 v[164:167], a[64:67], v[28:31], v[164:167]
    s_add_u32 s76, s78, 0
    s_add_u32 m0, s49, 0
    v_mfma_f32_16x16x32_bf16 v[164:167], a[88:91], v[40:43], v[164:167]
    buffer_load_dwordx4 v232, s[20:23], s76 offen nt lds
    v_mfma_f32_16x16x32_bf16 v[188:191], a[64:67], v[32:35], v[188:191]
    v_mfma_f32_16x16x32_bf16 v[188:191], a[88:91], v[44:47], v[188:191]
    v_mfma_f32_16x16x32_bf16 v[68:71], a[64:67], v[36:39], v[68:71]
    buffer_load_dwordx4 v233, s[20:23], s76 offen offset:1024 nt lds
    v_mfma_f32_16x16x32_bf16 v[68:71], a[88:91], v[48:51], v[68:71]
    v_mfma_f32_16x16x32_bf16 v[168:171], a[68:71], v[28:31], v[168:171]
    v_mfma_f32_16x16x32_bf16 v[168:171], a[92:95], v[40:43], v[168:171]
    buffer_load_dwordx4 v234, s[20:23], s76 offen offset:2048 nt lds
    v_mfma_f32_16x16x32_bf16 v[192:195], a[68:71], v[32:35], v[192:195]
    v_mfma_f32_16x16x32_bf16 v[192:195], a[92:95], v[44:47], v[192:195]
    v_mfma_f32_16x16x32_bf16 v[72:75], a[68:71], v[36:39], v[72:75]
    v_mfma_f32_16x16x32_bf16 v[72:75], a[92:95], v[48:51], v[72:75]
    s_waitcnt lgkmcnt(0)
    v_mfma_f32_16x16x32_bf16 v[148:151], a[96:99], v[4:7], v[148:151]
    v_mfma_f32_16x16x32_bf16 v[148:151], a[120:123], v[16:19], v[148:151]
    v_mfma_f32_16x16x32_bf16 v[172:175], a[96:99], v[8:11], v[172:175]
    ds_read_b128 v[28:31], v230 offset:24832
    v_mfma_f32_16x16x32_bf16 v[172:175], a[120:123], v[20:23], v[172:175]
    v_mfma_f32_16x16x32_bf16 v[52:55], a[96:99], v[12:15], v[52:55]
    v_mfma_f32_16x16x32_bf16 v[52:55], a[120:123], v[24:27], v[52:55]
    v_mfma_f32_16x16x32_bf16 v[152:155], a[100:103], v[4:7], v[152:155]
    ds_read_b128 v[32:35], v230 offset:37120
    v_mfma_f32_16x16x32_bf16 v[152:155], a[124:127], v[16:19], v[152:155]
    v_mfma_f32_16x16x32_bf16 v[176:179], a[100:103], v[8:11], v[176:179]
    s_add_u32 s77, s78, 768
    s_add_u32 m0, s49, 12288
    v_mfma_f32_16x16x32_bf16 v[176:179], a[124:127], v[20:23], v[176:179]
    buffer_load_dwordx4 v232, s[20:23], s77 offen nt lds
    v_mfma_f32_16x16x32_bf16 v[56:59], a[100:103], v[12:15], v[56:59]
    ds_read_b128 v[36:39], v242 offset:24832
    v_mfma_f32_16x16x32_bf16 v[56:59], a[124:127], v[24:27], v[56:59]
    v_mfma_f32_16x16x32_bf16 v[156:159], a[104:107], v[4:7], v[156:159]
    buffer_load_dwordx4 v233, s[20:23], s77 offen offset:1024 nt lds
    v_mfma_f32_16x16x32_bf16 v[156:159], a[128:131], v[16:19], v[156:159]
    v_mfma_f32_16x16x32_bf16 v[180:183], a[104:107], v[8:11], v[180:183]
    ds_read_b128 v[40:43], v231 offset:24832
    v_mfma_f32_16x16x32_bf16 v[180:183], a[128:131], v[20:23], v[180:183]
    buffer_load_dwordx4 v234, s[20:23], s77 offen offset:2048 nt lds
    v_mfma_f32_16x16x32_bf16 v[60:63], a[104:107], v[12:15], v[60:63]
    v_mfma_f32_16x16x32_bf16 v[60:63], a[128:131], v[24:27], v[60:63]
    v_mfma_f32_16x16x32_bf16 v[160:163], a[108:111], v[4:7], v[160:163]
    ds_read_b128 v[44:47], v231 offset:37120
    v_mfma_f32_16x16x32_bf16 v[160:163], a[132:135], v[16:19], v[160:163]
    v_mfma_f32_16x16x32_bf16 v[184:187], a[108:111], v[8:11], v[184:187]
    v_mfma_f32_16x16x32_bf16 v[184:187], a[132:135], v[20:23], v[184:187]
    v_mfma_f32_16x16x32_bf16 v[64:67], a[108:111], v[12:15], v[64:67]
    ds_read_b128 v[48:51], v243 offset:24832
    v_mfma_f32_16x16x32_bf16 v[64:67], a[132:135], v[24:27], v[64:67]
    v_mfma_f32_16x16x32_bf16 v[164:167], a[112:115], v[4:7], v[164:167]
    v_mfma_f32_16x16x32_bf16 v[164:167], a[136:139], v[16:19], v[164:167]
    v_mfma_f32_16x16x32_bf16 v[188:191], a[112:115], v[8:11], v[188:191]
    v_mfma_f32_16x16x32_bf16 v[188:191], a[136:139], v[20:23], v[188:191]
    v_mfma_f32_16x16x32_bf16 v[68:71], a[112:115], v[12:15], v[68:71]
    v_mfma_f32_16x16x32_bf16 v[68:71], a[136:139], v[24:27], v[68:71]
    v_mfma_f32_16x16x32_bf16 v[168:171], a[116:119], v[4:7], v[168:171]
    v_mfma_f32_16x16x32_bf16 v[168:171], a[140:143], v[16:19], v[168:171]
    v_mfma_f32_16x16x32_bf16 v[192:195], a[116:119], v[8:11], v[192:195]
    v_mfma_f32_16x16x32_bf16 v[192:195], a[140:143], v[20:23], v[192:195]
    v_mfma_f32_16x16x32_bf16 v[72:75], a[116:119], v[12:15], v[72:75]
    v_mfma_f32_16x16x32_bf16 v[72:75], a[140:143], v[24:27], v[72:75]
    s_waitcnt lgkmcnt(0)
    v_mfma_f32_16x16x32_bf16 v[148:151], a[144:147], v[28:31], v[148:151]
    v_mfma_f32_16x16x32_bf16 v[148:151], a[168:171], v[40:43], v[148:151]
    v_mfma_f32_16x16x32_bf16 v[172:175], a[144:147], v[32:35], v[172:175]
    ds_read_b128 v[4:7], v228 offset:25088
    v_mfma_f32_16x16x32_bf16 v[172:175], a[168:171], v[44:47], v[172:175]
    v_mfma_f32_16x16x32_bf16 v[52:55], a[144:147], v[36:39], v[52:55]
    v_mfma_f32_16x16x32_bf16 v[52:55], a[168:171], v[48:51], v[52:55]
    v_mfma_f32_16x16x32_bf16 v[152:155], a[148:151], v[28:31], v[152:155]
    ds_read_b128 v[8:11], v228 offset:37376
    v_mfma_f32_16x16x32_bf16 v[152:155], a[172:175], v[40:43], v[152:155]
    v_mfma_f32_16x16x32_bf16 v[176:179], a[148:151], v[32:35], v[176:179]
    v_mfma_f32_16x16x32_bf16 v[176:179], a[172:175], v[44:47], v[176:179]
    v_mfma_f32_16x16x32_bf16 v[56:59], a[148:151], v[36:39], v[56:59]
    ds_read_b128 v[12:15], v240 offset:25088
    v_mfma_f32_16x16x32_bf16 v[56:59], a[172:175], v[48:51], v[56:59]
    v_mfma_f32_16x16x32_bf16 v[156:159], a[152:155], v[28:31], v[156:159]
    v_mfma_f32_16x16x32_bf16 v[156:159], a[176:179], v[40:43], v[156:159]
    v_mfma_f32_16x16x32_bf16 v[180:183], a[152:155], v[32:35], v[180:183]
    ds_read_b128 v[16:19], v229 offset:25088
    v_mfma_f32_16x16x32_bf16 v[180:183], a[176:179], v[44:47], v[180:183]
    v_mfma_f32_16x16x32_bf16 v[60:63], a[152:155], v[36:39], v[60:63]
    v_mfma_f32_16x16x32_bf16 v[60:63], a[176:179], v[48:51], v[60:63]
    v_mfma_f32_16x16x32_bf16 v[160:163], a[156:159], v[28:31], v[160:163]
    ds_read_b128 v[20:23], v229 offset:37376
    v_mfma_f32_16x16x32_bf16 v[160:163], a[180:183], v[40:43], v[160:163]
    v_mfma_f32_16x16x32_bf16 v[184:187], a[156:159], v[32:35], v[184:187]
    v_mfma_f32_16x16x32_bf16 v[184:187], a[180:183], v[44:47], v[184:187]
    v_mfma_f32_16x16x32_bf16 v[64:67], a[156:159], v[36:39], v[64:67]
    ds_read_b128 v[24:27], v241 offset:25088
    v_mfma_f32_16x16x32_bf16 v[64:67], a[180:183], v[48:51], v[64:67]
    v_mfma_f32_16x16x32_bf16 v[164:167], a[160:163], v[28:31], v[164:167]
    v_mfma_f32_16x16x32_bf16 v[164:167], a[184:187], v[40:43], v[164:167]
    v_mfma_f32_16x16x32_bf16 v[188:191], a[160:163], v[32:35], v[188:191]
    v_mfma_f32_16x16x32_bf16 v[188:191], a[184:187], v[44:47], v[188:191]
    v_mfma_f32_16x16x32_bf16 v[68:71], a[160:163], v[36:39], v[68:71]
    v_mfma_f32_16x16x32_bf16 v[68:71], a[184:187], v[48:51], v[68:71]
    v_mfma_f32_16x16x32_bf16 v[168:171], a[164:167], v[28:31], v[168:171]
    v_mfma_f32_16x16x32_bf16 v[168:171], a[188:191], v[40:43], v[168:171]
    v_mfma_f32_16x16x32_bf16 v[192:195], a[164:167], v[32:35], v[192:195]
    v_mfma_f32_16x16x32_bf16 v[192:195], a[188:191], v[44:47], v[192:195]
    v_mfma_f32_16x16x32_bf16 v[72:75], a[164:167], v[36:39], v[72:75]
    v_mfma_f32_16x16x32_bf16 v[72:75], a[188:191], v[48:51], v[72:75]
    s_waitcnt lgkmcnt(0)
    v_mfma_f32_16x16x32_bf16 v[148:151], a[192:195], v[4:7], v[148:151]
    s_load_dword s72, s[14:15], 0
    v_mfma_f32_16x16x32_bf16 v[148:151], a[216:219], v[16:19], v[148:151]
    v_mfma_f32_16x16x32_bf16 v[172:175], a[192:195], v[8:11], v[172:175]
    ds_read_b128 v[28:31], v230 offset:25088
    v_mfma_f32_16x16x32_bf16 v[172:175], a[216:219], v[20:23], v[172:175]
    v_mfma_f32_16x16x32_bf16 v[52:55], a[192:195], v[12:15], v[52:55]
    v_mfma_f32_16x16x32_bf16 v[52:55], a[216:219], v[24:27], v[52:55]
    v_mfma_f32_16x16x32_bf16 v[152:155], a[196:199], v[4:7], v[152:155]
    ds_read_b128 v[32:35], v230 offset:37376
    v_mfma_f32_16x16x32_bf16 v[152:155], a[220:223], v[16:19], v[152:155]
    v_mfma_f32_16x16x32_bf16 v[176:179], a[196:199], v[8:11], v[176:179]
    v_mfma_f32_16x16x32_bf16 v[176:179], a[220:223], v[20:23], v[176:179]
    v_mfma_f32_16x16x32_bf16 v[56:59], a[196:199], v[12:15], v[56:59]
    ds_read_b128 v[36:39], v242 offset:25088
    v_mfma_f32_16x16x32_bf16 v[56:59], a[220:223], v[24:27], v[56:59]
    v_mfma_f32_16x16x32_bf16 v[156:159], a[200:203], v[4:7], v[156:159]
    v_mfma_f32_16x16x32_bf16 v[156:159], a[224:227], v[16:19], v[156:159]
    v_mfma_f32_16x16x32_bf16 v[180:183], a[200:203], v[8:11], v[180:183]
    ds_read_b128 v[40:43], v231 offset:25088
    v_mfma_f32_16x16x32_bf16 v[180:183], a[224:227], v[20:23], v[180:183]
    v_mfma_f32_16x16x32_bf16 v[60:63], a[200:203], v[12:15], v[60:63]
    v_mfma_f32_16x16x32_bf16 v[60:63], a[224:227], v[24:27], v[60:63]
    v_mfma_f32_16x16x32_bf16 v[160:163], a[204:207], v[4:7], v[160:163]
    ds_read_b128 v[44:47], v231 offset:37376
    v_mfma_f32_16x16x32_bf16 v[160:163], a[228:231], v[16:19], v[160:163]
    v_mfma_f32_16x16x32_bf16 v[184:187], a[204:207], v[8:11], v[184:187]
    v_mfma_f32_16x16x32_bf16 v[184:187], a[228:231], v[20:23], v[184:187]
    v_mfma_f32_16x16x32_bf16 v[64:67], a[204:207], v[12:15], v[64:67]
    ds_read_b128 v[48:51], v243 offset:25088
    v_mfma_f32_16x16x32_bf16 v[64:67], a[228:231], v[24:27], v[64:67]
    v_mfma_f32_16x16x32_bf16 v[164:167], a[208:211], v[4:7], v[164:167]
    v_mfma_f32_16x16x32_bf16 v[164:167], a[232:235], v[16:19], v[164:167]
    v_mfma_f32_16x16x32_bf16 v[188:191], a[208:211], v[8:11], v[188:191]
    v_mfma_f32_16x16x32_bf16 v[188:191], a[232:235], v[20:23], v[188:191]
    v_mfma_f32_16x16x32_bf16 v[68:71], a[208:211], v[12:15], v[68:71]
    v_mfma_f32_16x16x32_bf16 v[68:71], a[232:235], v[24:27], v[68:71]
    v_mfma_f32_16x16x32_bf16 v[168:171], a[212:215], v[4:7], v[168:171]
    v_mfma_f32_16x16x32_bf16 v[168:171], a[236:239], v[16:19], v[168:171]
    v_mfma_f32_16x16x32_bf16 v[192:195], a[212:215], v[8:11], v[192:195]
    v_mfma_f32_16x16x32_bf16 v[192:195], a[236:239], v[20:23], v[192:195]
    v_mfma_f32_16x16x32_bf16 v[72:75], a[212:215], v[12:15], v[72:75]
    s_waitcnt lgkmcnt(0)
    s_cmp_ge_u32 s72, 24
    s_cbranch_scc0 L_nopft
    s_mov_b32 exec_hi, 15
    buffer_load_dword v254, v253, s[40:43], 0 offen sc1
    s_mov_b64 exec, -1
L_nopft:
    v_mfma_f32_16x16x32_bf16 v[72:75], a[236:239], v[24:27], v[72:75]
    s_waitcnt vmcnt(6) lgkmcnt(0)
    s_barrier
    v_mfma_f32_16x16x32_bf16 v[148:151], a[240:243], v[28:31], v[148:151]
    v_mfma_f32_16x16x32_bf16 v[148:151], v[204:207], v[40:43], v[148:151]
    v_mfma_f32_16x16x32_bf16 v[172:175], a[240:243], v[32:35], v[172:175]
    ds_read_b128 v[4:7], v240 offset:36864
    v_mfma_f32_16x16x32_bf16 v[172:175], v[204:207], v[44:47], v[172:175]
    v_mfma_f32_16x16x32_bf16 v[52:55], a[240:243], v[36:39], v[52:55]
    v_mfma_f32_16x16x32_bf16 v[52:55], v[204:207], v[48:51], v[52:55]
    v_mfma_f32_16x16x32_bf16 v[152:155], a[244:247], v[28:31], v[152:155]
    ds_read_b128 v[8:11], v240 offset:49152
    v_mfma_f32_16x16x32_bf16 v[152:155], v[208:211], v[40:43], v[152:155]
    v_mfma_f32_16x16x32_bf16 v[176:179], a[244:247], v[32:35], v[176:179]
    v_mfma_f32_16x16x32_bf16 v[176:179], v[208:211], v[44:47], v[176:179]
    v_mfma_f32_16x16x32_bf16 v[56:59], a[244:247], v[36:39], v[56:59]
    ds_read_b128 v[12:15], v240 offset:61440
    v_mfma_f32_16x16x32_bf16 v[56:59], v[208:211], v[48:51], v[56:59]
    v_mfma_f32_16x16x32_bf16 v[156:159], a[248:251], v[28:31], v[156:159]
    v_mfma_f32_16x16x32_bf16 v[156:159], v[212:215], v[40:43], v[156:159]
    v_mfma_f32_16x16x32_bf16 v[180:183], a[248:251], v[32:35], v[180:183]
    ds_read_b128 v[16:19], v241 offset:36864
    v_mfma_f32_16x16x32_bf16 v[180:183], v[212:215], v[44:47], v[180:183]
    v_mfma_f32_16x16x32_bf16 v[60:63], a[248:251], v[36:39], v[60:63]
    v_mfma_f32_16x16x32_bf16 v[60:63], v[212:215], v[48:51], v[60:63]
    v_mfma_f32_16x16x32_bf16 v[160:163], a[252:255], v[28:31], v[160:163]
    ds_read_b128 v[20:23], v241 offset:49152
    v_mfma_f32_16x16x32_bf16 v[160:163], v[216:219], v[40:43], v[160:163]
    v_mfma_f32_16x16x32_bf16 v[184:187], a[252:255], v[32:35], v[184:187]
    v_mfma_f32_16x16x32_bf16 v[184:187], v[216:219], v[44:47], v[184:187]
    v_mfma_f32_16x16x32_bf16 v[64:67], a[252:255], v[36:39], v[64:67]
    ds_read_b128 v[24:27], v241 offset:61440
    v_mfma_f32_16x16x32_bf16 v[64:67], v[216:219], v[48:51], v[64:67]
    v_mfma_f32_16x16x32_bf16 v[164:167], v[196:199], v[28:31], v[164:167]
    v_mfma_f32_16x16x32_bf16 v[164:167], v[220:223], v[40:43], v[164:167]
    v_mfma_f32_16x16x32_bf16 v[188:191], v[196:199], v[32:35], v[188:191]
    v_mfma_f32_16x16x32_bf16 v[188:191], v[220:223], v[44:47], v[188:191]
    v_mfma_f32_16x16x32_bf16 v[68:71], v[196:199], v[36:39], v[68:71]
    v_mfma_f32_16x16x32_bf16 v[68:71], v[220:223], v[48:51], v[68:71]
    v_mfma_f32_16x16x32_bf16 v[168:171], v[200:203], v[28:31], v[168:171]
    v_mfma_f32_16x16x32_bf16 v[168:171], v[224:227], v[40:43], v[168:171]
    v_mfma_f32_16x16x32_bf16 v[192:195], v[200:203], v[32:35], v[192:195]
    v_mfma_f32_16x16x32_bf16 v[192:195], v[224:227], v[44:47], v[192:195]
    v_mfma_f32_16x16x32_bf16 v[72:75], v[200:203], v[36:39], v[72:75]
    v_mfma_f32_16x16x32_bf16 v[72:75], v[224:227], v[48:51], v[72:75]
L_p2done:
    s_cmp_ge_u32 s72, 24
    s_cbranch_scc0 L_poll
L_ready:
    s_waitcnt lgkmcnt(0)
    v_cvt_pk_bf16_f32 v112, v148, v149
    v_cvt_pk_bf16_f32 v113, v150, v151
    v_mfma_f32_16x16x32_bf16 v[148:151], a[0:3], v[4:7], 0
    v_mfma_f32_16x16x32_bf16 v[148:151], a[24:27], v[16:19], v[148:151]
    v_cvt_pk_bf16_f32 v124, v172, v173
    v_cvt_pk_bf16_f32 v125, v174, v175
    v_mfma_f32_16x16x32_bf16 v[172:175], a[0:3], v[8:11], 0
    ds_read_b128 v[28:31], v242 offset:36864
    s_mov_b32 s74, 0
    v_mfma_f32_16x16x32_bf16 v[172:175], a[24:27], v[20:23], v[172:175]
    v_cvt_pk_bf16_f32 v136, v52, v53
    v_cvt_pk_bf16_f32 v137, v54, v55
    v_mfma_f32_16x16x32_bf16 v[52:55], a[0:3], v[12:15], 0
    buffer_load_dwordx4 a[0:3], v252, s[40:43], s74 offen sc1
    v_mfma_f32_16x16x32_bf16 v[52:55], a[24:27], v[24:27], v[52:55]
    v_cvt_pk_bf16_f32 v114, v152, v153
    v_cvt_pk_bf16_f32 v115, v154, v155
    v_mfma_f32_16x16x32_bf16 v[152:155], a[4:7], v[4:7], 0
    ds_read_b128 v[32:35], v242 offset:49152
    v_mfma_f32_16x16x32_bf16 v[152:155], a[28:31], v[16:19], v[152:155]
    v_cvt_pk_bf16_f32 v126, v176, v177
    v_cvt_pk_bf16_f32 v127, v178, v179
    buffer_load_dwordx4 a[24:27], v252, s[40:43], s74 offen offset:1024 sc1
    v_mfma_f32_16x16x32_bf16 v[176:179], a[4:7], v[8:11], 0
    v_mfma_f32_16x16x32_bf16 v[176:179], a[28:31], v[20:23], v[176:179]
    v_cvt_pk_bf16_f32 v138, v56, v57
    v_cvt_pk_bf16_f32 v139, v58, v59
    v_mfma_f32_16x16x32_bf16 v[56:59], a[4:7], v[12:15], 0
    ds_read_b128 v[36:39], v242 offset:61440
    buffer_load_dwordx4 a[4:7], v252, s[40:43], s74 offen offset:2048 sc1
    v_mfma_f32_16x16x32_bf16 v[56:59], a[28:31], v[24:27], v[56:59]
    v_cvt_pk_bf16_f32 v116, v156, v157
    v_cvt_pk_bf16_f32 v117, v158, v159
    v_mfma_f32_16x16x32_bf16 v[156:159], a[8:11], v[4:7], 0
    v_mfma_f32_16x16x32_bf16 v[156:159], a[32:35], v[16:19], v[156:159]
    v_cvt_pk_bf16_f32 v128, v180, v181
    v_cvt_pk_bf16_f32 v129, v182, v183
    buffer_load_dwordx4 a[28:31], v252, s[40:43], s74 offen offset:3072 sc1
    v_mfma_f32_16x16x32_bf16 v[180:183], a[8:11], v[8:11], 0
    ds_read_b128 v[40:43], v243 offset:36864
    s_mov_b32 s75, 4096
    v_mfma_f32_16x16x32_bf16 v[180:183], a[32:35], v[20:23], v[180:183]
    v_cvt_pk_bf16_f32 v140, v60, v61
    v_cvt_pk_bf16_f32 v141, v62, v63
    v_mfma_f32_16x16x32_bf16 v[60:63], a[8:11], v[12:15], 0
    buffer_load_dwordx4 a[8:11], v252, s[40:43], s75 offen sc1
    v_mfma_f32_16x16x32_bf16 v[60:63], a[32:35], v[24:27], v[60:63]
    v_cvt_pk_bf16_f32 v118, v160, v161
    v_cvt_pk_bf16_f32 v119, v162, v163
    v_mfma_f32_16x16x32_bf16 v[160:163], a[12:15], v[4:7], 0
    ds_read_b128 v[44:47], v243 offset:49152
    v_mfma_f32_16x16x32_bf16 v[160:163], a[36:39], v[16:19], v[160:163]
    v_cvt_pk_bf16_f32 v130, v184, v185
    v_cvt_pk_bf16_f32 v131, v186, v187
    buffer_load_dwordx4 a[32:35], v252, s[40:43], s75 offen offset:1024 sc1
    v_mfma_f32_16x16x32_bf16 v[184:187], a[12:15], v[8:11], 0
    v_mfma_f32_16x16x32_bf16 v[184:187], a[36:39], v[20:23], v[184:187]
    v_cvt_pk_bf16_f32 v142, v64, v65
    v_cvt_pk_bf16_f32 v143, v66, v67
    v_mfma_f32_16x16x32_bf16 v[64:67], a[12:15], v[12:15], 0
    ds_read_b128 v[48:51], v243 offset:61440
    buffer_load_dwordx4 a[12:15], v252, s[40:43], s75 offen offset:2048 sc1
    v_mfma_f32_16x16x32_bf16 v[64:67], a[36:39], v[24:27], v[64:67]
    v_cvt_pk_bf16_f32 v120, v164, v165
    v_cvt_pk_bf16_f32 v121, v166, v167
    v_mfma_f32_16x16x32_bf16 v[164:167], a[16:19], v[4:7], 0
    v_mfma_f32_16x16x32_bf16 v[164:167], a[40:43], v[16:19], v[164:167]
    v_cvt_pk_bf16_f32 v132, v188, v189
    v_cvt_pk_bf16_f32 v133, v190, v191
    buffer_load_dwordx4 a[36:39], v252, s[40:43], s75 offen offset:3072 sc1
    v_mfma_f32_16x16x32_bf16 v[188:191], a[16:19], v[8:11], 0
    s_mov_b32 s76, 8192
    v_mfma_f32_16x16x32_bf16 v[188:191], a[40:43], v[20:23], v[188:191]
    v_cvt_pk_bf16_f32 v144, v68, v69
    v_cvt_pk_bf16_f32 v145, v70, v71
    v_mfma_f32_16x16x32_bf16 v[68:71], a[16:19], v[12:15], 0
    buffer_load_dwordx4 a[16:19], v252, s[40:43], s76 offen sc1
    v_mfma_f32_16x16x32_bf16 v[68:71], a[40:43], v[24:27], v[68:71]
    v_cvt_pk_bf16_f32 v122, v168, v169
    v_cvt_pk_bf16_f32 v123, v170, v171
    v_mfma_f32_16x16x32_bf16 v[168:171], a[20:23], v[4:7], 0
    v_mfma_f32_16x16x32_bf16 v[168:171], a[44:47], v[16:19], v[168:171]
    v_cvt_pk_bf16_f32 v134, v192, v193
    v_cvt_pk_bf16_f32 v135, v194, v195
    buffer_load_dwordx4 a[40:43], v252, s[40:43], s76 offen offset:1024 sc1
    v_mfma_f32_16x16x32_bf16 v[192:195], a[20:23], v[8:11], 0
    v_mfma_f32_16x16x32_bf16 v[192:195], a[44:47], v[20:23], v[192:195]
    v_cvt_pk_bf16_f32 v146, v72, v73
    v_cvt_pk_bf16_f32 v147, v74, v75
    v_mfma_f32_16x16x32_bf16 v[72:75], a[20:23], v[12:15], 0
    buffer_load_dwordx4 a[20:23], v252, s[40:43], s76 offen offset:2048 sc1
    v_mfma_f32_16x16x32_bf16 v[72:75], a[44:47], v[24:27], v[72:75]
    s_waitcnt lgkmcnt(0)
    v_mfma_f32_16x16x32_bf16 v[148:151], a[48:51], v[28:31], v[148:151]
    v_mfma_f32_16x16x32_bf16 v[148:151], a[72:75], v[40:43], v[148:151]
    buffer_load_dwordx4 a[44:47], v252, s[40:43], s76 offen offset:3072 sc1
    v_mfma_f32_16x16x32_bf16 v[172:175], a[48:51], v[32:35], v[172:175]
    ds_read_b128 v[4:7], v240 offset:37120
    s_mov_b32 s77, 12288
    v_mfma_f32_16x16x32_bf16 v[172:175], a[72:75], v[44:47], v[172:175]
    v_mfma_f32_16x16x32_bf16 v[52:55], a[48:51], v[36:39], v[52:55]
    buffer_load_dwordx4 a[48:51], v252, s[40:43], s77 offen sc1
    v_mfma_f32_16x16x32_bf16 v[52:55], a[72:75], v[48:51], v[52:55]
    v_mfma_f32_16x16x32_bf16 v[152:155], a[52:55], v[28:31], v[152:155]
    ds_read_b128 v[8:11], v240 offset:49408
    v_mfma_f32_16x16x32_bf16 v[152:155], a[76:79], v[40:43], v[152:155]
    buffer_load_dwordx4 a[72:75], v252, s[40:43], s77 offen offset:1024 sc1
    v_mfma_f32_16x16x32_bf16 v[176:179], a[52:55], v[32:35], v[176:179]
    v_mfma_f32_16x16x32_bf16 v[176:179], a[76:79], v[44:47], v[176:179]
    v_mfma_f32_16x16x32_bf16 v[56:59], a[52:55], v[36:39], v[56:59]
    ds_read_b128 v[12:15], v240 offset:61696
    buffer_load_dwordx4 a[52:55], v252, s[40:43], s77 offen offset:2048 sc1
    v_mfma_f32_16x16x32_bf16 v[56:59], a[76:79], v[48:51], v[56:59]
    v_mfma_f32_16x16x32_bf16 v[156:159], a[56:59], v[28:31], v[156:159]
    v_mfma_f32_16x16x32_bf16 v[156:159], a[80:83], v[40:43], v[156:159]
    buffer_load_dwordx4 a[76:79], v252, s[40:43], s77 offen offset:3072 sc1
    v_mfma_f32_16x16x32_bf16 v[180:183], a[56:59], v[32:35], v[180:183]
    ds_read_b128 v[16:19], v241 offset:37120
    s_mov_b32 s74, 16384
    v_mfma_f32_16x16x32_bf16 v[180:183], a[80:83], v[44:47], v[180:183]
    v_mfma_f32_16x16x32_bf16 v[60:63], a[56:59], v[36:39], v[60:63]
    buffer_load_dwordx4 a[56:59], v252, s[40:43], s74 offen sc1
    v_mfma_f32_16x16x32_bf16 v[60:63], a[80:83], v[48:51], v[60:63]
    v_mfma_f32_16x16x32_bf16 v[160:163], a[60:63], v[28:31], v[160:163]
    ds_read_b128 v[20:23], v241 offset:49408
    v_mfma_f32_16x16x32_bf16 v[160:163], a[84:87], v[40:43], v[160:163]
    buffer_load_dwordx4 a[80:83], v252, s[40:43], s74 offen offset:1024 sc1
    v_mfma_f32_16x16x32_bf16 v[184:187], a[60:63], v[32:35], v[184:187]
    v_mfma_f32_16x16x32_bf16 v[184:187], a[84:87], v[44:47], v[184:187]
    v_mfma_f32_16x16x32_bf16 v[64:67], a[60:63], v[36:39], v[64:67]
    ds_read_b128 v[24:27], v241 offset:61696
    buffer_load_dwordx4 a[60:63], v252, s[40:43], s74 offen offset:2048 sc1
    v_mfma_f32_16x16x32_bf16 v[64:67], a[84:87], v[48:51], v[64:67]
    v_mfma_f32_16x16x32_bf16 v[164:167], a[64:67], v[28:31], v[164:167]
    v_mfma_f32_16x16x32_bf16 v[164:167], a[88:91], v[40:43], v[164:167]
    buffer_load_dwordx4 a[84:87], v252, s[40:43], s74 offen offset:3072 sc1
    v_mfma_f32_16x16x32_bf16 v[188:191], a[64:67], v[32:35], v[188:191]
    s_mov_b32 s75, 20480
    v_mfma_f32_16x16x32_bf16 v[188:191], a[88:91], v[44:47], v[188:191]
    v_mfma_f32_16x16x32_bf16 v[68:71], a[64:67], v[36:39], v[68:71]
    buffer_load_dwordx4 a[64:67], v252, s[40:43], s75 offen sc1
    v_mfma_f32_16x16x32_bf16 v[68:71], a[88:91], v[48:51], v[68:71]
    v_mfma_f32_16x16x32_bf16 v[168:171], a[68:71], v[28:31], v[168:171]
    v_mfma_f32_16x16x32_bf16 v[168:171], a[92:95], v[40:43], v[168:171]
    buffer_load_dwordx4 a[88:91], v252, s[40:43], s75 offen offset:1024 sc1
    v_mfma_f32_16x16x32_bf16 v[192:195], a[68:71], v[32:35], v[192:195]
    v_mfma_f32_16x16x32_bf16 v[192:195], a[92:95], v[44:47], v[192:195]
    v_mfma_f32_16x16x32_bf16 v[72:75], a[68:71], v[36:39], v[72:75]
    buffer_load_dwordx4 a[68:71], v252, s[40:43], s75 offen offset:2048 sc1
    v_mfma_f32_16x16x32_bf16 v[72:75], a[92:95], v[48:51], v[72:75]
    s_waitcnt lgkmcnt(0)
    v_mfma_f32_16x16x32_bf16 v[148:151], a[96:99], v[4:7], v[148:151]
    v_mfma_f32_16x16x32_bf16 v[148:151], a[120:123], v[16:19], v[148:151]
    buffer_load_dwordx4 a[92:95], v252, s[40:43], s75 offen offset:3072 sc1
    v_mfma_f32_16x16x32_bf16 v[172:175], a[96:99], v[8:11], v[172:175]
    ds_read_b128 v[28:31], v242 offset:37120
    s_mov_b32 s76, 24576
    v_mfma_f32_16x16x32_bf16 v[172:175], a[120:123], v[20:23], v[172:175]
    v_mfma_f32_16x16x32_bf16 v[52:55], a[96:99], v[12:15], v[52:55]
    buffer_load_dwordx4 a[96:99], v252, s[40:43], s76 offen sc1
    v_mfma_f32_16x16x32_bf16 v[52:55], a[120:123], v[24:27], v[52:55]
    v_mfma_f32_16x16x32_bf16 v[152:155], a[100:103], v[4:7], v[152:155]
    ds_read_b128 v[32:35], v242 offset:49408
    v_mfma_f32_16x16x32_bf16 v[152:155], a[124:127], v[16:19], v[152:155]
    buffer_load_dwordx4 a[120:123], v252, s[40:43], s76 offen offset:1024 sc1
    v_mfma_f32_16x16x32_bf16 v[176:179], a[100:103], v[8:11], v[176:179]
    v_mfma_f32_16x16x32_bf16 v[176:179], a[124:127], v[20:23], v[176:179]
    v_mfma_f32_16x16x32_bf16 v[56:59], a[100:103], v[12:15], v[56:59]
    ds_read_b128 v[36:39], v242 offset:61696
    buffer_load_dwordx4 a[100:103], v252, s[40:43], s76 offen offset:2048 sc1
    v_mfma_f32_16x16x32_bf16 v[56:59], a[124:127], v[24:27], v[56:59]
    v_mfma_f32_16x16x32_bf16 v[156:159], a[104:107], v[4:7], v[156:159]
    v_mfma_f32_16x16x32_bf16 v[156:159], a[128:131], v[16:19], v[156:159]
    buffer_load_dwordx4 a[124:127], v252, s[40:43], s76 offen offset:3072 sc1
    v_mfma_f32_16x16x32_bf16 v[180:183], a[104:107], v[8:11], v[180:183]
    ds_read_b128 v[40:43], v243 offset:37120
    s_mov_b32 s77, 28672
    v_mfma_f32_16x16x32_bf16 v[180:183], a[128:131], v[20:23], v[180:183]
    v_mfma_f32_16x16x32_bf16 v[60:63], a[104:107], v[12:15], v[60:63]
    buffer_load_dwordx4 a[104:107], v252, s[40:43], s77 offen sc1
    v_mfma_f32_16x16x32_bf16 v[60:63], a[128:131], v[24:27], v[60:63]
    v_mfma_f32_16x16x32_bf16 v[160:163], a[108:111], v[4:7], v[160:163]
    ds_read_b128 v[44:47], v243 offset:49408
    v_mfma_f32_16x16x32_bf16 v[160:163], a[132:135], v[16:19], v[160:163]
    buffer_load_dwordx4 a[128:131], v252, s[40:43], s77 offen offset:1024 sc1
    v_mfma_f32_16x16x32_bf16 v[184:187], a[108:111], v[8:11], v[184:187]
    v_mfma_f32_16x16x32_bf16 v[184:187], a[132:135], v[20:23], v[184:187]
    v_mfma_f32_16x16x32_bf16 v[64:67], a[108:111], v[12:15], v[64:67]
    ds_read_b128 v[48:51], v243 offset:61696
    buffer_load_dwordx4 a[108:111], v252, s[40:43], s77 offen offset:2048 sc1
    v_mfma_f32_16x16x32_bf16 v[64:67], a[132:135], v[24:27], v[64:67]
    v_mfma_f32_16x16x32_bf16 v[164:167], a[112:115], v[4:7], v[164:167]
    v_mfma_f32_16x16x32_bf16 v[164:167], a[136:139], v[16:19], v[164:167]
    buffer_load_dwordx4 a[132:135], v252, s[40:43], s77 offen offset:3072 sc1
    v_mfma_f32_16x16x32_bf16 v[188:191], a[112:115], v[8:11], v[188:191]
    s_mov_b32 s74, 32768
    v_mfma_f32_16x16x32_bf16 v[188:191], a[136:139], v[20:23], v[188:191]
    v_mfma_f32_16x16x32_bf16 v[68:71], a[112:115], v[12:15], v[68:71]
    buffer_load_dwordx4 a[112:115], v252, s[40:43], s74 offen sc1
    v_mfma_f32_16x16x32_bf16 v[68:71], a[136:139], v[24:27], v[68:71]
    v_mfma_f32_16x16x32_bf16 v[168:171], a[116:119], v[4:7], v[168:171]
    v_mfma_f32_16x16x32_bf16 v[168:171], a[140:143], v[16:19], v[168:171]
    buffer_load_dwordx4 a[136:139], v252, s[40:43], s74 offen offset:1024 sc1
    v_mfma_f32_16x16x32_bf16 v[192:195], a[116:119], v[8:11], v[192:195]
    v_mfma_f32_16x16x32_bf16 v[192:195], a[140:143], v[20:23], v[192:195]
    v_mfma_f32_16x16x32_bf16 v[72:75], a[116:119], v[12:15], v[72:75]
    buffer_load_dwordx4 a[116:119], v252, s[40:43], s74 offen offset:2048 sc1
    v_mfma_f32_16x16x32_bf16 v[72:75], a[140:143], v[24:27], v[72:75]
    s_waitcnt lgkmcnt(0)
    v_mfma_f32_16x16x32_bf16 v[148:151], a[144:147], v[28:31], v[148:151]
    v_mfma_f32_16x16x32_bf16 v[148:151], a[168:171], v[40:43], v[148:151]
    buffer_load_dwordx4 a[140:143], v252, s[40:43], s74 offen offset:3072 sc1
    v_mfma_f32_16x16x32_bf16 v[172:175], a[144:147], v[32:35], v[172:175]
    ds_read_b128 v[4:7], v240 offset:37376
    s_mov_b32 s75, 36864
    v_mfma_f32_16x16x32_bf16 v[172:175], a[168:171], v[44:47], v[172:175]
    v_mfma_f32_16x16x32_bf16 v[52:55], a[144:147], v[36:39], v[52:55]
    buffer_load_dwordx4 a[144:147], v252, s[40:43], s75 offen sc1
    v_mfma_f32_16x16x32_bf16 v[52:55], a[168:171], v[48:51], v[52:55]
    v_mfma_f32_16x16x32_bf16 v[152:155], a[148:151], v[28:31], v[152:155]
    ds_read_b128 v[8:11], v240 offset:49664
    v_mfma_f32_16x16x32_bf16 v[152:155], a[172:175], v[40:43], v[152:155]
    buffer_load_dwordx4 a[168:171], v252, s[40:43], s75 offen offset:1024 sc1
    v_mfma_f32_16x16x32_bf16 v[176:179], a[148:151], v[32:35], v[176:179]
    v_mfma_f32_16x16x32_bf16 v[176:179], a[172:175], v[44:47], v[176:179]
    v_mfma_f32_16x16x32_bf16 v[56:59], a[148:151], v[36:39], v[56:59]
    ds_read_b128 v[12:15], v240 offset:61952
    buffer_load_dwordx4 a[148:151], v252, s[40:43], s75 offen offset:2048 sc1
    v_mfma_f32_16x16x32_bf16 v[56:59], a[172:175], v[48:51], v[56:59]
    v_mfma_f32_16x16x32_bf16 v[156:159], a[152:155], v[28:31], v[156:159]
    v_mfma_f32_16x16x32_bf16 v[156:159], a[176:179], v[40:43], v[156:159]
    buffer_load_dwordx4 a[172:175], v252, s[40:43], s75 offen offset:3072 sc1
    v_mfma_f32_16x16x32_bf16 v[180:183], a[152:155], v[32:35], v[180:183]
    ds_read_b128 v[16:19], v241 offset:37376
    s_mov_b32 s76, 40960
    v_mfma_f32_16x16x32_bf16 v[180:183], a[176:179], v[44:47], v[180:183]
    v_mfma_f32_16x16x32_bf16 v[60:63], a[152:155], v[36:39], v[60:63]
    buffer_load_dwordx4 a[152:155], v252, s[40:43], s76 offen sc1
    v_mfma_f32_16x16x32_bf16 v[60:63], a[176:179], v[48:51], v[60:63]
    v_mfma_f32_16x16x32_bf16 v[160:163], a[156:159], v[28:31], v[160:163]
    ds_read_b128 v[20:23], v241 offset:49664
    v_mfma_f32_16x16x32_bf16 v[160:163], a[180:183], v[40:43], v[160:163]
    buffer_load_dwordx4 a[176:179], v252, s[40:43], s76 offen offset:1024 sc1
    v_mfma_f32_16x16x32_bf16 v[184:187], a[156:159], v[32:35], v[184:187]
    v_mfma_f32_16x16x32_bf16 v[184:187], a[180:183], v[44:47], v[184:187]
    v_mfma_f32_16x16x32_bf16 v[64:67], a[156:159], v[36:39], v[64:67]
    ds_read_b128 v[24:27], v241 offset:61952
    buffer_load_dwordx4 a[156:159], v252, s[40:43], s76 offen offset:2048 sc1
    v_mfma_f32_16x16x32_bf16 v[64:67], a[180:183], v[48:51], v[64:67]
    v_mfma_f32_16x16x32_bf16 v[164:167], a[160:163], v[28:31], v[164:167]
    v_mfma_f32_16x16x32_bf16 v[164:167], a[184:187], v[40:43], v[164:167]
    buffer_load_dwordx4 a[180:183], v252, s[40:43], s76 offen offset:3072 sc1
    v_mfma_f32_16x16x32_bf16 v[188:191], a[160:163], v[32:35], v[188:191]
    s_mov_b32 s77, 45056
    v_mfma_f32_16x16x32_bf16 v[188:191], a[184:187], v[44:47], v[188:191]
    v_mfma_f32_16x16x32_bf16 v[68:71], a[160:163], v[36:39], v[68:71]
    buffer_load_dwordx4 a[160:163], v252, s[40:43], s77 offen sc1
    v_mfma_f32_16x16x32_bf16 v[68:71], a[184:187], v[48:51], v[68:71]
    v_mfma_f32_16x16x32_bf16 v[168:171], a[164:167], v[28:31], v[168:171]
    v_mfma_f32_16x16x32_bf16 v[168:171], a[188:191], v[40:43], v[168:171]
    buffer_load_dwordx4 a[184:187], v252, s[40:43], s77 offen offset:1024 sc1
    v_mfma_f32_16x16x32_bf16 v[192:195], a[164:167], v[32:35], v[192:195]
    v_mfma_f32_16x16x32_bf16 v[192:195], a[188:191], v[44:47], v[192:195]
    v_mfma_f32_16x16x32_bf16 v[72:75], a[164:167], v[36:39], v[72:75]
    buffer_load_dwordx4 a[164:167], v252, s[40:43], s77 offen offset:2048 sc1
    v_mfma_f32_16x16x32_bf16 v[72:75], a[188:191], v[48:51], v[72:75]
    s_waitcnt lgkmcnt(0)
    v_mfma_f32_16x16x32_bf16 v[148:151], a[192:195], v[4:7], v[148:151]
    v_mfma_f32_16x16x32_bf16 v[148:151], a[216:219], v[16:19], v[148:151]
    buffer_load_dwordx4 a[188:191], v252, s[40:43], s77 offen offset:3072 sc1
    v_mfma_f32_16x16x32_bf16 v[172:175], a[192:195], v[8:11], v[172:175]
    ds_read_b128 v[28:31], v242 offset:37376
    s_mov_b32 s74, 49152
    v_mfma_f32_16x16x32_bf16 v[172:175], a[216:219], v[20:23], v[172:175]
    v_mfma_f32_16x16x32_bf16 v[52:55], a[192:195], v[12:15], v[52:55]
    buffer_load_dwordx4 a[192:195], v252, s[40:43], s74 offen sc1
    v_mfma_f32_16x16x32_bf16 v[52:55], a[216:219], v[24:27], v[52:55]
    v_mfma_f32_16x16x32_bf16 v[152:155], a[196:199], v[4:7], v[152:155]
    ds_read_b128 v[32:35], v242 offset:49664
    v_mfma_f32_16x16x32_bf16 v[152:155], a[220:223], v[16:19], v[152:155]
    buffer_load_dwordx4 a[216:219], v252, s[40:43], s74 offen offset:1024 sc1
    v_mfma_f32_16x16x32_bf16 v[176:179], a[196:199], v[8:11], v[176:179]
    v_mfma_f32_16x16x32_bf16 v[176:179], a[220:223], v[20:23], v[176:179]
    v_mfma_f32_16x16x32_bf16 v[56:59], a[196:199], v[12:15], v[56:59]
    ds_read_b128 v[36:39], v242 offset:61952
    buffer_load_dwordx4 a[196:199], v252, s[40:43], s74 offen offset:2048 sc1
    v_mfma_f32_16x16x32_bf16 v[56:59], a[220:223], v[24:27], v[56:59]
    v_mfma_f32_16x16x32_bf16 v[156:159], a[200:203], v[4:7], v[156:159]
    v_mfma_f32_16x16x32_bf16 v[156:159], a[224:227], v[16:19], v[156:159]
    buffer_load_dwordx4 a[220:223], v252, s[40:43], s74 offen offset:3072 sc1
    v_mfma_f32_16x16x32_bf16 v[180:183], a[200:203], v[8:11], v[180:183]
    ds_read_b128 v[40:43], v243 offset:37376
    s_mov_b32 s75, 53248
    v_mfma_f32_16x16x32_bf16 v[180:183], a[224:227], v[20:23], v[180:183]
    v_mfma_f32_16x16x32_bf16 v[60:63], a[200:203], v[12:15], v[60:63]
    buffer_load_dwordx4 a[200:203], v252, s[40:43], s75 offen sc1
    v_mfma_f32_16x16x32_bf16 v[60:63], a[224:227], v[24:27], v[60:63]
    v_mfma_f32_16x16x32_bf16 v[160:163], a[204:207], v[4:7], v[160:163]
    ds_read_b128 v[44:47], v243 offset:49664
    v_mfma_f32_16x16x32_bf16 v[160:163], a[228:231], v[16:19], v[160:163]
    buffer_load_dwordx4 a[224:227], v252, s[40:43], s75 offen offset:1024 sc1
    v_mfma_f32_16x16x32_bf16 v[184:187], a[204:207], v[8:11], v[184:187]
    v_mfma_f32_16x16x32_bf16 v[184:187], a[228:231], v[20:23], v[184:187]
    v_mfma_f32_16x16x32_bf16 v[64:67], a[204:207], v[12:15], v[64:67]
    ds_read_b128 v[48:51], v243 offset:61952
    buffer_load_dwordx4 a[204:207], v252, s[40:43], s75 offen offset:2048 sc1
    v_mfma_f32_16x16x32_bf16 v[64:67], a[228:231], v[24:27], v[64:67]
    v_mfma_f32_16x16x32_bf16 v[164:167], a[208:211], v[4:7], v[164:167]
    v_mfma_f32_16x16x32_bf16 v[164:167], a[232:235], v[16:19], v[164:167]
    buffer_load_dwordx4 a[228:231], v252, s[40:43], s75 offen offset:3072 sc1
    v_mfma_f32_16x16x32_bf16 v[188:191], a[208:211], v[8:11], v[188:191]
    s_mov_b32 s76, 57344
    v_mfma_f32_16x16x32_bf16 v[188:191], a[232:235], v[20:23], v[188:191]
    v_mfma_f32_16x16x32_bf16 v[68:71], a[208:211], v[12:15], v[68:71]
    buffer_load_dwordx4 a[208:211], v252, s[40:43], s76 offen sc1
    v_mfma_f32_16x16x32_bf16 v[68:71], a[232:235], v[24:27], v[68:71]
    v_mfma_f32_16x16x32_bf16 v[168:171], a[212:215], v[4:7], v[168:171]
    v_mfma_f32_16x16x32_bf16 v[168:171], a[236:239], v[16:19], v[168:171]
    buffer_load_dwordx4 a[232:235], v252, s[40:43], s76 offen offset:1024 sc1
    v_mfma_f32_16x16x32_bf16 v[192:195], a[212:215], v[8:11], v[192:195]
    v_mfma_f32_16x16x32_bf16 v[192:195], a[236:239], v[20:23], v[192:195]
    v_mfma_f32_16x16x32_bf16 v[72:75], a[212:215], v[12:15], v[72:75]
    buffer_load_dwordx4 a[212:215], v252, s[40:43], s76 offen offset:2048 sc1
    v_mfma_f32_16x16x32_bf16 v[72:75], a[236:239], v[24:27], v[72:75]
    s_waitcnt vmcnt(59) lgkmcnt(0)
    s_barrier
    v_mfma_f32_16x16x32_bf16 v[148:151], a[240:243], v[28:31], v[148:151]
    v_mfma_f32_16x16x32_bf16 v[148:151], v[204:207], v[40:43], v[148:151]
    buffer_load_dwordx4 a[236:239], v252, s[40:43], s76 offen offset:3072 sc1
    v_mfma_f32_16x16x32_bf16 v[172:175], a[240:243], v[32:35], v[172:175]
    s_mov_b32 s77, 61440
    v_mfma_f32_16x16x32_bf16 v[172:175], v[204:207], v[44:47], v[172:175]
    v_mfma_f32_16x16x32_bf16 v[52:55], a[240:243], v[36:39], v[52:55]
    buffer_load_dwordx4 a[240:243], v252, s[40:43], s77 offen sc1
    v_mfma_f32_16x16x32_bf16 v[52:55], v[204:207], v[48:51], v[52:55]
    v_mfma_f32_16x16x32_bf16 v[152:155], a[244:247], v[28:31], v[152:155]
    v_mfma_f32_16x16x32_bf16 v[152:155], v[208:211], v[40:43], v[152:155]
    buffer_load_dwordx4 v[204:207], v252, s[40:43], s77 offen offset:1024 sc1
    v_mfma_f32_16x16x32_bf16 v[176:179], a[244:247], v[32:35], v[176:179]
    v_mfma_f32_16x16x32_bf16 v[176:179], v[208:211], v[44:47], v[176:179]
    v_mfma_f32_16x16x32_bf16 v[56:59], a[244:247], v[36:39], v[56:59]
    buffer_load_dwordx4 a[244:247], v252, s[40:43], s77 offen offset:2048 sc1
    v_mfma_f32_16x16x32_bf16 v[56:59], v[208:211], v[48:51], v[56:59]
    v_mfma_f32_16x16x32_bf16 v[156:159], a[248:251], v[28:31], v[156:159]
    v_mfma_f32_16x16x32_bf16 v[156:159], v[212:215], v[40:43], v[156:159]
    buffer_load_dwordx4 v[208:211], v252, s[40:43], s77 offen offset:3072 sc1
    v_mfma_f32_16x16x32_bf16 v[180:183], a[248:251], v[32:35], v[180:183]
    s_mov_b32 s74, 65536
    v_mfma_f32_16x16x32_bf16 v[180:183], v[212:215], v[44:47], v[180:183]
    v_mfma_f32_16x16x32_bf16 v[60:63], a[248:251], v[36:39], v[60:63]
    buffer_load_dwordx4 a[248:251], v252, s[40:43], s74 offen sc1
    v_mfma_f32_16x16x32_bf16 v[60:63], v[212:215], v[48:51], v[60:63]
    v_mfma_f32_16x16x32_bf16 v[160:163], a[252:255], v[28:31], v[160:163]
    v_mfma_f32_16x16x32_bf16 v[160:163], v[216:219], v[40:43], v[160:163]
    buffer_load_dwordx4 v[212:215], v252, s[40:43], s74 offen offset:1024 sc1
    v_mfma_f32_16x16x32_bf16 v[184:187], a[252:255], v[32:35], v[184:187]
    v_mfma_f32_16x16x32_bf16 v[184:187], v[216:219], v[44:47], v[184:187]
    v_mfma_f32_16x16x32_bf16 v[64:67], a[252:255], v[36:39], v[64:67]
    buffer_load_dwordx4 a[252:255], v252, s[40:43], s74 offen offset:2048 sc1
    v_mfma_f32_16x16x32_bf16 v[64:67], v[216:219], v[48:51], v[64:67]
    v_mfma_f32_16x16x32_bf16 v[164:167], v[196:199], v[28:31], v[164:167]
    v_mfma_f32_16x16x32_bf16 v[164:167], v[220:223], v[40:43], v[164:167]
    buffer_load_dwordx4 v[216:219], v252, s[40:43], s74 offen offset:3072 sc1
    v_mfma_f32_16x16x32_bf16 v[188:191], v[196:199], v[32:35], v[188:191]
    s_mov_b32 s75, 69632
    v_mfma_f32_16x16x32_bf16 v[188:191], v[220:223], v[44:47], v[188:191]
    v_mfma_f32_16x16x32_bf16 v[68:71], v[196:199], v[36:39], v[68:71]
    buffer_load_dwordx4 v[196:199], v252, s[40:43], s75 offen sc1
    v_mfma_f32_16x16x32_bf16 v[68:71], v[220:223], v[48:51], v[68:71]
    v_mfma_f32_16x16x32_bf16 v[168:171], v[200:203], v[28:31], v[168:171]
    v_mfma_f32_16x16x32_bf16 v[168:171], v[224:227], v[40:43], v[168:171]
    buffer_load_dwordx4 v[220:223], v252, s[40:43], s75 offen offset:1024 sc1
    v_mfma_f32_16x16x32_bf16 v[192:195], v[200:203], v[32:35], v[192:195]
    v_mfma_f32_16x16x32_bf16 v[192:195], v[224:227], v[44:47], v[192:195]
    v_mfma_f32_16x16x32_bf16 v[72:75], v[200:203], v[36:39], v[72:75]
    buffer_load_dwordx4 v[200:203], v252, s[40:43], s75 offen offset:2048 sc1
    v_mfma_f32_16x16x32_bf16 v[72:75], v[224:227], v[48:51], v[72:75]
    buffer_load_dwordx4 v[224:227], v252, s[40:43], s75 offen offset:3072 sc1
L_postd:
    ds_read_b128 v[4:7], v228 offset:0
    ds_read_b128 v[8:11], v229 offset:0
    ds_read_b128 v[12:15], v230 offset:0
    ds_read_b128 v[16:19], v231 offset:0
    ds_read_b128 v[20:23], v228 offset:256
    ds_read_b128 v[24:27], v229 offset:256
    ds_read_b128 v[28:31], v230 offset:256
    ds_read_b128 v[32:35], v231 offset:256
    ds_read_b128 v[36:39], v228 offset:512
    ds_read_b128 v[40:43], v229 offset:512
    ds_read_b128 v[44:47], v230 offset:512
    ds_read_b128 v[48:51], v231 offset:512
    v_cvt_pk_bf16_f32 v148, v148, v149
    v_cvt_pk_bf16_f32 v149, v150, v151
    v_cvt_pk_bf16_f32 v150, v152, v153
    v_cvt_pk_bf16_f32 v151, v154, v155
    v_cvt_pk_bf16_f32 v152, v156, v157
    v_cvt_pk_bf16_f32 v153, v158, v159
    v_cvt_pk_bf16_f32 v154, v160, v161
    v_cvt_pk_bf16_f32 v155, v162, v163
    v_cvt_pk_bf16_f32 v156, v164, v165
    v_cvt_pk_bf16_f32 v157, v166, v167
    v_cvt_pk_bf16_f32 v158, v168, v169
    v_cvt_pk_bf16_f32 v159, v170, v171
    v_cvt_pk_bf16_f32 v160, v172, v173
    v_cvt_pk_bf16_f32 v161, v174, v175
    v_cvt_pk_bf16_f32 v162, v176, v177
    v_cvt_pk_bf16_f32 v163, v178, v179
    v_cvt_pk_bf16_f32 v164, v180, v181
    v_cvt_pk_bf16_f32 v165, v182, v183
    v_cvt_pk_bf16_f32 v166, v184, v185
    v_cvt_pk_bf16_f32 v167, v186, v187
    v_cvt_pk_bf16_f32 v168, v188, v189
    v_cvt_pk_bf16_f32 v169, v190, v191
    v_cvt_pk_bf16_f32 v170, v192, v193
    v_cvt_pk_bf16_f32 v171, v194, v195
    v_cvt_pk_bf16_f32 v172, v52, v53
    v_cvt_pk_bf16_f32 v173, v54, v55
    v_cvt_pk_bf16_f32 v174, v56, v57
    v_cvt_pk_bf16_f32 v175, v58, v59
    v_cvt_pk_bf16_f32 v176, v60, v61
    v_cvt_pk_bf16_f32 v177, v62, v63
    v_cvt_pk_bf16_f32 v178, v64, v65
    v_cvt_pk_bf16_f32 v179, v66, v67
    v_cvt_pk_bf16_f32 v180, v68, v69
    v_cvt_pk_bf16_f32 v181, v70, v71
    v_cvt_pk_bf16_f32 v182, v72, v73
    v_cvt_pk_bf16_f32 v183, v74, v75
    v_lshlrev_b32 v184, 16, v76
    v_and_b32 v185, s59, v76
    v_lshlrev_b32 v186, 16, v77
    v_and_b32 v187, s59, v77
    v_lshlrev_b32 v188, 16, v78
    v_and_b32 v189, s59, v78
    v_lshlrev_b32 v190, 16, v79
    v_and_b32 v191, s59, v79
    v_lshlrev_b32 v192, 16, v80
    v_and_b32 v193, s59, v80
    v_lshlrev_b32 v194, 16, v81
    v_and_b32 v195, s59, v81
    v_lshlrev_b32 v76, 16, v82
    v_and_b32 v77, s59, v82
    v_lshlrev_b32 v78, 16, v83
    v_and_b32 v79, s59, v83
    s_waitcnt vmcnt(0)
    s_waitcnt lgkmcnt(0)
.p2align 6
L_p2:
    s_waitcnt lgkmcnt(10)
    v_mfma_f32_16x16x32_bf16 v[52:55], a[0:3], v[4:7], v[184:187]
    v_mfma_f32_16x16x32_bf16 v[52:55], a[24:27], v[8:11], v[52:55]
    v_mfma_f32_16x16x32_bf16 v[52:55], a[48:51], v[12:15], v[52:55]
    s_waitcnt lgkmcnt(6)
    v_mfma_f32_16x16x32_bf16 v[52:55], a[72:75], v[16:19], v[52:55]
    v_cvt_pk_bf16_f32 v0, v68, v69
    v_cvt_pk_bf16_f32 v1, v70, v71
    v_mfma_f32_16x16x32_bf16 v[52:55], a[96:99], v[20:23], v[52:55]
    v_mfma_f32_16x16x32_bf16 v[52:55], a[120:123], v[24:27], v[52:55]
    s_waitcnt lgkmcnt(3)
    v_mfma_f32_16x16x32_bf16 v[52:55], a[144:147], v[28:31], v[52:55]
    v_mfma_f32_16x16x32_bf16 v[52:55], a[168:171], v[32:35], v[52:55]
    v_mfma_f32_16x16x32_bf16 v[52:55], a[192:195], v[36:39], v[52:55]
    s_waitcnt lgkmcnt(0)
    v_mfma_f32_16x16x32_bf16 v[52:55], a[216:219], v[40:43], v[52:55]
    v_cvt_pk_bf16_f32 v2, v72, v73
    v_cvt_pk_bf16_f32 v3, v74, v75
    v_mfma_f32_16x16x32_bf16 v[52:55], a[240:243], v[44:47], v[52:55]
    ds_write_b128 v237, v[0:3] offset:36864
    v_mfma_f32_16x16x32_bf16 v[52:55], v[204:207], v[48:51], v[52:55]
    v_mfma_f32_16x16x32_bf16 v[56:59], a[4:7], v[4:7], v[188:191]
    s_add_u32 s55, s81, 294912
    v_mfma_f32_16x16x32_bf16 v[56:59], a[28:31], v[8:11], v[56:59]
    s_add_u32 m0, s82, 24576
    v_mfma_f32_16x16x32_bf16 v[56:59], a[52:55], v[12:15], v[56:59]
    buffer_load_dwordx4 v232, s[20:23], s55 offen nt lds
    v_mfma_f32_16x16x32_bf16 v[56:59], a[76:79], v[16:19], v[56:59]
    v_mfma_f32_16x16x32_bf16 v[56:59], a[100:103], v[20:23], v[56:59]
    v_mfma_f32_16x16x32_bf16 v[56:59], a[124:127], v[24:27], v[56:59]
    buffer_load_dwordx4 v233, s[20:23], s55 offen offset:1024 nt lds
    v_mfma_f32_16x16x32_bf16 v[56:59], a[148:151], v[28:31], v[56:59]
    v_mfma_f32_16x16x32_bf16 v[56:59], a[172:175], v[32:35], v[56:59]
    v_mfma_f32_16x16x32_bf16 v[56:59], a[196:199], v[36:39], v[56:59]
    buffer_load_dwordx4 v234, s[20:23], s55 offen offset:2048 nt lds
    v_mfma_f32_16x16x32_bf16 v[56:59], a[220:223], v[40:43], v[56:59]
    s_cbranch_vccz L_lo0
    s_waitcnt vmcnt(6)
L_lo0:
    v_cvt_pk_bf16_f32 v0, v52, v53
    v_cvt_pk_bf16_f32 v1, v54, v55
    v_mfma_f32_16x16x32_bf16 v[56:59], a[244:247], v[44:47], v[56:59]
    s_set_gpr_idx_on s54, gpr_idx(SRC0)
    v_mov_b64 v[252:253], v[84:85]
    v_mov_b64 v[254:255], v[86:87]
    s_set_gpr_idx_off
    v_mfma_f32_16x16x32_bf16 v[56:59], v[208:211], v[48:51], v[56:59]
    v_lshlrev_b32 v80, 16, v252
    v_and_b32 v81, s59, v252
    v_mfma_f32_16x16x32_bf16 v[60:63], a[8:11], v[4:7], v[192:195]
    v_lshlrev_b32 v82, 16, v253
    v_and_b32 v83, s59, v253
    v_mfma_f32_16x16x32_bf16 v[60:63], a[32:35], v[8:11], v[60:63]
    v_lshlrev_b32 v84, 16, v254
    v_and_b32 v85, s59, v254
    v_mfma_f32_16x16x32_bf16 v[60:63], a[56:59], v[12:15], v[60:63]
    v_lshlrev_b32 v86, 16, v255
    v_and_b32 v87, s59, v255
    v_mfma_f32_16x16x32_bf16 v[60:63], a[80:83], v[16:19], v[60:63]
    v_mfma_f32_16x16x32_bf16 v[60:63], a[104:107], v[20:23], v[60:63]
    v_mfma_f32_16x16x32_bf16 v[60:63], a[128:131], v[24:27], v[60:63]
    v_mfma_f32_16x16x32_bf16 v[60:63], a[152:155], v[28:31], v[60:63]
    v_mfma_f32_16x16x32_bf16 v[60:63], a[176:179], v[32:35], v[60:63]
    s_cmp_eq_u32 s65, 0
    s_cbranch_scc1 L_md0
    s_waitcnt vmcnt(6)
L_md0:
    v_mfma_f32_16x16x32_bf16 v[60:63], a[200:203], v[36:39], v[60:63]
    v_cvt_pk_bf16_f32 v2, v56, v57
    v_cvt_pk_bf16_f32 v3, v58, v59
    v_mfma_f32_16x16x32_bf16 v[60:63], a[224:227], v[40:43], v[60:63]
    ds_write_b128 v235, v[0:3] offset:0
    v_mfma_f32_16x16x32_bf16 v[60:63], a[248:251], v[44:47], v[60:63]
    v_mfma_f32_16x16x32_bf16 v[60:63], v[212:215], v[48:51], v[60:63]
    v_mfma_f32_16x16x32_bf16 v[64:67], a[12:15], v[4:7], v[76:79]
    v_mfma_f32_16x16x32_bf16 v[64:67], a[36:39], v[8:11], v[64:67]
    v_mfma_f32_16x16x32_bf16 v[64:67], a[60:63], v[12:15], v[64:67]
    v_mfma_f32_16x16x32_bf16 v[64:67], a[84:87], v[16:19], v[64:67]
    v_mfma_f32_16x16x32_bf16 v[64:67], a[108:111], v[20:23], v[64:67]
    v_mfma_f32_16x16x32_bf16 v[64:67], a[132:135], v[24:27], v[64:67]
    v_mfma_f32_16x16x32_bf16 v[64:67], a[156:159], v[28:31], v[64:67]
    v_mfma_f32_16x16x32_bf16 v[64:67], a[180:183], v[32:35], v[64:67]
    v_mfma_f32_16x16x32_bf16 v[64:67], a[204:207], v[36:39], v[64:67]
    v_cvt_pk_bf16_f32 v0, v60, v61
    v_cvt_pk_bf16_f32 v1, v62, v63
    v_mfma_f32_16x16x32_bf16 v[64:67], a[228:231], v[40:43], v[64:67]
    v_mfma_f32_16x16x32_bf16 v[64:67], a[252:255], v[44:47], v[64:67]
    v_mfma_f32_16x16x32_bf16 v[64:67], v[216:219], v[48:51], v[64:67]
    v_mfma_f32_16x16x32_bf16 v[68:71], a[16:19], v[4:7], v[80:83]
    v_mfma_f32_16x16x32_bf16 v[68:71], a[40:43], v[8:11], v[68:71]
    s_waitcnt vmcnt(6) lgkmcnt(1)
    s_barrier
    v_mfma_f32_16x16x32_bf16 v[68:71], a[64:67], v[12:15], v[68:71]
    ds_read_b128 v[240:243], v238 offset:36864
    v_mfma_f32_16x16x32_bf16 v[68:71], a[88:91], v[16:19], v[68:71]
    ds_read_b128 v[244:247], v238 offset:37888
    v_mfma_f32_16x16x32_bf16 v[68:71], a[112:115], v[20:23], v[68:71]
    v_mfma_f32_16x16x32_bf16 v[68:71], a[136:139], v[24:27], v[68:71]
    v_mfma_f32_16x16x32_bf16 v[72:75], a[20:23], v[4:7], v[84:87]
    ds_read_b128 v[4:7], v228 offset:12288
    v_mfma_f32_16x16x32_bf16 v[72:75], a[44:47], v[8:11], v[72:75]
    ds_read_b128 v[248:251], v238 offset:38912
    v_mfma_f32_16x16x32_bf16 v[72:75], a[68:71], v[12:15], v[72:75]
    ds_read_b128 v[8:11], v229 offset:12288
    v_mfma_f32_16x16x32_bf16 v[72:75], a[92:95], v[16:19], v[72:75]
    v_cvt_pk_bf16_f32 v2, v64, v65
    v_cvt_pk_bf16_f32 v3, v66, v67
    v_mfma_f32_16x16x32_bf16 v[72:75], a[116:119], v[20:23], v[72:75]
    ds_read_b128 v[12:15], v230 offset:12288
    v_mfma_f32_16x16x32_bf16 v[72:75], a[140:143], v[24:27], v[72:75]
    ds_write_b128 v236, v[0:3] offset:0
    v_mfma_f32_16x16x32_bf16 v[68:71], a[160:163], v[28:31], v[68:71]
    ds_read_b128 v[16:19], v231 offset:12288
    v_mfma_f32_16x16x32_bf16 v[68:71], a[184:187], v[32:35], v[68:71]
    v_mfma_f32_16x16x32_bf16 v[68:71], a[208:211], v[36:39], v[68:71]
    s_waitcnt lgkmcnt(7)
    buffer_store_dwordx4 v[240:243], v232, s[36:39], s56 offen sc1
    ds_read_b128 v[20:23], v228 offset:12544
    v_mfma_f32_16x16x32_bf16 v[68:71], a[232:235], v[40:43], v[68:71]
    v_mfma_f32_16x16x32_bf16 v[68:71], v[196:199], v[44:47], v[68:71]
    ds_read_b128 v[24:27], v229 offset:12544
    v_mfma_f32_16x16x32_bf16 v[68:71], v[220:223], v[48:51], v[68:71]
    v_mfma_f32_16x16x32_bf16 v[72:75], a[164:167], v[28:31], v[72:75]
    s_waitcnt lgkmcnt(8)
    buffer_store_dwordx4 v[244:247], v233, s[36:39], s56 offen offset:1024 sc1
    ds_read_b128 v[28:31], v230 offset:12544
    v_mfma_f32_16x16x32_bf16 v[72:75], a[188:191], v[32:35], v[72:75]
    ds_read_b128 v[32:35], v231 offset:12544
    v_mfma_f32_16x16x32_bf16 v[72:75], a[212:215], v[36:39], v[72:75]
    ds_read_b128 v[36:39], v228 offset:12800
    v_mfma_f32_16x16x32_bf16 v[72:75], a[236:239], v[40:43], v[72:75]
    ds_read_b128 v[40:43], v229 offset:12800
    v_mfma_f32_16x16x32_bf16 v[72:75], v[200:203], v[44:47], v[72:75]
    s_waitcnt lgkmcnt(10)
    buffer_store_dwordx4 v[248:251], v234, s[36:39], s56 offen offset:2048 sc1
    s_add_u32 s56, s78, 0
    ds_read_b128 v[44:47], v230 offset:12800
    v_mfma_f32_16x16x32_bf16 v[72:75], v[224:227], v[48:51], v[72:75]
    ds_read_b128 v[48:51], v231 offset:12800
    s_waitcnt lgkmcnt(10)
    v_mfma_f32_16x16x32_bf16 v[52:55], a[0:3], v[4:7], v[184:187]
    v_mfma_f32_16x16x32_bf16 v[52:55], a[24:27], v[8:11], v[52:55]
    v_mfma_f32_16x16x32_bf16 v[52:55], a[48:51], v[12:15], v[52:55]
    s_waitcnt lgkmcnt(6)
    v_mfma_f32_16x16x32_bf16 v[52:55], a[72:75], v[16:19], v[52:55]
    v_cvt_pk_bf16_f32 v0, v68, v69
    v_cvt_pk_bf16_f32 v1, v70, v71
    v_mfma_f32_16x16x32_bf16 v[52:55], a[96:99], v[20:23], v[52:55]
    v_mfma_f32_16x16x32_bf16 v[52:55], a[120:123], v[24:27], v[52:55]
    s_waitcnt lgkmcnt(3)
    v_mfma_f32_16x16x32_bf16 v[52:55], a[144:147], v[28:31], v[52:55]
    v_mfma_f32_16x16x32_bf16 v[52:55], a[168:171], v[32:35], v[52:55]
    v_mfma_f32_16x16x32_bf16 v[52:55], a[192:195], v[36:39], v[52:55]
    s_waitcnt lgkmcnt(0)
    v_mfma_f32_16x16x32_bf16 v[52:55], a[216:219], v[40:43], v[52:55]
    v_cvt_pk_bf16_f32 v2, v72, v73
    v_cvt_pk_bf16_f32 v3, v74, v75
    v_mfma_f32_16x16x32_bf16 v[52:55], a[240:243], v[44:47], v[52:55]
    ds_write_b128 v237, v[0:3] offset:0
    v_mfma_f32_16x16x32_bf16 v[52:55], v[204:207], v[48:51], v[52:55]
    v_mfma_f32_16x16x32_bf16 v[56:59], a[4:7], v[4:7], v[188:191]
    s_add_u32 s55, s81, 295680
    v_mfma_f32_16x16x32_bf16 v[56:59], a[28:31], v[8:11], v[56:59]
    s_add_u32 m0, s82, 36864
    v_mfma_f32_16x16x32_bf16 v[56:59], a[52:55], v[12:15], v[56:59]
    buffer_load_dwordx4 v232, s[20:23], s55 offen nt lds
    v_mfma_f32_16x16x32_bf16 v[56:59], a[76:79], v[16:19], v[56:59]
    v_mfma_f32_16x16x32_bf16 v[56:59], a[100:103], v[20:23], v[56:59]
    v_mfma_f32_16x16x32_bf16 v[56:59], a[124:127], v[24:27], v[56:59]
    buffer_load_dwordx4 v233, s[20:23], s55 offen offset:1024 nt lds
    v_mfma_f32_16x16x32_bf16 v[56:59], a[148:151], v[28:31], v[56:59]
    v_mfma_f32_16x16x32_bf16 v[56:59], a[172:175], v[32:35], v[56:59]
    v_mfma_f32_16x16x32_bf16 v[56:59], a[196:199], v[36:39], v[56:59]
    buffer_load_dwordx4 v234, s[20:23], s55 offen offset:2048 nt lds
    v_mfma_f32_16x16x32_bf16 v[56:59], a[220:223], v[40:43], v[56:59]
    s_cbranch_vccz L_lo1
    s_waitcnt vmcnt(6)
L_lo1:
    v_cvt_pk_bf16_f32 v0, v52, v53
    v_cvt_pk_bf16_f32 v1, v54, v55
    v_mfma_f32_16x16x32_bf16 v[56:59], a[244:247], v[44:47], v[56:59]
    v_mfma_f32_16x16x32_bf16 v[56:59], v[208:211], v[48:51], v[56:59]
    s_add_u32 s54, s54, 12
    v_mfma_f32_16x16x32_bf16 v[60:63], a[8:11], v[4:7], v[192:195]
    v_mfma_f32_16x16x32_bf16 v[60:63], a[32:35], v[8:11], v[60:63]
    v_mfma_f32_16x16x32_bf16 v[60:63], a[56:59], v[12:15], v[60:63]
    v_mfma_f32_16x16x32_bf16 v[60:63], a[80:83], v[16:19], v[60:63]
    v_mfma_f32_16x16x32_bf16 v[60:63], a[104:107], v[20:23], v[60:63]
    v_mfma_f32_16x16x32_bf16 v[60:63], a[128:131], v[24:27], v[60:63]
    v_mfma_f32_16x16x32_bf16 v[60:63], a[152:155], v[28:31], v[60:63]
    v_mfma_f32_16x16x32_bf16 v[60:63], a[176:179], v[32:35], v[60:63]
    s_cmp_eq_u32 s65, 0
    s_cbranch_scc1 L_md1
    s_waitcnt vmcnt(6)
L_md1:
    v_mfma_f32_16x16x32_bf16 v[60:63], a[200:203], v[36:39], v[60:63]
    v_cvt_pk_bf16_f32 v2, v56, v57
    v_cvt_pk_bf16_f32 v3, v58, v59
    v_mfma_f32_16x16x32_bf16 v[60:63], a[224:227], v[40:43], v[60:63]
    ds_write_b128 v235, v[0:3] offset:12288
    v_mfma_f32_16x16x32_bf16 v[60:63], a[248:251], v[44:47], v[60:63]
    v_mfma_f32_16x16x32_bf16 v[60:63], v[212:215], v[48:51], v[60:63]
    v_mfma_f32_16x16x32_bf16 v[64:67], a[12:15], v[4:7], v[76:79]
    s_cmp_eq_u32 s19, s85
    s_cselect_b32 s57, 99, s19
    v_mfma_f32_16x16x32_bf16 v[64:67], a[36:39], v[8:11], v[64:67]
    s_cmp_lt_u32 s57, 9
    s_cselect_b32 s81, s79, 2147483648
    s_cselect_b32 s82, s49, 163840
    v_mfma_f32_16x16x32_bf16 v[64:67], a[60:63], v[12:15], v[64:67]
    v_mfma_f32_16x16x32_bf16 v[64:67], a[84:87], v[16:19], v[64:67]
    v_mfma_f32_16x16x32_bf16 v[64:67], a[108:111], v[20:23], v[64:67]
    v_mfma_f32_16x16x32_bf16 v[64:67], a[132:135], v[24:27], v[64:67]
    v_mfma_f32_16x16x32_bf16 v[64:67], a[156:159], v[28:31], v[64:67]
    v_mfma_f32_16x16x32_bf16 v[64:67], a[180:183], v[32:35], v[64:67]
    v_mfma_f32_16x16x32_bf16 v[64:67], a[204:207], v[36:39], v[64:67]
    v_cvt_pk_bf16_f32 v0, v60, v61
    v_cvt_pk_bf16_f32 v1, v62, v63
    v_mfma_f32_16x16x32_bf16 v[64:67], a[228:231], v[40:43], v[64:67]
    v_mfma_f32_16x16x32_bf16 v[64:67], a[252:255], v[44:47], v[64:67]
    v_mfma_f32_16x16x32_bf16 v[64:67], v[216:219], v[48:51], v[64:67]
    v_mfma_f32_16x16x32_bf16 v[68:71], a[16:19], v[4:7], v[80:83]
    v_mfma_f32_16x16x32_bf16 v[68:71], a[40:43], v[8:11], v[68:71]
    s_waitcnt vmcnt(6) lgkmcnt(1)
    s_barrier
    v_mfma_f32_16x16x32_bf16 v[68:71], a[64:67], v[12:15], v[68:71]
    ds_read_b128 v[240:243], v238 offset:0
    v_mfma_f32_16x16x32_bf16 v[68:71], a[88:91], v[16:19], v[68:71]
    ds_read_b128 v[244:247], v238 offset:1024
    v_mfma_f32_16x16x32_bf16 v[68:71], a[112:115], v[20:23], v[68:71]
    v_mfma_f32_16x16x32_bf16 v[68:71], a[136:139], v[24:27], v[68:71]
    v_mfma_f32_16x16x32_bf16 v[72:75], a[20:23], v[4:7], v[84:87]
    ds_read_b128 v[4:7], v228 offset:24576
    v_mfma_f32_16x16x32_bf16 v[72:75], a[44:47], v[8:11], v[72:75]
    ds_read_b128 v[248:251], v238 offset:2048
    v_mfma_f32_16x16x32_bf16 v[72:75], a[68:71], v[12:15], v[72:75]
    ds_read_b128 v[8:11], v229 offset:24576
    v_mfma_f32_16x16x32_bf16 v[72:75], a[92:95], v[16:19], v[72:75]
    v_cvt_pk_bf16_f32 v2, v64, v65
    v_cvt_pk_bf16_f32 v3, v66, v67
    v_mfma_f32_16x16x32_bf16 v[72:75], a[116:119], v[20:23], v[72:75]
    ds_read_b128 v[12:15], v230 offset:24576
    v_mfma_f32_16x16x32_bf16 v[72:75], a[140:143], v[24:27], v[72:75]
    ds_write_b128 v236, v[0:3] offset:12288
    v_mfma_f32_16x16x32_bf16 v[68:71], a[160:163], v[28:31], v[68:71]
    ds_read_b128 v[16:19], v231 offset:24576
    v_mfma_f32_16x16x32_bf16 v[68:71], a[184:187], v[32:35], v[68:71]
    v_mfma_f32_16x16x32_bf16 v[68:71], a[208:211], v[36:39], v[68:71]
    s_waitcnt lgkmcnt(7)
    buffer_store_dwordx4 v[240:243], v232, s[36:39], s56 offen sc1
    ds_read_b128 v[20:23], v228 offset:24832
    v_mfma_f32_16x16x32_bf16 v[68:71], a[232:235], v[40:43], v[68:71]
    v_mfma_f32_16x16x32_bf16 v[68:71], v[196:199], v[44:47], v[68:71]
    ds_read_b128 v[24:27], v229 offset:24832
    v_mfma_f32_16x16x32_bf16 v[68:71], v[220:223], v[48:51], v[68:71]
    v_mfma_f32_16x16x32_bf16 v[72:75], a[164:167], v[28:31], v[72:75]
    s_waitcnt lgkmcnt(8)
    buffer_store_dwordx4 v[244:247], v233, s[36:39], s56 offen offset:1024 sc1
    ds_read_b128 v[28:31], v230 offset:24832
    v_mfma_f32_16x16x32_bf16 v[72:75], a[188:191], v[32:35], v[72:75]
    ds_read_b128 v[32:35], v231 offset:24832
    v_mfma_f32_16x16x32_bf16 v[72:75], a[212:215], v[36:39], v[72:75]
    ds_read_b128 v[36:39], v228 offset:25088
    v_mfma_f32_16x16x32_bf16 v[72:75], a[236:239], v[40:43], v[72:75]
    ds_read_b128 v[40:43], v229 offset:25088
    v_mfma_f32_16x16x32_bf16 v[72:75], v[200:203], v[44:47], v[72:75]
    s_waitcnt lgkmcnt(10)
    buffer_store_dwordx4 v[248:251], v234, s[36:39], s56 offen offset:2048 sc1
    s_add_u32 s56, s78, 768
    ds_read_b128 v[44:47], v230 offset:25088
    v_mfma_f32_16x16x32_bf16 v[72:75], v[224:227], v[48:51], v[72:75]
    ds_read_b128 v[48:51], v231 offset:25088
    s_waitcnt lgkmcnt(10)
    v_mfma_f32_16x16x32_bf16 v[52:55], a[0:3], v[4:7], v[184:187]
    v_mfma_f32_16x16x32_bf16 v[52:55], a[24:27], v[8:11], v[52:55]
    v_mfma_f32_16x16x32_bf16 v[52:55], a[48:51], v[12:15], v[52:55]
    s_waitcnt lgkmcnt(6)
    v_mfma_f32_16x16x32_bf16 v[52:55], a[72:75], v[16:19], v[52:55]
    v_cvt_pk_bf16_f32 v0, v68, v69
    v_cvt_pk_bf16_f32 v1, v70, v71
    v_mfma_f32_16x16x32_bf16 v[52:55], a[96:99], v[20:23], v[52:55]
    v_mfma_f32_16x16x32_bf16 v[52:55], a[120:123], v[24:27], v[52:55]
    s_waitcnt lgkmcnt(3)
    v_mfma_f32_16x16x32_bf16 v[52:55], a[144:147], v[28:31], v[52:55]
    v_mfma_f32_16x16x32_bf16 v[52:55], a[168:171], v[32:35], v[52:55]
    v_mfma_f32_16x16x32_bf16 v[52:55], a[192:195], v[36:39], v[52:55]
    s_waitcnt lgkmcnt(0)
    v_mfma_f32_16x16x32_bf16 v[52:55], a[216:219], v[40:43], v[52:55]
    v_cvt_pk_bf16_f32 v2, v72, v73
    v_cvt_pk_bf16_f32 v3, v74, v75
    v_mfma_f32_16x16x32_bf16 v[52:55], a[240:243], v[44:47], v[52:55]
    ds_write_b128 v237, v[0:3] offset:12288
    v_mfma_f32_16x16x32_bf16 v[52:55], v[204:207], v[48:51], v[52:55]
    v_mfma_f32_16x16x32_bf16 v[56:59], a[4:7], v[4:7], v[188:191]
    s_add_u32 s55, s81, 0
    v_mfma_f32_16x16x32_bf16 v[56:59], a[28:31], v[8:11], v[56:59]
    s_add_u32 m0, s82, 0
    v_mfma_f32_16x16x32_bf16 v[56:59], a[52:55], v[12:15], v[56:59]
    buffer_load_dwordx4 v232, s[20:23], s55 offen nt lds
    v_mfma_f32_16x16x32_bf16 v[56:59], a[76:79], v[16:19], v[56:59]
    v_mfma_f32_16x16x32_bf16 v[56:59], a[100:103], v[20:23], v[56:59]
    v_mfma_f32_16x16x32_bf16 v[56:59], a[124:127], v[24:27], v[56:59]
    buffer_load_dwordx4 v233, s[20:23], s55 offen offset:1024 nt lds
    v_mfma_f32_16x16x32_bf16 v[56:59], a[148:151], v[28:31], v[56:59]
    v_mfma_f32_16x16x32_bf16 v[56:59], a[172:175], v[32:35], v[56:59]
    v_mfma_f32_16x16x32_bf16 v[56:59], a[196:199], v[36:39], v[56:59]
    buffer_load_dwordx4 v234, s[20:23], s55 offen offset:2048 nt lds
    v_mfma_f32_16x16x32_bf16 v[56:59], a[220:223], v[40:43], v[56:59]
    s_cbranch_vccz L_lo2
    s_waitcnt vmcnt(6)
L_lo2:
    v_cvt_pk_bf16_f32 v0, v52, v53
    v_cvt_pk_bf16_f32 v1, v54, v55
    v_mfma_f32_16x16x32_bf16 v[56:59], a[244:247], v[44:47], v[56:59]
    v_mfma_f32_16x16x32_bf16 v[56:59], v[208:211], v[48:51], v[56:59]
    v_mfma_f32_16x16x32_bf16 v[60:63], a[8:11], v[4:7], v[192:195]
    v_mfma_f32_16x16x32_bf16 v[60:63], a[32:35], v[8:11], v[60:63]
    v_mfma_f32_16x16x32_bf16 v[60:63], a[56:59], v[12:15], v[60:63]
    v_mfma_f32_16x16x32_bf16 v[60:63], a[80:83], v[16:19], v[60:63]
    v_mfma_f32_16x16x32_bf16 v[60:63], a[104:107], v[20:23], v[60:63]
    v_mfma_f32_16x16x32_bf16 v[60:63], a[128:131], v[24:27], v[60:63]
    v_mfma_f32_16x16x32_bf16 v[60:63], a[152:155], v[28:31], v[60:63]
    v_mfma_f32_16x16x32_bf16 v[60:63], a[176:179], v[32:35], v[60:63]
    s_cmp_eq_u32 s65, 0
    s_cbranch_scc1 L_md2
    s_waitcnt vmcnt(6)
L_md2:
    v_mfma_f32_16x16x32_bf16 v[60:63], a[200:203], v[36:39], v[60:63]
    v_cvt_pk_bf16_f32 v2, v56, v57
    v_cvt_pk_bf16_f32 v3, v58, v59
    v_mfma_f32_16x16x32_bf16 v[60:63], a[224:227], v[40:43], v[60:63]
    ds_write_b128 v235, v[0:3] offset:24576
    v_mfma_f32_16x16x32_bf16 v[60:63], a[248:251], v[44:47], v[60:63]
    v_mfma_f32_16x16x32_bf16 v[60:63], v[212:215], v[48:51], v[60:63]
    v_mfma_f32_16x16x32_bf16 v[64:67], a[12:15], v[4:7], v[76:79]
    s_add_u32 s67, s67, 43
    s_and_b32 s67, s67, 255
    v_mfma_f32_16x16x32_bf16 v[64:67], a[36:39], v[8:11], v[64:67]
    s_add_u32 s19, s19, 1
    s_lshl_b32 s87, s19, 8
    v_mfma_f32_16x16x32_bf16 v[64:67], a[60:63], v[12:15], v[64:67]
    s_add_u32 s87, s87, s67
    s_mul_hi_u32 s57, s87, 0x15555556
    v_mfma_f32_16x16x32_bf16 v[64:67], a[84:87], v[16:19], v[64:67]
    s_mul_i32 s57, s57, 294912
    s_mul_i32 s58, s87, 24576
    v_mfma_f32_16x16x32_bf16 v[64:67], a[108:111], v[20:23], v[64:67]
    s_add_u32 s80, s57, s58
    v_mfma_f32_16x16x32_bf16 v[64:67], a[132:135], v[24:27], v[64:67]
    v_mfma_f32_16x16x32_bf16 v[64:67], a[156:159], v[28:31], v[64:67]
    v_mfma_f32_16x16x32_bf16 v[64:67], a[180:183], v[32:35], v[64:67]
    v_mfma_f32_16x16x32_bf16 v[64:67], a[204:207], v[36:39], v[64:67]
    v_cvt_pk_bf16_f32 v0, v60, v61
    v_cvt_pk_bf16_f32 v1, v62, v63
    v_mfma_f32_16x16x32_bf16 v[64:67], a[228:231], v[40:43], v[64:67]
    v_mfma_f32_16x16x32_bf16 v[64:67], a[252:255], v[44:47], v[64:67]
    v_mfma_f32_16x16x32_bf16 v[64:67], v[216:219], v[48:51], v[64:67]
    v_mfma_f32_16x16x32_bf16 v[68:71], a[16:19], v[4:7], v[80:83]
    v_mfma_f32_16x16x32_bf16 v[68:71], a[40:43], v[8:11], v[68:71]
    s_waitcnt vmcnt(6) lgkmcnt(1)
    s_barrier
    v_mfma_f32_16x16x32_bf16 v[68:71], a[64:67], v[12:15], v[68:71]
    ds_read_b128 v[240:243], v238 offset:12288
    v_mfma_f32_16x16x32_bf16 v[68:71], a[88:91], v[16:19], v[68:71]
    ds_read_b128 v[244:247], v238 offset:13312
    v_mfma_f32_16x16x32_bf16 v[68:71], a[112:115], v[20:23], v[68:71]
    v_mfma_f32_16x16x32_bf16 v[68:71], a[136:139], v[24:27], v[68:71]
    v_mfma_f32_16x16x32_bf16 v[72:75], a[20:23], v[4:7], v[84:87]
    ds_read_b128 v[4:7], v228 offset:36864
    v_mfma_f32_16x16x32_bf16 v[72:75], a[44:47], v[8:11], v[72:75]
    ds_read_b128 v[248:251], v238 offset:14336
    v_mfma_f32_16x16x32_bf16 v[72:75], a[68:71], v[12:15], v[72:75]
    ds_read_b128 v[8:11], v229 offset:36864
    v_mfma_f32_16x16x32_bf16 v[72:75], a[92:95], v[16:19], v[72:75]
    v_cvt_pk_bf16_f32 v2, v64, v65
    v_cvt_pk_bf16_f32 v3, v66, v67
    v_mfma_f32_16x16x32_bf16 v[72:75], a[116:119], v[20:23], v[72:75]
    ds_read_b128 v[12:15], v230 offset:36864
    v_mfma_f32_16x16x32_bf16 v[72:75], a[140:143], v[24:27], v[72:75]
    ds_write_b128 v236, v[0:3] offset:24576
    v_mfma_f32_16x16x32_bf16 v[68:71], a[160:163], v[28:31], v[68:71]
    ds_read_b128 v[16:19], v231 offset:36864
    v_mfma_f32_16x16x32_bf16 v[68:71], a[184:187], v[32:35], v[68:71]
    v_mfma_f32_16x16x32_bf16 v[68:71], a[208:211], v[36:39], v[68:71]
    s_waitcnt lgkmcnt(7)
    buffer_store_dwordx4 v[240:243], v232, s[36:39], s56 offen sc1
    ds_read_b128 v[20:23], v228 offset:37120
    v_mfma_f32_16x16x32_bf16 v[68:71], a[232:235], v[40:43], v[68:71]
    v_mfma_f32_16x16x32_bf16 v[68:71], v[196:199], v[44:47], v[68:71]
    ds_read_b128 v[24:27], v229 offset:37120
    v_mfma_f32_16x16x32_bf16 v[68:71], v[220:223], v[48:51], v[68:71]
    v_mfma_f32_16x16x32_bf16 v[72:75], a[164:167], v[28:31], v[72:75]
    s_waitcnt lgkmcnt(8)
    buffer_store_dwordx4 v[244:247], v233, s[36:39], s56 offen offset:1024 sc1
    ds_read_b128 v[28:31], v230 offset:37120
    v_mfma_f32_16x16x32_bf16 v[72:75], a[188:191], v[32:35], v[72:75]
    ds_read_b128 v[32:35], v231 offset:37120
    v_mfma_f32_16x16x32_bf16 v[72:75], a[212:215], v[36:39], v[72:75]
    ds_read_b128 v[36:39], v228 offset:37376
    v_mfma_f32_16x16x32_bf16 v[72:75], a[236:239], v[40:43], v[72:75]
    ds_read_b128 v[40:43], v229 offset:37376
    v_mfma_f32_16x16x32_bf16 v[72:75], v[200:203], v[44:47], v[72:75]
    s_waitcnt lgkmcnt(10)
    buffer_store_dwordx4 v[248:251], v234, s[36:39], s56 offen offset:2048 sc1
    s_add_u32 s56, s78, 294912
    ds_read_b128 v[44:47], v230 offset:37376
    v_mfma_f32_16x16x32_bf16 v[72:75], v[224:227], v[48:51], v[72:75]
    ds_read_b128 v[48:51], v231 offset:37376
    s_waitcnt lgkmcnt(10)
    v_mfma_f32_16x16x32_bf16 v[52:55], a[0:3], v[4:7], v[184:187]
    s_cmp_eq_u32 s83, s85
    s_cselect_b32 s53, -49152, 0
    v_mfma_f32_16x16x32_bf16 v[52:55], a[24:27], v[8:11], v[52:55]
    s_add_u32 s83, s83, 1
    v_mfma_f32_16x16x32_bf16 v[52:55], a[48:51], v[12:15], v[52:55]
    s_waitcnt lgkmcnt(6)
    v_mfma_f32_16x16x32_bf16 v[52:55], a[72:75], v[16:19], v[52:55]
    v_cvt_pk_bf16_f32 v0, v68, v69
    v_cvt_pk_bf16_f32 v1, v70, v71
    v_mfma_f32_16x16x32_bf16 v[52:55], a[96:99], v[20:23], v[52:55]
    s_cmp_eq_u32 s83, s85
    s_cselect_b32 s53, 49152, s53
    v_mfma_f32_16x16x32_bf16 v[52:55], a[120:123], v[24:27], v[52:55]
    s_waitcnt lgkmcnt(3)
    v_mfma_f32_16x16x32_bf16 v[52:55], a[144:147], v[28:31], v[52:55]
    v_mfma_f32_16x16x32_bf16 v[52:55], a[168:171], v[32:35], v[52:55]
    v_mfma_f32_16x16x32_bf16 v[52:55], a[192:195], v[36:39], v[52:55]
    s_waitcnt lgkmcnt(0)
    v_mfma_f32_16x16x32_bf16 v[52:55], a[216:219], v[40:43], v[52:55]
    v_cvt_pk_bf16_f32 v2, v72, v73
    v_cvt_pk_bf16_f32 v3, v74, v75
    v_mfma_f32_16x16x32_bf16 v[52:55], a[240:243], v[44:47], v[52:55]
    ds_write_b128 v237, v[0:3] offset:24576
    v_mfma_f32_16x16x32_bf16 v[52:55], v[204:207], v[48:51], v[52:55]
    v_mfma_f32_16x16x32_bf16 v[56:59], a[4:7], v[4:7], v[188:191]
    s_add_u32 s55, s81, 768
    v_mfma_f32_16x16x32_bf16 v[56:59], a[28:31], v[8:11], v[56:59]
    s_add_u32 m0, s82, 12288
    v_mfma_f32_16x16x32_bf16 v[56:59], a[52:55], v[12:15], v[56:59]
    buffer_load_dwordx4 v232, s[20:23], s55 offen nt lds
    v_mfma_f32_16x16x32_bf16 v[56:59], a[76:79], v[16:19], v[56:59]
    v_mfma_f32_16x16x32_bf16 v[56:59], a[100:103], v[20:23], v[56:59]
    v_mfma_f32_16x16x32_bf16 v[56:59], a[124:127], v[24:27], v[56:59]
    buffer_load_dwordx4 v233, s[20:23], s55 offen offset:1024 nt lds
    v_mfma_f32_16x16x32_bf16 v[56:59], a[148:151], v[28:31], v[56:59]
    v_mfma_f32_16x16x32_bf16 v[56:59], a[172:175], v[32:35], v[56:59]
    v_mfma_f32_16x16x32_bf16 v[56:59], a[196:199], v[36:39], v[56:59]
    buffer_load_dwordx4 v234, s[20:23], s55 offen offset:2048 nt lds
    v_mfma_f32_16x16x32_bf16 v[56:59], a[220:223], v[40:43], v[56:59]
    s_cbranch_vccz L_lo3
    s_waitcnt vmcnt(6)
L_lo3:
    v_cvt_pk_bf16_f32 v0, v52, v53
    v_cvt_pk_bf16_f32 v1, v54, v55
    v_mfma_f32_16x16x32_bf16 v[56:59], a[244:247], v[44:47], v[56:59]
    s_set_gpr_idx_on s54, gpr_idx(SRC0)
    v_mov_b64 v[252:253], v[76:77]
    v_mov_b64 v[254:255], v[78:79]
    s_set_gpr_idx_off
    v_mfma_f32_16x16x32_bf16 v[56:59], v[208:211], v[48:51], v[56:59]
    v_lshlrev_b32 v184, 16, v252
    v_and_b32 v185, s59, v252
    v_mfma_f32_16x16x32_bf16 v[60:63], a[8:11], v[4:7], v[192:195]
    v_lshlrev_b32 v186, 16, v253
    v_and_b32 v187, s59, v253
    v_mfma_f32_16x16x32_bf16 v[60:63], a[32:35], v[8:11], v[60:63]
    v_lshlrev_b32 v188, 16, v254
    v_and_b32 v189, s59, v254
    v_mfma_f32_16x16x32_bf16 v[60:63], a[56:59], v[12:15], v[60:63]
    v_lshlrev_b32 v190, 16, v255
    v_and_b32 v191, s59, v255
    v_mfma_f32_16x16x32_bf16 v[60:63], a[80:83], v[16:19], v[60:63]
    v_mfma_f32_16x16x32_bf16 v[60:63], a[104:107], v[20:23], v[60:63]
    v_mfma_f32_16x16x32_bf16 v[60:63], a[128:131], v[24:27], v[60:63]
    v_mfma_f32_16x16x32_bf16 v[60:63], a[152:155], v[28:31], v[60:63]
    v_mfma_f32_16x16x32_bf16 v[60:63], a[176:179], v[32:35], v[60:63]
    s_cmp_eq_u32 s65, 0
    s_cbranch_scc1 L_md3
    s_waitcnt vmcnt(6)
L_md3:
    v_mfma_f32_16x16x32_bf16 v[60:63], a[200:203], v[36:39], v[60:63]
    v_cvt_pk_bf16_f32 v2, v56, v57
    v_cvt_pk_bf16_f32 v3, v58, v59
    v_mfma_f32_16x16x32_bf16 v[60:63], a[224:227], v[40:43], v[60:63]
    ds_write_b128 v235, v[0:3] offset:36864
    v_mfma_f32_16x16x32_bf16 v[60:63], a[248:251], v[44:47], v[60:63]
    v_mfma_f32_16x16x32_bf16 v[60:63], v[212:215], v[48:51], v[60:63]
    v_mfma_f32_16x16x32_bf16 v[64:67], a[12:15], v[4:7], v[76:79]
    v_add_u32 v228, s53, v228
    v_add_u32 v229, s53, v229
    v_mfma_f32_16x16x32_bf16 v[64:67], a[36:39], v[8:11], v[64:67]
    v_add_u32 v230, s53, v230
    v_add_u32 v231, s53, v231
    v_mfma_f32_16x16x32_bf16 v[64:67], a[60:63], v[12:15], v[64:67]
    v_mfma_f32_16x16x32_bf16 v[64:67], a[84:87], v[16:19], v[64:67]
    v_mfma_f32_16x16x32_bf16 v[64:67], a[108:111], v[20:23], v[64:67]
    v_mfma_f32_16x16x32_bf16 v[64:67], a[132:135], v[24:27], v[64:67]
    v_mfma_f32_16x16x32_bf16 v[64:67], a[156:159], v[28:31], v[64:67]
    v_mfma_f32_16x16x32_bf16 v[64:67], a[180:183], v[32:35], v[64:67]
    v_mfma_f32_16x16x32_bf16 v[64:67], a[204:207], v[36:39], v[64:67]
    v_cvt_pk_bf16_f32 v0, v60, v61
    v_cvt_pk_bf16_f32 v1, v62, v63
    v_mfma_f32_16x16x32_bf16 v[64:67], a[228:231], v[40:43], v[64:67]
    s_set_gpr_idx_on s54, gpr_idx(SRC0)
    v_mov_b64 v[252:253], v[80:81]
    v_mov_b64 v[254:255], v[82:83]
    s_set_gpr_idx_off
    v_mfma_f32_16x16x32_bf16 v[64:67], a[252:255], v[44:47], v[64:67]
    v_lshlrev_b32 v192, 16, v252
    v_and_b32 v193, s59, v252
    v_mfma_f32_16x16x32_bf16 v[64:67], v[216:219], v[48:51], v[64:67]
    v_lshlrev_b32 v194, 16, v253
    v_and_b32 v195, s59, v253
    v_mfma_f32_16x16x32_bf16 v[68:71], a[16:19], v[4:7], v[80:83]
    v_lshlrev_b32 v76, 16, v254
    v_and_b32 v77, s59, v254
    v_mfma_f32_16x16x32_bf16 v[68:71], a[40:43], v[8:11], v[68:71]
    s_waitcnt vmcnt(6) lgkmcnt(1)
    s_barrier
    v_lshlrev_b32 v78, 16, v255
    v_and_b32 v79, s59, v255
    v_mfma_f32_16x16x32_bf16 v[68:71], a[64:67], v[12:15], v[68:71]
    ds_read_b128 v[240:243], v238 offset:24576
    v_mfma_f32_16x16x32_bf16 v[68:71], a[88:91], v[16:19], v[68:71]
    ds_read_b128 v[244:247], v238 offset:25600
    v_mfma_f32_16x16x32_bf16 v[68:71], a[112:115], v[20:23], v[68:71]
    v_mfma_f32_16x16x32_bf16 v[68:71], a[136:139], v[24:27], v[68:71]
    v_mfma_f32_16x16x32_bf16 v[72:75], a[20:23], v[4:7], v[84:87]
    ds_read_b128 v[4:7], v228 offset:0
    v_mfma_f32_16x16x32_bf16 v[72:75], a[44:47], v[8:11], v[72:75]
    ds_read_b128 v[248:251], v238 offset:26624
    v_mfma_f32_16x16x32_bf16 v[72:75], a[68:71], v[12:15], v[72:75]
    ds_read_b128 v[8:11], v229 offset:0
    v_mfma_f32_16x16x32_bf16 v[72:75], a[92:95], v[16:19], v[72:75]
    v_cvt_pk_bf16_f32 v2, v64, v65
    v_cvt_pk_bf16_f32 v3, v66, v67
    v_mfma_f32_16x16x32_bf16 v[72:75], a[116:119], v[20:23], v[72:75]
    ds_read_b128 v[12:15], v230 offset:0
    v_mfma_f32_16x16x32_bf16 v[72:75], a[140:143], v[24:27], v[72:75]
    ds_write_b128 v236, v[0:3] offset:36864
    v_mfma_f32_16x16x32_bf16 v[68:71], a[160:163], v[28:31], v[68:71]
    ds_read_b128 v[16:19], v231 offset:0
    v_mfma_f32_16x16x32_bf16 v[68:71], a[184:187], v[32:35], v[68:71]
    v_mfma_f32_16x16x32_bf16 v[68:71], a[208:211], v[36:39], v[68:71]
    s_waitcnt lgkmcnt(7)
    buffer_store_dwordx4 v[240:243], v232, s[36:39], s56 offen sc1
    ds_read_b128 v[20:23], v228 offset:256
    v_mfma_f32_16x16x32_bf16 v[68:71], a[232:235], v[40:43], v[68:71]
    v_mfma_f32_16x16x32_bf16 v[68:71], v[196:199], v[44:47], v[68:71]
    ds_read_b128 v[24:27], v229 offset:256
    v_mfma_f32_16x16x32_bf16 v[68:71], v[220:223], v[48:51], v[68:71]
    v_mfma_f32_16x16x32_bf16 v[72:75], a[164:167], v[28:31], v[72:75]
    s_waitcnt lgkmcnt(8)
    buffer_store_dwordx4 v[244:247], v233, s[36:39], s56 offen offset:1024 sc1
    ds_read_b128 v[28:31], v230 offset:256
    v_mfma_f32_16x16x32_bf16 v[72:75], a[188:191], v[32:35], v[72:75]
    ds_read_b128 v[32:35], v231 offset:256
    v_mfma_f32_16x16x32_bf16 v[72:75], a[212:215], v[36:39], v[72:75]
    ds_read_b128 v[36:39], v228 offset:512
    v_mfma_f32_16x16x32_bf16 v[72:75], a[236:239], v[40:43], v[72:75]
    ds_read_b128 v[40:43], v229 offset:512
    s_cmp_eq_u32 s83, 8
    s_cselect_b32 s65, vcc_lo, s65
    s_cselect_b64 vcc, 0, vcc
    v_mfma_f32_16x16x32_bf16 v[72:75], v[200:203], v[44:47], v[72:75]
    s_waitcnt lgkmcnt(10)
    buffer_store_dwordx4 v[248:251], v234, s[36:39], s56 offen offset:2048 sc1
    s_add_u32 s56, s78, 295680
    ds_read_b128 v[44:47], v230 offset:512
    v_mfma_f32_16x16x32_bf16 v[72:75], v[224:227], v[48:51], v[72:75]
    ds_read_b128 v[48:51], v231 offset:512
    s_mov_b32 s78, s79
    s_mov_b32 s79, s80
    s_cmp_lg_u32 s83, 8
    s_cbranch_scc1 L_p2
    s_waitcnt lgkmcnt(10)
    v_mfma_f32_16x16x32_bf16 v[52:55], a[0:3], v[4:7], v[184:187]
    v_mfma_f32_16x16x32_bf16 v[52:55], a[24:27], v[8:11], v[52:55]
    v_mfma_f32_16x16x32_bf16 v[52:55], a[48:51], v[12:15], v[52:55]
    s_waitcnt lgkmcnt(6)
    v_mfma_f32_16x16x32_bf16 v[52:55], a[72:75], v[16:19], v[52:55]
    v_cvt_pk_bf16_f32 v0, v68, v69
    v_cvt_pk_bf16_f32 v1, v70, v71
    v_mfma_f32_16x16x32_bf16 v[52:55], a[96:99], v[20:23], v[52:55]
    v_mfma_f32_16x16x32_bf16 v[52:55], a[120:123], v[24:27], v[52:55]
    s_waitcnt lgkmcnt(3)
    v_mfma_f32_16x16x32_bf16 v[52:55], a[144:147], v[28:31], v[52:55]
    v_mfma_f32_16x16x32_bf16 v[52:55], a[168:171], v[32:35], v[52:55]
    v_mfma_f32_16x16x32_bf16 v[52:55], a[192:195], v[36:39], v[52:55]
    s_waitcnt lgkmcnt(0)
    v_mfma_f32_16x16x32_bf16 v[52:55], a[216:219], v[40:43], v[52:55]
    v_cvt_pk_bf16_f32 v2, v72, v73
    v_cvt_pk_bf16_f32 v3, v74, v75
    v_mfma_f32_16x16x32_bf16 v[52:55], a[240:243], v[44:47], v[52:55]
    ds_write_b128 v237, v[0:3] offset:36864
    v_mfma_f32_16x16x32_bf16 v[52:55], v[204:207], v[48:51], v[52:55]
    v_mfma_f32_16x16x32_bf16 v[56:59], a[4:7], v[4:7], v[188:191]
    s_add_u32 s55, s81, 294912
    v_mfma_f32_16x16x32_bf16 v[56:59], a[28:31], v[8:11], v[56:59]
    s_add_u32 m0, s82, 24576
    v_mfma_f32_16x16x32_bf16 v[56:59], a[52:55], v[12:15], v[56:59]
    buffer_load_dwordx4 v232, s[20:23], s55 offen nt lds
    v_mfma_f32_16x16x32_bf16 v[56:59], a[76:79], v[16:19], v[56:59]
    v_mfma_f32_16x16x32_bf16 v[56:59], a[100:103], v[20:23], v[56:59]
    v_mfma_f32_16x16x32_bf16 v[56:59], a[124:127], v[24:27], v[56:59]
    buffer_load_dwordx4 v233, s[20:23], s55 offen offset:1024 nt lds
    v_mfma_f32_16x16x32_bf16 v[56:59], a[148:151], v[28:31], v[56:59]
    v_mfma_f32_16x16x32_bf16 v[56:59], a[172:175], v[32:35], v[56:59]
    v_mfma_f32_16x16x32_bf16 v[56:59], a[196:199], v[36:39], v[56:59]
    buffer_load_dwordx4 v234, s[20:23], s55 offen offset:2048 nt lds
    v_mfma_f32_16x16x32_bf16 v[56:59], a[220:223], v[40:43], v[56:59]
    v_cvt_pk_bf16_f32 v0, v52, v53
    v_cvt_pk_bf16_f32 v1, v54, v55
    v_mfma_f32_16x16x32_bf16 v[56:59], a[244:247], v[44:47], v[56:59]
    s_set_gpr_idx_on s54, gpr_idx(SRC0)
    v_mov_b64 v[252:253], v[84:85]
    v_mov_b64 v[254:255], v[86:87]
    s_set_gpr_idx_off
    v_mfma_f32_16x16x32_bf16 v[56:59], v[208:211], v[48:51], v[56:59]
    v_lshlrev_b32 v80, 16, v252
    v_and_b32 v81, s59, v252
    v_mfma_f32_16x16x32_bf16 v[60:63], a[8:11], v[4:7], v[192:195]
    v_lshlrev_b32 v82, 16, v253
    v_and_b32 v83, s59, v253
    v_mfma_f32_16x16x32_bf16 v[60:63], a[32:35], v[8:11], v[60:63]
    v_lshlrev_b32 v84, 16, v254
    v_and_b32 v85, s59, v254
    v_mfma_f32_16x16x32_bf16 v[60:63], a[56:59], v[12:15], v[60:63]
    v_lshlrev_b32 v86, 16, v255
    v_and_b32 v87, s59, v255
    v_mfma_f32_16x16x32_bf16 v[60:63], a[80:83], v[16:19], v[60:63]
    v_mfma_f32_16x16x32_bf16 v[60:63], a[104:107], v[20:23], v[60:63]
    v_mfma_f32_16x16x32_bf16 v[60:63], a[128:131], v[24:27], v[60:63]
    v_mfma_f32_16x16x32_bf16 v[60:63], a[152:155], v[28:31], v[60:63]
    v_mfma_f32_16x16x32_bf16 v[60:63], a[176:179], v[32:35], v[60:63]
    v_mfma_f32_16x16x32_bf16 v[60:63], a[200:203], v[36:39], v[60:63]
    v_cvt_pk_bf16_f32 v2, v56, v57
    v_cvt_pk_bf16_f32 v3, v58, v59
    v_mfma_f32_16x16x32_bf16 v[60:63], a[224:227], v[40:43], v[60:63]
    ds_write_b128 v235, v[0:3] offset:0
    v_mfma_f32_16x16x32_bf16 v[60:63], a[248:251], v[44:47], v[60:63]
    v_mfma_f32_16x16x32_bf16 v[60:63], v[212:215], v[48:51], v[60:63]
    v_mfma_f32_16x16x32_bf16 v[64:67], a[12:15], v[4:7], v[76:79]
    v_mfma_f32_16x16x32_bf16 v[64:67], a[36:39], v[8:11], v[64:67]
    v_mfma_f32_16x16x32_bf16 v[64:67], a[60:63], v[12:15], v[64:67]
    v_mfma_f32_16x16x32_bf16 v[64:67], a[84:87], v[16:19], v[64:67]
    v_mfma_f32_16x16x32_bf16 v[64:67], a[108:111], v[20:23], v[64:67]
    v_mfma_f32_16x16x32_bf16 v[64:67], a[132:135], v[24:27], v[64:67]
    v_mfma_f32_16x16x32_bf16 v[64:67], a[156:159], v[28:31], v[64:67]
    v_mfma_f32_16x16x32_bf16 v[64:67], a[180:183], v[32:35], v[64:67]
    v_mfma_f32_16x16x32_bf16 v[64:67], a[204:207], v[36:39], v[64:67]
    v_cvt_pk_bf16_f32 v0, v60, v61
    v_cvt_pk_bf16_f32 v1, v62, v63
    v_mfma_f32_16x16x32_bf16 v[64:67], a[228:231], v[40:43], v[64:67]
    v_mfma_f32_16x16x32_bf16 v[64:67], a[252:255], v[44:47], v[64:67]
    v_mfma_f32_16x16x32_bf16 v[64:67], v[216:219], v[48:51], v[64:67]
    v_mfma_f32_16x16x32_bf16 v[68:71], a[16:19], v[4:7], v[80:83]
    v_mfma_f32_16x16x32_bf16 v[68:71], a[40:43], v[8:11], v[68:71]
    s_waitcnt vmcnt(6) lgkmcnt(1)
    s_barrier
    v_mfma_f32_16x16x32_bf16 v[68:71], a[64:67], v[12:15], v[68:71]
    ds_read_b128 v[240:243], v238 offset:36864
    v_mfma_f32_16x16x32_bf16 v[68:71], a[88:91], v[16:19], v[68:71]
    ds_read_b128 v[244:247], v238 offset:37888
    v_mfma_f32_16x16x32_bf16 v[68:71], a[112:115], v[20:23], v[68:71]
    v_mfma_f32_16x16x32_bf16 v[68:71], a[136:139], v[24:27], v[68:71]
    v_mfma_f32_16x16x32_bf16 v[72:75], a[20:23], v[4:7], v[84:87]
    ds_read_b128 v[4:7], v228 offset:12288
    v_mfma_f32_16x16x32_bf16 v[72:75], a[44:47], v[8:11], v[72:75]
    ds_read_b128 v[248:251], v238 offset:38912
    v_mfma_f32_16x16x32_bf16 v[72:75], a[68:71], v[12:15], v[72:75]
    ds_read_b128 v[8:11], v229 offset:12288
    v_mfma_f32_16x16x32_bf16 v[72:75], a[92:95], v[16:19], v[72:75]
    v_cvt_pk_bf16_f32 v2, v64, v65
    v_cvt_pk_bf16_f32 v3, v66, v67
    v_mfma_f32_16x16x32_bf16 v[72:75], a[116:119], v[20:23], v[72:75]
    ds_read_b128 v[12:15], v230 offset:12288
    v_mfma_f32_16x16x32_bf16 v[72:75], a[140:143], v[24:27], v[72:75]
    ds_write_b128 v236, v[0:3] offset:0
    v_mfma_f32_16x16x32_bf16 v[68:71], a[160:163], v[28:31], v[68:71]
    ds_read_b128 v[16:19], v231 offset:12288
    v_mfma_f32_16x16x32_bf16 v[68:71], a[184:187], v[32:35], v[68:71]
    v_mfma_f32_16x16x32_bf16 v[68:71], a[208:211], v[36:39], v[68:71]
    s_waitcnt lgkmcnt(7)
    buffer_store_dwordx4 v[240:243], v232, s[36:39], s56 offen sc1
    ds_read_b128 v[20:23], v228 offset:12544
    v_mfma_f32_16x16x32_bf16 v[68:71], a[232:235], v[40:43], v[68:71]
    v_mfma_f32_16x16x32_bf16 v[68:71], v[196:199], v[44:47], v[68:71]
    ds_read_b128 v[24:27], v229 offset:12544
    v_mfma_f32_16x16x32_bf16 v[68:71], v[220:223], v[48:51], v[68:71]
    v_mfma_f32_16x16x32_bf16 v[72:75], a[164:167], v[28:31], v[72:75]
    s_waitcnt lgkmcnt(8)
    buffer_store_dwordx4 v[244:247], v233, s[36:39], s56 offen offset:1024 sc1
    ds_read_b128 v[28:31], v230 offset:12544
    v_mfma_f32_16x16x32_bf16 v[72:75], a[188:191], v[32:35], v[72:75]
    ds_read_b128 v[32:35], v231 offset:12544
    v_mfma_f32_16x16x32_bf16 v[72:75], a[212:215], v[36:39], v[72:75]
    ds_read_b128 v[36:39], v228 offset:12800
    v_mfma_f32_16x16x32_bf16 v[72:75], a[236:239], v[40:43], v[72:75]
    ds_read_b128 v[40:43], v229 offset:12800
    v_mfma_f32_16x16x32_bf16 v[72:75], v[200:203], v[44:47], v[72:75]
    s_waitcnt lgkmcnt(10)
    buffer_store_dwordx4 v[248:251], v234, s[36:39], s56 offen offset:2048 sc1
    s_add_u32 s56, s78, 0
    ds_read_b128 v[44:47], v230 offset:12800
    v_mfma_f32_16x16x32_bf16 v[72:75], v[224:227], v[48:51], v[72:75]
    ds_read_b128 v[48:51], v231 offset:12800
    s_waitcnt lgkmcnt(10)
    v_mfma_f32_16x16x32_bf16 v[52:55], a[0:3], v[4:7], v[184:187]
    v_mfma_f32_16x16x32_bf16 v[52:55], a[24:27], v[8:11], v[52:55]
    v_mfma_f32_16x16x32_bf16 v[52:55], a[48:51], v[12:15], v[52:55]
    s_waitcnt lgkmcnt(6)
    v_mfma_f32_16x16x32_bf16 v[52:55], a[72:75], v[16:19], v[52:55]
    v_cvt_pk_bf16_f32 v0, v68, v69
    v_cvt_pk_bf16_f32 v1, v70, v71
    v_mfma_f32_16x16x32_bf16 v[52:55], a[96:99], v[20:23], v[52:55]
    v_mfma_f32_16x16x32_bf16 v[52:55], a[120:123], v[24:27], v[52:55]
    s_waitcnt lgkmcnt(3)
    v_mfma_f32_16x16x32_bf16 v[52:55], a[144:147], v[28:31], v[52:55]
    v_mfma_f32_16x16x32_bf16 v[52:55], a[168:171], v[32:35], v[52:55]
    v_mfma_f32_16x16x32_bf16 v[52:55], a[192:195], v[36:39], v[52:55]
    s_waitcnt lgkmcnt(0)
    v_mfma_f32_16x16x32_bf16 v[52:55], a[216:219], v[40:43], v[52:55]
    v_cvt_pk_bf16_f32 v2, v72, v73
    v_cvt_pk_bf16_f32 v3, v74, v75
    v_mfma_f32_16x16x32_bf16 v[52:55], a[240:243], v[44:47], v[52:55]
    ds_write_b128 v237, v[0:3] offset:0
    v_mfma_f32_16x16x32_bf16 v[52:55], v[204:207], v[48:51], v[52:55]
    v_mfma_f32_16x16x32_bf16 v[56:59], a[4:7], v[4:7], v[188:191]
    s_add_u32 s55, s81, 295680
    v_mfma_f32_16x16x32_bf16 v[56:59], a[28:31], v[8:11], v[56:59]
    s_add_u32 m0, s82, 36864
    v_mfma_f32_16x16x32_bf16 v[56:59], a[52:55], v[12:15], v[56:59]
    buffer_load_dwordx4 v232, s[20:23], s55 offen nt lds
    v_mfma_f32_16x16x32_bf16 v[56:59], a[76:79], v[16:19], v[56:59]
    v_mfma_f32_16x16x32_bf16 v[56:59], a[100:103], v[20:23], v[56:59]
    v_mfma_f32_16x16x32_bf16 v[56:59], a[124:127], v[24:27], v[56:59]
    buffer_load_dwordx4 v233, s[20:23], s55 offen offset:1024 nt lds
    v_mfma_f32_16x16x32_bf16 v[56:59], a[148:151], v[28:31], v[56:59]
    v_mfma_f32_16x16x32_bf16 v[56:59], a[172:175], v[32:35], v[56:59]
    v_mfma_f32_16x16x32_bf16 v[56:59], a[196:199], v[36:39], v[56:59]
    buffer_load_dwordx4 v234, s[20:23], s55 offen offset:2048 nt lds
    v_mfma_f32_16x16x32_bf16 v[56:59], a[220:223], v[40:43], v[56:59]
    v_cvt_pk_bf16_f32 v0, v52, v53
    v_cvt_pk_bf16_f32 v1, v54, v55
    v_mfma_f32_16x16x32_bf16 v[56:59], a[244:247], v[44:47], v[56:59]
    v_mfma_f32_16x16x32_bf16 v[56:59], v[208:211], v[48:51], v[56:59]
    s_add_u32 s54, s54, 12
    v_mfma_f32_16x16x32_bf16 v[60:63], a[8:11], v[4:7], v[192:195]
    v_mfma_f32_16x16x32_bf16 v[60:63], a[32:35], v[8:11], v[60:63]
    v_mfma_f32_16x16x32_bf16 v[60:63], a[56:59], v[12:15], v[60:63]
    v_mfma_f32_16x16x32_bf16 v[60:63], a[80:83], v[16:19], v[60:63]
    v_mfma_f32_16x16x32_bf16 v[60:63], a[104:107], v[20:23], v[60:63]
    v_mfma_f32_16x16x32_bf16 v[60:63], a[128:131], v[24:27], v[60:63]
    v_mfma_f32_16x16x32_bf16 v[60:63], a[152:155], v[28:31], v[60:63]
    v_mfma_f32_16x16x32_bf16 v[60:63], a[176:179], v[32:35], v[60:63]
    v_mfma_f32_16x16x32_bf16 v[60:63], a[200:203], v[36:39], v[60:63]
    v_cvt_pk_bf16_f32 v2, v56, v57
    v_cvt_pk_bf16_f32 v3, v58, v59
    v_mfma_f32_16x16x32_bf16 v[60:63], a[224:227], v[40:43], v[60:63]
    ds_write_b128 v235, v[0:3] offset:12288
    v_mfma_f32_16x16x32_bf16 v[60:63], a[248:251], v[44:47], v[60:63]
    v_mfma_f32_16x16x32_bf16 v[60:63], v[212:215], v[48:51], v[60:63]
    v_mfma_f32_16x16x32_bf16 v[64:67], a[12:15], v[4:7], v[76:79]
    v_mfma_f32_16x16x32_bf16 v[64:67], a[36:39], v[8:11], v[64:67]
    v_mfma_f32_16x16x32_bf16 v[64:67], a[60:63], v[12:15], v[64:67]
    v_mfma_f32_16x16x32_bf16 v[64:67], a[84:87], v[16:19], v[64:67]
    v_mfma_f32_16x16x32_bf16 v[64:67], a[108:111], v[20:23], v[64:67]
    v_mfma_f32_16x16x32_bf16 v[64:67], a[132:135], v[24:27], v[64:67]
    v_mfma_f32_16x16x32_bf16 v[64:67], a[156:159], v[28:31], v[64:67]
    v_mfma_f32_16x16x32_bf16 v[64:67], a[180:183], v[32:35], v[64:67]
    v_mfma_f32_16x16x32_bf16 v[64:67], a[204:207], v[36:39], v[64:67]
    v_cvt_pk_bf16_f32 v0, v60, v61
    v_cvt_pk_bf16_f32 v1, v62, v63
    v_mfma_f32_16x16x32_bf16 v[64:67], a[228:231], v[40:43], v[64:67]
    v_mfma_f32_16x16x32_bf16 v[64:67], a[252:255], v[44:47], v[64:67]
    v_mfma_f32_16x16x32_bf16 v[64:67], v[216:219], v[48:51], v[64:67]
    v_mfma_f32_16x16x32_bf16 v[68:71], a[16:19], v[4:7], v[80:83]
    v_mfma_f32_16x16x32_bf16 v[68:71], a[40:43], v[8:11], v[68:71]
    s_waitcnt vmcnt(6) lgkmcnt(1)
    s_barrier
    v_mfma_f32_16x16x32_bf16 v[68:71], a[64:67], v[12:15], v[68:71]
    ds_read_b128 v[240:243], v238 offset:0
    v_mfma_f32_16x16x32_bf16 v[68:71], a[88:91], v[16:19], v[68:71]
    ds_read_b128 v[244:247], v238 offset:1024
    v_mfma_f32_16x16x32_bf16 v[68:71], a[112:115], v[20:23], v[68:71]
    v_mfma_f32_16x16x32_bf16 v[68:71], a[136:139], v[24:27], v[68:71]
    v_mfma_f32_16x16x32_bf16 v[72:75], a[20:23], v[4:7], v[84:87]
    ds_read_b128 v[4:7], v228 offset:24576
    v_mfma_f32_16x16x32_bf16 v[72:75], a[44:47], v[8:11], v[72:75]
    ds_read_b128 v[248:251], v238 offset:2048
    v_mfma_f32_16x16x32_bf16 v[72:75], a[68:71], v[12:15], v[72:75]
    ds_read_b128 v[8:11], v229 offset:24576
    v_mfma_f32_16x16x32_bf16 v[72:75], a[92:95], v[16:19], v[72:75]
    v_cvt_pk_bf16_f32 v2, v64, v65
    v_cvt_pk_bf16_f32 v3, v66, v67
    v_mfma_f32_16x16x32_bf16 v[72:75], a[116:119], v[20:23], v[72:75]
    ds_read_b128 v[12:15], v230 offset:24576
    v_mfma_f32_16x16x32_bf16 v[72:75], a[140:143], v[24:27], v[72:75]
    ds_write_b128 v236, v[0:3] offset:12288
    v_mfma_f32_16x16x32_bf16 v[68:71], a[160:163], v[28:31], v[68:71]
    ds_read_b128 v[16:19], v231 offset:24576
    v_mfma_f32_16x16x32_bf16 v[68:71], a[184:187], v[32:35], v[68:71]
    v_mfma_f32_16x16x32_bf16 v[68:71], a[208:211], v[36:39], v[68:71]
    s_waitcnt lgkmcnt(7)
    buffer_store_dwordx4 v[240:243], v232, s[36:39], s56 offen sc1
    ds_read_b128 v[20:23], v228 offset:24832
    v_mfma_f32_16x16x32_bf16 v[68:71], a[232:235], v[40:43], v[68:71]
    v_mfma_f32_16x16x32_bf16 v[68:71], v[196:199], v[44:47], v[68:71]
    ds_read_b128 v[24:27], v229 offset:24832
    v_mfma_f32_16x16x32_bf16 v[68:71], v[220:223], v[48:51], v[68:71]
    v_mfma_f32_16x16x32_bf16 v[72:75], a[164:167], v[28:31], v[72:75]
    s_waitcnt lgkmcnt(8)
    buffer_store_dwordx4 v[244:247], v233, s[36:39], s56 offen offset:1024 sc1
    ds_read_b128 v[28:31], v230 offset:24832
    v_mfma_f32_16x16x32_bf16 v[72:75], a[188:191], v[32:35], v[72:75]
    ds_read_b128 v[32:35], v231 offset:24832
    v_mfma_f32_16x16x32_bf16 v[72:75], a[212:215], v[36:39], v[72:75]
    ds_read_b128 v[36:39], v228 offset:25088
    v_mfma_f32_16x16x32_bf16 v[72:75], a[236:239], v[40:43], v[72:75]
    ds_read_b128 v[40:43], v229 offset:25088
    v_mfma_f32_16x16x32_bf16 v[72:75], v[200:203], v[44:47], v[72:75]
    s_waitcnt lgkmcnt(10)
    buffer_store_dwordx4 v[248:251], v234, s[36:39], s56 offen offset:2048 sc1
    s_add_u32 s56, s78, 768
    ds_read_b128 v[44:47], v230 offset:25088
    v_mfma_f32_16x16x32_bf16 v[72:75], v[224:227], v[48:51], v[72:75]
    ds_read_b128 v[48:51], v231 offset:25088
    s_waitcnt lgkmcnt(10)
    v_mfma_f32_16x16x32_bf16 v[52:55], a[0:3], v[4:7], v[184:187]
    v_mfma_f32_16x16x32_bf16 v[52:55], a[24:27], v[8:11], v[52:55]
    v_mfma_f32_16x16x32_bf16 v[52:55], a[48:51], v[12:15], v[52:55]
    s_waitcnt lgkmcnt(6)
    v_mfma_f32_16x16x32_bf16 v[52:55], a[72:75], v[16:19], v[52:55]
    v_cvt_pk_bf16_f32 v0, v68, v69
    v_cvt_pk_bf16_f32 v1, v70, v71
    v_mfma_f32_16x16x32_bf16 v[52:55], a[96:99], v[20:23], v[52:55]
    v_mfma_f32_16x16x32_bf16 v[52:55], a[120:123], v[24:27], v[52:55]
    s_waitcnt lgkmcnt(3)
    v_mfma_f32_16x16x32_bf16 v[52:55], a[144:147], v[28:31], v[52:55]
    v_mfma_f32_16x16x32_bf16 v[52:55], a[168:171], v[32:35], v[52:55]
    v_mfma_f32_16x16x32_bf16 v[52:55], a[192:195], v[36:39], v[52:55]
    s_waitcnt lgkmcnt(0)
    v_mfma_f32_16x16x32_bf16 v[52:55], a[216:219], v[40:43], v[52:55]
    v_cvt_pk_bf16_f32 v2, v72, v73
    v_cvt_pk_bf16_f32 v3, v74, v75
    v_mfma_f32_16x16x32_bf16 v[52:55], a[240:243], v[44:47], v[52:55]
    ds_write_b128 v237, v[0:3] offset:12288
    v_mfma_f32_16x16x32_bf16 v[52:55], v[204:207], v[48:51], v[52:55]
    v_mfma_f32_16x16x32_bf16 v[56:59], a[4:7], v[4:7], v[188:191]
    s_add_u32 s55, s97, 0
    v_mfma_f32_16x16x32_bf16 v[56:59], a[28:31], v[8:11], v[56:59]
    s_add_u32 m0, s49, 147456
    v_mfma_f32_16x16x32_bf16 v[56:59], a[52:55], v[12:15], v[56:59]
    buffer_load_dwordx4 v232, s[20:23], s55 offen nt lds
    v_mfma_f32_16x16x32_bf16 v[56:59], a[76:79], v[16:19], v[56:59]
    v_mfma_f32_16x16x32_bf16 v[56:59], a[100:103], v[20:23], v[56:59]
    v_mfma_f32_16x16x32_bf16 v[56:59], a[124:127], v[24:27], v[56:59]
    buffer_load_dwordx4 v233, s[20:23], s55 offen offset:1024 nt lds
    v_mfma_f32_16x16x32_bf16 v[56:59], a[148:151], v[28:31], v[56:59]
    v_mfma_f32_16x16x32_bf16 v[56:59], a[172:175], v[32:35], v[56:59]
    v_mfma_f32_16x16x32_bf16 v[56:59], a[196:199], v[36:39], v[56:59]
    v_mfma_f32_16x16x32_bf16 v[56:59], a[220:223], v[40:43], v[56:59]
    v_cvt_pk_bf16_f32 v0, v52, v53
    v_cvt_pk_bf16_f32 v1, v54, v55
    v_mfma_f32_16x16x32_bf16 v[56:59], a[244:247], v[44:47], v[56:59]
    v_mfma_f32_16x16x32_bf16 v[56:59], v[208:211], v[48:51], v[56:59]
    v_mfma_f32_16x16x32_bf16 v[60:63], a[8:11], v[4:7], v[192:195]
    v_mfma_f32_16x16x32_bf16 v[60:63], a[32:35], v[8:11], v[60:63]
    v_mfma_f32_16x16x32_bf16 v[60:63], a[56:59], v[12:15], v[60:63]
    v_mfma_f32_16x16x32_bf16 v[60:63], a[80:83], v[16:19], v[60:63]
    v_mfma_f32_16x16x32_bf16 v[60:63], a[104:107], v[20:23], v[60:63]
    v_mfma_f32_16x16x32_bf16 v[60:63], a[128:131], v[24:27], v[60:63]
    v_mfma_f32_16x16x32_bf16 v[60:63], a[152:155], v[28:31], v[60:63]
    v_mfma_f32_16x16x32_bf16 v[60:63], a[176:179], v[32:35], v[60:63]
    v_mfma_f32_16x16x32_bf16 v[60:63], a[200:203], v[36:39], v[60:63]
    v_cvt_pk_bf16_f32 v2, v56, v57
    v_cvt_pk_bf16_f32 v3, v58, v59
    v_mfma_f32_16x16x32_bf16 v[60:63], a[224:227], v[40:43], v[60:63]
    ds_write_b128 v235, v[0:3] offset:24576
    v_mfma_f32_16x16x32_bf16 v[60:63], a[248:251], v[44:47], v[60:63]
    v_mfma_f32_16x16x32_bf16 v[60:63], v[212:215], v[48:51], v[60:63]
    v_mfma_f32_16x16x32_bf16 v[64:67], a[12:15], v[4:7], v[76:79]
    v_mfma_f32_16x16x32_bf16 v[64:67], a[36:39], v[8:11], v[64:67]
    v_mfma_f32_16x16x32_bf16 v[64:67], a[60:63], v[12:15], v[64:67]
    v_mfma_f32_16x16x32_bf16 v[64:67], a[84:87], v[16:19], v[64:67]
    v_mfma_f32_16x16x32_bf16 v[64:67], a[108:111], v[20:23], v[64:67]
    v_mfma_f32_16x16x32_bf16 v[64:67], a[132:135], v[24:27], v[64:67]
    v_mfma_f32_16x16x32_bf16 v[64:67], a[156:159], v[28:31], v[64:67]
    v_mfma_f32_16x16x32_bf16 v[64:67], a[180:183], v[32:35], v[64:67]
    v_mfma_f32_16x16x32_bf16 v[64:67], a[204:207], v[36:39], v[64:67]
    v_cvt_pk_bf16_f32 v0, v60, v61
    v_cvt_pk_bf16_f32 v1, v62, v63
    v_mfma_f32_16x16x32_bf16 v[64:67], a[228:231], v[40:43], v[64:67]
    v_mfma_f32_16x16x32_bf16 v[64:67], a[252:255], v[44:47], v[64:67]
    v_mfma_f32_16x16x32_bf16 v[64:67], v[216:219], v[48:51], v[64:67]
    v_mfma_f32_16x16x32_bf16 v[68:71], a[16:19], v[4:7], v[80:83]
    v_mfma_f32_16x16x32_bf16 v[68:71], a[40:43], v[8:11], v[68:71]
    s_waitcnt vmcnt(5) lgkmcnt(1)
    s_barrier
    v_mfma_f32_16x16x32_bf16 v[68:71], a[64:67], v[12:15], v[68:71]
    ds_read_b128 v[240:243], v238 offset:12288
    v_mfma_f32_16x16x32_bf16 v[68:71], a[88:91], v[16:19], v[68:71]
    ds_read_b128 v[244:247], v238 offset:13312
    v_mfma_f32_16x16x32_bf16 v[68:71], a[112:115], v[20:23], v[68:71]
    v_mfma_f32_16x16x32_bf16 v[68:71], a[136:139], v[24:27], v[68:71]
    v_mfma_f32_16x16x32_bf16 v[72:75], a[20:23], v[4:7], v[84:87]
    ds_read_b128 v[4:7], v228 offset:36864
    v_mfma_f32_16x16x32_bf16 v[72:75], a[44:47], v[8:11], v[72:75]
    ds_read_b128 v[248:251], v238 offset:14336
    v_mfma_f32_16x16x32_bf16 v[72:75], a[68:71], v[12:15], v[72:75]
    ds_read_b128 v[8:11], v229 offset:36864
    v_mfma_f32_16x16x32_bf16 v[72:75], a[92:95], v[16:19], v[72:75]
    v_cvt_pk_bf16_f32 v2, v64, v65
    v_cvt_pk_bf16_f32 v3, v66, v67
    v_mfma_f32_16x16x32_bf16 v[72:75], a[116:119], v[20:23], v[72:75]
    ds_read_b128 v[12:15], v230 offset:36864
    v_mfma_f32_16x16x32_bf16 v[72:75], a[140:143], v[24:27], v[72:75]
    ds_write_b128 v236, v[0:3] offset:24576
    v_mfma_f32_16x16x32_bf16 v[68:71], a[160:163], v[28:31], v[68:71]
    ds_read_b128 v[16:19], v231 offset:36864
    v_mfma_f32_16x16x32_bf16 v[68:71], a[184:187], v[32:35], v[68:71]
    v_mfma_f32_16x16x32_bf16 v[68:71], a[208:211], v[36:39], v[68:71]
    s_waitcnt lgkmcnt(7)
    buffer_store_dwordx4 v[240:243], v232, s[36:39], s56 offen sc1
    ds_read_b128 v[20:23], v228 offset:37120
    v_mfma_f32_16x16x32_bf16 v[68:71], a[232:235], v[40:43], v[68:71]
    v_mfma_f32_16x16x32_bf16 v[68:71], v[196:199], v[44:47], v[68:71]
    ds_read_b128 v[24:27], v229 offset:37120
    v_mfma_f32_16x16x32_bf16 v[68:71], v[220:223], v[48:51], v[68:71]
    v_mfma_f32_16x16x32_bf16 v[72:75], a[164:167], v[28:31], v[72:75]
    s_waitcnt lgkmcnt(8)
    buffer_store_dwordx4 v[244:247], v233, s[36:39], s56 offen offset:1024 sc1
    ds_read_b128 v[28:31], v230 offset:37120
    v_mfma_f32_16x16x32_bf16 v[72:75], a[188:191], v[32:35], v[72:75]
    ds_read_b128 v[32:35], v231 offset:37120
    v_mfma_f32_16x16x32_bf16 v[72:75], a[212:215], v[36:39], v[72:75]
    ds_read_b128 v[36:39], v228 offset:37376
    v_mfma_f32_16x16x32_bf16 v[72:75], a[236:239], v[40:43], v[72:75]
    ds_read_b128 v[40:43], v229 offset:37376
    v_mfma_f32_16x16x32_bf16 v[72:75], v[200:203], v[44:47], v[72:75]
    s_waitcnt lgkmcnt(10)
    buffer_store_dwordx4 v[248:251], v234, s[36:39], s56 offen offset:2048 sc1
    s_add_u32 s56, s78, 294912
    ds_read_b128 v[44:47], v230 offset:37376
    v_mfma_f32_16x16x32_bf16 v[72:75], v[224:227], v[48:51], v[72:75]
    ds_read_b128 v[48:51], v231 offset:37376
    s_waitcnt lgkmcnt(10)
    v_mfma_f32_16x16x32_bf16 v[52:55], a[0:3], v[4:7], v[184:187]
    v_mfma_f32_16x16x32_bf16 v[52:55], a[24:27], v[8:11], v[52:55]
    s_add_u32 s83, s83, 1
    v_mfma_f32_16x16x32_bf16 v[52:55], a[48:51], v[12:15], v[52:55]
    s_waitcnt lgkmcnt(6)
    v_mfma_f32_16x16x32_bf16 v[52:55], a[72:75], v[16:19], v[52:55]
    v_cvt_pk_bf16_f32 v0, v68, v69
    v_cvt_pk_bf16_f32 v1, v70, v71
    v_mfma_f32_16x16x32_bf16 v[52:55], a[96:99], v[20:23], v[52:55]
    v_mfma_f32_16x16x32_bf16 v[52:55], a[120:123], v[24:27], v[52:55]
    s_waitcnt lgkmcnt(3)
    v_mfma_f32_16x16x32_bf16 v[52:55], a[144:147], v[28:31], v[52:55]
    v_mfma_f32_16x16x32_bf16 v[52:55], a[168:171], v[32:35], v[52:55]
    v_mfma_f32_16x16x32_bf16 v[52:55], a[192:195], v[36:39], v[52:55]
    s_waitcnt lgkmcnt(0)
    v_mfma_f32_16x16x32_bf16 v[52:55], a[216:219], v[40:43], v[52:55]
    v_cvt_pk_bf16_f32 v2, v72, v73
    v_cvt_pk_bf16_f32 v3, v74, v75
    v_mfma_f32_16x16x32_bf16 v[52:55], a[240:243], v[44:47], v[52:55]
    ds_write_b128 v237, v[0:3] offset:24576
    v_mfma_f32_16x16x32_bf16 v[52:55], v[204:207], v[48:51], v[52:55]
    v_mfma_f32_16x16x32_bf16 v[56:59], a[4:7], v[4:7], v[188:191]
    s_add_u32 s55, s97, 768
    v_mfma_f32_16x16x32_bf16 v[56:59], a[28:31], v[8:11], v[56:59]
    s_add_u32 m0, s49, 147456
    v_mfma_f32_16x16x32_bf16 v[56:59], a[52:55], v[12:15], v[56:59]
    buffer_load_dwordx4 v232, s[20:23], s55 offen nt lds
    v_mfma_f32_16x16x32_bf16 v[56:59], a[76:79], v[16:19], v[56:59]
    v_mfma_f32_16x16x32_bf16 v[56:59], a[100:103], v[20:23], v[56:59]
    v_mfma_f32_16x16x32_bf16 v[56:59], a[124:127], v[24:27], v[56:59]
    buffer_load_dwordx4 v233, s[20:23], s55 offen offset:1024 nt lds
    v_mfma_f32_16x16x32_bf16 v[56:59], a[148:151], v[28:31], v[56:59]
    v_mfma_f32_16x16x32_bf16 v[56:59], a[172:175], v[32:35], v[56:59]
    v_mfma_f32_16x16x32_bf16 v[56:59], a[196:199], v[36:39], v[56:59]
    v_mfma_f32_16x16x32_bf16 v[56:59], a[220:223], v[40:43], v[56:59]
    v_cvt_pk_bf16_f32 v0, v52, v53
    v_cvt_pk_bf16_f32 v1, v54, v55
    v_mfma_f32_16x16x32_bf16 v[56:59], a[244:247], v[44:47], v[56:59]
    v_mfma_f32_16x16x32_bf16 v[56:59], v[208:211], v[48:51], v[56:59]
    v_mfma_f32_16x16x32_bf16 v[60:63], a[8:11], v[4:7], v[192:195]
    v_mfma_f32_16x16x32_bf16 v[60:63], a[32:35], v[8:11], v[60:63]
    v_mfma_f32_16x16x32_bf16 v[60:63], a[56:59], v[12:15], v[60:63]
    v_mfma_f32_16x16x32_bf16 v[60:63], a[80:83], v[16:19], v[60:63]
    v_mfma_f32_16x16x32_bf16 v[60:63], a[104:107], v[20:23], v[60:63]
    v_mfma_f32_16x16x32_bf16 v[60:63], a[128:131], v[24:27], v[60:63]
    v_mfma_f32_16x16x32_bf16 v[60:63], a[152:155], v[28:31], v[60:63]
    v_mfma_f32_16x16x32_bf16 v[60:63], a[176:179], v[32:35], v[60:63]
    v_mfma_f32_16x16x32_bf16 v[60:63], a[200:203], v[36:39], v[60:63]
    v_cvt_pk_bf16_f32 v2, v56, v57
    v_cvt_pk_bf16_f32 v3, v58, v59
    v_mfma_f32_16x16x32_bf16 v[60:63], a[224:227], v[40:43], v[60:63]
    ds_write_b128 v235, v[0:3] offset:36864
    v_mfma_f32_16x16x32_bf16 v[60:63], a[248:251], v[44:47], v[60:63]
    v_mfma_f32_16x16x32_bf16 v[60:63], v[212:215], v[48:51], v[60:63]
    v_mfma_f32_16x16x32_bf16 v[64:67], a[12:15], v[4:7], v[76:79]
    v_mfma_f32_16x16x32_bf16 v[64:67], a[36:39], v[8:11], v[64:67]
    v_mfma_f32_16x16x32_bf16 v[64:67], a[60:63], v[12:15], v[64:67]
    v_mfma_f32_16x16x32_bf16 v[64:67], a[84:87], v[16:19], v[64:67]
    v_mfma_f32_16x16x32_bf16 v[64:67], a[108:111], v[20:23], v[64:67]
    v_mfma_f32_16x16x32_bf16 v[64:67], a[132:135], v[24:27], v[64:67]
    v_mfma_f32_16x16x32_bf16 v[64:67], a[156:159], v[28:31], v[64:67]
    v_mfma_f32_16x16x32_bf16 v[64:67], a[180:183], v[32:35], v[64:67]
    v_mfma_f32_16x16x32_bf16 v[64:67], a[204:207], v[36:39], v[64:67]
    v_cvt_pk_bf16_f32 v0, v60, v61
    v_cvt_pk_bf16_f32 v1, v62, v63
    v_mfma_f32_16x16x32_bf16 v[64:67], a[228:231], v[40:43], v[64:67]
    v_mfma_f32_16x16x32_bf16 v[64:67], a[252:255], v[44:47], v[64:67]
    v_mfma_f32_16x16x32_bf16 v[64:67], v[216:219], v[48:51], v[64:67]
    v_mfma_f32_16x16x32_bf16 v[68:71], a[16:19], v[4:7], v[80:83]
    v_mfma_f32_16x16x32_bf16 v[68:71], a[40:43], v[8:11], v[68:71]
    s_waitcnt lgkmcnt(1)
    s_barrier
    v_mfma_f32_16x16x32_bf16 v[68:71], a[64:67], v[12:15], v[68:71]
    ds_read_b128 v[240:243], v238 offset:24576
    v_mfma_f32_16x16x32_bf16 v[68:71], a[88:91], v[16:19], v[68:71]
    ds_read_b128 v[244:247], v238 offset:25600
    v_mfma_f32_16x16x32_bf16 v[68:71], a[112:115], v[20:23], v[68:71]
    v_mfma_f32_16x16x32_bf16 v[68:71], a[136:139], v[24:27], v[68:71]
    v_mfma_f32_16x16x32_bf16 v[72:75], a[20:23], v[4:7], v[84:87]
    v_mfma_f32_16x16x32_bf16 v[72:75], a[44:47], v[8:11], v[72:75]
    ds_read_b128 v[248:251], v238 offset:26624
    v_mfma_f32_16x16x32_bf16 v[72:75], a[68:71], v[12:15], v[72:75]
    v_mfma_f32_16x16x32_bf16 v[72:75], a[92:95], v[16:19], v[72:75]
    v_cvt_pk_bf16_f32 v2, v64, v65
    v_cvt_pk_bf16_f32 v3, v66, v67
    v_mfma_f32_16x16x32_bf16 v[72:75], a[116:119], v[20:23], v[72:75]
    v_mfma_f32_16x16x32_bf16 v[72:75], a[140:143], v[24:27], v[72:75]
    ds_write_b128 v236, v[0:3] offset:36864
    v_mfma_f32_16x16x32_bf16 v[68:71], a[160:163], v[28:31], v[68:71]
    v_mfma_f32_16x16x32_bf16 v[68:71], a[184:187], v[32:35], v[68:71]
    v_mfma_f32_16x16x32_bf16 v[68:71], a[208:211], v[36:39], v[68:71]
    s_waitcnt lgkmcnt(3)
    buffer_store_dwordx4 v[240:243], v232, s[36:39], s56 offen sc1
    v_mfma_f32_16x16x32_bf16 v[68:71], a[232:235], v[40:43], v[68:71]
    v_mfma_f32_16x16x32_bf16 v[68:71], v[196:199], v[44:47], v[68:71]
    v_mfma_f32_16x16x32_bf16 v[68:71], v[220:223], v[48:51], v[68:71]
    v_mfma_f32_16x16x32_bf16 v[72:75], a[164:167], v[28:31], v[72:75]
    s_waitcnt lgkmcnt(2)
    buffer_store_dwordx4 v[244:247], v233, s[36:39], s56 offen offset:1024 sc1
    v_mfma_f32_16x16x32_bf16 v[72:75], a[188:191], v[32:35], v[72:75]
    v_mfma_f32_16x16x32_bf16 v[72:75], a[212:215], v[36:39], v[72:75]
    v_mfma_f32_16x16x32_bf16 v[72:75], a[236:239], v[40:43], v[72:75]
    v_mfma_f32_16x16x32_bf16 v[72:75], v[200:203], v[44:47], v[72:75]
    s_waitcnt lgkmcnt(1)
    buffer_store_dwordx4 v[248:251], v234, s[36:39], s56 offen offset:2048 sc1
    s_add_u32 s56, s78, 295680
    v_mfma_f32_16x16x32_bf16 v[72:75], v[224:227], v[48:51], v[72:75]
    s_nop 3
    v_cvt_pk_bf16_f32 v0, v68, v69
    v_cvt_pk_bf16_f32 v1, v70, v71
    s_nop 4
    v_cvt_pk_bf16_f32 v2, v72, v73
    v_cvt_pk_bf16_f32 v3, v74, v75
    ds_write_b128 v237, v[0:3] offset:36864
    s_waitcnt lgkmcnt(0)
    s_barrier
    ds_read_b128 v[240:243], v238 offset:36864
    ds_read_b128 v[244:247], v238 offset:37888
    ds_read_b128 v[248:251], v238 offset:38912
    s_waitcnt lgkmcnt(2)
    buffer_store_dwordx4 v[240:243], v232, s[36:39], s56 offen sc1
    s_waitcnt lgkmcnt(1)
    buffer_store_dwordx4 v[244:247], v233, s[36:39], s56 offen offset:1024 sc1
    s_waitcnt lgkmcnt(0)
    buffer_store_dwordx4 v[248:251], v234, s[36:39], s56 offen offset:2048 sc1
    s_endpgm
L_prod:
    v_mul_u32_u24 v136, 192, v2
    v_lshl_add_u32 v136, v3, 4, v136
    v_add_u32 v136, s71, v136
    v_and_b32 v137, 1, v3
    v_lshrrev_b32 v138, 1, v3
    v_bfe_u32 v139, v0, 2, 2
    v_lshl_add_u32 v139, v137, 3, v139
    v_mul_u32_u24 v139, 192, v139
    v_and_b32 v1, 3, v0
    v_lshl_add_u32 v139, v1, 4, v139
    v_lshl_add_u32 v139, v138, 3, v139
    v_add_u32 v139, s71, v139
    v_cvt_pk_bf16_f32 v112, v148, v149
    v_cvt_pk_bf16_f32 v113, v150, v151
    v_cvt_pk_bf16_f32 v114, v152, v153
    v_cvt_pk_bf16_f32 v115, v154, v155
    v_cvt_pk_bf16_f32 v116, v156, v157
    v_cvt_pk_bf16_f32 v117, v158, v159
    v_cvt_pk_bf16_f32 v118, v160, v161
    v_cvt_pk_bf16_f32 v119, v162, v163
    v_cvt_pk_bf16_f32 v120, v164, v165
    v_cvt_pk_bf16_f32 v121, v166, v167
    v_cvt_pk_bf16_f32 v122, v168, v169
    v_cvt_pk_bf16_f32 v123, v170, v171
    ds_write_b128 v136, v[112:115] offset:0
    ds_write_b128 v136, v[116:119] offset:64
    ds_write_b128 v136, v[120:123] offset:128
    ds_read_b64_tr_b16 v[124:125], v139 offset:0
    ds_read_b64_tr_b16 v[126:127], v139 offset:768
    ds_read_b64_tr_b16 v[128:129], v139 offset:64
    ds_read_b64_tr_b16 v[130:131], v139 offset:832
    ds_read_b64_tr_b16 v[132:133], v139 offset:128
    ds_read_b64_tr_b16 v[134:135], v139 offset:896
    v_lshl_add_u32 v1, v137, 4, v2
    v_lshlrev_b32 v1, 4, v1
    v_lshl_add_u32 v1, v138, 11, v1
    s_mul_i32 s57, s48, 73728
    v_add_u32 v1, s57, v1
    s_lshr_b32 s57, s60, 2
    s_mul_i32 s57, s57, 12288
    s_and_b32 s58, s60, 3
    s_lshl_b32 s58, s58, 9
    s_add_u32 s57, s57, s58
    s_add_u32 s58, s57, 4096
    s_add_u32 s68, s57, 8192
    s_waitcnt lgkmcnt(0)
    buffer_store_dwordx4 v[124:127], v1, s[40:43], s57 offen sc0 sc1
    buffer_store_dwordx4 v[128:131], v1, s[40:43], s58 offen sc0 sc1
    buffer_store_dwordx4 v[132:135], v1, s[40:43], s68 offen sc0 sc1
    s_waitcnt vmcnt(12)
    s_branch L_prod_ret
L_poll:
    s_load_dword s72, s[14:15], 64
    s_waitcnt lgkmcnt(0)
    s_cmp_ge_u32 s72, 24
    s_cbranch_scc1 L_got
    s_sleep 8
    s_load_dword s72, s[14:15], 128
    s_waitcnt lgkmcnt(0)
    s_cmp_ge_u32 s72, 24
    s_cbranch_scc1 L_got
    s_sleep 8
    s_load_dword s72, s[14:15], 192
    s_waitcnt lgkmcnt(0)
    s_cmp_ge_u32 s72, 24
    s_cbranch_scc1 L_got
    s_mov_b32 s58, 0
L_poll2:
    buffer_load_dword v254, off, s[44:47], 0 sc1
    s_waitcnt vmcnt(0)
    v_readfirstlane_b32 s72, v254
    s_nop 3
    s_cmp_ge_u32 s72, 24
    s_cbranch_scc1 L_got
    s_sleep 4
    s_add_u32 s58, s58, 1
    s_cmp_lt_u32 s58, 0x40000
    s_cbranch_scc1 L_poll2
L_got:
    s_mov_b32 exec_hi, 15
    buffer_load_dword v254, v253, s[40:43], 0 offen sc1
    s_mov_b64 exec, -1
    s_branch L_ready
L_end:
    s_endpgm
.section .rodata,"a"
.p2align 6
.amdhsa_kernel standalone__detection_seg_fpn_lateral__vision_kernel
  .amdhsa_next_free_vgpr 512
  .amdhsa_next_free_sgpr 102
  .amdhsa_accum_offset 256
  .amdhsa_group_segment_fixed_size 0
  .amdhsa_kernarg_size 56
  .amdhsa_user_sgpr_count 2
  .amdhsa_user_sgpr_kernarg_segment_ptr 1
  .amdhsa_system_sgpr_workgroup_id_x 1
.end_amdhsa_kernel
```

```asm
; @launch grid=(256,1,1) block=(256,1,1) lds=163840
.amdgcn_target "amdgcn-amd-amdhsa--gfx950"
.text
.globl standalone__detection_seg_fpn_lateral__vision_kernel
.p2align 8
.type standalone__detection_seg_fpn_lateral__vision_kernel,@function
standalone__detection_seg_fpn_lateral__vision_kernel:
    s_load_dwordx8 s[4:11], s[0:1], 0
    s_getpc_b64 s[18:19]
L_pc:
    s_cmp_ge_u32 s2, 256
    s_cbranch_scc1 L_end
    s_and_b32 s57, s2, 0x30
    s_cbranch_scc1 L_nocpf
    s_and_b32 s57, s2, 8
    s_lshl_b32 s57, s57, 12
    v_lshl_add_u32 v1, v0, 7, s57
    v_min_u32 v1, L_end-L_pc, v1
    global_load_dword v96, v1, s[18:19]
L_nocpf:
    v_lshrrev_b32 v1, 6, v0
    v_and_b32 v0, 63, v0
    v_readfirstlane_b32 s48, v1
    v_lshrrev_b32 v3, 4, v0
    v_lshlrev_b32 v85, 7, v0
    s_lshr_b32 s68, s2, 3
    s_lshl_b32 s68, s68, 2
    s_add_u32 s68, s68, s48
    s_mul_i32 s68, s68, 2304
    s_mul_i32 s49, s48, 3072
    s_mul_i32 s57, s48, 516
    v_mad_u32_u24 v80, v3, 43, s57
    v_lshl_add_u32 v81, v0, 4, s49
    v_lshrrev_b32 v1, 3, v80
    v_and_b32 v1, 0xf0, v1
    v_xor_b32 v244, v1, v81
    v_mad_u32_u24 v232, v1, 48, v244
    v_add_u32 v80, 172, v80
    v_lshrrev_b32 v1, 3, v80
    v_and_b32 v1, 0xf0, v1
    v_xor_b32 v245, v1, v81
    v_mad_u32_u24 v233, v1, 48, v245
    v_add_u32 v80, 172, v80
    v_lshrrev_b32 v1, 3, v80
    v_and_b32 v1, 0xf0, v1
    v_xor_b32 v246, v1, v81
    v_mad_u32_u24 v234, v1, 48, v246
    s_lshr_b32 s57, s2, 4
    s_lshl_b32 s60, s57, 2
    s_bfe_u32 s57, s2, 131073
    s_add_u32 s60, s60, s57
    s_and_b32 s57, s2, 9
    s_cselect_b32 s60, 99, s60
    s_bitcmp1_b32 s2, 3
    s_cselect_b32 s61, 2, 1
    s_cmp_lt_u32 s60, 24
    s_cselect_b32 s61, 0, s61
    s_mov_b32 s34, 294912
    s_mov_b32 s35, 0x20000
    s_mov_b32 s26, 28311552
    s_mov_b32 s27, 0x20000
    s_waitcnt lgkmcnt(0)
    s_mov_b64 s[32:33], s[10:11]
    s_mov_b64 exec, 0x3ffff
    buffer_load_dword v97, v85, s[32:35], s68 offen
    s_mov_b64 exec, -1
    s_mov_b64 s[24:25], s[6:7]
    s_load_dwordx4 s[12:15], s[0:1], 32
    s_load_dwordx2 s[16:17], s[0:1], 48
    s_cmp_eq_u32 s61, 1
    s_cbranch_scc1 L_pre_done
    s_cmp_eq_u32 s61, 2
    s_cbranch_scc1 L_pre_2
    s_mov_b32 s28, s8
    s_mov_b32 s29, s9
    s_mov_b32 s30, 294912
    s_mov_b32 s31, 0x20000
    s_mul_i32 s57, s60, 12288
    s_add_u32 s75, s57, 0
    s_add_u32 m0, s49, 110592
    s_nop 0
    buffer_load_dwordx4 v244, s[28:31], s75 offen lds
    buffer_load_dwordx4 v245, s[28:31], s75 offen offset:1024 lds
    buffer_load_dwordx4 v246, s[28:31], s75 offen offset:2048 lds
    s_branch L_pre_done
L_pre_2:
    s_add_u32 s76, s2, 0
    s_and_b32 s76, s76, 255
    s_add_u32 s76, s76, 0
    s_mul_i32 s76, s76, 12288
    s_add_u32 m0, s49, 110592
    s_nop 0
    buffer_load_dwordx4 v244, s[24:27], s76 offen nt lds
    buffer_load_dwordx4 v245, s[24:27], s76 offen offset:1024 nt lds
    buffer_load_dwordx4 v246, s[24:27], s76 offen offset:2048 nt lds
    s_add_u32 s77, s2, 43
    s_and_b32 s77, s77, 255
    s_add_u32 s77, s77, 256
    s_mul_i32 s77, s77, 12288
    s_add_u32 m0, s49, 122880
    s_nop 0
    buffer_load_dwordx4 v244, s[24:27], s77 offen nt lds
    buffer_load_dwordx4 v245, s[24:27], s77 offen offset:1024 nt lds
    buffer_load_dwordx4 v246, s[24:27], s77 offen offset:2048 nt lds
    s_add_u32 s74, s2, 86
    s_and_b32 s74, s74, 255
    s_add_u32 s74, s74, 512
    s_mul_i32 s74, s74, 12288
    s_add_u32 m0, s49, 135168
    s_nop 0
    buffer_load_dwordx4 v244, s[24:27], s74 offen nt lds
    buffer_load_dwordx4 v245, s[24:27], s74 offen offset:1024 nt lds
    buffer_load_dwordx4 v246, s[24:27], s74 offen offset:2048 nt lds
    s_add_u32 s75, s2, 129
    s_and_b32 s75, s75, 255
    s_add_u32 s75, s75, 768
    s_mul_i32 s75, s75, 12288
    s_add_u32 m0, s49, 24576
    s_nop 0
    buffer_load_dwordx4 v244, s[24:27], s75 offen nt lds
    buffer_load_dwordx4 v245, s[24:27], s75 offen offset:1024 nt lds
    buffer_load_dwordx4 v246, s[24:27], s75 offen offset:2048 nt lds
    s_add_u32 s76, s2, 172
    s_and_b32 s76, s76, 255
    s_add_u32 s76, s76, 1024
    s_mul_i32 s76, s76, 12288
    s_add_u32 m0, s49, 36864
    s_nop 0
    buffer_load_dwordx4 v244, s[24:27], s76 offen nt lds
    buffer_load_dwordx4 v245, s[24:27], s76 offen offset:1024 nt lds
    buffer_load_dwordx4 v246, s[24:27], s76 offen offset:2048 nt lds
    s_add_u32 s77, s2, 215
    s_and_b32 s77, s77, 255
    s_add_u32 s77, s77, 1280
    s_mul_i32 s77, s77, 12288
    s_add_u32 m0, s49, 98304
    s_nop 0
    buffer_load_dwordx4 v244, s[24:27], s77 offen nt lds
    buffer_load_dwordx4 v245, s[24:27], s77 offen offset:1024 nt lds
    buffer_load_dwordx4 v246, s[24:27], s77 offen offset:2048 nt lds
L_pre_done:
    s_mul_i32 s57, s48, 192
    s_and_b32 s58, s48, 1
    s_lshl_b32 s50, s58, 6
    s_add_u32 s50, s50, s57
    s_xor_b32 s58, s58, 1
    s_lshl_b32 s51, s58, 7
    s_add_u32 s51, s51, s57
    v_lshrrev_b32 v76, 3, v0
    v_and_b32 v77, 7, v0
    v_lshrrev_b32 v78, 2, v0
    v_and_b32 v79, 3, v0
    v_and_b32 v1, 4, v78
    v_xor_b32 v1, v1, v77
    v_mul_u32_u24 v247, 768, v76
    v_lshl_add_u32 v247, v1, 4, v247
    v_add_u32 v247, s50, v247
    v_mul_u32_u24 v248, 768, v78
    v_lshl_add_u32 v248, v79, 4, v248
    v_add_u32 v248, s51, v248
    s_mul_i32 s70, s48, 12288
    s_add_u32 s70, s70, 49152
    s_lshl_b32 s71, s48, 12
    s_add_u32 s71, s71, 147456
    s_add_u32 m0, s70, 0
    s_mov_b32 s74, 0
    buffer_load_dwordx4 v247, s[32:35], s74 offen lds
    s_mov_b32 s75, 5120
    buffer_load_dwordx4 v247, s[32:35], s75 offen offset:1024 lds
    s_mov_b32 s76, 10240
    buffer_load_dwordx4 v247, s[32:35], s76 offen offset:2048 lds
    s_mov_b32 s77, 15360
    buffer_load_dwordx4 v247, s[32:35], s77 offen offset:3072 lds
    s_add_u32 m0, s71, 0
    s_mov_b32 s74, 0
    buffer_load_dwordx4 v248, s[32:35], s74 offen lds
    s_mov_b32 s75, 11264
    buffer_load_dwordx4 v248, s[32:35], s75 offen offset:1024 lds
    s_add_u32 m0, s70, 4096
    s_mov_b32 s76, 24576
    buffer_load_dwordx4 v247, s[32:35], s76 offen lds
    s_mov_b32 s77, 29696
    buffer_load_dwordx4 v247, s[32:35], s77 offen offset:1024 lds
    s_mov_b32 s74, 34816
    buffer_load_dwordx4 v247, s[32:35], s74 offen offset:2048 lds
    s_mov_b32 s75, 39936
    buffer_load_dwordx4 v247, s[32:35], s75 offen offset:3072 lds
    s_add_u32 m0, s71, 2048
    s_mov_b32 s76, 24576
    buffer_load_dwordx4 v248, s[32:35], s76 offen lds
    s_mov_b32 s77, 35840
    buffer_load_dwordx4 v248, s[32:35], s77 offen offset:1024 lds
    s_add_u32 m0, s70, 8192
    s_mov_b32 s74, 49152
    buffer_load_dwordx4 v247, s[32:35], s74 offen lds
    s_mov_b32 s75, 54272
    buffer_load_dwordx4 v247, s[32:35], s75 offen offset:1024 lds
    s_mov_b32 s76, 59392
    buffer_load_dwordx4 v247, s[32:35], s76 offen offset:2048 lds
    s_mov_b32 s77, 64512
    buffer_load_dwordx4 v247, s[32:35], s77 offen offset:3072 lds
    v_and_b32 v2, 15, v0
    s_mov_b32 s20, s4
    s_mov_b32 s21, s5
    s_mov_b32 s22, 113246208
    s_mov_b32 s23, 0x20000
    s_mul_hi_u32 s57, s2, 0x15555556
    s_mul_i32 s57, s57, 294912
    s_mul_i32 s78, s2, 24576
    s_add_u32 s78, s78, s57
    s_add_u32 s67, s2, 43
    s_and_b32 s67, s67, 255
    s_add_u32 s87, s67, 256
    s_mul_hi_u32 s57, s87, 0x15555556
    s_mul_i32 s57, s57, 294912
    s_mul_i32 s79, s87, 24576
    s_add_u32 s79, s79, s57
    s_bfe_u32 s85, s2, 196612
    s_add_u32 s85, s85, 1
    s_mul_i32 s68, s85, 43
    s_add_u32 s68, s68, s2
    s_and_b32 s68, s68, 255
    s_lshl_b32 s58, s85, 8
    s_add_u32 s68, s68, s58
    s_mul_hi_u32 s57, s68, 0x15555556
    s_mul_i32 s57, s57, 294912
    s_mul_i32 s84, s68, 24576
    s_add_u32 s84, s84, s57
    s_cmp_eq_u32 s61, 2
    s_cselect_b32 s85, 59, s85
    v_and_b32 v1, 3, v78
    v_lshl_add_u32 v80, v3, 3, v1
    v_and_b32 v1, 2, v1
    v_lshl_add_u32 v1, v1, 1, v79
    v_lshlrev_b32 v1, 4, v1
    v_lshl_add_u32 v249, v80, 7, v1
    v_add_u32 v249, s70, v249
    v_xor_b32 v250, 64, v249
    v_lshlrev_b32 v1, 4, v79
    v_lshl_add_u32 v251, v80, 6, v1
    v_add_u32 v251, s71, v251
    v_xor_b32 v1, v2, v3
    v_lshlrev_b32 v1, 4, v1
    v_mul_u32_u24 v80, 768, v2
    v_add_u32 v228, v80, v1
    v_xor_b32 v229, 64, v228
    v_xor_b32 v230, 128, v228
    v_xor_b32 v231, 192, v228
    s_mov_b32 s57, 73728
    s_cmp_eq_u32 s61, 1
    s_cselect_b32 s57, 163840, s57
    v_add_u32 v240, s57, v228
    v_add_u32 v241, s57, v229
    v_add_u32 v242, s57, v230
    v_add_u32 v243, s57, v231
    s_mov_b32 s57, s50
    s_and_b32 s58, s57, 0xc0
    s_andn2_b32 s57, s57, 0xff
    s_add_u32 s57, s57, 98304
    v_xor_b32 v235, s58, v228
    v_add_u32 v235, s57, v235
    s_add_u32 s57, s50, 64
    s_and_b32 s58, s57, 0xc0
    s_andn2_b32 s57, s57, 0xff
    s_add_u32 s57, s57, 98304
    v_xor_b32 v236, s58, v228
    v_add_u32 v236, s57, v236
    s_mov_b32 s57, s51
    s_and_b32 s58, s57, 0xc0
    s_andn2_b32 s57, s57, 0xff
    s_add_u32 s57, s57, 98304
    v_xor_b32 v237, s58, v228
    v_add_u32 v237, s57, v237
    s_add_u32 s57, s49, 98304
    v_lshlrev_b32 v1, 4, v0
    v_add_u32 v238, s57, v1
    s_mul_i32 s57, s48, 73728
    v_add_u32 v252, s57, v1
    s_lshr_b32 s58, s2, 4
    s_lshl_b32 s58, s58, 2
    s_add_u32 s58, s58, s48
    s_mul_i32 s58, s58, 4608
    v_add_u32 v253, s58, v85
    s_cmp_eq_u32 s61, 2
    s_cselect_b32 s62, 2147483648, 0
    s_cselect_b32 s63, 90112, s49
    s_cselect_b32 s64, 163840, s49
    s_mov_b32 s58, 1
    s_waitcnt lgkmcnt(0)
    s_mov_b32 s36, s12
    s_mov_b32 s37, s13
    s_mov_b32 s38, 113246208
    s_mov_b32 s39, 0x20000
    s_mov_b32 s40, s16
    s_mov_b32 s41, s17
    s_mov_b32 s42, 1048576
    s_mov_b32 s43, 0x20000
    s_bfe_u32 s66, s2, 131076
    s_lshl_b32 s66, s66, 2
    s_add_u32 s66, s66, s48
    s_lshl_b32 s66, s66, 7
    s_add_u32 s66, s66, 0x80000
    buffer_load_dword v239, off, s[40:43], s66 sc1
    s_mov_b32 s44, s14
    s_mov_b32 s45, s15
    s_mov_b32 s46, 256
    s_mov_b32 s47, 0x20000
    s_mov_b32 s59, 0xffff0000
    s_mov_b32 s19, 1
    s_cmp_eq_u32 s58, 1
    s_cselect_b32 s81, s78, 2147483648
    s_cselect_b32 s82, s49, 163840
    s_mov_b32 s54, 0
    s_getreg_b32 s57, hwreg(HW_REG_XCC_ID)
    s_bitcmp0_b32 s57, 0
    s_cselect_b64 vcc, -1, 0
    s_cmp_eq_u32 s61, 0
    s_cselect_b64 vcc, 0, vcc
    s_mov_b32 s65, 1
    s_mov_b64 s[98:99], vcc
    s_mov_b32 s83, 0
    s_brev_b32 s56, 1
    s_mov_b32 s97, s78
    s_waitcnt vmcnt(10)
    s_barrier
    ds_read_b64_tr_b16 a[16:17], v251 offset:0
    ds_read_b64_tr_b16 a[18:19], v251 offset:256
    ds_read_b64_tr_b16 a[20:21], v251 offset:8
    ds_read_b64_tr_b16 a[22:23], v251 offset:264
    ds_read_b64_tr_b16 a[0:1], v249 offset:0
    ds_read_b64_tr_b16 a[2:3], v249 offset:512
    ds_read_b64_tr_b16 a[4:5], v249 offset:8
    ds_read_b64_tr_b16 a[6:7], v249 offset:520
    ds_read_b64_tr_b16 a[8:9], v250 offset:0
    ds_read_b64_tr_b16 a[10:11], v250 offset:512
    ds_read_b64_tr_b16 a[12:13], v250 offset:8
    ds_read_b64_tr_b16 a[14:15], v250 offset:520
    ds_read_b128 v[4:7], v240 offset:36864
    ds_read_b128 v[8:11], v240 offset:49152
    ds_read_b128 v[12:15], v240 offset:61440
    s_waitcnt lgkmcnt(11)
    s_add_u32 m0, s71, 0
    s_mov_b32 s74, 49152
    buffer_load_dwordx4 v248, s[32:35], s74 offen lds
    s_mov_b32 s75, 60416
    buffer_load_dwordx4 v248, s[32:35], s75 offen offset:1024 lds
    s_waitcnt lgkmcnt(0)
    s_add_u32 m0, s70, 0
    s_mov_b32 s76, 73728
    buffer_load_dwordx4 v247, s[32:35], s76 offen lds
    s_mov_b32 s77, 78848
    buffer_load_dwordx4 v247, s[32:35], s77 offen offset:1024 lds
    s_mov_b32 s74, 83968
    buffer_load_dwordx4 v247, s[32:35], s74 offen offset:2048 lds
    s_mov_b32 s75, 89088
    buffer_load_dwordx4 v247, s[32:35], s75 offen offset:3072 lds
    s_waitcnt vmcnt(10)
    ds_read_b64_tr_b16 a[40:41], v251 offset:2048
    ds_read_b64_tr_b16 a[42:43], v251 offset:2304
    v_mfma_f32_16x16x32_bf16 v[148:151], a[0:3], v[4:7], 0
    ds_read_b64_tr_b16 a[44:45], v251 offset:2056
    ds_read_b64_tr_b16 a[46:47], v251 offset:2312
    v_mfma_f32_16x16x32_bf16 v[172:175], a[0:3], v[8:11], 0
    ds_read_b64_tr_b16 a[24:25], v249 offset:4096
    ds_read_b64_tr_b16 a[26:27], v249 offset:4608
    v_mfma_f32_16x16x32_bf16 v[52:55], a[0:3], v[12:15], 0
    ds_read_b64_tr_b16 a[28:29], v249 offset:4104
    ds_read_b64_tr_b16 a[30:31], v249 offset:4616
    v_mfma_f32_16x16x32_bf16 v[152:155], a[4:7], v[4:7], 0
    ds_read_b64_tr_b16 a[32:33], v250 offset:4096
    ds_read_b64_tr_b16 a[34:35], v250 offset:4608
    v_mfma_f32_16x16x32_bf16 v[176:179], a[4:7], v[8:11], 0
    ds_read_b64_tr_b16 a[36:37], v250 offset:4104
    ds_read_b64_tr_b16 a[38:39], v250 offset:4616
    v_mfma_f32_16x16x32_bf16 v[56:59], a[4:7], v[12:15], 0
    ds_read_b128 v[16:19], v241 offset:36864
    ds_read_b128 v[20:23], v241 offset:49152
    s_waitcnt lgkmcnt(10)
    s_add_u32 m0, s71, 2048
    s_mov_b32 s76, 73728
    buffer_load_dwordx4 v248, s[32:35], s76 offen lds
    v_mfma_f32_16x16x32_bf16 v[156:159], a[8:11], v[4:7], 0
    ds_read_b128 v[24:27], v241 offset:61440
    v_mfma_f32_16x16x32_bf16 v[180:183], a[8:11], v[8:11], 0
    s_mov_b32 s77, 84992
    buffer_load_dwordx4 v248, s[32:35], s77 offen offset:1024 lds
    v_mfma_f32_16x16x32_bf16 v[60:63], a[8:11], v[12:15], 0
    v_mfma_f32_16x16x32_bf16 v[160:163], a[12:15], v[4:7], 0
    v_mfma_f32_16x16x32_bf16 v[184:187], a[12:15], v[8:11], 0
    v_mfma_f32_16x16x32_bf16 v[64:67], a[12:15], v[12:15], 0
    s_waitcnt lgkmcnt(0)
    s_add_u32 m0, s70, 4096
    s_mov_b32 s74, 98304
    buffer_load_dwordx4 v247, s[32:35], s74 offen lds
    v_mfma_f32_16x16x32_bf16 v[164:167], a[16:19], v[4:7], 0
    s_mov_b32 s75, 103424
    buffer_load_dwordx4 v247, s[32:35], s75 offen offset:1024 lds
    v_mfma_f32_16x16x32_bf16 v[188:191], a[16:19], v[8:11], 0
    s_mov_b32 s76, 108544
    buffer_load_dwordx4 v247, s[32:35], s76 offen offset:2048 lds
    v_mfma_f32_16x16x32_bf16 v[68:71], a[16:19], v[12:15], 0
    s_mov_b32 s77, 113664
    buffer_load_dwordx4 v247, s[32:35], s77 offen offset:3072 lds
    v_mfma_f32_16x16x32_bf16 v[168:171], a[20:23], v[4:7], 0
    v_mfma_f32_16x16x32_bf16 v[192:195], a[20:23], v[8:11], 0
    v_mfma_f32_16x16x32_bf16 v[72:75], a[20:23], v[12:15], 0
    s_waitcnt vmcnt(10)
    ds_read_b64_tr_b16 a[64:65], v251 offset:0
    ds_read_b64_tr_b16 a[66:67], v251 offset:256
    v_mfma_f32_16x16x32_bf16 v[148:151], a[24:27], v[16:19], v[148:151]
    ds_read_b64_tr_b16 a[68:69], v251 offset:8
    ds_read_b64_tr_b16 a[70:71], v251 offset:264
    v_mfma_f32_16x16x32_bf16 v[172:175], a[24:27], v[20:23], v[172:175]
    ds_read_b64_tr_b16 a[48:49], v249 offset:8192
    ds_read_b64_tr_b16 a[50:51], v249 offset:8704
    v_mfma_f32_16x16x32_bf16 v[52:55], a[24:27], v[24:27], v[52:55]
    ds_read_b64_tr_b16 a[52:53], v249 offset:8200
    ds_read_b64_tr_b16 a[54:55], v249 offset:8712
    v_mfma_f32_16x16x32_bf16 v[152:155], a[28:31], v[16:19], v[152:155]
    ds_read_b64_tr_b16 a[56:57], v250 offset:8192
    ds_read_b64_tr_b16 a[58:59], v250 offset:8704
    v_mfma_f32_16x16x32_bf16 v[176:179], a[28:31], v[20:23], v[176:179]
    ds_read_b64_tr_b16 a[60:61], v250 offset:8200
    ds_read_b64_tr_b16 a[62:63], v250 offset:8712
    v_mfma_f32_16x16x32_bf16 v[56:59], a[28:31], v[24:27], v[56:59]
    ds_read_b128 v[28:31], v242 offset:36864
    ds_read_b128 v[32:35], v242 offset:49152
    s_waitcnt lgkmcnt(10)
    s_add_u32 m0, s71, 0
    s_mov_b32 s74, 98304
    buffer_load_dwordx4 v248, s[32:35], s74 offen lds
    v_mfma_f32_16x16x32_bf16 v[156:159], a[32:35], v[16:19], v[156:159]
    ds_read_b128 v[36:39], v242 offset:61440
    v_mfma_f32_16x16x32_bf16 v[180:183], a[32:35], v[20:23], v[180:183]
    s_mov_b32 s75, 109568
    buffer_load_dwordx4 v248, s[32:35], s75 offen offset:1024 lds
    v_mfma_f32_16x16x32_bf16 v[60:63], a[32:35], v[24:27], v[60:63]
    v_mfma_f32_16x16x32_bf16 v[160:163], a[36:39], v[16:19], v[160:163]
    v_mfma_f32_16x16x32_bf16 v[184:187], a[36:39], v[20:23], v[184:187]
    v_mfma_f32_16x16x32_bf16 v[64:67], a[36:39], v[24:27], v[64:67]
    s_waitcnt lgkmcnt(0)
    s_add_u32 m0, s70, 8192
    s_mov_b32 s76, 122880
    buffer_load_dwordx4 v247, s[32:35], s76 offen lds
    v_mfma_f32_16x16x32_bf16 v[164:167], a[40:43], v[16:19], v[164:167]
    s_mov_b32 s77, 128000
    buffer_load_dwordx4 v247, s[32:35], s77 offen offset:1024 lds
    v_mfma_f32_16x16x32_bf16 v[188:191], a[40:43], v[20:23], v[188:191]
    s_mov_b32 s74, 133120
    buffer_load_dwordx4 v247, s[32:35], s74 offen offset:2048 lds
    v_mfma_f32_16x16x32_bf16 v[68:71], a[40:43], v[24:27], v[68:71]
    s_mov_b32 s75, 138240
    buffer_load_dwordx4 v247, s[32:35], s75 offen offset:3072 lds
    v_mfma_f32_16x16x32_bf16 v[168:171], a[44:47], v[16:19], v[168:171]
    v_mfma_f32_16x16x32_bf16 v[192:195], a[44:47], v[20:23], v[192:195]
    v_mfma_f32_16x16x32_bf16 v[72:75], a[44:47], v[24:27], v[72:75]
    s_waitcnt vmcnt(10)
    ds_read_b64_tr_b16 a[88:89], v251 offset:2048
    ds_read_b64_tr_b16 a[90:91], v251 offset:2304
    v_mfma_f32_16x16x32_bf16 v[148:151], a[48:51], v[28:31], v[148:151]
    ds_read_b64_tr_b16 a[92:93], v251 offset:2056
    ds_read_b64_tr_b16 a[94:95], v251 offset:2312
    v_mfma_f32_16x16x32_bf16 v[172:175], a[48:51], v[32:35], v[172:175]
    ds_read_b64_tr_b16 a[72:73], v249 offset:0
    ds_read_b64_tr_b16 a[74:75], v249 offset:512
    v_mfma_f32_16x16x32_bf16 v[52:55], a[48:51], v[36:39], v[52:55]
    ds_read_b64_tr_b16 a[76:77], v249 offset:8
    ds_read_b64_tr_b16 a[78:79], v249 offset:520
    v_mfma_f32_16x16x32_bf16 v[152:155], a[52:55], v[28:31], v[152:155]
    ds_read_b64_tr_b16 a[80:81], v250 offset:0
    ds_read_b64_tr_b16 a[82:83], v250 offset:512
    v_mfma_f32_16x16x32_bf16 v[176:179], a[52:55], v[32:35], v[176:179]
    ds_read_b64_tr_b16 a[84:85], v250 offset:8
    ds_read_b64_tr_b16 a[86:87], v250 offset:520
    v_mfma_f32_16x16x32_bf16 v[56:59], a[52:55], v[36:39], v[56:59]
    ds_read_b128 v[40:43], v243 offset:36864
    ds_read_b128 v[44:47], v243 offset:49152
    s_waitcnt lgkmcnt(10)
    s_add_u32 m0, s71, 2048
    s_mov_b32 s76, 122880
    buffer_load_dwordx4 v248, s[32:35], s76 offen lds
    v_mfma_f32_16x16x32_bf16 v[156:159], a[56:59], v[28:31], v[156:159]
    ds_read_b128 v[48:51], v243 offset:61440
    v_mfma_f32_16x16x32_bf16 v[180:183], a[56:59], v[32:35], v[180:183]
    s_mov_b32 s77, 134144
    buffer_load_dwordx4 v248, s[32:35], s77 offen offset:1024 lds
    v_mfma_f32_16x16x32_bf16 v[60:63], a[56:59], v[36:39], v[60:63]
    v_mfma_f32_16x16x32_bf16 v[160:163], a[60:63], v[28:31], v[160:163]
    v_mfma_f32_16x16x32_bf16 v[184:187], a[60:63], v[32:35], v[184:187]
    v_mfma_f32_16x16x32_bf16 v[64:67], a[60:63], v[36:39], v[64:67]
    s_waitcnt lgkmcnt(0)
    s_add_u32 m0, s70, 0
    s_mov_b32 s74, 147456
    buffer_load_dwordx4 v247, s[32:35], s74 offen lds
    v_mfma_f32_16x16x32_bf16 v[164:167], a[64:67], v[28:31], v[164:167]
    s_mov_b32 s75, 152576
    buffer_load_dwordx4 v247, s[32:35], s75 offen offset:1024 lds
    v_mfma_f32_16x16x32_bf16 v[188:191], a[64:67], v[32:35], v[188:191]
    s_mov_b32 s76, 157696
    buffer_load_dwordx4 v247, s[32:35], s76 offen offset:2048 lds
    v_mfma_f32_16x16x32_bf16 v[68:71], a[64:67], v[36:39], v[68:71]
    s_mov_b32 s77, 162816
    buffer_load_dwordx4 v247, s[32:35], s77 offen offset:3072 lds
    v_mfma_f32_16x16x32_bf16 v[168:171], a[68:71], v[28:31], v[168:171]
    v_mfma_f32_16x16x32_bf16 v[192:195], a[68:71], v[32:35], v[192:195]
    v_mfma_f32_16x16x32_bf16 v[72:75], a[68:71], v[36:39], v[72:75]
    s_waitcnt vmcnt(10)
    ds_read_b64_tr_b16 a[112:113], v251 offset:0
    ds_read_b64_tr_b16 a[114:115], v251 offset:256
    v_mfma_f32_16x16x32_bf16 v[148:151], a[72:75], v[40:43], v[148:151]
    ds_read_b64_tr_b16 a[116:117], v251 offset:8
    ds_read_b64_tr_b16 a[118:119], v251 offset:264
    v_mfma_f32_16x16x32_bf16 v[172:175], a[72:75], v[44:47], v[172:175]
    ds_read_b64_tr_b16 a[96:97], v249 offset:4096
    ds_read_b64_tr_b16 a[98:99], v249 offset:4608
    v_mfma_f32_16x16x32_bf16 v[52:55], a[72:75], v[48:51], v[52:55]
    ds_read_b64_tr_b16 a[100:101], v249 offset:4104
    ds_read_b64_tr_b16 a[102:103], v249 offset:4616
    v_mfma_f32_16x16x32_bf16 v[152:155], a[76:79], v[40:43], v[152:155]
    ds_read_b64_tr_b16 a[104:105], v250 offset:4096
    ds_read_b64_tr_b16 a[106:107], v250 offset:4608
    v_mfma_f32_16x16x32_bf16 v[176:179], a[76:79], v[44:47], v[176:179]
    ds_read_b64_tr_b16 a[108:109], v250 offset:4104
    ds_read_b64_tr_b16 a[110:111], v250 offset:4616
    v_mfma_f32_16x16x32_bf16 v[56:59], a[76:79], v[48:51], v[56:59]
    ds_read_b128 v[4:7], v240 offset:37120
    ds_read_b128 v[8:11], v240 offset:49408
    s_waitcnt lgkmcnt(10)
    s_add_u32 m0, s71, 0
    s_mov_b32 s74, 147456
    buffer_load_dwordx4 v248, s[32:35], s74 offen lds
    v_mfma_f32_16x16x32_bf16 v[156:159], a[80:83], v[40:43], v[156:159]
    ds_read_b128 v[12:15], v240 offset:61696
    v_mfma_f32_16x16x32_bf16 v[180:183], a[80:83], v[44:47], v[180:183]
    s_mov_b32 s75, 158720
    buffer_load_dwordx4 v248, s[32:35], s75 offen offset:1024 lds
    v_mfma_f32_16x16x32_bf16 v[60:63], a[80:83], v[48:51], v[60:63]
    v_mfma_f32_16x16x32_bf16 v[160:163], a[84:87], v[40:43], v[160:163]
    v_mfma_f32_16x16x32_bf16 v[184:187], a[84:87], v[44:47], v[184:187]
    v_mfma_f32_16x16x32_bf16 v[64:67], a[84:87], v[48:51], v[64:67]
    s_waitcnt lgkmcnt(0)
    s_add_u32 m0, s70, 4096
    s_mov_b32 s76, 172032
    buffer_load_dwordx4 v247, s[32:35], s76 offen lds
    v_mfma_f32_16x16x32_bf16 v[164:167], a[88:91], v[40:43], v[164:167]
    s_mov_b32 s77, 177152
    buffer_load_dwordx4 v247, s[32:35], s77 offen offset:1024 lds
    v_mfma_f32_16x16x32_bf16 v[188:191], a[88:91], v[44:47], v[188:191]
    s_mov_b32 s74, 182272
    buffer_load_dwordx4 v247, s[32:35], s74 offen offset:2048 lds
    v_mfma_f32_16x16x32_bf16 v[68:71], a[88:91], v[48:51], v[68:71]
    s_mov_b32 s75, 187392
    buffer_load_dwordx4 v247, s[32:35], s75 offen offset:3072 lds
    v_mfma_f32_16x16x32_bf16 v[168:171], a[92:95], v[40:43], v[168:171]
    v_mfma_f32_16x16x32_bf16 v[192:195], a[92:95], v[44:47], v[192:195]
    v_mfma_f32_16x16x32_bf16 v[72:75], a[92:95], v[48:51], v[72:75]
    s_waitcnt vmcnt(10)
    ds_read_b64_tr_b16 a[136:137], v251 offset:2048
    ds_read_b64_tr_b16 a[138:139], v251 offset:2304
    v_mfma_f32_16x16x32_bf16 v[148:151], a[96:99], v[4:7], v[148:151]
    ds_read_b64_tr_b16 a[140:141], v251 offset:2056
    ds_read_b64_tr_b16 a[142:143], v251 offset:2312
    v_mfma_f32_16x16x32_bf16 v[172:175], a[96:99], v[8:11], v[172:175]
    ds_read_b64_tr_b16 a[120:121], v249 offset:8192
    ds_read_b64_tr_b16 a[122:123], v249 offset:8704
    v_mfma_f32_16x16x32_bf16 v[52:55], a[96:99], v[12:15], v[52:55]
    ds_read_b64_tr_b16 a[124:125], v249 offset:8200
    ds_read_b64_tr_b16 a[126:127], v249 offset:8712
    v_mfma_f32_16x16x32_bf16 v[152:155], a[100:103], v[4:7], v[152:155]
    ds_read_b64_tr_b16 a[128:129], v250 offset:8192
    ds_read_b64_tr_b16 a[130:131], v250 offset:8704
    v_mfma_f32_16x16x32_bf16 v[176:179], a[100:103], v[8:11], v[176:179]
    ds_read_b64_tr_b16 a[132:133], v250 offset:8200
    ds_read_b64_tr_b16 a[134:135], v250 offset:8712
    v_mfma_f32_16x16x32_bf16 v[56:59], a[100:103], v[12:15], v[56:59]
    ds_read_b128 v[16:19], v241 offset:37120
    ds_read_b128 v[20:23], v241 offset:49408
    s_waitcnt lgkmcnt(10)
    s_add_u32 m0, s71, 2048
    s_mov_b32 s76, 172032
    buffer_load_dwordx4 v248, s[32:35], s76 offen lds
    v_mfma_f32_16x16x32_bf16 v[156:159], a[104:107], v[4:7], v[156:159]
    ds_read_b128 v[24:27], v241 offset:61696
    v_mfma_f32_16x16x32_bf16 v[180:183], a[104:107], v[8:11], v[180:183]
    s_mov_b32 s77, 183296
    buffer_load_dwordx4 v248, s[32:35], s77 offen offset:1024 lds
    v_mfma_f32_16x16x32_bf16 v[60:63], a[104:107], v[12:15], v[60:63]
    v_mfma_f32_16x16x32_bf16 v[160:163], a[108:111], v[4:7], v[160:163]
    v_mfma_f32_16x16x32_bf16 v[184:187], a[108:111], v[8:11], v[184:187]
    v_mfma_f32_16x16x32_bf16 v[64:67], a[108:111], v[12:15], v[64:67]
    s_waitcnt lgkmcnt(0)
    s_add_u32 m0, s70, 8192
    s_mov_b32 s74, 196608
    buffer_load_dwordx4 v247, s[32:35], s74 offen lds
    v_mfma_f32_16x16x32_bf16 v[164:167], a[112:115], v[4:7], v[164:167]
    s_mov_b32 s75, 201728
    buffer_load_dwordx4 v247, s[32:35], s75 offen offset:1024 lds
    v_mfma_f32_16x16x32_bf16 v[188:191], a[112:115], v[8:11], v[188:191]
    s_mov_b32 s76, 206848
    buffer_load_dwordx4 v247, s[32:35], s76 offen offset:2048 lds
    v_mfma_f32_16x16x32_bf16 v[68:71], a[112:115], v[12:15], v[68:71]
    s_mov_b32 s77, 211968
    buffer_load_dwordx4 v247, s[32:35], s77 offen offset:3072 lds
    v_mfma_f32_16x16x32_bf16 v[168:171], a[116:119], v[4:7], v[168:171]
    v_mfma_f32_16x16x32_bf16 v[192:195], a[116:119], v[8:11], v[192:195]
    v_mfma_f32_16x16x32_bf16 v[72:75], a[116:119], v[12:15], v[72:75]
    s_waitcnt vmcnt(10)
    ds_read_b64_tr_b16 a[160:161], v251 offset:0
    ds_read_b64_tr_b16 a[162:163], v251 offset:256
    v_mfma_f32_16x16x32_bf16 v[148:151], a[120:123], v[16:19], v[148:151]
    ds_read_b64_tr_b16 a[164:165], v251 offset:8
    ds_read_b64_tr_b16 a[166:167], v251 offset:264
    v_mfma_f32_16x16x32_bf16 v[172:175], a[120:123], v[20:23], v[172:175]
    ds_read_b64_tr_b16 a[144:145], v249 offset:0
    ds_read_b64_tr_b16 a[146:147], v249 offset:512
    v_mfma_f32_16x16x32_bf16 v[52:55], a[120:123], v[24:27], v[52:55]
    ds_read_b64_tr_b16 a[148:149], v249 offset:8
    ds_read_b64_tr_b16 a[150:151], v249 offset:520
    v_mfma_f32_16x16x32_bf16 v[152:155], a[124:127], v[16:19], v[152:155]
    ds_read_b64_tr_b16 a[152:153], v250 offset:0
    ds_read_b64_tr_b16 a[154:155], v250 offset:512
    v_mfma_f32_16x16x32_bf16 v[176:179], a[124:127], v[20:23], v[176:179]
    ds_read_b64_tr_b16 a[156:157], v250 offset:8
    ds_read_b64_tr_b16 a[158:159], v250 offset:520
    v_mfma_f32_16x16x32_bf16 v[56:59], a[124:127], v[24:27], v[56:59]
    ds_read_b128 v[28:31], v242 offset:37120
    ds_read_b128 v[32:35], v242 offset:49408
    s_waitcnt lgkmcnt(10)
    s_add_u32 m0, s71, 0
    s_mov_b32 s74, 196608
    buffer_load_dwordx4 v248, s[32:35], s74 offen lds
    v_mfma_f32_16x16x32_bf16 v[156:159], a[128:131], v[16:19], v[156:159]
    ds_read_b128 v[36:39], v242 offset:61696
    v_mfma_f32_16x16x32_bf16 v[180:183], a[128:131], v[20:23], v[180:183]
    s_mov_b32 s75, 207872
    buffer_load_dwordx4 v248, s[32:35], s75 offen offset:1024 lds
    v_mfma_f32_16x16x32_bf16 v[60:63], a[128:131], v[24:27], v[60:63]
    v_mfma_f32_16x16x32_bf16 v[160:163], a[132:135], v[16:19], v[160:163]
    v_mfma_f32_16x16x32_bf16 v[184:187], a[132:135], v[20:23], v[184:187]
    v_mfma_f32_16x16x32_bf16 v[64:67], a[132:135], v[24:27], v[64:67]
    s_waitcnt lgkmcnt(0)
    s_add_u32 m0, s70, 0
    s_mov_b32 s76, 221184
    buffer_load_dwordx4 v247, s[32:35], s76 offen lds
    v_mfma_f32_16x16x32_bf16 v[164:167], a[136:139], v[16:19], v[164:167]
    s_mov_b32 s77, 226304
    buffer_load_dwordx4 v247, s[32:35], s77 offen offset:1024 lds
    v_mfma_f32_16x16x32_bf16 v[188:191], a[136:139], v[20:23], v[188:191]
    s_mov_b32 s74, 231424
    buffer_load_dwordx4 v247, s[32:35], s74 offen offset:2048 lds
    v_mfma_f32_16x16x32_bf16 v[68:71], a[136:139], v[24:27], v[68:71]
    s_mov_b32 s75, 236544
    buffer_load_dwordx4 v247, s[32:35], s75 offen offset:3072 lds
    v_mfma_f32_16x16x32_bf16 v[168:171], a[140:143], v[16:19], v[168:171]
    v_mfma_f32_16x16x32_bf16 v[192:195], a[140:143], v[20:23], v[192:195]
    v_mfma_f32_16x16x32_bf16 v[72:75], a[140:143], v[24:27], v[72:75]
    s_waitcnt vmcnt(10)
    ds_read_b64_tr_b16 a[184:185], v251 offset:2048
    ds_read_b64_tr_b16 a[186:187], v251 offset:2304
    v_mfma_f32_16x16x32_bf16 v[148:151], a[144:147], v[28:31], v[148:151]
    ds_read_b64_tr_b16 a[188:189], v251 offset:2056
    ds_read_b64_tr_b16 a[190:191], v251 offset:2312
    v_mfma_f32_16x16x32_bf16 v[172:175], a[144:147], v[32:35], v[172:175]
    ds_read_b64_tr_b16 a[168:169], v249 offset:4096
    ds_read_b64_tr_b16 a[170:171], v249 offset:4608
    v_mfma_f32_16x16x32_bf16 v[52:55], a[144:147], v[36:39], v[52:55]
    ds_read_b64_tr_b16 a[172:173], v249 offset:4104
    ds_read_b64_tr_b16 a[174:175], v249 offset:4616
    v_mfma_f32_16x16x32_bf16 v[152:155], a[148:151], v[28:31], v[152:155]
    ds_read_b64_tr_b16 a[176:177], v250 offset:4096
    ds_read_b64_tr_b16 a[178:179], v250 offset:4608
    v_mfma_f32_16x16x32_bf16 v[176:179], a[148:151], v[32:35], v[176:179]
    ds_read_b64_tr_b16 a[180:181], v250 offset:4104
    ds_read_b64_tr_b16 a[182:183], v250 offset:4616
    v_mfma_f32_16x16x32_bf16 v[56:59], a[148:151], v[36:39], v[56:59]
    ds_read_b128 v[40:43], v243 offset:37120
    ds_read_b128 v[44:47], v243 offset:49408
    s_waitcnt lgkmcnt(10)
    s_add_u32 m0, s71, 2048
    s_mov_b32 s76, 221184
    buffer_load_dwordx4 v248, s[32:35], s76 offen lds
    v_mfma_f32_16x16x32_bf16 v[156:159], a[152:155], v[28:31], v[156:159]
    ds_read_b128 v[48:51], v243 offset:61696
    v_mfma_f32_16x16x32_bf16 v[180:183], a[152:155], v[32:35], v[180:183]
    s_mov_b32 s77, 232448
    buffer_load_dwordx4 v248, s[32:35], s77 offen offset:1024 lds
    v_mfma_f32_16x16x32_bf16 v[60:63], a[152:155], v[36:39], v[60:63]
    v_mfma_f32_16x16x32_bf16 v[160:163], a[156:159], v[28:31], v[160:163]
    v_mfma_f32_16x16x32_bf16 v[184:187], a[156:159], v[32:35], v[184:187]
    v_mfma_f32_16x16x32_bf16 v[64:67], a[156:159], v[36:39], v[64:67]
    s_waitcnt lgkmcnt(0)
    s_add_u32 m0, s70, 4096
    s_mov_b32 s74, 245760
    buffer_load_dwordx4 v247, s[32:35], s74 offen lds
    v_mfma_f32_16x16x32_bf16 v[164:167], a[160:163], v[28:31], v[164:167]
    s_mov_b32 s75, 250880
    buffer_load_dwordx4 v247, s[32:35], s75 offen offset:1024 lds
    v_mfma_f32_16x16x32_bf16 v[188:191], a[160:163], v[32:35], v[188:191]
    s_mov_b32 s76, 256000
    buffer_load_dwordx4 v247, s[32:35], s76 offen offset:2048 lds
    v_mfma_f32_16x16x32_bf16 v[68:71], a[160:163], v[36:39], v[68:71]
    s_mov_b32 s77, 261120
    buffer_load_dwordx4 v247, s[32:35], s77 offen offset:3072 lds
    v_mfma_f32_16x16x32_bf16 v[168:171], a[164:167], v[28:31], v[168:171]
    v_mfma_f32_16x16x32_bf16 v[192:195], a[164:167], v[32:35], v[192:195]
    v_mfma_f32_16x16x32_bf16 v[72:75], a[164:167], v[36:39], v[72:75]
    s_waitcnt vmcnt(10)
    ds_read_b64_tr_b16 a[208:209], v251 offset:0
    ds_read_b64_tr_b16 a[210:211], v251 offset:256
    v_mfma_f32_16x16x32_bf16 v[148:151], a[168:171], v[40:43], v[148:151]
    ds_read_b64_tr_b16 a[212:213], v251 offset:8
    ds_read_b64_tr_b16 a[214:215], v251 offset:264
    v_mfma_f32_16x16x32_bf16 v[172:175], a[168:171], v[44:47], v[172:175]
    ds_read_b64_tr_b16 a[192:193], v249 offset:8192
    ds_read_b64_tr_b16 a[194:195], v249 offset:8704
    v_mfma_f32_16x16x32_bf16 v[52:55], a[168:171], v[48:51], v[52:55]
    ds_read_b64_tr_b16 a[196:197], v249 offset:8200
    ds_read_b64_tr_b16 a[198:199], v249 offset:8712
    v_mfma_f32_16x16x32_bf16 v[152:155], a[172:175], v[40:43], v[152:155]
    ds_read_b64_tr_b16 a[200:201], v250 offset:8192
    ds_read_b64_tr_b16 a[202:203], v250 offset:8704
    v_mfma_f32_16x16x32_bf16 v[176:179], a[172:175], v[44:47], v[176:179]
    ds_read_b64_tr_b16 a[204:205], v250 offset:8200
    ds_read_b64_tr_b16 a[206:207], v250 offset:8712
    v_mfma_f32_16x16x32_bf16 v[56:59], a[172:175], v[48:51], v[56:59]
    ds_read_b128 v[4:7], v240 offset:37376
    ds_read_b128 v[8:11], v240 offset:49664
    s_waitcnt lgkmcnt(10)
    s_add_u32 m0, s71, 0
    s_mov_b32 s74, 245760
    buffer_load_dwordx4 v248, s[32:35], s74 offen lds
    v_mfma_f32_16x16x32_bf16 v[156:159], a[176:179], v[40:43], v[156:159]
    ds_read_b128 v[12:15], v240 offset:61952
    v_mfma_f32_16x16x32_bf16 v[180:183], a[176:179], v[44:47], v[180:183]
    s_mov_b32 s75, 257024
    buffer_load_dwordx4 v248, s[32:35], s75 offen offset:1024 lds
    v_mfma_f32_16x16x32_bf16 v[60:63], a[176:179], v[48:51], v[60:63]
    v_mfma_f32_16x16x32_bf16 v[160:163], a[180:183], v[40:43], v[160:163]
    v_mfma_f32_16x16x32_bf16 v[184:187], a[180:183], v[44:47], v[184:187]
    v_mfma_f32_16x16x32_bf16 v[64:67], a[180:183], v[48:51], v[64:67]
    s_waitcnt lgkmcnt(0)
    s_add_u32 m0, s70, 8192
    s_mov_b32 s76, 270336
    buffer_load_dwordx4 v247, s[32:35], s76 offen lds
    v_mfma_f32_16x16x32_bf16 v[164:167], a[184:187], v[40:43], v[164:167]
    s_mov_b32 s77, 275456
    buffer_load_dwordx4 v247, s[32:35], s77 offen offset:1024 lds
    v_mfma_f32_16x16x32_bf16 v[188:191], a[184:187], v[44:47], v[188:191]
    s_mov_b32 s74, 280576
    buffer_load_dwordx4 v247, s[32:35], s74 offen offset:2048 lds
    v_mfma_f32_16x16x32_bf16 v[68:71], a[184:187], v[48:51], v[68:71]
    s_mov_b32 s75, 285696
    buffer_load_dwordx4 v247, s[32:35], s75 offen offset:3072 lds
    v_mfma_f32_16x16x32_bf16 v[168:171], a[188:191], v[40:43], v[168:171]
    v_mfma_f32_16x16x32_bf16 v[192:195], a[188:191], v[44:47], v[192:195]
    v_mfma_f32_16x16x32_bf16 v[72:75], a[188:191], v[48:51], v[72:75]
    s_waitcnt vmcnt(10)
    ds_read_b64_tr_b16 a[232:233], v251 offset:2048
    ds_read_b64_tr_b16 a[234:235], v251 offset:2304
    v_mfma_f32_16x16x32_bf16 v[148:151], a[192:195], v[4:7], v[148:151]
    ds_read_b64_tr_b16 a[236:237], v251 offset:2056
    ds_read_b64_tr_b16 a[238:239], v251 offset:2312
    v_mfma_f32_16x16x32_bf16 v[172:175], a[192:195], v[8:11], v[172:175]
    ds_read_b64_tr_b16 a[216:217], v249 offset:0
    ds_read_b64_tr_b16 a[218:219], v249 offset:512
    v_mfma_f32_16x16x32_bf16 v[52:55], a[192:195], v[12:15], v[52:55]
    ds_read_b64_tr_b16 a[220:221], v249 offset:8
    ds_read_b64_tr_b16 a[222:223], v249 offset:520
    v_mfma_f32_16x16x32_bf16 v[152:155], a[196:199], v[4:7], v[152:155]
    ds_read_b64_tr_b16 a[224:225], v250 offset:0
    ds_read_b64_tr_b16 a[226:227], v250 offset:512
    v_mfma_f32_16x16x32_bf16 v[176:179], a[196:199], v[8:11], v[176:179]
    ds_read_b64_tr_b16 a[228:229], v250 offset:8
    ds_read_b64_tr_b16 a[230:231], v250 offset:520
    v_mfma_f32_16x16x32_bf16 v[56:59], a[196:199], v[12:15], v[56:59]
    ds_read_b128 v[16:19], v241 offset:37376
    ds_read_b128 v[20:23], v241 offset:49664
    s_waitcnt lgkmcnt(10)
    s_add_u32 m0, s71, 2048
    s_mov_b32 s76, 270336
    buffer_load_dwordx4 v248, s[32:35], s76 offen lds
    v_mfma_f32_16x16x32_bf16 v[156:159], a[200:203], v[4:7], v[156:159]
    ds_read_b128 v[24:27], v241 offset:61952
    v_mfma_f32_16x16x32_bf16 v[180:183], a[200:203], v[8:11], v[180:183]
    s_mov_b32 s77, 281600
    buffer_load_dwordx4 v248, s[32:35], s77 offen offset:1024 lds
    v_mfma_f32_16x16x32_bf16 v[60:63], a[200:203], v[12:15], v[60:63]
    s_add_u32 s74, s2, 0
    s_and_b32 s74, s74, 255
    s_add_u32 s74, s74, 0
    v_mfma_f32_16x16x32_bf16 v[160:163], a[204:207], v[4:7], v[160:163]
    s_mul_i32 s74, s74, 12288
    s_or_b32 s74, s74, s62
    s_add_u32 m0, s63, 122880
    v_mfma_f32_16x16x32_bf16 v[184:187], a[204:207], v[8:11], v[184:187]
    buffer_load_dwordx4 v244, s[24:27], s74 offen nt lds
    v_mfma_f32_16x16x32_bf16 v[64:67], a[204:207], v[12:15], v[64:67]
    s_waitcnt lgkmcnt(0)
    buffer_load_dwordx4 v245, s[24:27], s74 offen offset:1024 nt lds
    v_mfma_f32_16x16x32_bf16 v[164:167], a[208:211], v[4:7], v[164:167]
    buffer_load_dwordx4 v246, s[24:27], s74 offen offset:2048 nt lds
    v_mfma_f32_16x16x32_bf16 v[188:191], a[208:211], v[8:11], v[188:191]
    s_add_u32 s75, s2, 43
    s_and_b32 s75, s75, 255
    s_add_u32 s75, s75, 256
    s_mul_i32 s75, s75, 12288
    s_or_b32 s75, s75, s62
    s_add_u32 m0, s63, 135168
    v_mfma_f32_16x16x32_bf16 v[68:71], a[208:211], v[12:15], v[68:71]
    buffer_load_dwordx4 v244, s[24:27], s75 offen nt lds
    v_mfma_f32_16x16x32_bf16 v[168:171], a[212:215], v[4:7], v[168:171]
    buffer_load_dwordx4 v245, s[24:27], s75 offen offset:1024 nt lds
    v_mfma_f32_16x16x32_bf16 v[192:195], a[212:215], v[8:11], v[192:195]
    buffer_load_dwordx4 v246, s[24:27], s75 offen offset:2048 nt lds
    v_mfma_f32_16x16x32_bf16 v[72:75], a[212:215], v[12:15], v[72:75]
    s_waitcnt vmcnt(12)
    ds_read_b64_tr_b16 v[196:197], v251 offset:0
    ds_read_b64_tr_b16 v[198:199], v251 offset:256
    v_mfma_f32_16x16x32_bf16 v[148:151], a[216:219], v[16:19], v[148:151]
    ds_read_b64_tr_b16 v[200:201], v251 offset:8
    ds_read_b64_tr_b16 v[202:203], v251 offset:264
    v_mfma_f32_16x16x32_bf16 v[172:175], a[216:219], v[20:23], v[172:175]
    ds_read_b64_tr_b16 a[240:241], v249 offset:4096
    ds_read_b64_tr_b16 a[242:243], v249 offset:4608
    v_mfma_f32_16x16x32_bf16 v[52:55], a[216:219], v[24:27], v[52:55]
    ds_read_b64_tr_b16 a[244:245], v249 offset:4104
    ds_read_b64_tr_b16 a[246:247], v249 offset:4616
    v_mfma_f32_16x16x32_bf16 v[152:155], a[220:223], v[16:19], v[152:155]
    ds_read_b64_tr_b16 a[248:249], v250 offset:4096
    ds_read_b64_tr_b16 a[250:251], v250 offset:4608
    v_mfma_f32_16x16x32_bf16 v[176:179], a[220:223], v[20:23], v[176:179]
    ds_read_b64_tr_b16 a[252:253], v250 offset:4104
    ds_read_b64_tr_b16 a[254:255], v250 offset:4616
    v_mfma_f32_16x16x32_bf16 v[56:59], a[220:223], v[24:27], v[56:59]
    ds_read_b128 v[28:31], v242 offset:37376
    ds_read_b128 v[32:35], v242 offset:49664
    s_add_u32 s76, s2, 86
    s_and_b32 s76, s76, 255
    v_mfma_f32_16x16x32_bf16 v[156:159], a[224:227], v[16:19], v[156:159]
    ds_read_b128 v[36:39], v242 offset:61952
    s_add_u32 s76, s76, 512
    s_mul_i32 s76, s76, 12288
    v_mfma_f32_16x16x32_bf16 v[180:183], a[224:227], v[20:23], v[180:183]
    s_or_b32 s76, s76, s62
    s_add_u32 m0, s64, 12288
    v_mfma_f32_16x16x32_bf16 v[60:63], a[224:227], v[24:27], v[60:63]
    buffer_load_dwordx4 v244, s[24:27], s76 offen nt lds
    v_mfma_f32_16x16x32_bf16 v[160:163], a[228:231], v[16:19], v[160:163]
    buffer_load_dwordx4 v245, s[24:27], s76 offen offset:1024 nt lds
    v_mfma_f32_16x16x32_bf16 v[184:187], a[228:231], v[20:23], v[184:187]
    buffer_load_dwordx4 v246, s[24:27], s76 offen offset:2048 nt lds
    v_mfma_f32_16x16x32_bf16 v[64:67], a[228:231], v[24:27], v[64:67]
    s_waitcnt lgkmcnt(0)
    s_add_u32 s77, s2, 129
    s_and_b32 s77, s77, 255
    v_mfma_f32_16x16x32_bf16 v[164:167], a[232:235], v[16:19], v[164:167]
    s_add_u32 s77, s77, 768
    s_mul_i32 s77, s77, 12288
    v_mfma_f32_16x16x32_bf16 v[188:191], a[232:235], v[20:23], v[188:191]
    s_or_b32 s77, s77, s62
    s_add_u32 m0, s64, 24576
    v_mfma_f32_16x16x32_bf16 v[68:71], a[232:235], v[24:27], v[68:71]
    buffer_load_dwordx4 v244, s[24:27], s77 offen nt lds
    v_mfma_f32_16x16x32_bf16 v[168:171], a[236:239], v[16:19], v[168:171]
    buffer_load_dwordx4 v245, s[24:27], s77 offen offset:1024 nt lds
    v_mfma_f32_16x16x32_bf16 v[192:195], a[236:239], v[20:23], v[192:195]
    buffer_load_dwordx4 v246, s[24:27], s77 offen offset:2048 nt lds
    v_mfma_f32_16x16x32_bf16 v[72:75], a[236:239], v[24:27], v[72:75]
    s_waitcnt vmcnt(12)
    ds_read_b64_tr_b16 v[220:221], v251 offset:2048
    ds_read_b64_tr_b16 v[222:223], v251 offset:2304
    v_mfma_f32_16x16x32_bf16 v[148:151], a[240:243], v[28:31], v[148:151]
    ds_read_b64_tr_b16 v[224:225], v251 offset:2056
    ds_read_b64_tr_b16 v[226:227], v251 offset:2312
    v_mfma_f32_16x16x32_bf16 v[172:175], a[240:243], v[32:35], v[172:175]
    ds_read_b64_tr_b16 v[204:205], v249 offset:8192
    ds_read_b64_tr_b16 v[206:207], v249 offset:8704
    v_mfma_f32_16x16x32_bf16 v[52:55], a[240:243], v[36:39], v[52:55]
    ds_read_b64_tr_b16 v[208:209], v249 offset:8200
    ds_read_b64_tr_b16 v[210:211], v249 offset:8712
    v_mfma_f32_16x16x32_bf16 v[152:155], a[244:247], v[28:31], v[152:155]
    ds_read_b64_tr_b16 v[212:213], v250 offset:8192
    ds_read_b64_tr_b16 v[214:215], v250 offset:8704
    v_mfma_f32_16x16x32_bf16 v[176:179], a[244:247], v[32:35], v[176:179]
    ds_read_b64_tr_b16 v[216:217], v250 offset:8200
    ds_read_b64_tr_b16 v[218:219], v250 offset:8712
    v_mfma_f32_16x16x32_bf16 v[56:59], a[244:247], v[36:39], v[56:59]
    ds_read_b128 v[40:43], v243 offset:37376
    ds_read_b128 v[44:47], v243 offset:49664
    s_add_u32 s74, s2, 172
    s_and_b32 s74, s74, 255
    v_mfma_f32_16x16x32_bf16 v[156:159], a[248:251], v[28:31], v[156:159]
    ds_read_b128 v[48:51], v243 offset:61952
    s_add_u32 s74, s74, 1024
    s_mul_i32 s74, s74, 12288
    v_mfma_f32_16x16x32_bf16 v[180:183], a[248:251], v[32:35], v[180:183]
    s_or_b32 s74, s74, s62
    s_add_u32 m0, s64, 36864
    v_mfma_f32_16x16x32_bf16 v[60:63], a[248:251], v[36:39], v[60:63]
    buffer_load_dwordx4 v244, s[24:27], s74 offen nt lds
    v_mfma_f32_16x16x32_bf16 v[160:163], a[252:255], v[28:31], v[160:163]
    buffer_load_dwordx4 v245, s[24:27], s74 offen offset:1024 nt lds
    v_mfma_f32_16x16x32_bf16 v[184:187], a[252:255], v[32:35], v[184:187]
    buffer_load_dwordx4 v246, s[24:27], s74 offen offset:2048 nt lds
    v_mfma_f32_16x16x32_bf16 v[64:67], a[252:255], v[36:39], v[64:67]
    s_waitcnt lgkmcnt(0)
    s_add_u32 s75, s2, 215
    s_and_b32 s75, s75, 255
    v_mfma_f32_16x16x32_bf16 v[164:167], v[196:199], v[28:31], v[164:167]
    s_add_u32 s75, s75, 1280
    s_mul_i32 s75, s75, 12288
    v_mfma_f32_16x16x32_bf16 v[188:191], v[196:199], v[32:35], v[188:191]
    s_or_b32 s75, s75, s62
    s_add_u32 m0, s63, 98304
    v_mfma_f32_16x16x32_bf16 v[68:71], v[196:199], v[36:39], v[68:71]
    buffer_load_dwordx4 v244, s[24:27], s75 offen nt lds
    v_mfma_f32_16x16x32_bf16 v[168:171], v[200:203], v[28:31], v[168:171]
    buffer_load_dwordx4 v245, s[24:27], s75 offen offset:1024 nt lds
    v_mfma_f32_16x16x32_bf16 v[192:195], v[200:203], v[32:35], v[192:195]
    buffer_load_dwordx4 v246, s[24:27], s75 offen offset:2048 nt lds
    v_mfma_f32_16x16x32_bf16 v[72:75], v[200:203], v[36:39], v[72:75]
    v_mfma_f32_16x16x32_bf16 v[148:151], v[204:207], v[40:43], v[148:151]
    v_mfma_f32_16x16x32_bf16 v[172:175], v[204:207], v[44:47], v[172:175]
    s_cmp_lg_u32 s61, 2
    s_cbranch_scc1 L_nb
    s_barrier
    ds_read_b128 v[4:7], v228 offset:24576
    ds_read_b128 v[8:11], v228 offset:36864
    ds_read_b128 v[12:15], v240 offset:24576
    ds_read_b128 v[16:19], v229 offset:24576
    ds_read_b128 v[20:23], v229 offset:36864
    ds_read_b128 v[24:27], v241 offset:24576
L_nb:
    v_mfma_f32_16x16x32_bf16 v[52:55], v[204:207], v[48:51], v[52:55]
    v_mfma_f32_16x16x32_bf16 v[152:155], v[208:211], v[40:43], v[152:155]
    v_mfma_f32_16x16x32_bf16 v[176:179], v[208:211], v[44:47], v[176:179]
    v_mfma_f32_16x16x32_bf16 v[56:59], v[208:211], v[48:51], v[56:59]
    v_mfma_f32_16x16x32_bf16 v[156:159], v[212:215], v[40:43], v[156:159]
    v_mfma_f32_16x16x32_bf16 v[180:183], v[212:215], v[44:47], v[180:183]
    v_mfma_f32_16x16x32_bf16 v[60:63], v[212:215], v[48:51], v[60:63]
    v_mfma_f32_16x16x32_bf16 v[160:163], v[216:219], v[40:43], v[160:163]
    v_mfma_f32_16x16x32_bf16 v[184:187], v[216:219], v[44:47], v[184:187]
    v_mfma_f32_16x16x32_bf16 v[64:67], v[216:219], v[48:51], v[64:67]
    v_mfma_f32_16x16x32_bf16 v[164:167], v[220:223], v[40:43], v[164:167]
    v_mfma_f32_16x16x32_bf16 v[188:191], v[220:223], v[44:47], v[188:191]
    v_mfma_f32_16x16x32_bf16 v[68:71], v[220:223], v[48:51], v[68:71]
    v_mfma_f32_16x16x32_bf16 v[168:171], v[224:227], v[40:43], v[168:171]
    v_mfma_f32_16x16x32_bf16 v[192:195], v[224:227], v[44:47], v[192:195]
    v_mfma_f32_16x16x32_bf16 v[72:75], v[224:227], v[48:51], v[72:75]
    s_cmp_eq_u32 s61, 2
    s_cbranch_scc1 L_pass2t
    s_cmp_eq_u32 s61, 0
    s_cbranch_scc1 L_prod
    v_add_u32 v240, 73728, v228
    v_add_u32 v241, 73728, v229
    v_add_u32 v242, 73728, v230
    v_add_u32 v243, 73728, v231
    s_waitcnt vmcnt(9)
L_prod_ret:
    s_barrier
    ds_read_b128 v[4:7], v240 offset:49152
    ds_read_b128 v[8:11], v240 offset:61440
    ds_read_b128 v[12:15], v228 offset:12288
    ds_read_b128 v[16:19], v241 offset:49152
    ds_read_b128 v[20:23], v241 offset:61440
    ds_read_b128 v[24:27], v229 offset:12288
    s_waitcnt lgkmcnt(0)
    v_mfma_f32_16x16x32_bf16 v[148:151], a[0:3], v[4:7], 0
    v_mfma_f32_16x16x32_bf16 v[148:151], a[24:27], v[16:19], v[148:151]
    v_mfma_f32_16x16x32_bf16 v[172:175], a[0:3], v[8:11], 0
    ds_read_b128 v[28:31], v242 offset:49152
    v_mfma_f32_16x16x32_bf16 v[172:175], a[24:27], v[20:23], v[172:175]
    v_mfma_f32_16x16x32_bf16 v[52:55], a[0:3], v[12:15], 0
    v_mfma_f32_16x16x32_bf16 v[52:55], a[24:27], v[24:27], v[52:55]
    v_mfma_f32_16x16x32_bf16 v[152:155], a[4:7], v[4:7], 0
    ds_read_b128 v[32:35], v242 offset:61440
    s_add_u32 s76, s84, 0
    s_add_u32 m0, s49, 49152
    v_mfma_f32_16x16x32_bf16 v[152:155], a[28:31], v[16:19], v[152:155]
    buffer_load_dwordx4 v232, s[20:23], s76 offen nt lds
    v_mfma_f32_16x16x32_bf16 v[176:179], a[4:7], v[8:11], 0
    v_mfma_f32_16x16x32_bf16 v[176:179], a[28:31], v[20:23], v[176:179]
    v_mfma_f32_16x16x32_bf16 v[56:59], a[4:7], v[12:15], 0
    ds_read_b128 v[36:39], v230 offset:12288
    buffer_load_dwordx4 v233, s[20:23], s76 offen offset:1024 nt lds
    v_mfma_f32_16x16x32_bf16 v[56:59], a[28:31], v[24:27], v[56:59]
    v_mfma_f32_16x16x32_bf16 v[156:159], a[8:11], v[4:7], 0
    v_mfma_f32_16x16x32_bf16 v[156:159], a[32:35], v[16:19], v[156:159]
    buffer_load_dwordx4 v234, s[20:23], s76 offen offset:2048 nt lds
    v_mfma_f32_16x16x32_bf16 v[180:183], a[8:11], v[8:11], 0
    ds_read_b128 v[40:43], v243 offset:49152
    v_mfma_f32_16x16x32_bf16 v[180:183], a[32:35], v[20:23], v[180:183]
    v_mfma_f32_16x16x32_bf16 v[60:63], a[8:11], v[12:15], 0
    v_mfma_f32_16x16x32_bf16 v[60:63], a[32:35], v[24:27], v[60:63]
    v_mfma_f32_16x16x32_bf16 v[160:163], a[12:15], v[4:7], 0
    ds_read_b128 v[44:47], v243 offset:61440
    v_mfma_f32_16x16x32_bf16 v[160:163], a[36:39], v[16:19], v[160:163]
    v_mfma_f32_16x16x32_bf16 v[184:187], a[12:15], v[8:11], 0
    v_mfma_f32_16x16x32_bf16 v[184:187], a[36:39], v[20:23], v[184:187]
    v_mfma_f32_16x16x32_bf16 v[64:67], a[12:15], v[12:15], 0
    ds_read_b128 v[48:51], v231 offset:12288
    v_mfma_f32_16x16x32_bf16 v[64:67], a[36:39], v[24:27], v[64:67]
    v_mfma_f32_16x16x32_bf16 v[164:167], a[16:19], v[4:7], 0
    v_mfma_f32_16x16x32_bf16 v[164:167], a[40:43], v[16:19], v[164:167]
    v_mfma_f32_16x16x32_bf16 v[188:191], a[16:19], v[8:11], 0
    v_mfma_f32_16x16x32_bf16 v[188:191], a[40:43], v[20:23], v[188:191]
    v_mfma_f32_16x16x32_bf16 v[68:71], a[16:19], v[12:15], 0
    v_mfma_f32_16x16x32_bf16 v[68:71], a[40:43], v[24:27], v[68:71]
    v_mfma_f32_16x16x32_bf16 v[168:171], a[20:23], v[4:7], 0
    s_add_u32 s77, s84, 768
    s_add_u32 m0, s49, 61440
    v_mfma_f32_16x16x32_bf16 v[168:171], a[44:47], v[16:19], v[168:171]
    buffer_load_dwordx4 v232, s[20:23], s77 offen nt lds
    v_mfma_f32_16x16x32_bf16 v[192:195], a[20:23], v[8:11], 0
    v_mfma_f32_16x16x32_bf16 v[192:195], a[44:47], v[20:23], v[192:195]
    v_mfma_f32_16x16x32_bf16 v[72:75], a[20:23], v[12:15], 0
    buffer_load_dwordx4 v233, s[20:23], s77 offen offset:1024 nt lds
    v_mfma_f32_16x16x32_bf16 v[72:75], a[44:47], v[24:27], v[72:75]
    s_waitcnt lgkmcnt(0)
    v_mfma_f32_16x16x32_bf16 v[148:151], a[48:51], v[28:31], v[148:151]
    v_mfma_f32_16x16x32_bf16 v[148:151], a[72:75], v[40:43], v[148:151]
    buffer_load_dwordx4 v234, s[20:23], s77 offen offset:2048 nt lds
    v_mfma_f32_16x16x32_bf16 v[172:175], a[48:51], v[32:35], v[172:175]
    ds_read_b128 v[4:7], v240 offset:49408
    v_mfma_f32_16x16x32_bf16 v[172:175], a[72:75], v[44:47], v[172:175]
    v_mfma_f32_16x16x32_bf16 v[52:55], a[48:51], v[36:39], v[52:55]
    v_mfma_f32_16x16x32_bf16 v[52:55], a[72:75], v[48:51], v[52:55]
    v_mfma_f32_16x16x32_bf16 v[152:155], a[52:55], v[28:31], v[152:155]
    ds_read_b128 v[8:11], v240 offset:61696
    v_mfma_f32_16x16x32_bf16 v[152:155], a[76:79], v[40:43], v[152:155]
    v_mfma_f32_16x16x32_bf16 v[176:179], a[52:55], v[32:35], v[176:179]
    v_mfma_f32_16x16x32_bf16 v[176:179], a[76:79], v[44:47], v[176:179]
    v_mfma_f32_16x16x32_bf16 v[56:59], a[52:55], v[36:39], v[56:59]
    ds_read_b128 v[12:15], v228 offset:12544
    v_mfma_f32_16x16x32_bf16 v[56:59], a[76:79], v[48:51], v[56:59]
    s_cmp_lg_u32 s61, 0
    s_cbranch_scc1 L_pub_done
    s_waitcnt vmcnt(6)
    s_barrier
    s_cmp_lg_u32 s48, 0
    s_cbranch_scc1 L_pub_done
    v_mov_b32 v254, 1
    v_lshlrev_b32 v255, 6, v0
    s_mov_b64 exec, 15
    buffer_atomic_add v254, v255, s[44:47], 0 offen sc1
    s_mov_b64 exec, -1
L_pub_done:
    v_mfma_f32_16x16x32_bf16 v[156:159], a[56:59], v[28:31], v[156:159]
    v_mfma_f32_16x16x32_bf16 v[156:159], a[80:83], v[40:43], v[156:159]
    v_mfma_f32_16x16x32_bf16 v[180:183], a[56:59], v[32:35], v[180:183]
    ds_read_b128 v[16:19], v241 offset:49408
    v_mfma_f32_16x16x32_bf16 v[180:183], a[80:83], v[44:47], v[180:183]
    v_mfma_f32_16x16x32_bf16 v[60:63], a[56:59], v[36:39], v[60:63]
    v_mfma_f32_16x16x32_bf16 v[60:63], a[80:83], v[48:51], v[60:63]
    v_mfma_f32_16x16x32_bf16 v[160:163], a[60:63], v[28:31], v[160:163]
    ds_read_b128 v[20:23], v241 offset:61696
    v_mfma_f32_16x16x32_bf16 v[160:163], a[84:87], v[40:43], v[160:163]
    v_mfma_f32_16x16x32_bf16 v[184:187], a[60:63], v[32:35], v[184:187]
    v_mfma_f32_16x16x32_bf16 v[184:187], a[84:87], v[44:47], v[184:187]
    v_mfma_f32_16x16x32_bf16 v[64:67], a[60:63], v[36:39], v[64:67]
    ds_read_b128 v[24:27], v229 offset:12544
    v_mfma_f32_16x16x32_bf16 v[64:67], a[84:87], v[48:51], v[64:67]
    v_mfma_f32_16x16x32_bf16 v[164:167], a[64:67], v[28:31], v[164:167]
    v_mfma_f32_16x16x32_bf16 v[164:167], a[88:91], v[40:43], v[164:167]
    v_mfma_f32_16x16x32_bf16 v[188:191], a[64:67], v[32:35], v[188:191]
    v_mfma_f32_16x16x32_bf16 v[188:191], a[88:91], v[44:47], v[188:191]
    v_mfma_f32_16x16x32_bf16 v[68:71], a[64:67], v[36:39], v[68:71]
    v_mfma_f32_16x16x32_bf16 v[68:71], a[88:91], v[48:51], v[68:71]
    v_mfma_f32_16x16x32_bf16 v[168:171], a[68:71], v[28:31], v[168:171]
    v_mfma_f32_16x16x32_bf16 v[168:171], a[92:95], v[40:43], v[168:171]
    v_mfma_f32_16x16x32_bf16 v[192:195], a[68:71], v[32:35], v[192:195]
    v_mfma_f32_16x16x32_bf16 v[192:195], a[92:95], v[44:47], v[192:195]
    v_mfma_f32_16x16x32_bf16 v[72:75], a[68:71], v[36:39], v[72:75]
    v_mfma_f32_16x16x32_bf16 v[72:75], a[92:95], v[48:51], v[72:75]
    s_waitcnt lgkmcnt(0)
    v_mfma_f32_16x16x32_bf16 v[148:151], a[96:99], v[4:7], v[148:151]
    v_mfma_f32_16x16x32_bf16 v[148:151], a[120:123], v[16:19], v[148:151]
    v_mfma_f32_16x16x32_bf16 v[172:175], a[96:99], v[8:11], v[172:175]
    ds_read_b128 v[28:31], v242 offset:49408
    v_mfma_f32_16x16x32_bf16 v[172:175], a[120:123], v[20:23], v[172:175]
    v_mfma_f32_16x16x32_bf16 v[52:55], a[96:99], v[12:15], v[52:55]
    v_mfma_f32_16x16x32_bf16 v[52:55], a[120:123], v[24:27], v[52:55]
    v_mfma_f32_16x16x32_bf16 v[152:155], a[100:103], v[4:7], v[152:155]
    ds_read_b128 v[32:35], v242 offset:61696
    v_mfma_f32_16x16x32_bf16 v[152:155], a[124:127], v[16:19], v[152:155]
    v_mfma_f32_16x16x32_bf16 v[176:179], a[100:103], v[8:11], v[176:179]
    v_mfma_f32_16x16x32_bf16 v[176:179], a[124:127], v[20:23], v[176:179]
    v_mfma_f32_16x16x32_bf16 v[56:59], a[100:103], v[12:15], v[56:59]
    ds_read_b128 v[36:39], v230 offset:12544
    v_mfma_f32_16x16x32_bf16 v[56:59], a[124:127], v[24:27], v[56:59]
    v_mfma_f32_16x16x32_bf16 v[156:159], a[104:107], v[4:7], v[156:159]
    v_mfma_f32_16x16x32_bf16 v[156:159], a[128:131], v[16:19], v[156:159]
    v_mfma_f32_16x16x32_bf16 v[180:183], a[104:107], v[8:11], v[180:183]
    ds_read_b128 v[40:43], v243 offset:49408
    v_mfma_f32_16x16x32_bf16 v[180:183], a[128:131], v[20:23], v[180:183]
    v_mfma_f32_16x16x32_bf16 v[60:63], a[104:107], v[12:15], v[60:63]
    v_mfma_f32_16x16x32_bf16 v[60:63], a[128:131], v[24:27], v[60:63]
    v_mfma_f32_16x16x32_bf16 v[160:163], a[108:111], v[4:7], v[160:163]
    ds_read_b128 v[44:47], v243 offset:61696
    v_mfma_f32_16x16x32_bf16 v[160:163], a[132:135], v[16:19], v[160:163]
    v_mfma_f32_16x16x32_bf16 v[184:187], a[108:111], v[8:11], v[184:187]
    v_mfma_f32_16x16x32_bf16 v[184:187], a[132:135], v[20:23], v[184:187]
    v_mfma_f32_16x16x32_bf16 v[64:67], a[108:111], v[12:15], v[64:67]
    ds_read_b128 v[48:51], v231 offset:12544
    v_mfma_f32_16x16x32_bf16 v[64:67], a[132:135], v[24:27], v[64:67]
    v_mfma_f32_16x16x32_bf16 v[164:167], a[112:115], v[4:7], v[164:167]
    v_mfma_f32_16x16x32_bf16 v[164:167], a[136:139], v[16:19], v[164:167]
    v_mfma_f32_16x16x32_bf16 v[188:191], a[112:115], v[8:11], v[188:191]
    v_mfma_f32_16x16x32_bf16 v[188:191], a[136:139], v[20:23], v[188:191]
    v_mfma_f32_16x16x32_bf16 v[68:71], a[112:115], v[12:15], v[68:71]
    v_mfma_f32_16x16x32_bf16 v[68:71], a[136:139], v[24:27], v[68:71]
    v_mfma_f32_16x16x32_bf16 v[168:171], a[116:119], v[4:7], v[168:171]
    v_mfma_f32_16x16x32_bf16 v[168:171], a[140:143], v[16:19], v[168:171]
    v_mfma_f32_16x16x32_bf16 v[192:195], a[116:119], v[8:11], v[192:195]
    v_mfma_f32_16x16x32_bf16 v[192:195], a[140:143], v[20:23], v[192:195]
    v_mfma_f32_16x16x32_bf16 v[72:75], a[116:119], v[12:15], v[72:75]
    v_mfma_f32_16x16x32_bf16 v[72:75], a[140:143], v[24:27], v[72:75]
    s_waitcnt lgkmcnt(0)
    v_mfma_f32_16x16x32_bf16 v[148:151], a[144:147], v[28:31], v[148:151]
    v_mfma_f32_16x16x32_bf16 v[148:151], a[168:171], v[40:43], v[148:151]
    v_mfma_f32_16x16x32_bf16 v[172:175], a[144:147], v[32:35], v[172:175]
    ds_read_b128 v[4:7], v240 offset:49664
    v_mfma_f32_16x16x32_bf16 v[172:175], a[168:171], v[44:47], v[172:175]
    v_mfma_f32_16x16x32_bf16 v[52:55], a[144:147], v[36:39], v[52:55]
    v_mfma_f32_16x16x32_bf16 v[52:55], a[168:171], v[48:51], v[52:55]
    v_mfma_f32_16x16x32_bf16 v[152:155], a[148:151], v[28:31], v[152:155]
    ds_read_b128 v[8:11], v240 offset:61952
    v_mfma_f32_16x16x32_bf16 v[152:155], a[172:175], v[40:43], v[152:155]
    v_mfma_f32_16x16x32_bf16 v[176:179], a[148:151], v[32:35], v[176:179]
    v_mfma_f32_16x16x32_bf16 v[176:179], a[172:175], v[44:47], v[176:179]
    v_mfma_f32_16x16x32_bf16 v[56:59], a[148:151], v[36:39], v[56:59]
    ds_read_b128 v[12:15], v228 offset:12800
    v_mfma_f32_16x16x32_bf16 v[56:59], a[172:175], v[48:51], v[56:59]
    v_mfma_f32_16x16x32_bf16 v[156:159], a[152:155], v[28:31], v[156:159]
    v_mfma_f32_16x16x32_bf16 v[156:159], a[176:179], v[40:43], v[156:159]
    v_mfma_f32_16x16x32_bf16 v[180:183], a[152:155], v[32:35], v[180:183]
    ds_read_b128 v[16:19], v241 offset:49664
    v_mfma_f32_16x16x32_bf16 v[180:183], a[176:179], v[44:47], v[180:183]
    v_mfma_f32_16x16x32_bf16 v[60:63], a[152:155], v[36:39], v[60:63]
    v_mfma_f32_16x16x32_bf16 v[60:63], a[176:179], v[48:51], v[60:63]
    v_mfma_f32_16x16x32_bf16 v[160:163], a[156:159], v[28:31], v[160:163]
    ds_read_b128 v[20:23], v241 offset:61952
    v_mfma_f32_16x16x32_bf16 v[160:163], a[180:183], v[40:43], v[160:163]
    v_mfma_f32_16x16x32_bf16 v[184:187], a[156:159], v[32:35], v[184:187]
    v_mfma_f32_16x16x32_bf16 v[184:187], a[180:183], v[44:47], v[184:187]
    v_mfma_f32_16x16x32_bf16 v[64:67], a[156:159], v[36:39], v[64:67]
    ds_read_b128 v[24:27], v229 offset:12800
    v_mfma_f32_16x16x32_bf16 v[64:67], a[180:183], v[48:51], v[64:67]
    v_mfma_f32_16x16x32_bf16 v[164:167], a[160:163], v[28:31], v[164:167]
    v_mfma_f32_16x16x32_bf16 v[164:167], a[184:187], v[40:43], v[164:167]
    v_mfma_f32_16x16x32_bf16 v[188:191], a[160:163], v[32:35], v[188:191]
    v_mfma_f32_16x16x32_bf16 v[188:191], a[184:187], v[44:47], v[188:191]
    v_mfma_f32_16x16x32_bf16 v[68:71], a[160:163], v[36:39], v[68:71]
    v_mfma_f32_16x16x32_bf16 v[68:71], a[184:187], v[48:51], v[68:71]
    v_mfma_f32_16x16x32_bf16 v[168:171], a[164:167], v[28:31], v[168:171]
    v_mfma_f32_16x16x32_bf16 v[168:171], a[188:191], v[40:43], v[168:171]
    v_mfma_f32_16x16x32_bf16 v[192:195], a[164:167], v[32:35], v[192:195]
    v_mfma_f32_16x16x32_bf16 v[192:195], a[188:191], v[44:47], v[192:195]
    v_mfma_f32_16x16x32_bf16 v[72:75], a[164:167], v[36:39], v[72:75]
    v_mfma_f32_16x16x32_bf16 v[72:75], a[188:191], v[48:51], v[72:75]
    s_waitcnt lgkmcnt(0)
    v_mfma_f32_16x16x32_bf16 v[148:151], a[192:195], v[4:7], v[148:151]
    v_mfma_f32_16x16x32_bf16 v[148:151], a[216:219], v[16:19], v[148:151]
    v_mfma_f32_16x16x32_bf16 v[172:175], a[192:195], v[8:11], v[172:175]
    ds_read_b128 v[28:31], v242 offset:49664
    v_mfma_f32_16x16x32_bf16 v[172:175], a[216:219], v[20:23], v[172:175]
    v_mfma_f32_16x16x32_bf16 v[52:55], a[192:195], v[12:15], v[52:55]
    v_mfma_f32_16x16x32_bf16 v[52:55], a[216:219], v[24:27], v[52:55]
    v_mfma_f32_16x16x32_bf16 v[152:155], a[196:199], v[4:7], v[152:155]
    ds_read_b128 v[32:35], v242 offset:61952
    v_mfma_f32_16x16x32_bf16 v[152:155], a[220:223], v[16:19], v[152:155]
    v_mfma_f32_16x16x32_bf16 v[176:179], a[196:199], v[8:11], v[176:179]
    v_mfma_f32_16x16x32_bf16 v[176:179], a[220:223], v[20:23], v[176:179]
    v_mfma_f32_16x16x32_bf16 v[56:59], a[196:199], v[12:15], v[56:59]
    ds_read_b128 v[36:39], v230 offset:12800
    v_mfma_f32_16x16x32_bf16 v[56:59], a[220:223], v[24:27], v[56:59]
    v_mfma_f32_16x16x32_bf16 v[156:159], a[200:203], v[4:7], v[156:159]
    v_mfma_f32_16x16x32_bf16 v[156:159], a[224:227], v[16:19], v[156:159]
    v_mfma_f32_16x16x32_bf16 v[180:183], a[200:203], v[8:11], v[180:183]
    ds_read_b128 v[40:43], v243 offset:49664
    v_mfma_f32_16x16x32_bf16 v[180:183], a[224:227], v[20:23], v[180:183]
    v_mfma_f32_16x16x32_bf16 v[60:63], a[200:203], v[12:15], v[60:63]
    v_mfma_f32_16x16x32_bf16 v[60:63], a[224:227], v[24:27], v[60:63]
    v_mfma_f32_16x16x32_bf16 v[160:163], a[204:207], v[4:7], v[160:163]
    ds_read_b128 v[44:47], v243 offset:61952
    v_mfma_f32_16x16x32_bf16 v[160:163], a[228:231], v[16:19], v[160:163]
    v_mfma_f32_16x16x32_bf16 v[184:187], a[204:207], v[8:11], v[184:187]
    v_mfma_f32_16x16x32_bf16 v[184:187], a[228:231], v[20:23], v[184:187]
    v_mfma_f32_16x16x32_bf16 v[64:67], a[204:207], v[12:15], v[64:67]
    ds_read_b128 v[48:51], v231 offset:12800
    v_mfma_f32_16x16x32_bf16 v[64:67], a[228:231], v[24:27], v[64:67]
    v_mfma_f32_16x16x32_bf16 v[164:167], a[208:211], v[4:7], v[164:167]
    v_mfma_f32_16x16x32_bf16 v[164:167], a[232:235], v[16:19], v[164:167]
    v_mfma_f32_16x16x32_bf16 v[188:191], a[208:211], v[8:11], v[188:191]
    v_mfma_f32_16x16x32_bf16 v[188:191], a[232:235], v[20:23], v[188:191]
    v_mfma_f32_16x16x32_bf16 v[68:71], a[208:211], v[12:15], v[68:71]
    v_mfma_f32_16x16x32_bf16 v[68:71], a[232:235], v[24:27], v[68:71]
    v_mfma_f32_16x16x32_bf16 v[168:171], a[212:215], v[4:7], v[168:171]
    v_mfma_f32_16x16x32_bf16 v[168:171], a[236:239], v[16:19], v[168:171]
    v_mfma_f32_16x16x32_bf16 v[192:195], a[212:215], v[8:11], v[192:195]
    v_mfma_f32_16x16x32_bf16 v[192:195], a[236:239], v[20:23], v[192:195]
    v_mfma_f32_16x16x32_bf16 v[72:75], a[212:215], v[12:15], v[72:75]
    v_mfma_f32_16x16x32_bf16 v[72:75], a[236:239], v[24:27], v[72:75]
    s_waitcnt vmcnt(6) lgkmcnt(0)
    s_barrier
    v_mfma_f32_16x16x32_bf16 v[148:151], a[240:243], v[28:31], v[148:151]
    v_mfma_f32_16x16x32_bf16 v[148:151], v[204:207], v[40:43], v[148:151]
    v_mfma_f32_16x16x32_bf16 v[172:175], a[240:243], v[32:35], v[172:175]
    ds_read_b128 v[4:7], v228 offset:24576
    v_mfma_f32_16x16x32_bf16 v[172:175], v[204:207], v[44:47], v[172:175]
    v_mfma_f32_16x16x32_bf16 v[52:55], a[240:243], v[36:39], v[52:55]
    v_mfma_f32_16x16x32_bf16 v[52:55], v[204:207], v[48:51], v[52:55]
    v_mfma_f32_16x16x32_bf16 v[152:155], a[244:247], v[28:31], v[152:155]
    ds_read_b128 v[8:11], v228 offset:36864
    v_mfma_f32_16x16x32_bf16 v[152:155], v[208:211], v[40:43], v[152:155]
    v_mfma_f32_16x16x32_bf16 v[176:179], a[244:247], v[32:35], v[176:179]
    v_mfma_f32_16x16x32_bf16 v[176:179], v[208:211], v[44:47], v[176:179]
    v_mfma_f32_16x16x32_bf16 v[56:59], a[244:247], v[36:39], v[56:59]
    ds_read_b128 v[12:15], v240 offset:24576
    v_mfma_f32_16x16x32_bf16 v[56:59], v[208:211], v[48:51], v[56:59]
    v_mfma_f32_16x16x32_bf16 v[156:159], a[248:251], v[28:31], v[156:159]
    v_mfma_f32_16x16x32_bf16 v[156:159], v[212:215], v[40:43], v[156:159]
    v_mfma_f32_16x16x32_bf16 v[180:183], a[248:251], v[32:35], v[180:183]
    ds_read_b128 v[16:19], v229 offset:24576
    v_mfma_f32_16x16x32_bf16 v[180:183], v[212:215], v[44:47], v[180:183]
    v_mfma_f32_16x16x32_bf16 v[60:63], a[248:251], v[36:39], v[60:63]
    v_mfma_f32_16x16x32_bf16 v[60:63], v[212:215], v[48:51], v[60:63]
    v_mfma_f32_16x16x32_bf16 v[160:163], a[252:255], v[28:31], v[160:163]
    ds_read_b128 v[20:23], v229 offset:36864
    v_mfma_f32_16x16x32_bf16 v[160:163], v[216:219], v[40:43], v[160:163]
    v_mfma_f32_16x16x32_bf16 v[184:187], a[252:255], v[32:35], v[184:187]
    v_mfma_f32_16x16x32_bf16 v[184:187], v[216:219], v[44:47], v[184:187]
    v_mfma_f32_16x16x32_bf16 v[64:67], a[252:255], v[36:39], v[64:67]
    ds_read_b128 v[24:27], v241 offset:24576
    v_mfma_f32_16x16x32_bf16 v[64:67], v[216:219], v[48:51], v[64:67]
    v_mfma_f32_16x16x32_bf16 v[164:167], v[196:199], v[28:31], v[164:167]
    v_mfma_f32_16x16x32_bf16 v[164:167], v[220:223], v[40:43], v[164:167]
    v_mfma_f32_16x16x32_bf16 v[188:191], v[196:199], v[32:35], v[188:191]
    v_mfma_f32_16x16x32_bf16 v[188:191], v[220:223], v[44:47], v[188:191]
    v_mfma_f32_16x16x32_bf16 v[68:71], v[196:199], v[36:39], v[68:71]
    v_mfma_f32_16x16x32_bf16 v[68:71], v[220:223], v[48:51], v[68:71]
    v_mfma_f32_16x16x32_bf16 v[168:171], v[200:203], v[28:31], v[168:171]
    v_mfma_f32_16x16x32_bf16 v[168:171], v[224:227], v[40:43], v[168:171]
    v_mfma_f32_16x16x32_bf16 v[192:195], v[200:203], v[32:35], v[192:195]
    v_mfma_f32_16x16x32_bf16 v[192:195], v[224:227], v[44:47], v[192:195]
    v_mfma_f32_16x16x32_bf16 v[72:75], v[200:203], v[36:39], v[72:75]
    v_mfma_f32_16x16x32_bf16 v[72:75], v[224:227], v[48:51], v[72:75]
    s_waitcnt lgkmcnt(0)
    v_cvt_pk_bf16_f32 v76, v148, v149
    v_cvt_pk_bf16_f32 v77, v150, v151
    v_mfma_f32_16x16x32_bf16 v[148:151], a[0:3], v[4:7], 0
    s_add_u32 s74, s2, 258
    s_and_b32 s74, s74, 255
    v_mfma_f32_16x16x32_bf16 v[148:151], a[24:27], v[16:19], v[148:151]
    v_cvt_pk_bf16_f32 v88, v172, v173
    v_cvt_pk_bf16_f32 v89, v174, v175
    s_add_u32 s74, s74, 1536
    s_mul_i32 s74, s74, 12288
    v_mfma_f32_16x16x32_bf16 v[172:175], a[0:3], v[8:11], 0
    ds_read_b128 v[28:31], v230 offset:24576
    s_add_u32 m0, s49, 110592
    v_mfma_f32_16x16x32_bf16 v[172:175], a[24:27], v[20:23], v[172:175]
    v_cvt_pk_bf16_f32 v100, v52, v53
    v_cvt_pk_bf16_f32 v101, v54, v55
    buffer_load_dwordx4 v244, s[24:27], s74 offen nt lds
    v_mfma_f32_16x16x32_bf16 v[52:55], a[0:3], v[12:15], 0
    v_mfma_f32_16x16x32_bf16 v[52:55], a[24:27], v[24:27], v[52:55]
    v_cvt_pk_bf16_f32 v78, v152, v153
    v_cvt_pk_bf16_f32 v79, v154, v155
    v_mfma_f32_16x16x32_bf16 v[152:155], a[4:7], v[4:7], 0
    ds_read_b128 v[32:35], v230 offset:36864
    buffer_load_dwordx4 v245, s[24:27], s74 offen offset:1024 nt lds
    v_mfma_f32_16x16x32_bf16 v[152:155], a[28:31], v[16:19], v[152:155]
    v_cvt_pk_bf16_f32 v90, v176, v177
    v_cvt_pk_bf16_f32 v91, v178, v179
    v_mfma_f32_16x16x32_bf16 v[176:179], a[4:7], v[8:11], 0
    v_mfma_f32_16x16x32_bf16 v[176:179], a[28:31], v[20:23], v[176:179]
    v_cvt_pk_bf16_f32 v102, v56, v57
    v_cvt_pk_bf16_f32 v103, v58, v59
    buffer_load_dwordx4 v246, s[24:27], s74 offen offset:2048 nt lds
    v_mfma_f32_16x16x32_bf16 v[56:59], a[4:7], v[12:15], 0
    ds_read_b128 v[36:39], v242 offset:24576
    v_mfma_f32_16x16x32_bf16 v[56:59], a[28:31], v[24:27], v[56:59]
    v_cvt_pk_bf16_f32 v80, v156, v157
    v_cvt_pk_bf16_f32 v81, v158, v159
    v_mfma_f32_16x16x32_bf16 v[156:159], a[8:11], v[4:7], 0
    v_mfma_f32_16x16x32_bf16 v[156:159], a[32:35], v[16:19], v[156:159]
    v_cvt_pk_bf16_f32 v92, v180, v181
    v_cvt_pk_bf16_f32 v93, v182, v183
    v_mfma_f32_16x16x32_bf16 v[180:183], a[8:11], v[8:11], 0
    ds_read_b128 v[40:43], v231 offset:24576
    v_mfma_f32_16x16x32_bf16 v[180:183], a[32:35], v[20:23], v[180:183]
    v_cvt_pk_bf16_f32 v104, v60, v61
    v_cvt_pk_bf16_f32 v105, v62, v63
    v_mfma_f32_16x16x32_bf16 v[60:63], a[8:11], v[12:15], 0
    v_mfma_f32_16x16x32_bf16 v[60:63], a[32:35], v[24:27], v[60:63]
    v_cvt_pk_bf16_f32 v82, v160, v161
    v_cvt_pk_bf16_f32 v83, v162, v163
    v_mfma_f32_16x16x32_bf16 v[160:163], a[12:15], v[4:7], 0
    ds_read_b128 v[44:47], v231 offset:36864
    v_mfma_f32_16x16x32_bf16 v[160:163], a[36:39], v[16:19], v[160:163]
    v_cvt_pk_bf16_f32 v94, v184, v185
    v_cvt_pk_bf16_f32 v95, v186, v187
    v_mfma_f32_16x16x32_bf16 v[184:187], a[12:15], v[8:11], 0
    v_mfma_f32_16x16x32_bf16 v[184:187], a[36:39], v[20:23], v[184:187]
    v_cvt_pk_bf16_f32 v106, v64, v65
    v_cvt_pk_bf16_f32 v107, v66, v67
    v_mfma_f32_16x16x32_bf16 v[64:67], a[12:15], v[12:15], 0
    ds_read_b128 v[48:51], v243 offset:24576
    v_mfma_f32_16x16x32_bf16 v[64:67], a[36:39], v[24:27], v[64:67]
    v_cvt_pk_bf16_f32 v84, v164, v165
    v_cvt_pk_bf16_f32 v85, v166, v167
    v_mfma_f32_16x16x32_bf16 v[164:167], a[16:19], v[4:7], 0
    s_add_u32 s75, s2, 301
    s_and_b32 s75, s75, 255
    v_mfma_f32_16x16x32_bf16 v[164:167], a[40:43], v[16:19], v[164:167]
    v_cvt_pk_bf16_f32 v96, v188, v189
    v_cvt_pk_bf16_f32 v97, v190, v191
    s_add_u32 s75, s75, 1792
    s_mul_i32 s75, s75, 12288
    v_mfma_f32_16x16x32_bf16 v[188:191], a[16:19], v[8:11], 0
    s_add_u32 m0, s49, 122880
    v_mfma_f32_16x16x32_bf16 v[188:191], a[40:43], v[20:23], v[188:191]
    v_cvt_pk_bf16_f32 v108, v68, v69
    v_cvt_pk_bf16_f32 v109, v70, v71
    buffer_load_dwordx4 v244, s[24:27], s75 offen nt lds
    v_mfma_f32_16x16x32_bf16 v[68:71], a[16:19], v[12:15], 0
    v_mfma_f32_16x16x32_bf16 v[68:71], a[40:43], v[24:27], v[68:71]
    v_cvt_pk_bf16_f32 v86, v168, v169
    v_cvt_pk_bf16_f32 v87, v170, v171
    v_mfma_f32_16x16x32_bf16 v[168:171], a[20:23], v[4:7], 0
    buffer_load_dwordx4 v245, s[24:27], s75 offen offset:1024 nt lds
    v_mfma_f32_16x16x32_bf16 v[168:171], a[44:47], v[16:19], v[168:171]
    v_cvt_pk_bf16_f32 v98, v192, v193
    v_cvt_pk_bf16_f32 v99, v194, v195
    v_mfma_f32_16x16x32_bf16 v[192:195], a[20:23], v[8:11], 0
    v_mfma_f32_16x16x32_bf16 v[192:195], a[44:47], v[20:23], v[192:195]
    v_cvt_pk_bf16_f32 v110, v72, v73
    v_cvt_pk_bf16_f32 v111, v74, v75
    buffer_load_dwordx4 v246, s[24:27], s75 offen offset:2048 nt lds
    v_mfma_f32_16x16x32_bf16 v[72:75], a[20:23], v[12:15], 0
    v_mfma_f32_16x16x32_bf16 v[72:75], a[44:47], v[24:27], v[72:75]
    s_waitcnt lgkmcnt(0)
    v_mfma_f32_16x16x32_bf16 v[148:151], a[48:51], v[28:31], v[148:151]
    v_mfma_f32_16x16x32_bf16 v[148:151], a[72:75], v[40:43], v[148:151]
    v_mfma_f32_16x16x32_bf16 v[172:175], a[48:51], v[32:35], v[172:175]
    ds_read_b128 v[4:7], v228 offset:24832
    v_mfma_f32_16x16x32_bf16 v[172:175], a[72:75], v[44:47], v[172:175]
    v_mfma_f32_16x16x32_bf16 v[52:55], a[48:51], v[36:39], v[52:55]
    v_mfma_f32_16x16x32_bf16 v[52:55], a[72:75], v[48:51], v[52:55]
    v_mfma_f32_16x16x32_bf16 v[152:155], a[52:55], v[28:31], v[152:155]
    ds_read_b128 v[8:11], v228 offset:37120
    v_mfma_f32_16x16x32_bf16 v[152:155], a[76:79], v[40:43], v[152:155]
    v_mfma_f32_16x16x32_bf16 v[176:179], a[52:55], v[32:35], v[176:179]
    v_mfma_f32_16x16x32_bf16 v[176:179], a[76:79], v[44:47], v[176:179]
    v_mfma_f32_16x16x32_bf16 v[56:59], a[52:55], v[36:39], v[56:59]
    ds_read_b128 v[12:15], v240 offset:24832
    v_mfma_f32_16x16x32_bf16 v[56:59], a[76:79], v[48:51], v[56:59]
    v_mfma_f32_16x16x32_bf16 v[156:159], a[56:59], v[28:31], v[156:159]
    s_add_u32 s76, s2, 344
    s_and_b32 s76, s76, 255
    v_mfma_f32_16x16x32_bf16 v[156:159], a[80:83], v[40:43], v[156:159]
    s_add_u32 s76, s76, 2048
    s_mul_i32 s76, s76, 12288
    v_mfma_f32_16x16x32_bf16 v[180:183], a[56:59], v[32:35], v[180:183]
    ds_read_b128 v[16:19], v229 offset:24832
    s_add_u32 m0, s49, 135168
    v_mfma_f32_16x16x32_bf16 v[180:183], a[80:83], v[44:47], v[180:183]
    buffer_load_dwordx4 v244, s[24:27], s76 offen nt lds
    v_mfma_f32_16x16x32_bf16 v[60:63], a[56:59], v[36:39], v[60:63]
    v_mfma_f32_16x16x32_bf16 v[60:63], a[80:83], v[48:51], v[60:63]
    v_mfma_f32_16x16x32_bf16 v[160:163], a[60:63], v[28:31], v[160:163]
    ds_read_b128 v[20:23], v229 offset:37120
    buffer_load_dwordx4 v245, s[24:27], s76 offen offset:1024 nt lds
    v_mfma_f32_16x16x32_bf16 v[160:163], a[84:87], v[40:43], v[160:163]
    v_mfma_f32_16x16x32_bf16 v[184:187], a[60:63], v[32:35], v[184:187]
    v_mfma_f32_16x16x32_bf16 v[184:187], a[84:87], v[44:47], v[184:187]
    buffer_load_dwordx4 v246, s[24:27], s76 offen offset:2048 nt lds
    v_mfma_f32_16x16x32_bf16 v[64:67], a[60:63], v[36:39], v[64:67]
    ds_read_b128 v[24:27], v241 offset:24832
    v_mfma_f32_16x16x32_bf16 v[64:67], a[84:87], v[48:51], v[64:67]
    v_mfma_f32_16x16x32_bf16 v[164:167], a[64:67], v[28:31], v[164:167]
    v_mfma_f32_16x16x32_bf16 v[164:167], a[88:91], v[40:43], v[164:167]
    v_mfma_f32_16x16x32_bf16 v[188:191], a[64:67], v[32:35], v[188:191]
    v_mfma_f32_16x16x32_bf16 v[188:191], a[88:91], v[44:47], v[188:191]
    v_mfma_f32_16x16x32_bf16 v[68:71], a[64:67], v[36:39], v[68:71]
    v_mfma_f32_16x16x32_bf16 v[68:71], a[88:91], v[48:51], v[68:71]
    v_mfma_f32_16x16x32_bf16 v[168:171], a[68:71], v[28:31], v[168:171]
    v_mfma_f32_16x16x32_bf16 v[168:171], a[92:95], v[40:43], v[168:171]
    v_mfma_f32_16x16x32_bf16 v[192:195], a[68:71], v[32:35], v[192:195]
    v_mfma_f32_16x16x32_bf16 v[192:195], a[92:95], v[44:47], v[192:195]
    v_mfma_f32_16x16x32_bf16 v[72:75], a[68:71], v[36:39], v[72:75]
    v_mfma_f32_16x16x32_bf16 v[72:75], a[92:95], v[48:51], v[72:75]
    s_waitcnt lgkmcnt(0)
    v_mfma_f32_16x16x32_bf16 v[148:151], a[96:99], v[4:7], v[148:151]
    s_add_u32 s77, s78, 0
    s_add_u32 m0, s49, 0
    v_mfma_f32_16x16x32_bf16 v[148:151], a[120:123], v[16:19], v[148:151]
    buffer_load_dwordx4 v232, s[20:23], s77 offen nt lds
    v_mfma_f32_16x16x32_bf16 v[172:175], a[96:99], v[8:11], v[172:175]
    ds_read_b128 v[28:31], v230 offset:24832
    v_mfma_f32_16x16x32_bf16 v[172:175], a[120:123], v[20:23], v[172:175]
    v_mfma_f32_16x16x32_bf16 v[52:55], a[96:99], v[12:15], v[52:55]
    buffer_load_dwordx4 v233, s[20:23], s77 offen offset:1024 nt lds
    v_mfma_f32_16x16x32_bf16 v[52:55], a[120:123], v[24:27], v[52:55]
    v_mfma_f32_16x16x32_bf16 v[152:155], a[100:103], v[4:7], v[152:155]
    ds_read_b128 v[32:35], v230 offset:37120
    v_mfma_f32_16x16x32_bf16 v[152:155], a[124:127], v[16:19], v[152:155]
    buffer_load_dwordx4 v234, s[20:23], s77 offen offset:2048 nt lds
    v_mfma_f32_16x16x32_bf16 v[176:179], a[100:103], v[8:11], v[176:179]
    v_mfma_f32_16x16x32_bf16 v[176:179], a[124:127], v[20:23], v[176:179]
    v_mfma_f32_16x16x32_bf16 v[56:59], a[100:103], v[12:15], v[56:59]
    ds_read_b128 v[36:39], v242 offset:24832
    v_mfma_f32_16x16x32_bf16 v[56:59], a[124:127], v[24:27], v[56:59]
    v_mfma_f32_16x16x32_bf16 v[156:159], a[104:107], v[4:7], v[156:159]
    v_mfma_f32_16x16x32_bf16 v[156:159], a[128:131], v[16:19], v[156:159]
    v_mfma_f32_16x16x32_bf16 v[180:183], a[104:107], v[8:11], v[180:183]
    ds_read_b128 v[40:43], v231 offset:24832
    v_mfma_f32_16x16x32_bf16 v[180:183], a[128:131], v[20:23], v[180:183]
    v_mfma_f32_16x16x32_bf16 v[60:63], a[104:107], v[12:15], v[60:63]
    v_mfma_f32_16x16x32_bf16 v[60:63], a[128:131], v[24:27], v[60:63]
    v_mfma_f32_16x16x32_bf16 v[160:163], a[108:111], v[4:7], v[160:163]
    ds_read_b128 v[44:47], v231 offset:37120
    v_mfma_f32_16x16x32_bf16 v[160:163], a[132:135], v[16:19], v[160:163]
    v_mfma_f32_16x16x32_bf16 v[184:187], a[108:111], v[8:11], v[184:187]
    v_mfma_f32_16x16x32_bf16 v[184:187], a[132:135], v[20:23], v[184:187]
    v_mfma_f32_16x16x32_bf16 v[64:67], a[108:111], v[12:15], v[64:67]
    ds_read_b128 v[48:51], v243 offset:24832
    v_mfma_f32_16x16x32_bf16 v[64:67], a[132:135], v[24:27], v[64:67]
    v_mfma_f32_16x16x32_bf16 v[164:167], a[112:115], v[4:7], v[164:167]
    s_add_u32 s74, s78, 768
    s_add_u32 m0, s49, 12288
    v_mfma_f32_16x16x32_bf16 v[164:167], a[136:139], v[16:19], v[164:167]
    buffer_load_dwordx4 v232, s[20:23], s74 offen nt lds
    v_mfma_f32_16x16x32_bf16 v[188:191], a[112:115], v[8:11], v[188:191]
    v_mfma_f32_16x16x32_bf16 v[188:191], a[136:139], v[20:23], v[188:191]
    v_mfma_f32_16x16x32_bf16 v[68:71], a[112:115], v[12:15], v[68:71]
    buffer_load_dwordx4 v233, s[20:23], s74 offen offset:1024 nt lds
    v_mfma_f32_16x16x32_bf16 v[68:71], a[136:139], v[24:27], v[68:71]
    v_mfma_f32_16x16x32_bf16 v[168:171], a[116:119], v[4:7], v[168:171]
    v_mfma_f32_16x16x32_bf16 v[168:171], a[140:143], v[16:19], v[168:171]
    buffer_load_dwordx4 v234, s[20:23], s74 offen offset:2048 nt lds
    v_mfma_f32_16x16x32_bf16 v[192:195], a[116:119], v[8:11], v[192:195]
    v_mfma_f32_16x16x32_bf16 v[192:195], a[140:143], v[20:23], v[192:195]
    v_mfma_f32_16x16x32_bf16 v[72:75], a[116:119], v[12:15], v[72:75]
    v_mfma_f32_16x16x32_bf16 v[72:75], a[140:143], v[24:27], v[72:75]
    s_waitcnt lgkmcnt(0)
    v_mfma_f32_16x16x32_bf16 v[148:151], a[144:147], v[28:31], v[148:151]
    v_mfma_f32_16x16x32_bf16 v[148:151], a[168:171], v[40:43], v[148:151]
    v_mfma_f32_16x16x32_bf16 v[172:175], a[144:147], v[32:35], v[172:175]
    ds_read_b128 v[4:7], v228 offset:25088
    v_mfma_f32_16x16x32_bf16 v[172:175], a[168:171], v[44:47], v[172:175]
    v_mfma_f32_16x16x32_bf16 v[52:55], a[144:147], v[36:39], v[52:55]
    v_mfma_f32_16x16x32_bf16 v[52:55], a[168:171], v[48:51], v[52:55]
    v_mfma_f32_16x16x32_bf16 v[152:155], a[148:151], v[28:31], v[152:155]
    ds_read_b128 v[8:11], v228 offset:37376
    v_mfma_f32_16x16x32_bf16 v[152:155], a[172:175], v[40:43], v[152:155]
    v_mfma_f32_16x16x32_bf16 v[176:179], a[148:151], v[32:35], v[176:179]
    v_mfma_f32_16x16x32_bf16 v[176:179], a[172:175], v[44:47], v[176:179]
    v_mfma_f32_16x16x32_bf16 v[56:59], a[148:151], v[36:39], v[56:59]
    ds_read_b128 v[12:15], v240 offset:25088
    v_mfma_f32_16x16x32_bf16 v[56:59], a[172:175], v[48:51], v[56:59]
    v_mfma_f32_16x16x32_bf16 v[156:159], a[152:155], v[28:31], v[156:159]
    s_add_u32 s75, s84, 294912
    s_add_u32 m0, s49, 73728
    v_mfma_f32_16x16x32_bf16 v[156:159], a[176:179], v[40:43], v[156:159]
    buffer_load_dwordx4 v232, s[20:23], s75 offen nt lds
    v_mfma_f32_16x16x32_bf16 v[180:183], a[152:155], v[32:35], v[180:183]
    ds_read_b128 v[16:19], v229 offset:25088
    v_mfma_f32_16x16x32_bf16 v[180:183], a[176:179], v[44:47], v[180:183]
    v_mfma_f32_16x16x32_bf16 v[60:63], a[152:155], v[36:39], v[60:63]
    buffer_load_dwordx4 v233, s[20:23], s75 offen offset:1024 nt lds
    v_mfma_f32_16x16x32_bf16 v[60:63], a[176:179], v[48:51], v[60:63]
    v_mfma_f32_16x16x32_bf16 v[160:163], a[156:159], v[28:31], v[160:163]
    ds_read_b128 v[20:23], v229 offset:37376
    v_mfma_f32_16x16x32_bf16 v[160:163], a[180:183], v[40:43], v[160:163]
    buffer_load_dwordx4 v234, s[20:23], s75 offen offset:2048 nt lds
    v_mfma_f32_16x16x32_bf16 v[184:187], a[156:159], v[32:35], v[184:187]
    v_mfma_f32_16x16x32_bf16 v[184:187], a[180:183], v[44:47], v[184:187]
    v_mfma_f32_16x16x32_bf16 v[64:67], a[156:159], v[36:39], v[64:67]
    ds_read_b128 v[24:27], v241 offset:25088
    v_mfma_f32_16x16x32_bf16 v[64:67], a[180:183], v[48:51], v[64:67]
    v_mfma_f32_16x16x32_bf16 v[164:167], a[160:163], v[28:31], v[164:167]
    v_mfma_f32_16x16x32_bf16 v[164:167], a[184:187], v[40:43], v[164:167]
    v_mfma_f32_16x16x32_bf16 v[188:191], a[160:163], v[32:35], v[188:191]
    v_mfma_f32_16x16x32_bf16 v[188:191], a[184:187], v[44:47], v[188:191]
    v_mfma_f32_16x16x32_bf16 v[68:71], a[160:163], v[36:39], v[68:71]
    v_mfma_f32_16x16x32_bf16 v[68:71], a[184:187], v[48:51], v[68:71]
    v_mfma_f32_16x16x32_bf16 v[168:171], a[164:167], v[28:31], v[168:171]
    v_mfma_f32_16x16x32_bf16 v[168:171], a[188:191], v[40:43], v[168:171]
    v_mfma_f32_16x16x32_bf16 v[192:195], a[164:167], v[32:35], v[192:195]
    v_mfma_f32_16x16x32_bf16 v[192:195], a[188:191], v[44:47], v[192:195]
    v_mfma_f32_16x16x32_bf16 v[72:75], a[164:167], v[36:39], v[72:75]
    v_mfma_f32_16x16x32_bf16 v[72:75], a[188:191], v[48:51], v[72:75]
    s_waitcnt lgkmcnt(0)
    v_mfma_f32_16x16x32_bf16 v[148:151], a[192:195], v[4:7], v[148:151]
    s_add_u32 s76, s84, 295680
    s_add_u32 m0, s49, 86016
    s_load_dword s72, s[14:15], 0
    v_mfma_f32_16x16x32_bf16 v[148:151], a[216:219], v[16:19], v[148:151]
    buffer_load_dwordx4 v232, s[20:23], s76 offen nt lds
    v_mfma_f32_16x16x32_bf16 v[172:175], a[192:195], v[8:11], v[172:175]
    ds_read_b128 v[28:31], v230 offset:25088
    v_mfma_f32_16x16x32_bf16 v[172:175], a[216:219], v[20:23], v[172:175]
    v_mfma_f32_16x16x32_bf16 v[52:55], a[192:195], v[12:15], v[52:55]
    buffer_load_dwordx4 v233, s[20:23], s76 offen offset:1024 nt lds
    v_mfma_f32_16x16x32_bf16 v[52:55], a[216:219], v[24:27], v[52:55]
    v_mfma_f32_16x16x32_bf16 v[152:155], a[196:199], v[4:7], v[152:155]
    ds_read_b128 v[32:35], v230 offset:37376
    v_mfma_f32_16x16x32_bf16 v[152:155], a[220:223], v[16:19], v[152:155]
    buffer_load_dwordx4 v234, s[20:23], s76 offen offset:2048 nt lds
    v_mfma_f32_16x16x32_bf16 v[176:179], a[196:199], v[8:11], v[176:179]
    v_mfma_f32_16x16x32_bf16 v[176:179], a[220:223], v[20:23], v[176:179]
    v_mfma_f32_16x16x32_bf16 v[56:59], a[196:199], v[12:15], v[56:59]
    ds_read_b128 v[36:39], v242 offset:25088
    v_mfma_f32_16x16x32_bf16 v[56:59], a[220:223], v[24:27], v[56:59]
    v_mfma_f32_16x16x32_bf16 v[156:159], a[200:203], v[4:7], v[156:159]
    v_mfma_f32_16x16x32_bf16 v[156:159], a[224:227], v[16:19], v[156:159]
    v_mfma_f32_16x16x32_bf16 v[180:183], a[200:203], v[8:11], v[180:183]
    ds_read_b128 v[40:43], v231 offset:25088
    v_mfma_f32_16x16x32_bf16 v[180:183], a[224:227], v[20:23], v[180:183]
    v_mfma_f32_16x16x32_bf16 v[60:63], a[200:203], v[12:15], v[60:63]
    v_mfma_f32_16x16x32_bf16 v[60:63], a[224:227], v[24:27], v[60:63]
    v_mfma_f32_16x16x32_bf16 v[160:163], a[204:207], v[4:7], v[160:163]
    ds_read_b128 v[44:47], v231 offset:37376
    v_mfma_f32_16x16x32_bf16 v[160:163], a[228:231], v[16:19], v[160:163]
    v_mfma_f32_16x16x32_bf16 v[184:187], a[204:207], v[8:11], v[184:187]
    v_mfma_f32_16x16x32_bf16 v[184:187], a[228:231], v[20:23], v[184:187]
    v_mfma_f32_16x16x32_bf16 v[64:67], a[204:207], v[12:15], v[64:67]
    ds_read_b128 v[48:51], v243 offset:25088
    v_mfma_f32_16x16x32_bf16 v[64:67], a[228:231], v[24:27], v[64:67]
    v_mfma_f32_16x16x32_bf16 v[164:167], a[208:211], v[4:7], v[164:167]
    v_mfma_f32_16x16x32_bf16 v[164:167], a[232:235], v[16:19], v[164:167]
    v_mfma_f32_16x16x32_bf16 v[188:191], a[208:211], v[8:11], v[188:191]
    v_mfma_f32_16x16x32_bf16 v[188:191], a[232:235], v[20:23], v[188:191]
    v_mfma_f32_16x16x32_bf16 v[68:71], a[208:211], v[12:15], v[68:71]
    v_mfma_f32_16x16x32_bf16 v[68:71], a[232:235], v[24:27], v[68:71]
    v_mfma_f32_16x16x32_bf16 v[168:171], a[212:215], v[4:7], v[168:171]
    v_mfma_f32_16x16x32_bf16 v[168:171], a[236:239], v[16:19], v[168:171]
    v_mfma_f32_16x16x32_bf16 v[192:195], a[212:215], v[8:11], v[192:195]
    v_mfma_f32_16x16x32_bf16 v[192:195], a[236:239], v[20:23], v[192:195]
    v_mfma_f32_16x16x32_bf16 v[72:75], a[212:215], v[12:15], v[72:75]
    s_waitcnt lgkmcnt(0)
    s_cmp_ge_u32 s72, 24
    s_cbranch_scc0 L_nopfw
    s_mov_b32 exec_hi, 15
    buffer_load_dword v254, v253, s[40:43], 0 offen sc1
    s_mov_b64 exec, -1
L_nopfw:
    v_mfma_f32_16x16x32_bf16 v[72:75], a[236:239], v[24:27], v[72:75]
    s_waitcnt vmcnt(12) lgkmcnt(0)
    s_barrier
    v_mfma_f32_16x16x32_bf16 v[148:151], a[240:243], v[28:31], v[148:151]
    v_mfma_f32_16x16x32_bf16 v[148:151], v[204:207], v[40:43], v[148:151]
    v_mfma_f32_16x16x32_bf16 v[172:175], a[240:243], v[32:35], v[172:175]
    ds_read_b128 v[4:7], v240 offset:36864
    v_mfma_f32_16x16x32_bf16 v[172:175], v[204:207], v[44:47], v[172:175]
    v_mfma_f32_16x16x32_bf16 v[52:55], a[240:243], v[36:39], v[52:55]
    v_mfma_f32_16x16x32_bf16 v[52:55], v[204:207], v[48:51], v[52:55]
    v_mfma_f32_16x16x32_bf16 v[152:155], a[244:247], v[28:31], v[152:155]
    ds_read_b128 v[8:11], v240 offset:49152
    v_mfma_f32_16x16x32_bf16 v[152:155], v[208:211], v[40:43], v[152:155]
    v_mfma_f32_16x16x32_bf16 v[176:179], a[244:247], v[32:35], v[176:179]
    v_mfma_f32_16x16x32_bf16 v[176:179], v[208:211], v[44:47], v[176:179]
    v_mfma_f32_16x16x32_bf16 v[56:59], a[244:247], v[36:39], v[56:59]
    ds_read_b128 v[12:15], v240 offset:61440
    v_mfma_f32_16x16x32_bf16 v[56:59], v[208:211], v[48:51], v[56:59]
    v_mfma_f32_16x16x32_bf16 v[156:159], a[248:251], v[28:31], v[156:159]
    v_mfma_f32_16x16x32_bf16 v[156:159], v[212:215], v[40:43], v[156:159]
    v_mfma_f32_16x16x32_bf16 v[180:183], a[248:251], v[32:35], v[180:183]
    ds_read_b128 v[16:19], v241 offset:36864
    v_mfma_f32_16x16x32_bf16 v[180:183], v[212:215], v[44:47], v[180:183]
    v_mfma_f32_16x16x32_bf16 v[60:63], a[248:251], v[36:39], v[60:63]
    v_mfma_f32_16x16x32_bf16 v[60:63], v[212:215], v[48:51], v[60:63]
    v_mfma_f32_16x16x32_bf16 v[160:163], a[252:255], v[28:31], v[160:163]
    ds_read_b128 v[20:23], v241 offset:49152
    v_mfma_f32_16x16x32_bf16 v[160:163], v[216:219], v[40:43], v[160:163]
    v_mfma_f32_16x16x32_bf16 v[184:187], a[252:255], v[32:35], v[184:187]
    v_mfma_f32_16x16x32_bf16 v[184:187], v[216:219], v[44:47], v[184:187]
    v_mfma_f32_16x16x32_bf16 v[64:67], a[252:255], v[36:39], v[64:67]
    ds_read_b128 v[24:27], v241 offset:61440
    v_mfma_f32_16x16x32_bf16 v[64:67], v[216:219], v[48:51], v[64:67]
    v_mfma_f32_16x16x32_bf16 v[164:167], v[196:199], v[28:31], v[164:167]
    v_mfma_f32_16x16x32_bf16 v[164:167], v[220:223], v[40:43], v[164:167]
    v_mfma_f32_16x16x32_bf16 v[188:191], v[196:199], v[32:35], v[188:191]
    v_mfma_f32_16x16x32_bf16 v[188:191], v[220:223], v[44:47], v[188:191]
    v_mfma_f32_16x16x32_bf16 v[68:71], v[196:199], v[36:39], v[68:71]
    v_mfma_f32_16x16x32_bf16 v[68:71], v[220:223], v[48:51], v[68:71]
    v_mfma_f32_16x16x32_bf16 v[168:171], v[200:203], v[28:31], v[168:171]
    v_mfma_f32_16x16x32_bf16 v[168:171], v[224:227], v[40:43], v[168:171]
    v_mfma_f32_16x16x32_bf16 v[192:195], v[200:203], v[32:35], v[192:195]
    v_mfma_f32_16x16x32_bf16 v[192:195], v[224:227], v[44:47], v[192:195]
    v_mfma_f32_16x16x32_bf16 v[72:75], v[200:203], v[36:39], v[72:75]
    v_mfma_f32_16x16x32_bf16 v[72:75], v[224:227], v[48:51], v[72:75]
    s_branch L_p2done
L_pass2t:
    s_waitcnt lgkmcnt(0)
    v_cvt_pk_bf16_f32 v76, v148, v149
    v_cvt_pk_bf16_f32 v77, v150, v151
    v_mfma_f32_16x16x32_bf16 v[148:151], a[0:3], v[4:7], 0
    s_add_u32 s77, s2, 258
    s_and_b32 s77, s77, 255
    v_mfma_f32_16x16x32_bf16 v[148:151], a[24:27], v[16:19], v[148:151]
    v_cvt_pk_bf16_f32 v88, v172, v173
    v_cvt_pk_bf16_f32 v89, v174, v175
    s_add_u32 s77, s77, 1536
    s_mul_i32 s77, s77, 12288
    v_mfma_f32_16x16x32_bf16 v[172:175], a[0:3], v[8:11], 0
    ds_read_b128 v[28:31], v230 offset:24576
    s_add_u32 m0, s49, 110592
    v_mfma_f32_16x16x32_bf16 v[172:175], a[24:27], v[20:23], v[172:175]
    v_cvt_pk_bf16_f32 v100, v52, v53
    v_cvt_pk_bf16_f32 v101, v54, v55
    buffer_load_dwordx4 v244, s[24:27], s77 offen nt lds
    v_mfma_f32_16x16x32_bf16 v[52:55], a[0:3], v[12:15], 0
    v_mfma_f32_16x16x32_bf16 v[52:55], a[24:27], v[24:27], v[52:55]
    v_cvt_pk_bf16_f32 v78, v152, v153
    v_cvt_pk_bf16_f32 v79, v154, v155
    v_mfma_f32_16x16x32_bf16 v[152:155], a[4:7], v[4:7], 0
    ds_read_b128 v[32:35], v230 offset:36864
    buffer_load_dwordx4 v245, s[24:27], s77 offen offset:1024 nt lds
    v_mfma_f32_16x16x32_bf16 v[152:155], a[28:31], v[16:19], v[152:155]
    v_cvt_pk_bf16_f32 v90, v176, v177
    v_cvt_pk_bf16_f32 v91, v178, v179
    v_mfma_f32_16x16x32_bf16 v[176:179], a[4:7], v[8:11], 0
    v_mfma_f32_16x16x32_bf16 v[176:179], a[28:31], v[20:23], v[176:179]
    v_cvt_pk_bf16_f32 v102, v56, v57
    v_cvt_pk_bf16_f32 v103, v58, v59
    buffer_load_dwordx4 v246, s[24:27], s77 offen offset:2048 nt lds
    v_mfma_f32_16x16x32_bf16 v[56:59], a[4:7], v[12:15], 0
    ds_read_b128 v[36:39], v242 offset:24576
    v_mfma_f32_16x16x32_bf16 v[56:59], a[28:31], v[24:27], v[56:59]
    v_cvt_pk_bf16_f32 v80, v156, v157
    v_cvt_pk_bf16_f32 v81, v158, v159
    v_mfma_f32_16x16x32_bf16 v[156:159], a[8:11], v[4:7], 0
    v_mfma_f32_16x16x32_bf16 v[156:159], a[32:35], v[16:19], v[156:159]
    v_cvt_pk_bf16_f32 v92, v180, v181
    v_cvt_pk_bf16_f32 v93, v182, v183
    v_mfma_f32_16x16x32_bf16 v[180:183], a[8:11], v[8:11], 0
    ds_read_b128 v[40:43], v231 offset:24576
    v_mfma_f32_16x16x32_bf16 v[180:183], a[32:35], v[20:23], v[180:183]
    v_cvt_pk_bf16_f32 v104, v60, v61
    v_cvt_pk_bf16_f32 v105, v62, v63
    v_mfma_f32_16x16x32_bf16 v[60:63], a[8:11], v[12:15], 0
    v_mfma_f32_16x16x32_bf16 v[60:63], a[32:35], v[24:27], v[60:63]
    v_cvt_pk_bf16_f32 v82, v160, v161
    v_cvt_pk_bf16_f32 v83, v162, v163
    v_mfma_f32_16x16x32_bf16 v[160:163], a[12:15], v[4:7], 0
    ds_read_b128 v[44:47], v231 offset:36864
    v_mfma_f32_16x16x32_bf16 v[160:163], a[36:39], v[16:19], v[160:163]
    v_cvt_pk_bf16_f32 v94, v184, v185
    v_cvt_pk_bf16_f32 v95, v186, v187
    v_mfma_f32_16x16x32_bf16 v[184:187], a[12:15], v[8:11], 0
    s_add_u32 s74, s2, 301
    s_and_b32 s74, s74, 255
    v_mfma_f32_16x16x32_bf16 v[184:187], a[36:39], v[20:23], v[184:187]
    v_cvt_pk_bf16_f32 v106, v64, v65
    v_cvt_pk_bf16_f32 v107, v66, v67
    s_add_u32 s74, s74, 1792
    s_mul_i32 s74, s74, 12288
    v_mfma_f32_16x16x32_bf16 v[64:67], a[12:15], v[12:15], 0
    ds_read_b128 v[48:51], v243 offset:24576
    s_add_u32 m0, s49, 122880
    v_mfma_f32_16x16x32_bf16 v[64:67], a[36:39], v[24:27], v[64:67]
    v_cvt_pk_bf16_f32 v84, v164, v165
    v_cvt_pk_bf16_f32 v85, v166, v167
    buffer_load_dwordx4 v244, s[24:27], s74 offen nt lds
    v_mfma_f32_16x16x32_bf16 v[164:167], a[16:19], v[4:7], 0
    v_mfma_f32_16x16x32_bf16 v[164:167], a[40:43], v[16:19], v[164:167]
    v_cvt_pk_bf16_f32 v96, v188, v189
    v_cvt_pk_bf16_f32 v97, v190, v191
    v_mfma_f32_16x16x32_bf16 v[188:191], a[16:19], v[8:11], 0
    buffer_load_dwordx4 v245, s[24:27], s74 offen offset:1024 nt lds
    v_mfma_f32_16x16x32_bf16 v[188:191], a[40:43], v[20:23], v[188:191]
    v_cvt_pk_bf16_f32 v108, v68, v69
    v_cvt_pk_bf16_f32 v109, v70, v71
    v_mfma_f32_16x16x32_bf16 v[68:71], a[16:19], v[12:15], 0
    v_mfma_f32_16x16x32_bf16 v[68:71], a[40:43], v[24:27], v[68:71]
    v_cvt_pk_bf16_f32 v86, v168, v169
    v_cvt_pk_bf16_f32 v87, v170, v171
    buffer_load_dwordx4 v246, s[24:27], s74 offen offset:2048 nt lds
    v_mfma_f32_16x16x32_bf16 v[168:171], a[20:23], v[4:7], 0
    v_mfma_f32_16x16x32_bf16 v[168:171], a[44:47], v[16:19], v[168:171]
    v_cvt_pk_bf16_f32 v98, v192, v193
    v_cvt_pk_bf16_f32 v99, v194, v195
    v_mfma_f32_16x16x32_bf16 v[192:195], a[20:23], v[8:11], 0
    v_mfma_f32_16x16x32_bf16 v[192:195], a[44:47], v[20:23], v[192:195]
    v_cvt_pk_bf16_f32 v110, v72, v73
    v_cvt_pk_bf16_f32 v111, v74, v75
    v_mfma_f32_16x16x32_bf16 v[72:75], a[20:23], v[12:15], 0
    v_mfma_f32_16x16x32_bf16 v[72:75], a[44:47], v[24:27], v[72:75]
    s_waitcnt lgkmcnt(0)
    v_mfma_f32_16x16x32_bf16 v[148:151], a[48:51], v[28:31], v[148:151]
    v_mfma_f32_16x16x32_bf16 v[148:151], a[72:75], v[40:43], v[148:151]
    v_mfma_f32_16x16x32_bf16 v[172:175], a[48:51], v[32:35], v[172:175]
    ds_read_b128 v[4:7], v228 offset:24832
    v_mfma_f32_16x16x32_bf16 v[172:175], a[72:75], v[44:47], v[172:175]
    v_mfma_f32_16x16x32_bf16 v[52:55], a[48:51], v[36:39], v[52:55]
    s_add_u32 s75, s2, 344
    s_and_b32 s75, s75, 255
    v_mfma_f32_16x16x32_bf16 v[52:55], a[72:75], v[48:51], v[52:55]
    s_add_u32 s75, s75, 2048
    s_mul_i32 s75, s75, 12288
    v_mfma_f32_16x16x32_bf16 v[152:155], a[52:55], v[28:31], v[152:155]
    ds_read_b128 v[8:11], v228 offset:37120
    s_add_u32 m0, s49, 135168
    v_mfma_f32_16x16x32_bf16 v[152:155], a[76:79], v[40:43], v[152:155]
    buffer_load_dwordx4 v244, s[24:27], s75 offen nt lds
    v_mfma_f32_16x16x32_bf16 v[176:179], a[52:55], v[32:35], v[176:179]
    v_mfma_f32_16x16x32_bf16 v[176:179], a[76:79], v[44:47], v[176:179]
    v_mfma_f32_16x16x32_bf16 v[56:59], a[52:55], v[36:39], v[56:59]
    ds_read_b128 v[12:15], v240 offset:24832
    buffer_load_dwordx4 v245, s[24:27], s75 offen offset:1024 nt lds
    v_mfma_f32_16x16x32_bf16 v[56:59], a[76:79], v[48:51], v[56:59]
    v_mfma_f32_16x16x32_bf16 v[156:159], a[56:59], v[28:31], v[156:159]
    v_mfma_f32_16x16x32_bf16 v[156:159], a[80:83], v[40:43], v[156:159]
    buffer_load_dwordx4 v246, s[24:27], s75 offen offset:2048 nt lds
    v_mfma_f32_16x16x32_bf16 v[180:183], a[56:59], v[32:35], v[180:183]
    ds_read_b128 v[16:19], v229 offset:24832
    v_mfma_f32_16x16x32_bf16 v[180:183], a[80:83], v[44:47], v[180:183]
    v_mfma_f32_16x16x32_bf16 v[60:63], a[56:59], v[36:39], v[60:63]
    v_mfma_f32_16x16x32_bf16 v[60:63], a[80:83], v[48:51], v[60:63]
    v_mfma_f32_16x16x32_bf16 v[160:163], a[60:63], v[28:31], v[160:163]
    ds_read_b128 v[20:23], v229 offset:37120
    v_mfma_f32_16x16x32_bf16 v[160:163], a[84:87], v[40:43], v[160:163]
    v_mfma_f32_16x16x32_bf16 v[184:187], a[60:63], v[32:35], v[184:187]
    v_mfma_f32_16x16x32_bf16 v[184:187], a[84:87], v[44:47], v[184:187]
    v_mfma_f32_16x16x32_bf16 v[64:67], a[60:63], v[36:39], v[64:67]
    ds_read_b128 v[24:27], v241 offset:24832
    v_mfma_f32_16x16x32_bf16 v[64:67], a[84:87], v[48:51], v[64:67]
    v_mfma_f32_16x16x32_bf16 v[164:167], a[64:67], v[28:31], v[164:167]
    s_add_u32 s76, s78, 0
    s_add_u32 m0, s49, 0
    v_mfma_f32_16x16x32_bf16 v[164:167], a[88:91], v[40:43], v[164:167]
    buffer_load_dwordx4 v232, s[20:23], s76 offen nt lds
    v_mfma_f32_16x16x32_bf16 v[188:191], a[64:67], v[32:35], v[188:191]
    v_mfma_f32_16x16x32_bf16 v[188:191], a[88:91], v[44:47], v[188:191]
    v_mfma_f32_16x16x32_bf16 v[68:71], a[64:67], v[36:39], v[68:71]
    buffer_load_dwordx4 v233, s[20:23], s76 offen offset:1024 nt lds
    v_mfma_f32_16x16x32_bf16 v[68:71], a[88:91], v[48:51], v[68:71]
    v_mfma_f32_16x16x32_bf16 v[168:171], a[68:71], v[28:31], v[168:171]
    v_mfma_f32_16x16x32_bf16 v[168:171], a[92:95], v[40:43], v[168:171]
    buffer_load_dwordx4 v234, s[20:23], s76 offen offset:2048 nt lds
    v_mfma_f32_16x16x32_bf16 v[192:195], a[68:71], v[32:35], v[192:195]
    v_mfma_f32_16x16x32_bf16 v[192:195], a[92:95], v[44:47], v[192:195]
    v_mfma_f32_16x16x32_bf16 v[72:75], a[68:71], v[36:39], v[72:75]
    v_mfma_f32_16x16x32_bf16 v[72:75], a[92:95], v[48:51], v[72:75]
    s_waitcnt lgkmcnt(0)
    v_mfma_f32_16x16x32_bf16 v[148:151], a[96:99], v[4:7], v[148:151]
    v_mfma_f32_16x16x32_bf16 v[148:151], a[120:123], v[16:19], v[148:151]
    v_mfma_f32_16x16x32_bf16 v[172:175], a[96:99], v[8:11], v[172:175]
    ds_read_b128 v[28:31], v230 offset:24832
    v_mfma_f32_16x16x32_bf16 v[172:175], a[120:123], v[20:23], v[172:175]
    v_mfma_f32_16x16x32_bf16 v[52:55], a[96:99], v[12:15], v[52:55]
    v_mfma_f32_16x16x32_bf16 v[52:55], a[120:123], v[24:27], v[52:55]
    v_mfma_f32_16x16x32_bf16 v[152:155], a[100:103], v[4:7], v[152:155]
    ds_read_b128 v[32:35], v230 offset:37120
    v_mfma_f32_16x16x32_bf16 v[152:155], a[124:127], v[16:19], v[152:155]
    v_mfma_f32_16x16x32_bf16 v[176:179], a[100:103], v[8:11], v[176:179]
    s_add_u32 s77, s78, 768
    s_add_u32 m0, s49, 12288
    v_mfma_f32_16x16x32_bf16 v[176:179], a[124:127], v[20:23], v[176:179]
    buffer_load_dwordx4 v232, s[20:23], s77 offen nt lds
    v_mfma_f32_16x16x32_bf16 v[56:59], a[100:103], v[12:15], v[56:59]
    ds_read_b128 v[36:39], v242 offset:24832
    v_mfma_f32_16x16x32_bf16 v[56:59], a[124:127], v[24:27], v[56:59]
    v_mfma_f32_16x16x32_bf16 v[156:159], a[104:107], v[4:7], v[156:159]
    buffer_load_dwordx4 v233, s[20:23], s77 offen offset:1024 nt lds
    v_mfma_f32_16x16x32_bf16 v[156:159], a[128:131], v[16:19], v[156:159]
    v_mfma_f32_16x16x32_bf16 v[180:183], a[104:107], v[8:11], v[180:183]
    ds_read_b128 v[40:43], v231 offset:24832
    v_mfma_f32_16x16x32_bf16 v[180:183], a[128:131], v[20:23], v[180:183]
    buffer_load_dwordx4 v234, s[20:23], s77 offen offset:2048 nt lds
    v_mfma_f32_16x16x32_bf16 v[60:63], a[104:107], v[12:15], v[60:63]
    v_mfma_f32_16x16x32_bf16 v[60:63], a[128:131], v[24:27], v[60:63]
    v_mfma_f32_16x16x32_bf16 v[160:163], a[108:111], v[4:7], v[160:163]
    ds_read_b128 v[44:47], v231 offset:37120
    v_mfma_f32_16x16x32_bf16 v[160:163], a[132:135], v[16:19], v[160:163]
    v_mfma_f32_16x16x32_bf16 v[184:187], a[108:111], v[8:11], v[184:187]
    v_mfma_f32_16x16x32_bf16 v[184:187], a[132:135], v[20:23], v[184:187]
    v_mfma_f32_16x16x32_bf16 v[64:67], a[108:111], v[12:15], v[64:67]
    ds_read_b128 v[48:51], v243 offset:24832
    v_mfma_f32_16x16x32_bf16 v[64:67], a[132:135], v[24:27], v[64:67]
    v_mfma_f32_16x16x32_bf16 v[164:167], a[112:115], v[4:7], v[164:167]
    v_mfma_f32_16x16x32_bf16 v[164:167], a[136:139], v[16:19], v[164:167]
    v_mfma_f32_16x16x32_bf16 v[188:191], a[112:115], v[8:11], v[188:191]
    v_mfma_f32_16x16x32_bf16 v[188:191], a[136:139], v[20:23], v[188:191]
    v_mfma_f32_16x16x32_bf16 v[68:71], a[112:115], v[12:15], v[68:71]
    v_mfma_f32_16x16x32_bf16 v[68:71], a[136:139], v[24:27], v[68:71]
    v_mfma_f32_16x16x32_bf16 v[168:171], a[116:119], v[4:7], v[168:171]
    v_mfma_f32_16x16x32_bf16 v[168:171], a[140:143], v[16:19], v[168:171]
    v_mfma_f32_16x16x32_bf16 v[192:195], a[116:119], v[8:11], v[192:195]
    v_mfma_f32_16x16x32_bf16 v[192:195], a[140:143], v[20:23], v[192:195]
    v_mfma_f32_16x16x32_bf16 v[72:75], a[116:119], v[12:15], v[72:75]
    v_mfma_f32_16x16x32_bf16 v[72:75], a[140:143], v[24:27], v[72:75]
    s_waitcnt lgkmcnt(0)
    v_mfma_f32_16x16x32_bf16 v[148:151], a[144:147], v[28:31], v[148:151]
    v_mfma_f32_16x16x32_bf16 v[148:151], a[168:171], v[40:43], v[148:151]
    v_mfma_f32_16x16x32_bf16 v[172:175], a[144:147], v[32:35], v[172:175]
    ds_read_b128 v[4:7], v228 offset:25088
    v_mfma_f32_16x16x32_bf16 v[172:175], a[168:171], v[44:47], v[172:175]
    v_mfma_f32_16x16x32_bf16 v[52:55], a[144:147], v[36:39], v[52:55]
    v_mfma_f32_16x16x32_bf16 v[52:55], a[168:171], v[48:51], v[52:55]
    v_mfma_f32_16x16x32_bf16 v[152:155], a[148:151], v[28:31], v[152:155]
    ds_read_b128 v[8:11], v228 offset:37376
    v_mfma_f32_16x16x32_bf16 v[152:155], a[172:175], v[40:43], v[152:155]
    v_mfma_f32_16x16x32_bf16 v[176:179], a[148:151], v[32:35], v[176:179]
    v_mfma_f32_16x16x32_bf16 v[176:179], a[172:175], v[44:47], v[176:179]
    v_mfma_f32_16x16x32_bf16 v[56:59], a[148:151], v[36:39], v[56:59]
    ds_read_b128 v[12:15], v240 offset:25088
    v_mfma_f32_16x16x32_bf16 v[56:59], a[172:175], v[48:51], v[56:59]
    v_mfma_f32_16x16x32_bf16 v[156:159], a[152:155], v[28:31], v[156:159]
    v_mfma_f32_16x16x32_bf16 v[156:159], a[176:179], v[40:43], v[156:159]
    v_mfma_f32_16x16x32_bf16 v[180:183], a[152:155], v[32:35], v[180:183]
    ds_read_b128 v[16:19], v229 offset:25088
    v_mfma_f32_16x16x32_bf16 v[180:183], a[176:179], v[44:47], v[180:183]
    v_mfma_f32_16x16x32_bf16 v[60:63], a[152:155], v[36:39], v[60:63]
    v_mfma_f32_16x16x32_bf16 v[60:63], a[176:179], v[48:51], v[60:63]
    v_mfma_f32_16x16x32_bf16 v[160:163], a[156:159], v[28:31], v[160:163]
    ds_read_b128 v[20:23], v229 offset:37376
    v_mfma_f32_16x16x32_bf16 v[160:163], a[180:183], v[40:43], v[160:163]
    v_mfma_f32_16x16x32_bf16 v[184:187], a[156:159], v[32:35], v[184:187]
    v_mfma_f32_16x16x32_bf16 v[184:187], a[180:183], v[44:47], v[184:187]
    v_mfma_f32_16x16x32_bf16 v[64:67], a[156:159], v[36:39], v[64:67]
    ds_read_b128 v[24:27], v241 offset:25088
    v_mfma_f32_16x16x32_bf16 v[64:67], a[180:183], v[48:51], v[64:67]
    v_mfma_f32_16x16x32_bf16 v[164:167], a[160:163], v[28:31], v[164:167]
    v_mfma_f32_16x16x32_bf16 v[164:167], a[184:187], v[40:43], v[164:167]
    v_mfma_f32_16x16x32_bf16 v[188:191], a[160:163], v[32:35], v[188:191]
    v_mfma_f32_16x16x32_bf16 v[188:191], a[184:187], v[44:47], v[188:191]
    v_mfma_f32_16x16x32_bf16 v[68:71], a[160:163], v[36:39], v[68:71]
    v_mfma_f32_16x16x32_bf16 v[68:71], a[184:187], v[48:51], v[68:71]
    v_mfma_f32_16x16x32_bf16 v[168:171], a[164:167], v[28:31], v[168:171]
    v_mfma_f32_16x16x32_bf16 v[168:171], a[188:191], v[40:43], v[168:171]
    v_mfma_f32_16x16x32_bf16 v[192:195], a[164:167], v[32:35], v[192:195]
    v_mfma_f32_16x16x32_bf16 v[192:195], a[188:191], v[44:47], v[192:195]
    v_mfma_f32_16x16x32_bf16 v[72:75], a[164:167], v[36:39], v[72:75]
    v_mfma_f32_16x16x32_bf16 v[72:75], a[188:191], v[48:51], v[72:75]
    s_waitcnt lgkmcnt(0)
    v_mfma_f32_16x16x32_bf16 v[148:151], a[192:195], v[4:7], v[148:151]
    s_load_dword s72, s[14:15], 0
    v_mfma_f32_16x16x32_bf16 v[148:151], a[216:219], v[16:19], v[148:151]
    v_mfma_f32_16x16x32_bf16 v[172:175], a[192:195], v[8:11], v[172:175]
    ds_read_b128 v[28:31], v230 offset:25088
    v_mfma_f32_16x16x32_bf16 v[172:175], a[216:219], v[20:23], v[172:175]
    v_mfma_f32_16x16x32_bf16 v[52:55], a[192:195], v[12:15], v[52:55]
    v_mfma_f32_16x16x32_bf16 v[52:55], a[216:219], v[24:27], v[52:55]
    v_mfma_f32_16x16x32_bf16 v[152:155], a[196:199], v[4:7], v[152:155]
    ds_read_b128 v[32:35], v230 offset:37376
    v_mfma_f32_16x16x32_bf16 v[152:155], a[220:223], v[16:19], v[152:155]
    v_mfma_f32_16x16x32_bf16 v[176:179], a[196:199], v[8:11], v[176:179]
    v_mfma_f32_16x16x32_bf16 v[176:179], a[220:223], v[20:23], v[176:179]
    v_mfma_f32_16x16x32_bf16 v[56:59], a[196:199], v[12:15], v[56:59]
    ds_read_b128 v[36:39], v242 offset:25088
    v_mfma_f32_16x16x32_bf16 v[56:59], a[220:223], v[24:27], v[56:59]
    v_mfma_f32_16x16x32_bf16 v[156:159], a[200:203], v[4:7], v[156:159]
    v_mfma_f32_16x16x32_bf16 v[156:159], a[224:227], v[16:19], v[156:159]
    v_mfma_f32_16x16x32_bf16 v[180:183], a[200:203], v[8:11], v[180:183]
    ds_read_b128 v[40:43], v231 offset:25088
    v_mfma_f32_16x16x32_bf16 v[180:183], a[224:227], v[20:23], v[180:183]
    v_mfma_f32_16x16x32_bf16 v[60:63], a[200:203], v[12:15], v[60:63]
    v_mfma_f32_16x16x32_bf16 v[60:63], a[224:227], v[24:27], v[60:63]
    v_mfma_f32_16x16x32_bf16 v[160:163], a[204:207], v[4:7], v[160:163]
    ds_read_b128 v[44:47], v231 offset:37376
    v_mfma_f32_16x16x32_bf16 v[160:163], a[228:231], v[16:19], v[160:163]
    v_mfma_f32_16x16x32_bf16 v[184:187], a[204:207], v[8:11], v[184:187]
    v_mfma_f32_16x16x32_bf16 v[184:187], a[228:231], v[20:23], v[184:187]
    v_mfma_f32_16x16x32_bf16 v[64:67], a[204:207], v[12:15], v[64:67]
    ds_read_b128 v[48:51], v243 offset:25088
    v_mfma_f32_16x16x32_bf16 v[64:67], a[228:231], v[24:27], v[64:67]
    v_mfma_f32_16x16x32_bf16 v[164:167], a[208:211], v[4:7], v[164:167]
    v_mfma_f32_16x16x32_bf16 v[164:167], a[232:235], v[16:19], v[164:167]
    v_mfma_f32_16x16x32_bf16 v[188:191], a[208:211], v[8:11], v[188:191]
    v_mfma_f32_16x16x32_bf16 v[188:191], a[232:235], v[20:23], v[188:191]
    v_mfma_f32_16x16x32_bf16 v[68:71], a[208:211], v[12:15], v[68:71]
    v_mfma_f32_16x16x32_bf16 v[68:71], a[232:235], v[24:27], v[68:71]
    v_mfma_f32_16x16x32_bf16 v[168:171], a[212:215], v[4:7], v[168:171]
    v_mfma_f32_16x16x32_bf16 v[168:171], a[236:239], v[16:19], v[168:171]
    v_mfma_f32_16x16x32_bf16 v[192:195], a[212:215], v[8:11], v[192:195]
    v_mfma_f32_16x16x32_bf16 v[192:195], a[236:239], v[20:23], v[192:195]
    v_mfma_f32_16x16x32_bf16 v[72:75], a[212:215], v[12:15], v[72:75]
    s_waitcnt lgkmcnt(0)
    s_cmp_ge_u32 s72, 24
    s_cbranch_scc0 L_nopft
    s_mov_b32 exec_hi, 15
    buffer_load_dword v254, v253, s[40:43], 0 offen sc1
    s_mov_b64 exec, -1
L_nopft:
    v_mfma_f32_16x16x32_bf16 v[72:75], a[236:239], v[24:27], v[72:75]
    s_waitcnt vmcnt(6) lgkmcnt(0)
    s_barrier
    v_mfma_f32_16x16x32_bf16 v[148:151], a[240:243], v[28:31], v[148:151]
    v_mfma_f32_16x16x32_bf16 v[148:151], v[204:207], v[40:43], v[148:151]
    v_mfma_f32_16x16x32_bf16 v[172:175], a[240:243], v[32:35], v[172:175]
    ds_read_b128 v[4:7], v240 offset:36864
    v_mfma_f32_16x16x32_bf16 v[172:175], v[204:207], v[44:47], v[172:175]
    v_mfma_f32_16x16x32_bf16 v[52:55], a[240:243], v[36:39], v[52:55]
    v_mfma_f32_16x16x32_bf16 v[52:55], v[204:207], v[48:51], v[52:55]
    v_mfma_f32_16x16x32_bf16 v[152:155], a[244:247], v[28:31], v[152:155]
    ds_read_b128 v[8:11], v240 offset:49152
    v_mfma_f32_16x16x32_bf16 v[152:155], v[208:211], v[40:43], v[152:155]
    v_mfma_f32_16x16x32_bf16 v[176:179], a[244:247], v[32:35], v[176:179]
    v_mfma_f32_16x16x32_bf16 v[176:179], v[208:211], v[44:47], v[176:179]
    v_mfma_f32_16x16x32_bf16 v[56:59], a[244:247], v[36:39], v[56:59]
    ds_read_b128 v[12:15], v240 offset:61440
    v_mfma_f32_16x16x32_bf16 v[56:59], v[208:211], v[48:51], v[56:59]
    v_mfma_f32_16x16x32_bf16 v[156:159], a[248:251], v[28:31], v[156:159]
    v_mfma_f32_16x16x32_bf16 v[156:159], v[212:215], v[40:43], v[156:159]
    v_mfma_f32_16x16x32_bf16 v[180:183], a[248:251], v[32:35], v[180:183]
    ds_read_b128 v[16:19], v241 offset:36864
    v_mfma_f32_16x16x32_bf16 v[180:183], v[212:215], v[44:47], v[180:183]
    v_mfma_f32_16x16x32_bf16 v[60:63], a[248:251], v[36:39], v[60:63]
    v_mfma_f32_16x16x32_bf16 v[60:63], v[212:215], v[48:51], v[60:63]
    v_mfma_f32_16x16x32_bf16 v[160:163], a[252:255], v[28:31], v[160:163]
    ds_read_b128 v[20:23], v241 offset:49152
    v_mfma_f32_16x16x32_bf16 v[160:163], v[216:219], v[40:43], v[160:163]
    v_mfma_f32_16x16x32_bf16 v[184:187], a[252:255], v[32:35], v[184:187]
    v_mfma_f32_16x16x32_bf16 v[184:187], v[216:219], v[44:47], v[184:187]
    v_mfma_f32_16x16x32_bf16 v[64:67], a[252:255], v[36:39], v[64:67]
    ds_read_b128 v[24:27], v241 offset:61440
    v_mfma_f32_16x16x32_bf16 v[64:67], v[216:219], v[48:51], v[64:67]
    v_mfma_f32_16x16x32_bf16 v[164:167], v[196:199], v[28:31], v[164:167]
    v_mfma_f32_16x16x32_bf16 v[164:167], v[220:223], v[40:43], v[164:167]
    v_mfma_f32_16x16x32_bf16 v[188:191], v[196:199], v[32:35], v[188:191]
    v_mfma_f32_16x16x32_bf16 v[188:191], v[220:223], v[44:47], v[188:191]
    v_mfma_f32_16x16x32_bf16 v[68:71], v[196:199], v[36:39], v[68:71]
    v_mfma_f32_16x16x32_bf16 v[68:71], v[220:223], v[48:51], v[68:71]
    v_mfma_f32_16x16x32_bf16 v[168:171], v[200:203], v[28:31], v[168:171]
    v_mfma_f32_16x16x32_bf16 v[168:171], v[224:227], v[40:43], v[168:171]
    v_mfma_f32_16x16x32_bf16 v[192:195], v[200:203], v[32:35], v[192:195]
    v_mfma_f32_16x16x32_bf16 v[192:195], v[224:227], v[44:47], v[192:195]
    v_mfma_f32_16x16x32_bf16 v[72:75], v[200:203], v[36:39], v[72:75]
    v_mfma_f32_16x16x32_bf16 v[72:75], v[224:227], v[48:51], v[72:75]
L_p2done:
    s_cmp_ge_u32 s72, 24
    s_cbranch_scc0 L_poll
L_ready:
    s_waitcnt lgkmcnt(0)
    v_cvt_pk_bf16_f32 v112, v148, v149
    v_cvt_pk_bf16_f32 v113, v150, v151
    v_mfma_f32_16x16x32_bf16 v[148:151], a[0:3], v[4:7], 0
    v_mfma_f32_16x16x32_bf16 v[148:151], a[24:27], v[16:19], v[148:151]
    v_cvt_pk_bf16_f32 v124, v172, v173
    v_cvt_pk_bf16_f32 v125, v174, v175
    v_mfma_f32_16x16x32_bf16 v[172:175], a[0:3], v[8:11], 0
    ds_read_b128 v[28:31], v242 offset:36864
    s_mov_b32 s74, 0
    v_mfma_f32_16x16x32_bf16 v[172:175], a[24:27], v[20:23], v[172:175]
    v_cvt_pk_bf16_f32 v136, v52, v53
    v_cvt_pk_bf16_f32 v137, v54, v55
    v_mfma_f32_16x16x32_bf16 v[52:55], a[0:3], v[12:15], 0
    buffer_load_dwordx4 a[0:3], v252, s[40:43], s74 offen sc1
    v_mfma_f32_16x16x32_bf16 v[52:55], a[24:27], v[24:27], v[52:55]
    v_cvt_pk_bf16_f32 v114, v152, v153
    v_cvt_pk_bf16_f32 v115, v154, v155
    v_mfma_f32_16x16x32_bf16 v[152:155], a[4:7], v[4:7], 0
    ds_read_b128 v[32:35], v242 offset:49152
    v_mfma_f32_16x16x32_bf16 v[152:155], a[28:31], v[16:19], v[152:155]
    v_cvt_pk_bf16_f32 v126, v176, v177
    v_cvt_pk_bf16_f32 v127, v178, v179
    buffer_load_dwordx4 a[24:27], v252, s[40:43], s74 offen offset:1024 sc1
    v_mfma_f32_16x16x32_bf16 v[176:179], a[4:7], v[8:11], 0
    v_mfma_f32_16x16x32_bf16 v[176:179], a[28:31], v[20:23], v[176:179]
    v_cvt_pk_bf16_f32 v138, v56, v57
    v_cvt_pk_bf16_f32 v139, v58, v59
    v_mfma_f32_16x16x32_bf16 v[56:59], a[4:7], v[12:15], 0
    ds_read_b128 v[36:39], v242 offset:61440
    buffer_load_dwordx4 a[4:7], v252, s[40:43], s74 offen offset:2048 sc1
    v_mfma_f32_16x16x32_bf16 v[56:59], a[28:31], v[24:27], v[56:59]
    v_cvt_pk_bf16_f32 v116, v156, v157
    v_cvt_pk_bf16_f32 v117, v158, v159
    v_mfma_f32_16x16x32_bf16 v[156:159], a[8:11], v[4:7], 0
    v_mfma_f32_16x16x32_bf16 v[156:159], a[32:35], v[16:19], v[156:159]
    v_cvt_pk_bf16_f32 v128, v180, v181
    v_cvt_pk_bf16_f32 v129, v182, v183
    buffer_load_dwordx4 a[28:31], v252, s[40:43], s74 offen offset:3072 sc1
    v_mfma_f32_16x16x32_bf16 v[180:183], a[8:11], v[8:11], 0
    ds_read_b128 v[40:43], v243 offset:36864
    s_mov_b32 s75, 4096
    v_mfma_f32_16x16x32_bf16 v[180:183], a[32:35], v[20:23], v[180:183]
    v_cvt_pk_bf16_f32 v140, v60, v61
    v_cvt_pk_bf16_f32 v141, v62, v63
    v_mfma_f32_16x16x32_bf16 v[60:63], a[8:11], v[12:15], 0
    buffer_load_dwordx4 a[8:11], v252, s[40:43], s75 offen sc1
    v_mfma_f32_16x16x32_bf16 v[60:63], a[32:35], v[24:27], v[60:63]
    v_cvt_pk_bf16_f32 v118, v160, v161
    v_cvt_pk_bf16_f32 v119, v162, v163
    v_mfma_f32_16x16x32_bf16 v[160:163], a[12:15], v[4:7], 0
    ds_read_b128 v[44:47], v243 offset:49152
    v_mfma_f32_16x16x32_bf16 v[160:163], a[36:39], v[16:19], v[160:163]
    v_cvt_pk_bf16_f32 v130, v184, v185
    v_cvt_pk_bf16_f32 v131, v186, v187
    buffer_load_dwordx4 a[32:35], v252, s[40:43], s75 offen offset:1024 sc1
    v_mfma_f32_16x16x32_bf16 v[184:187], a[12:15], v[8:11], 0
    v_mfma_f32_16x16x32_bf16 v[184:187], a[36:39], v[20:23], v[184:187]
    v_cvt_pk_bf16_f32 v142, v64, v65
    v_cvt_pk_bf16_f32 v143, v66, v67
    v_mfma_f32_16x16x32_bf16 v[64:67], a[12:15], v[12:15], 0
    ds_read_b128 v[48:51], v243 offset:61440
    buffer_load_dwordx4 a[12:15], v252, s[40:43], s75 offen offset:2048 sc1
    v_mfma_f32_16x16x32_bf16 v[64:67], a[36:39], v[24:27], v[64:67]
    v_cvt_pk_bf16_f32 v120, v164, v165
    v_cvt_pk_bf16_f32 v121, v166, v167
    v_mfma_f32_16x16x32_bf16 v[164:167], a[16:19], v[4:7], 0
    v_mfma_f32_16x16x32_bf16 v[164:167], a[40:43], v[16:19], v[164:167]
    v_cvt_pk_bf16_f32 v132, v188, v189
    v_cvt_pk_bf16_f32 v133, v190, v191
    buffer_load_dwordx4 a[36:39], v252, s[40:43], s75 offen offset:3072 sc1
    v_mfma_f32_16x16x32_bf16 v[188:191], a[16:19], v[8:11], 0
    s_mov_b32 s76, 8192
    v_mfma_f32_16x16x32_bf16 v[188:191], a[40:43], v[20:23], v[188:191]
    v_cvt_pk_bf16_f32 v144, v68, v69
    v_cvt_pk_bf16_f32 v145, v70, v71
    v_mfma_f32_16x16x32_bf16 v[68:71], a[16:19], v[12:15], 0
    buffer_load_dwordx4 a[16:19], v252, s[40:43], s76 offen sc1
    v_mfma_f32_16x16x32_bf16 v[68:71], a[40:43], v[24:27], v[68:71]
    v_cvt_pk_bf16_f32 v122, v168, v169
    v_cvt_pk_bf16_f32 v123, v170, v171
    v_mfma_f32_16x16x32_bf16 v[168:171], a[20:23], v[4:7], 0
    v_mfma_f32_16x16x32_bf16 v[168:171], a[44:47], v[16:19], v[168:171]
    v_cvt_pk_bf16_f32 v134, v192, v193
    v_cvt_pk_bf16_f32 v135, v194, v195
    buffer_load_dwordx4 a[40:43], v252, s[40:43], s76 offen offset:1024 sc1
    v_mfma_f32_16x16x32_bf16 v[192:195], a[20:23], v[8:11], 0
    v_mfma_f32_16x16x32_bf16 v[192:195], a[44:47], v[20:23], v[192:195]
    v_cvt_pk_bf16_f32 v146, v72, v73
    v_cvt_pk_bf16_f32 v147, v74, v75
    v_mfma_f32_16x16x32_bf16 v[72:75], a[20:23], v[12:15], 0
    buffer_load_dwordx4 a[20:23], v252, s[40:43], s76 offen offset:2048 sc1
    v_mfma_f32_16x16x32_bf16 v[72:75], a[44:47], v[24:27], v[72:75]
    s_waitcnt lgkmcnt(0)
    v_mfma_f32_16x16x32_bf16 v[148:151], a[48:51], v[28:31], v[148:151]
    v_mfma_f32_16x16x32_bf16 v[148:151], a[72:75], v[40:43], v[148:151]
    buffer_load_dwordx4 a[44:47], v252, s[40:43], s76 offen offset:3072 sc1
    v_mfma_f32_16x16x32_bf16 v[172:175], a[48:51], v[32:35], v[172:175]
    ds_read_b128 v[4:7], v240 offset:37120
    s_mov_b32 s77, 12288
    v_mfma_f32_16x16x32_bf16 v[172:175], a[72:75], v[44:47], v[172:175]
    v_mfma_f32_16x16x32_bf16 v[52:55], a[48:51], v[36:39], v[52:55]
    buffer_load_dwordx4 a[48:51], v252, s[40:43], s77 offen sc1
    v_mfma_f32_16x16x32_bf16 v[52:55], a[72:75], v[48:51], v[52:55]
    v_mfma_f32_16x16x32_bf16 v[152:155], a[52:55], v[28:31], v[152:155]
    ds_read_b128 v[8:11], v240 offset:49408
    v_mfma_f32_16x16x32_bf16 v[152:155], a[76:79], v[40:43], v[152:155]
    buffer_load_dwordx4 a[72:75], v252, s[40:43], s77 offen offset:1024 sc1
    v_mfma_f32_16x16x32_bf16 v[176:179], a[52:55], v[32:35], v[176:179]
    v_mfma_f32_16x16x32_bf16 v[176:179], a[76:79], v[44:47], v[176:179]
    v_mfma_f32_16x16x32_bf16 v[56:59], a[52:55], v[36:39], v[56:59]
    ds_read_b128 v[12:15], v240 offset:61696
    buffer_load_dwordx4 a[52:55], v252, s[40:43], s77 offen offset:2048 sc1
    v_mfma_f32_16x16x32_bf16 v[56:59], a[76:79], v[48:51], v[56:59]
    v_mfma_f32_16x16x32_bf16 v[156:159], a[56:59], v[28:31], v[156:159]
    v_mfma_f32_16x16x32_bf16 v[156:159], a[80:83], v[40:43], v[156:159]
    buffer_load_dwordx4 a[76:79], v252, s[40:43], s77 offen offset:3072 sc1
    v_mfma_f32_16x16x32_bf16 v[180:183], a[56:59], v[32:35], v[180:183]
    ds_read_b128 v[16:19], v241 offset:37120
    s_mov_b32 s74, 16384
    v_mfma_f32_16x16x32_bf16 v[180:183], a[80:83], v[44:47], v[180:183]
    v_mfma_f32_16x16x32_bf16 v[60:63], a[56:59], v[36:39], v[60:63]
    buffer_load_dwordx4 a[56:59], v252, s[40:43], s74 offen sc1
    v_mfma_f32_16x16x32_bf16 v[60:63], a[80:83], v[48:51], v[60:63]
    v_mfma_f32_16x16x32_bf16 v[160:163], a[60:63], v[28:31], v[160:163]
    ds_read_b128 v[20:23], v241 offset:49408
    v_mfma_f32_16x16x32_bf16 v[160:163], a[84:87], v[40:43], v[160:163]
    buffer_load_dwordx4 a[80:83], v252, s[40:43], s74 offen offset:1024 sc1
    v_mfma_f32_16x16x32_bf16 v[184:187], a[60:63], v[32:35], v[184:187]
    v_mfma_f32_16x16x32_bf16 v[184:187], a[84:87], v[44:47], v[184:187]
    v_mfma_f32_16x16x32_bf16 v[64:67], a[60:63], v[36:39], v[64:67]
    ds_read_b128 v[24:27], v241 offset:61696
    buffer_load_dwordx4 a[60:63], v252, s[40:43], s74 offen offset:2048 sc1
    v_mfma_f32_16x16x32_bf16 v[64:67], a[84:87], v[48:51], v[64:67]
    v_mfma_f32_16x16x32_bf16 v[164:167], a[64:67], v[28:31], v[164:167]
    v_mfma_f32_16x16x32_bf16 v[164:167], a[88:91], v[40:43], v[164:167]
    buffer_load_dwordx4 a[84:87], v252, s[40:43], s74 offen offset:3072 sc1
    v_mfma_f32_16x16x32_bf16 v[188:191], a[64:67], v[32:35], v[188:191]
    s_mov_b32 s75, 20480
    v_mfma_f32_16x16x32_bf16 v[188:191], a[88:91], v[44:47], v[188:191]
    v_mfma_f32_16x16x32_bf16 v[68:71], a[64:67], v[36:39], v[68:71]
    buffer_load_dwordx4 a[64:67], v252, s[40:43], s75 offen sc1
    v_mfma_f32_16x16x32_bf16 v[68:71], a[88:91], v[48:51], v[68:71]
    v_mfma_f32_16x16x32_bf16 v[168:171], a[68:71], v[28:31], v[168:171]
    v_mfma_f32_16x16x32_bf16 v[168:171], a[92:95], v[40:43], v[168:171]
    buffer_load_dwordx4 a[88:91], v252, s[40:43], s75 offen offset:1024 sc1
    v_mfma_f32_16x16x32_bf16 v[192:195], a[68:71], v[32:35], v[192:195]
    v_mfma_f32_16x16x32_bf16 v[192:195], a[92:95], v[44:47], v[192:195]
    v_mfma_f32_16x16x32_bf16 v[72:75], a[68:71], v[36:39], v[72:75]
    buffer_load_dwordx4 a[68:71], v252, s[40:43], s75 offen offset:2048 sc1
    v_mfma_f32_16x16x32_bf16 v[72:75], a[92:95], v[48:51], v[72:75]
    s_waitcnt lgkmcnt(0)
    v_mfma_f32_16x16x32_bf16 v[148:151], a[96:99], v[4:7], v[148:151]
    v_mfma_f32_16x16x32_bf16 v[148:151], a[120:123], v[16:19], v[148:151]
    buffer_load_dwordx4 a[92:95], v252, s[40:43], s75 offen offset:3072 sc1
    v_mfma_f32_16x16x32_bf16 v[172:175], a[96:99], v[8:11], v[172:175]
    ds_read_b128 v[28:31], v242 offset:37120
    s_mov_b32 s76, 24576
    v_mfma_f32_16x16x32_bf16 v[172:175], a[120:123], v[20:23], v[172:175]
    v_mfma_f32_16x16x32_bf16 v[52:55], a[96:99], v[12:15], v[52:55]
    buffer_load_dwordx4 a[96:99], v252, s[40:43], s76 offen sc1
    v_mfma_f32_16x16x32_bf16 v[52:55], a[120:123], v[24:27], v[52:55]
    v_mfma_f32_16x16x32_bf16 v[152:155], a[100:103], v[4:7], v[152:155]
    ds_read_b128 v[32:35], v242 offset:49408
    v_mfma_f32_16x16x32_bf16 v[152:155], a[124:127], v[16:19], v[152:155]
    buffer_load_dwordx4 a[120:123], v252, s[40:43], s76 offen offset:1024 sc1
    v_mfma_f32_16x16x32_bf16 v[176:179], a[100:103], v[8:11], v[176:179]
    v_mfma_f32_16x16x32_bf16 v[176:179], a[124:127], v[20:23], v[176:179]
    v_mfma_f32_16x16x32_bf16 v[56:59], a[100:103], v[12:15], v[56:59]
    ds_read_b128 v[36:39], v242 offset:61696
    buffer_load_dwordx4 a[100:103], v252, s[40:43], s76 offen offset:2048 sc1
    v_mfma_f32_16x16x32_bf16 v[56:59], a[124:127], v[24:27], v[56:59]
    v_mfma_f32_16x16x32_bf16 v[156:159], a[104:107], v[4:7], v[156:159]
    v_mfma_f32_16x16x32_bf16 v[156:159], a[128:131], v[16:19], v[156:159]
    buffer_load_dwordx4 a[124:127], v252, s[40:43], s76 offen offset:3072 sc1
    v_mfma_f32_16x16x32_bf16 v[180:183], a[104:107], v[8:11], v[180:183]
    ds_read_b128 v[40:43], v243 offset:37120
    s_mov_b32 s77, 28672
    v_mfma_f32_16x16x32_bf16 v[180:183], a[128:131], v[20:23], v[180:183]
    v_mfma_f32_16x16x32_bf16 v[60:63], a[104:107], v[12:15], v[60:63]
    buffer_load_dwordx4 a[104:107], v252, s[40:43], s77 offen sc1
    v_mfma_f32_16x16x32_bf16 v[60:63], a[128:131], v[24:27], v[60:63]
    v_mfma_f32_16x16x32_bf16 v[160:163], a[108:111], v[4:7], v[160:163]
    ds_read_b128 v[44:47], v243 offset:49408
    v_mfma_f32_16x16x32_bf16 v[160:163], a[132:135], v[16:19], v[160:163]
    buffer_load_dwordx4 a[128:131], v252, s[40:43], s77 offen offset:1024 sc1
    v_mfma_f32_16x16x32_bf16 v[184:187], a[108:111], v[8:11], v[184:187]
    v_mfma_f32_16x16x32_bf16 v[184:187], a[132:135], v[20:23], v[184:187]
    v_mfma_f32_16x16x32_bf16 v[64:67], a[108:111], v[12:15], v[64:67]
    ds_read_b128 v[48:51], v243 offset:61696
    buffer_load_dwordx4 a[108:111], v252, s[40:43], s77 offen offset:2048 sc1
    v_mfma_f32_16x16x32_bf16 v[64:67], a[132:135], v[24:27], v[64:67]
    v_mfma_f32_16x16x32_bf16 v[164:167], a[112:115], v[4:7], v[164:167]
    v_mfma_f32_16x16x32_bf16 v[164:167], a[136:139], v[16:19], v[164:167]
    buffer_load_dwordx4 a[132:135], v252, s[40:43], s77 offen offset:3072 sc1
    v_mfma_f32_16x16x32_bf16 v[188:191], a[112:115], v[8:11], v[188:191]
    s_mov_b32 s74, 32768
    v_mfma_f32_16x16x32_bf16 v[188:191], a[136:139], v[20:23], v[188:191]
    v_mfma_f32_16x16x32_bf16 v[68:71], a[112:115], v[12:15], v[68:71]
    buffer_load_dwordx4 a[112:115], v252, s[40:43], s74 offen sc1
    v_mfma_f32_16x16x32_bf16 v[68:71], a[136:139], v[24:27], v[68:71]
    v_mfma_f32_16x16x32_bf16 v[168:171], a[116:119], v[4:7], v[168:171]
    v_mfma_f32_16x16x32_bf16 v[168:171], a[140:143], v[16:19], v[168:171]
    buffer_load_dwordx4 a[136:139], v252, s[40:43], s74 offen offset:1024 sc1
    v_mfma_f32_16x16x32_bf16 v[192:195], a[116:119], v[8:11], v[192:195]
    v_mfma_f32_16x16x32_bf16 v[192:195], a[140:143], v[20:23], v[192:195]
    v_mfma_f32_16x16x32_bf16 v[72:75], a[116:119], v[12:15], v[72:75]
    buffer_load_dwordx4 a[116:119], v252, s[40:43], s74 offen offset:2048 sc1
    v_mfma_f32_16x16x32_bf16 v[72:75], a[140:143], v[24:27], v[72:75]
    s_waitcnt lgkmcnt(0)
    v_mfma_f32_16x16x32_bf16 v[148:151], a[144:147], v[28:31], v[148:151]
    v_mfma_f32_16x16x32_bf16 v[148:151], a[168:171], v[40:43], v[148:151]
    buffer_load_dwordx4 a[140:143], v252, s[40:43], s74 offen offset:3072 sc1
    v_mfma_f32_16x16x32_bf16 v[172:175], a[144:147], v[32:35], v[172:175]
    ds_read_b128 v[4:7], v240 offset:37376
    s_mov_b32 s75, 36864
    v_mfma_f32_16x16x32_bf16 v[172:175], a[168:171], v[44:47], v[172:175]
    v_mfma_f32_16x16x32_bf16 v[52:55], a[144:147], v[36:39], v[52:55]
    buffer_load_dwordx4 a[144:147], v252, s[40:43], s75 offen sc1
    v_mfma_f32_16x16x32_bf16 v[52:55], a[168:171], v[48:51], v[52:55]
    v_mfma_f32_16x16x32_bf16 v[152:155], a[148:151], v[28:31], v[152:155]
    ds_read_b128 v[8:11], v240 offset:49664
    v_mfma_f32_16x16x32_bf16 v[152:155], a[172:175], v[40:43], v[152:155]
    buffer_load_dwordx4 a[168:171], v252, s[40:43], s75 offen offset:1024 sc1
    v_mfma_f32_16x16x32_bf16 v[176:179], a[148:151], v[32:35], v[176:179]
    v_mfma_f32_16x16x32_bf16 v[176:179], a[172:175], v[44:47], v[176:179]
    v_mfma_f32_16x16x32_bf16 v[56:59], a[148:151], v[36:39], v[56:59]
    ds_read_b128 v[12:15], v240 offset:61952
    buffer_load_dwordx4 a[148:151], v252, s[40:43], s75 offen offset:2048 sc1
    v_mfma_f32_16x16x32_bf16 v[56:59], a[172:175], v[48:51], v[56:59]
    v_mfma_f32_16x16x32_bf16 v[156:159], a[152:155], v[28:31], v[156:159]
    v_mfma_f32_16x16x32_bf16 v[156:159], a[176:179], v[40:43], v[156:159]
    buffer_load_dwordx4 a[172:175], v252, s[40:43], s75 offen offset:3072 sc1
    v_mfma_f32_16x16x32_bf16 v[180:183], a[152:155], v[32:35], v[180:183]
    ds_read_b128 v[16:19], v241 offset:37376
    s_mov_b32 s76, 40960
    v_mfma_f32_16x16x32_bf16 v[180:183], a[176:179], v[44:47], v[180:183]
    v_mfma_f32_16x16x32_bf16 v[60:63], a[152:155], v[36:39], v[60:63]
    buffer_load_dwordx4 a[152:155], v252, s[40:43], s76 offen sc1
    v_mfma_f32_16x16x32_bf16 v[60:63], a[176:179], v[48:51], v[60:63]
    v_mfma_f32_16x16x32_bf16 v[160:163], a[156:159], v[28:31], v[160:163]
    ds_read_b128 v[20:23], v241 offset:49664
    v_mfma_f32_16x16x32_bf16 v[160:163], a[180:183], v[40:43], v[160:163]
    buffer_load_dwordx4 a[176:179], v252, s[40:43], s76 offen offset:1024 sc1
    v_mfma_f32_16x16x32_bf16 v[184:187], a[156:159], v[32:35], v[184:187]
    v_mfma_f32_16x16x32_bf16 v[184:187], a[180:183], v[44:47], v[184:187]
    v_mfma_f32_16x16x32_bf16 v[64:67], a[156:159], v[36:39], v[64:67]
    ds_read_b128 v[24:27], v241 offset:61952
    buffer_load_dwordx4 a[156:159], v252, s[40:43], s76 offen offset:2048 sc1
    v_mfma_f32_16x16x32_bf16 v[64:67], a[180:183], v[48:51], v[64:67]
    v_mfma_f32_16x16x32_bf16 v[164:167], a[160:163], v[28:31], v[164:167]
    v_mfma_f32_16x16x32_bf16 v[164:167], a[184:187], v[40:43], v[164:167]
    buffer_load_dwordx4 a[180:183], v252, s[40:43], s76 offen offset:3072 sc1
    v_mfma_f32_16x16x32_bf16 v[188:191], a[160:163], v[32:35], v[188:191]
    s_mov_b32 s77, 45056
    v_mfma_f32_16x16x32_bf16 v[188:191], a[184:187], v[44:47], v[188:191]
    v_mfma_f32_16x16x32_bf16 v[68:71], a[160:163], v[36:39], v[68:71]
    buffer_load_dwordx4 a[160:163], v252, s[40:43], s77 offen sc1
    v_mfma_f32_16x16x32_bf16 v[68:71], a[184:187], v[48:51], v[68:71]
    v_mfma_f32_16x16x32_bf16 v[168:171], a[164:167], v[28:31], v[168:171]
    v_mfma_f32_16x16x32_bf16 v[168:171], a[188:191], v[40:43], v[168:171]
    buffer_load_dwordx4 a[184:187], v252, s[40:43], s77 offen offset:1024 sc1
    v_mfma_f32_16x16x32_bf16 v[192:195], a[164:167], v[32:35], v[192:195]
    v_mfma_f32_16x16x32_bf16 v[192:195], a[188:191], v[44:47], v[192:195]
    v_mfma_f32_16x16x32_bf16 v[72:75], a[164:167], v[36:39], v[72:75]
    buffer_load_dwordx4 a[164:167], v252, s[40:43], s77 offen offset:2048 sc1
    v_mfma_f32_16x16x32_bf16 v[72:75], a[188:191], v[48:51], v[72:75]
    s_waitcnt lgkmcnt(0)
    v_mfma_f32_16x16x32_bf16 v[148:151], a[192:195], v[4:7], v[148:151]
    v_mfma_f32_16x16x32_bf16 v[148:151], a[216:219], v[16:19], v[148:151]
    buffer_load_dwordx4 a[188:191], v252, s[40:43], s77 offen offset:3072 sc1
    v_mfma_f32_16x16x32_bf16 v[172:175], a[192:195], v[8:11], v[172:175]
    ds_read_b128 v[28:31], v242 offset:37376
    s_mov_b32 s74, 49152
    v_mfma_f32_16x16x32_bf16 v[172:175], a[216:219], v[20:23], v[172:175]
    v_mfma_f32_16x16x32_bf16 v[52:55], a[192:195], v[12:15], v[52:55]
    buffer_load_dwordx4 a[192:195], v252, s[40:43], s74 offen sc1
    v_mfma_f32_16x16x32_bf16 v[52:55], a[216:219], v[24:27], v[52:55]
    v_mfma_f32_16x16x32_bf16 v[152:155], a[196:199], v[4:7], v[152:155]
    ds_read_b128 v[32:35], v242 offset:49664
    v_mfma_f32_16x16x32_bf16 v[152:155], a[220:223], v[16:19], v[152:155]
    buffer_load_dwordx4 a[216:219], v252, s[40:43], s74 offen offset:1024 sc1
    v_mfma_f32_16x16x32_bf16 v[176:179], a[196:199], v[8:11], v[176:179]
    v_mfma_f32_16x16x32_bf16 v[176:179], a[220:223], v[20:23], v[176:179]
    v_mfma_f32_16x16x32_bf16 v[56:59], a[196:199], v[12:15], v[56:59]
    ds_read_b128 v[36:39], v242 offset:61952
    buffer_load_dwordx4 a[196:199], v252, s[40:43], s74 offen offset:2048 sc1
    v_mfma_f32_16x16x32_bf16 v[56:59], a[220:223], v[24:27], v[56:59]
    v_mfma_f32_16x16x32_bf16 v[156:159], a[200:203], v[4:7], v[156:159]
    v_mfma_f32_16x16x32_bf16 v[156:159], a[224:227], v[16:19], v[156:159]
    buffer_load_dwordx4 a[220:223], v252, s[40:43], s74 offen offset:3072 sc1
    v_mfma_f32_16x16x32_bf16 v[180:183], a[200:203], v[8:11], v[180:183]
    ds_read_b128 v[40:43], v243 offset:37376
    s_mov_b32 s75, 53248
    v_mfma_f32_16x16x32_bf16 v[180:183], a[224:227], v[20:23], v[180:183]
    v_mfma_f32_16x16x32_bf16 v[60:63], a[200:203], v[12:15], v[60:63]
    buffer_load_dwordx4 a[200:203], v252, s[40:43], s75 offen sc1
    v_mfma_f32_16x16x32_bf16 v[60:63], a[224:227], v[24:27], v[60:63]
    v_mfma_f32_16x16x32_bf16 v[160:163], a[204:207], v[4:7], v[160:163]
    ds_read_b128 v[44:47], v243 offset:49664
    v_mfma_f32_16x16x32_bf16 v[160:163], a[228:231], v[16:19], v[160:163]
    buffer_load_dwordx4 a[224:227], v252, s[40:43], s75 offen offset:1024 sc1
    v_mfma_f32_16x16x32_bf16 v[184:187], a[204:207], v[8:11], v[184:187]
    v_mfma_f32_16x16x32_bf16 v[184:187], a[228:231], v[20:23], v[184:187]
    v_mfma_f32_16x16x32_bf16 v[64:67], a[204:207], v[12:15], v[64:67]
    ds_read_b128 v[48:51], v243 offset:61952
    buffer_load_dwordx4 a[204:207], v252, s[40:43], s75 offen offset:2048 sc1
    v_mfma_f32_16x16x32_bf16 v[64:67], a[228:231], v[24:27], v[64:67]
    v_mfma_f32_16x16x32_bf16 v[164:167], a[208:211], v[4:7], v[164:167]
    v_mfma_f32_16x16x32_bf16 v[164:167], a[232:235], v[16:19], v[164:167]
    buffer_load_dwordx4 a[228:231], v252, s[40:43], s75 offen offset:3072 sc1
    v_mfma_f32_16x16x32_bf16 v[188:191], a[208:211], v[8:11], v[188:191]
    s_mov_b32 s76, 57344
    v_mfma_f32_16x16x32_bf16 v[188:191], a[232:235], v[20:23], v[188:191]
    v_mfma_f32_16x16x32_bf16 v[68:71], a[208:211], v[12:15], v[68:71]
    buffer_load_dwordx4 a[208:211], v252, s[40:43], s76 offen sc1
    v_mfma_f32_16x16x32_bf16 v[68:71], a[232:235], v[24:27], v[68:71]
    v_mfma_f32_16x16x32_bf16 v[168:171], a[212:215], v[4:7], v[168:171]
    v_mfma_f32_16x16x32_bf16 v[168:171], a[236:239], v[16:19], v[168:171]
    buffer_load_dwordx4 a[232:235], v252, s[40:43], s76 offen offset:1024 sc1
    v_mfma_f32_16x16x32_bf16 v[192:195], a[212:215], v[8:11], v[192:195]
    v_mfma_f32_16x16x32_bf16 v[192:195], a[236:239], v[20:23], v[192:195]
    v_mfma_f32_16x16x32_bf16 v[72:75], a[212:215], v[12:15], v[72:75]
    buffer_load_dwordx4 a[212:215], v252, s[40:43], s76 offen offset:2048 sc1
    v_mfma_f32_16x16x32_bf16 v[72:75], a[236:239], v[24:27], v[72:75]
    s_waitcnt vmcnt(59) lgkmcnt(0)
    s_barrier
    v_mfma_f32_16x16x32_bf16 v[148:151], a[240:243], v[28:31], v[148:151]
    v_mfma_f32_16x16x32_bf16 v[148:151], v[204:207], v[40:43], v[148:151]
    buffer_load_dwordx4 a[236:239], v252, s[40:43], s76 offen offset:3072 sc1
    v_mfma_f32_16x16x32_bf16 v[172:175], a[240:243], v[32:35], v[172:175]
    s_mov_b32 s77, 61440
    v_mfma_f32_16x16x32_bf16 v[172:175], v[204:207], v[44:47], v[172:175]
    v_mfma_f32_16x16x32_bf16 v[52:55], a[240:243], v[36:39], v[52:55]
    buffer_load_dwordx4 a[240:243], v252, s[40:43], s77 offen sc1
    v_mfma_f32_16x16x32_bf16 v[52:55], v[204:207], v[48:51], v[52:55]
    v_mfma_f32_16x16x32_bf16 v[152:155], a[244:247], v[28:31], v[152:155]
    v_mfma_f32_16x16x32_bf16 v[152:155], v[208:211], v[40:43], v[152:155]
    buffer_load_dwordx4 v[204:207], v252, s[40:43], s77 offen offset:1024 sc1
    v_mfma_f32_16x16x32_bf16 v[176:179], a[244:247], v[32:35], v[176:179]
    v_mfma_f32_16x16x32_bf16 v[176:179], v[208:211], v[44:47], v[176:179]
    v_mfma_f32_16x16x32_bf16 v[56:59], a[244:247], v[36:39], v[56:59]
    buffer_load_dwordx4 a[244:247], v252, s[40:43], s77 offen offset:2048 sc1
    v_mfma_f32_16x16x32_bf16 v[56:59], v[208:211], v[48:51], v[56:59]
    v_mfma_f32_16x16x32_bf16 v[156:159], a[248:251], v[28:31], v[156:159]
    v_mfma_f32_16x16x32_bf16 v[156:159], v[212:215], v[40:43], v[156:159]
    buffer_load_dwordx4 v[208:211], v252, s[40:43], s77 offen offset:3072 sc1
    v_mfma_f32_16x16x32_bf16 v[180:183], a[248:251], v[32:35], v[180:183]
    s_mov_b32 s74, 65536
    v_mfma_f32_16x16x32_bf16 v[180:183], v[212:215], v[44:47], v[180:183]
    v_mfma_f32_16x16x32_bf16 v[60:63], a[248:251], v[36:39], v[60:63]
    buffer_load_dwordx4 a[248:251], v252, s[40:43], s74 offen sc1
    v_mfma_f32_16x16x32_bf16 v[60:63], v[212:215], v[48:51], v[60:63]
    v_mfma_f32_16x16x32_bf16 v[160:163], a[252:255], v[28:31], v[160:163]
    v_mfma_f32_16x16x32_bf16 v[160:163], v[216:219], v[40:43], v[160:163]
    buffer_load_dwordx4 v[212:215], v252, s[40:43], s74 offen offset:1024 sc1
    v_mfma_f32_16x16x32_bf16 v[184:187], a[252:255], v[32:35], v[184:187]
    v_mfma_f32_16x16x32_bf16 v[184:187], v[216:219], v[44:47], v[184:187]
    v_mfma_f32_16x16x32_bf16 v[64:67], a[252:255], v[36:39], v[64:67]
    buffer_load_dwordx4 a[252:255], v252, s[40:43], s74 offen offset:2048 sc1
    v_mfma_f32_16x16x32_bf16 v[64:67], v[216:219], v[48:51], v[64:67]
    v_mfma_f32_16x16x32_bf16 v[164:167], v[196:199], v[28:31], v[164:167]
    v_mfma_f32_16x16x32_bf16 v[164:167], v[220:223], v[40:43], v[164:167]
    buffer_load_dwordx4 v[216:219], v252, s[40:43], s74 offen offset:3072 sc1
    v_mfma_f32_16x16x32_bf16 v[188:191], v[196:199], v[32:35], v[188:191]
    s_mov_b32 s75, 69632
    v_mfma_f32_16x16x32_bf16 v[188:191], v[220:223], v[44:47], v[188:191]
    v_mfma_f32_16x16x32_bf16 v[68:71], v[196:199], v[36:39], v[68:71]
    buffer_load_dwordx4 v[196:199], v252, s[40:43], s75 offen sc1
    v_mfma_f32_16x16x32_bf16 v[68:71], v[220:223], v[48:51], v[68:71]
    v_mfma_f32_16x16x32_bf16 v[168:171], v[200:203], v[28:31], v[168:171]
    v_mfma_f32_16x16x32_bf16 v[168:171], v[224:227], v[40:43], v[168:171]
    buffer_load_dwordx4 v[220:223], v252, s[40:43], s75 offen offset:1024 sc1
    v_mfma_f32_16x16x32_bf16 v[192:195], v[200:203], v[32:35], v[192:195]
    v_mfma_f32_16x16x32_bf16 v[192:195], v[224:227], v[44:47], v[192:195]
    v_mfma_f32_16x16x32_bf16 v[72:75], v[200:203], v[36:39], v[72:75]
    buffer_load_dwordx4 v[200:203], v252, s[40:43], s75 offen offset:2048 sc1
    v_mfma_f32_16x16x32_bf16 v[72:75], v[224:227], v[48:51], v[72:75]
    buffer_load_dwordx4 v[224:227], v252, s[40:43], s75 offen offset:3072 sc1
L_postd:
    ds_read_b128 v[4:7], v228 offset:0
    ds_read_b128 v[8:11], v229 offset:0
    ds_read_b128 v[12:15], v230 offset:0
    ds_read_b128 v[16:19], v231 offset:0
    ds_read_b128 v[20:23], v228 offset:256
    ds_read_b128 v[24:27], v229 offset:256
    ds_read_b128 v[28:31], v230 offset:256
    ds_read_b128 v[32:35], v231 offset:256
    ds_read_b128 v[36:39], v228 offset:512
    ds_read_b128 v[40:43], v229 offset:512
    ds_read_b128 v[44:47], v230 offset:512
    ds_read_b128 v[48:51], v231 offset:512
    v_cvt_pk_bf16_f32 v148, v148, v149
    v_cvt_pk_bf16_f32 v149, v150, v151
    v_cvt_pk_bf16_f32 v150, v152, v153
    v_cvt_pk_bf16_f32 v151, v154, v155
    v_cvt_pk_bf16_f32 v152, v156, v157
    v_cvt_pk_bf16_f32 v153, v158, v159
    v_cvt_pk_bf16_f32 v154, v160, v161
    v_cvt_pk_bf16_f32 v155, v162, v163
    v_cvt_pk_bf16_f32 v156, v164, v165
    v_cvt_pk_bf16_f32 v157, v166, v167
    v_cvt_pk_bf16_f32 v158, v168, v169
    v_cvt_pk_bf16_f32 v159, v170, v171
    v_cvt_pk_bf16_f32 v160, v172, v173
    v_cvt_pk_bf16_f32 v161, v174, v175
    v_cvt_pk_bf16_f32 v162, v176, v177
    v_cvt_pk_bf16_f32 v163, v178, v179
    v_cvt_pk_bf16_f32 v164, v180, v181
    v_cvt_pk_bf16_f32 v165, v182, v183
    v_cvt_pk_bf16_f32 v166, v184, v185
    v_cvt_pk_bf16_f32 v167, v186, v187
    v_cvt_pk_bf16_f32 v168, v188, v189
    v_cvt_pk_bf16_f32 v169, v190, v191
    v_cvt_pk_bf16_f32 v170, v192, v193
    v_cvt_pk_bf16_f32 v171, v194, v195
    v_cvt_pk_bf16_f32 v172, v52, v53
    v_cvt_pk_bf16_f32 v173, v54, v55
    v_cvt_pk_bf16_f32 v174, v56, v57
    v_cvt_pk_bf16_f32 v175, v58, v59
    v_cvt_pk_bf16_f32 v176, v60, v61
    v_cvt_pk_bf16_f32 v177, v62, v63
    v_cvt_pk_bf16_f32 v178, v64, v65
    v_cvt_pk_bf16_f32 v179, v66, v67
    v_cvt_pk_bf16_f32 v180, v68, v69
    v_cvt_pk_bf16_f32 v181, v70, v71
    v_cvt_pk_bf16_f32 v182, v72, v73
    v_cvt_pk_bf16_f32 v183, v74, v75
    v_lshlrev_b32 v184, 16, v76
    v_and_b32 v185, s59, v76
    v_lshlrev_b32 v186, 16, v77
    v_and_b32 v187, s59, v77
    v_lshlrev_b32 v188, 16, v78
    v_and_b32 v189, s59, v78
    v_lshlrev_b32 v190, 16, v79
    v_and_b32 v191, s59, v79
    v_lshlrev_b32 v192, 16, v80
    v_and_b32 v193, s59, v80
    v_lshlrev_b32 v194, 16, v81
    v_and_b32 v195, s59, v81
    v_lshlrev_b32 v76, 16, v82
    v_and_b32 v77, s59, v82
    v_lshlrev_b32 v78, 16, v83
    v_and_b32 v79, s59, v83
    s_waitcnt vmcnt(0)
    v_readfirstlane_b32 s73, v239
    s_waitcnt lgkmcnt(0)
.p2align 6
L_p2:
    s_waitcnt lgkmcnt(10)
    v_mfma_f32_16x16x32_bf16 v[52:55], a[0:3], v[4:7], v[184:187]
    v_mfma_f32_16x16x32_bf16 v[52:55], a[24:27], v[8:11], v[52:55]
    v_mfma_f32_16x16x32_bf16 v[52:55], a[48:51], v[12:15], v[52:55]
    s_waitcnt lgkmcnt(6)
    v_mfma_f32_16x16x32_bf16 v[52:55], a[72:75], v[16:19], v[52:55]
    v_cvt_pk_bf16_f32 v0, v68, v69
    v_cvt_pk_bf16_f32 v1, v70, v71
    v_mfma_f32_16x16x32_bf16 v[52:55], a[96:99], v[20:23], v[52:55]
    v_mfma_f32_16x16x32_bf16 v[52:55], a[120:123], v[24:27], v[52:55]
    s_waitcnt lgkmcnt(3)
    v_mfma_f32_16x16x32_bf16 v[52:55], a[144:147], v[28:31], v[52:55]
    v_mfma_f32_16x16x32_bf16 v[52:55], a[168:171], v[32:35], v[52:55]
    v_mfma_f32_16x16x32_bf16 v[52:55], a[192:195], v[36:39], v[52:55]
    s_waitcnt lgkmcnt(0)
    v_mfma_f32_16x16x32_bf16 v[52:55], a[216:219], v[40:43], v[52:55]
    v_cvt_pk_bf16_f32 v2, v72, v73
    v_cvt_pk_bf16_f32 v3, v74, v75
    v_mfma_f32_16x16x32_bf16 v[52:55], a[240:243], v[44:47], v[52:55]
    ds_write_b128 v237, v[0:3] offset:36864
    v_mfma_f32_16x16x32_bf16 v[52:55], v[204:207], v[48:51], v[52:55]
    v_mfma_f32_16x16x32_bf16 v[56:59], a[4:7], v[4:7], v[188:191]
    s_add_u32 s55, s81, 294912
    v_mfma_f32_16x16x32_bf16 v[56:59], a[28:31], v[8:11], v[56:59]
    s_add_u32 m0, s82, 24576
    v_mfma_f32_16x16x32_bf16 v[56:59], a[52:55], v[12:15], v[56:59]
    buffer_load_dwordx4 v232, s[20:23], s55 offen nt lds
    v_mfma_f32_16x16x32_bf16 v[56:59], a[76:79], v[16:19], v[56:59]
    v_mfma_f32_16x16x32_bf16 v[56:59], a[100:103], v[20:23], v[56:59]
    v_mfma_f32_16x16x32_bf16 v[56:59], a[124:127], v[24:27], v[56:59]
    buffer_load_dwordx4 v233, s[20:23], s55 offen offset:1024 nt lds
    v_mfma_f32_16x16x32_bf16 v[56:59], a[148:151], v[28:31], v[56:59]
    v_mfma_f32_16x16x32_bf16 v[56:59], a[172:175], v[32:35], v[56:59]
    v_mfma_f32_16x16x32_bf16 v[56:59], a[196:199], v[36:39], v[56:59]
    buffer_load_dwordx4 v234, s[20:23], s55 offen offset:2048 nt lds
    v_mfma_f32_16x16x32_bf16 v[56:59], a[220:223], v[40:43], v[56:59]
    s_cbranch_vccz L_lo0
    s_waitcnt vmcnt(6)
L_lo0:
    v_cvt_pk_bf16_f32 v0, v52, v53
    v_cvt_pk_bf16_f32 v1, v54, v55
    v_mfma_f32_16x16x32_bf16 v[56:59], a[244:247], v[44:47], v[56:59]
    s_set_gpr_idx_on s54, gpr_idx(SRC0)
    v_mov_b64 v[252:253], v[84:85]
    v_mov_b64 v[254:255], v[86:87]
    s_set_gpr_idx_off
    v_mfma_f32_16x16x32_bf16 v[56:59], v[208:211], v[48:51], v[56:59]
    v_lshlrev_b32 v80, 16, v252
    v_and_b32 v81, s59, v252
    v_mfma_f32_16x16x32_bf16 v[60:63], a[8:11], v[4:7], v[192:195]
    v_lshlrev_b32 v82, 16, v253
    v_and_b32 v83, s59, v253
    v_mfma_f32_16x16x32_bf16 v[60:63], a[32:35], v[8:11], v[60:63]
    v_lshlrev_b32 v84, 16, v254
    v_and_b32 v85, s59, v254
    v_mfma_f32_16x16x32_bf16 v[60:63], a[56:59], v[12:15], v[60:63]
    v_lshlrev_b32 v86, 16, v255
    v_and_b32 v87, s59, v255
    v_mfma_f32_16x16x32_bf16 v[60:63], a[80:83], v[16:19], v[60:63]
    v_mfma_f32_16x16x32_bf16 v[60:63], a[104:107], v[20:23], v[60:63]
    v_mfma_f32_16x16x32_bf16 v[60:63], a[128:131], v[24:27], v[60:63]
    s_mov_b64 exec, 1
    v_mov_b32 v239, 1
    buffer_atomic_add v239, off, s[40:43], s66 sc0
    s_mov_b64 exec, -1
    v_mfma_f32_16x16x32_bf16 v[60:63], a[152:155], v[28:31], v[60:63]
    v_mfma_f32_16x16x32_bf16 v[60:63], a[176:179], v[32:35], v[60:63]
    s_cmp_eq_u32 s65, 0
    s_cbranch_scc1 L_md0
    s_waitcnt vmcnt(7)
L_md0:
    v_mfma_f32_16x16x32_bf16 v[60:63], a[200:203], v[36:39], v[60:63]
    v_cvt_pk_bf16_f32 v2, v56, v57
    v_cvt_pk_bf16_f32 v3, v58, v59
    v_mfma_f32_16x16x32_bf16 v[60:63], a[224:227], v[40:43], v[60:63]
    ds_write_b128 v235, v[0:3] offset:0
    v_mfma_f32_16x16x32_bf16 v[60:63], a[248:251], v[44:47], v[60:63]
    v_mfma_f32_16x16x32_bf16 v[60:63], v[212:215], v[48:51], v[60:63]
    v_mfma_f32_16x16x32_bf16 v[64:67], a[12:15], v[4:7], v[76:79]
    v_mfma_f32_16x16x32_bf16 v[64:67], a[36:39], v[8:11], v[64:67]
    v_mfma_f32_16x16x32_bf16 v[64:67], a[60:63], v[12:15], v[64:67]
    v_mfma_f32_16x16x32_bf16 v[64:67], a[84:87], v[16:19], v[64:67]
    v_mfma_f32_16x16x32_bf16 v[64:67], a[108:111], v[20:23], v[64:67]
    v_mfma_f32_16x16x32_bf16 v[64:67], a[132:135], v[24:27], v[64:67]
    v_mfma_f32_16x16x32_bf16 v[64:67], a[156:159], v[28:31], v[64:67]
    v_mfma_f32_16x16x32_bf16 v[64:67], a[180:183], v[32:35], v[64:67]
    v_mfma_f32_16x16x32_bf16 v[64:67], a[204:207], v[36:39], v[64:67]
    v_cvt_pk_bf16_f32 v0, v60, v61
    v_cvt_pk_bf16_f32 v1, v62, v63
    v_mfma_f32_16x16x32_bf16 v[64:67], a[228:231], v[40:43], v[64:67]
    v_mfma_f32_16x16x32_bf16 v[64:67], a[252:255], v[44:47], v[64:67]
    v_mfma_f32_16x16x32_bf16 v[64:67], v[216:219], v[48:51], v[64:67]
    v_mfma_f32_16x16x32_bf16 v[68:71], a[16:19], v[4:7], v[80:83]
    v_mfma_f32_16x16x32_bf16 v[68:71], a[40:43], v[8:11], v[68:71]
    s_waitcnt vmcnt(7) lgkmcnt(1)
    s_barrier
    v_mfma_f32_16x16x32_bf16 v[68:71], a[64:67], v[12:15], v[68:71]
    ds_read_b128 v[240:243], v238 offset:36864
    v_mfma_f32_16x16x32_bf16 v[68:71], a[88:91], v[16:19], v[68:71]
    ds_read_b128 v[244:247], v238 offset:37888
    v_mfma_f32_16x16x32_bf16 v[68:71], a[112:115], v[20:23], v[68:71]
    v_mfma_f32_16x16x32_bf16 v[68:71], a[136:139], v[24:27], v[68:71]
    v_mfma_f32_16x16x32_bf16 v[72:75], a[20:23], v[4:7], v[84:87]
    ds_read_b128 v[4:7], v228 offset:12288
    v_mfma_f32_16x16x32_bf16 v[72:75], a[44:47], v[8:11], v[72:75]
    ds_read_b128 v[248:251], v238 offset:38912
    v_mfma_f32_16x16x32_bf16 v[72:75], a[68:71], v[12:15], v[72:75]
    ds_read_b128 v[8:11], v229 offset:12288
    v_mfma_f32_16x16x32_bf16 v[72:75], a[92:95], v[16:19], v[72:75]
    v_cvt_pk_bf16_f32 v2, v64, v65
    v_cvt_pk_bf16_f32 v3, v66, v67
    v_mfma_f32_16x16x32_bf16 v[72:75], a[116:119], v[20:23], v[72:75]
    ds_read_b128 v[12:15], v230 offset:12288
    v_mfma_f32_16x16x32_bf16 v[72:75], a[140:143], v[24:27], v[72:75]
    ds_write_b128 v236, v[0:3] offset:0
    v_mfma_f32_16x16x32_bf16 v[68:71], a[160:163], v[28:31], v[68:71]
    ds_read_b128 v[16:19], v231 offset:12288
    v_mfma_f32_16x16x32_bf16 v[68:71], a[184:187], v[32:35], v[68:71]
    v_mfma_f32_16x16x32_bf16 v[68:71], a[208:211], v[36:39], v[68:71]
    s_waitcnt lgkmcnt(7)
    buffer_store_dwordx4 v[240:243], v232, s[36:39], s56 offen sc1
    ds_read_b128 v[20:23], v228 offset:12544
    v_mfma_f32_16x16x32_bf16 v[68:71], a[232:235], v[40:43], v[68:71]
    v_mfma_f32_16x16x32_bf16 v[68:71], v[196:199], v[44:47], v[68:71]
    ds_read_b128 v[24:27], v229 offset:12544
    v_mfma_f32_16x16x32_bf16 v[68:71], v[220:223], v[48:51], v[68:71]
    v_mfma_f32_16x16x32_bf16 v[72:75], a[164:167], v[28:31], v[72:75]
    s_waitcnt lgkmcnt(8)
    buffer_store_dwordx4 v[244:247], v233, s[36:39], s56 offen offset:1024 sc1
    ds_read_b128 v[28:31], v230 offset:12544
    v_mfma_f32_16x16x32_bf16 v[72:75], a[188:191], v[32:35], v[72:75]
    ds_read_b128 v[32:35], v231 offset:12544
    v_mfma_f32_16x16x32_bf16 v[72:75], a[212:215], v[36:39], v[72:75]
    ds_read_b128 v[36:39], v228 offset:12800
    v_mfma_f32_16x16x32_bf16 v[72:75], a[236:239], v[40:43], v[72:75]
    ds_read_b128 v[40:43], v229 offset:12800
    v_mfma_f32_16x16x32_bf16 v[72:75], v[200:203], v[44:47], v[72:75]
    s_waitcnt lgkmcnt(10)
    buffer_store_dwordx4 v[248:251], v234, s[36:39], s56 offen offset:2048 sc1
    s_add_u32 s56, s78, 0
    ds_read_b128 v[44:47], v230 offset:12800
    v_mfma_f32_16x16x32_bf16 v[72:75], v[224:227], v[48:51], v[72:75]
    ds_read_b128 v[48:51], v231 offset:12800
    s_waitcnt lgkmcnt(10)
    v_mfma_f32_16x16x32_bf16 v[52:55], a[0:3], v[4:7], v[184:187]
    v_mfma_f32_16x16x32_bf16 v[52:55], a[24:27], v[8:11], v[52:55]
    v_mfma_f32_16x16x32_bf16 v[52:55], a[48:51], v[12:15], v[52:55]
    s_waitcnt lgkmcnt(6)
    v_mfma_f32_16x16x32_bf16 v[52:55], a[72:75], v[16:19], v[52:55]
    v_cvt_pk_bf16_f32 v0, v68, v69
    v_cvt_pk_bf16_f32 v1, v70, v71
    v_mfma_f32_16x16x32_bf16 v[52:55], a[96:99], v[20:23], v[52:55]
    v_mfma_f32_16x16x32_bf16 v[52:55], a[120:123], v[24:27], v[52:55]
    s_waitcnt lgkmcnt(3)
    v_mfma_f32_16x16x32_bf16 v[52:55], a[144:147], v[28:31], v[52:55]
    v_mfma_f32_16x16x32_bf16 v[52:55], a[168:171], v[32:35], v[52:55]
    v_mfma_f32_16x16x32_bf16 v[52:55], a[192:195], v[36:39], v[52:55]
    s_waitcnt lgkmcnt(0)
    v_mfma_f32_16x16x32_bf16 v[52:55], a[216:219], v[40:43], v[52:55]
    v_cvt_pk_bf16_f32 v2, v72, v73
    v_cvt_pk_bf16_f32 v3, v74, v75
    v_mfma_f32_16x16x32_bf16 v[52:55], a[240:243], v[44:47], v[52:55]
    ds_write_b128 v237, v[0:3] offset:0
    v_mfma_f32_16x16x32_bf16 v[52:55], v[204:207], v[48:51], v[52:55]
    v_mfma_f32_16x16x32_bf16 v[56:59], a[4:7], v[4:7], v[188:191]
    s_add_u32 s55, s81, 295680
    v_mfma_f32_16x16x32_bf16 v[56:59], a[28:31], v[8:11], v[56:59]
    s_add_u32 m0, s82, 36864
    v_mfma_f32_16x16x32_bf16 v[56:59], a[52:55], v[12:15], v[56:59]
    buffer_load_dwordx4 v232, s[20:23], s55 offen nt lds
    v_mfma_f32_16x16x32_bf16 v[56:59], a[76:79], v[16:19], v[56:59]
    v_mfma_f32_16x16x32_bf16 v[56:59], a[100:103], v[20:23], v[56:59]
    v_mfma_f32_16x16x32_bf16 v[56:59], a[124:127], v[24:27], v[56:59]
    buffer_load_dwordx4 v233, s[20:23], s55 offen offset:1024 nt lds
    v_mfma_f32_16x16x32_bf16 v[56:59], a[148:151], v[28:31], v[56:59]
    v_mfma_f32_16x16x32_bf16 v[56:59], a[172:175], v[32:35], v[56:59]
    v_mfma_f32_16x16x32_bf16 v[56:59], a[196:199], v[36:39], v[56:59]
    buffer_load_dwordx4 v234, s[20:23], s55 offen offset:2048 nt lds
    v_mfma_f32_16x16x32_bf16 v[56:59], a[220:223], v[40:43], v[56:59]
    s_cbranch_vccz L_lo1
    s_waitcnt vmcnt(7)
L_lo1:
    v_cvt_pk_bf16_f32 v0, v52, v53
    v_cvt_pk_bf16_f32 v1, v54, v55
    v_mfma_f32_16x16x32_bf16 v[56:59], a[244:247], v[44:47], v[56:59]
    v_mfma_f32_16x16x32_bf16 v[56:59], v[208:211], v[48:51], v[56:59]
    s_add_u32 s54, s54, 12
    v_mfma_f32_16x16x32_bf16 v[60:63], a[8:11], v[4:7], v[192:195]
    v_mfma_f32_16x16x32_bf16 v[60:63], a[32:35], v[8:11], v[60:63]
    v_mfma_f32_16x16x32_bf16 v[60:63], a[56:59], v[12:15], v[60:63]
    v_mfma_f32_16x16x32_bf16 v[60:63], a[80:83], v[16:19], v[60:63]
    v_mfma_f32_16x16x32_bf16 v[60:63], a[104:107], v[20:23], v[60:63]
    v_mfma_f32_16x16x32_bf16 v[60:63], a[128:131], v[24:27], v[60:63]
    v_mfma_f32_16x16x32_bf16 v[60:63], a[152:155], v[28:31], v[60:63]
    v_mfma_f32_16x16x32_bf16 v[60:63], a[176:179], v[32:35], v[60:63]
    s_cmp_eq_u32 s65, 0
    s_cbranch_scc1 L_md1
    s_waitcnt vmcnt(7)
L_md1:
    v_mfma_f32_16x16x32_bf16 v[60:63], a[200:203], v[36:39], v[60:63]
    v_cvt_pk_bf16_f32 v2, v56, v57
    v_cvt_pk_bf16_f32 v3, v58, v59
    v_mfma_f32_16x16x32_bf16 v[60:63], a[224:227], v[40:43], v[60:63]
    ds_write_b128 v235, v[0:3] offset:12288
    v_mfma_f32_16x16x32_bf16 v[60:63], a[248:251], v[44:47], v[60:63]
    v_mfma_f32_16x16x32_bf16 v[60:63], v[212:215], v[48:51], v[60:63]
    v_mfma_f32_16x16x32_bf16 v[64:67], a[12:15], v[4:7], v[76:79]
    s_cmp_eq_u32 s19, s85
    s_cselect_b32 s57, 99, s19
    v_mfma_f32_16x16x32_bf16 v[64:67], a[36:39], v[8:11], v[64:67]
    s_cmp_lt_u32 s57, 9
    s_cselect_b32 s81, s79, 2147483648
    s_cselect_b32 s82, s49, 163840
    v_mfma_f32_16x16x32_bf16 v[64:67], a[60:63], v[12:15], v[64:67]
    v_mfma_f32_16x16x32_bf16 v[64:67], a[84:87], v[16:19], v[64:67]
    v_mfma_f32_16x16x32_bf16 v[64:67], a[108:111], v[20:23], v[64:67]
    v_mfma_f32_16x16x32_bf16 v[64:67], a[132:135], v[24:27], v[64:67]
    v_mfma_f32_16x16x32_bf16 v[64:67], a[156:159], v[28:31], v[64:67]
    v_mfma_f32_16x16x32_bf16 v[64:67], a[180:183], v[32:35], v[64:67]
    v_mfma_f32_16x16x32_bf16 v[64:67], a[204:207], v[36:39], v[64:67]
    v_cvt_pk_bf16_f32 v0, v60, v61
    v_cvt_pk_bf16_f32 v1, v62, v63
    v_mfma_f32_16x16x32_bf16 v[64:67], a[228:231], v[40:43], v[64:67]
    v_mfma_f32_16x16x32_bf16 v[64:67], a[252:255], v[44:47], v[64:67]
    v_mfma_f32_16x16x32_bf16 v[64:67], v[216:219], v[48:51], v[64:67]
    v_mfma_f32_16x16x32_bf16 v[68:71], a[16:19], v[4:7], v[80:83]
    v_mfma_f32_16x16x32_bf16 v[68:71], a[40:43], v[8:11], v[68:71]
    s_waitcnt vmcnt(7) lgkmcnt(1)
    s_barrier
    v_mfma_f32_16x16x32_bf16 v[68:71], a[64:67], v[12:15], v[68:71]
    ds_read_b128 v[240:243], v238 offset:0
    v_mfma_f32_16x16x32_bf16 v[68:71], a[88:91], v[16:19], v[68:71]
    ds_read_b128 v[244:247], v238 offset:1024
    v_mfma_f32_16x16x32_bf16 v[68:71], a[112:115], v[20:23], v[68:71]
    v_mfma_f32_16x16x32_bf16 v[68:71], a[136:139], v[24:27], v[68:71]
    v_mfma_f32_16x16x32_bf16 v[72:75], a[20:23], v[4:7], v[84:87]
    ds_read_b128 v[4:7], v228 offset:24576
    v_mfma_f32_16x16x32_bf16 v[72:75], a[44:47], v[8:11], v[72:75]
    ds_read_b128 v[248:251], v238 offset:2048
    v_mfma_f32_16x16x32_bf16 v[72:75], a[68:71], v[12:15], v[72:75]
    ds_read_b128 v[8:11], v229 offset:24576
    v_mfma_f32_16x16x32_bf16 v[72:75], a[92:95], v[16:19], v[72:75]
    v_cvt_pk_bf16_f32 v2, v64, v65
    v_cvt_pk_bf16_f32 v3, v66, v67
    v_mfma_f32_16x16x32_bf16 v[72:75], a[116:119], v[20:23], v[72:75]
    ds_read_b128 v[12:15], v230 offset:24576
    v_mfma_f32_16x16x32_bf16 v[72:75], a[140:143], v[24:27], v[72:75]
    ds_write_b128 v236, v[0:3] offset:12288
    v_mfma_f32_16x16x32_bf16 v[68:71], a[160:163], v[28:31], v[68:71]
    ds_read_b128 v[16:19], v231 offset:24576
    v_mfma_f32_16x16x32_bf16 v[68:71], a[184:187], v[32:35], v[68:71]
    v_mfma_f32_16x16x32_bf16 v[68:71], a[208:211], v[36:39], v[68:71]
    s_waitcnt lgkmcnt(7)
    buffer_store_dwordx4 v[240:243], v232, s[36:39], s56 offen sc1
    ds_read_b128 v[20:23], v228 offset:24832
    v_mfma_f32_16x16x32_bf16 v[68:71], a[232:235], v[40:43], v[68:71]
    v_mfma_f32_16x16x32_bf16 v[68:71], v[196:199], v[44:47], v[68:71]
    ds_read_b128 v[24:27], v229 offset:24832
    v_mfma_f32_16x16x32_bf16 v[68:71], v[220:223], v[48:51], v[68:71]
    v_mfma_f32_16x16x32_bf16 v[72:75], a[164:167], v[28:31], v[72:75]
    s_waitcnt lgkmcnt(8)
    buffer_store_dwordx4 v[244:247], v233, s[36:39], s56 offen offset:1024 sc1
    ds_read_b128 v[28:31], v230 offset:24832
    v_mfma_f32_16x16x32_bf16 v[72:75], a[188:191], v[32:35], v[72:75]
    ds_read_b128 v[32:35], v231 offset:24832
    v_mfma_f32_16x16x32_bf16 v[72:75], a[212:215], v[36:39], v[72:75]
    ds_read_b128 v[36:39], v228 offset:25088
    v_mfma_f32_16x16x32_bf16 v[72:75], a[236:239], v[40:43], v[72:75]
    ds_read_b128 v[40:43], v229 offset:25088
    v_mfma_f32_16x16x32_bf16 v[72:75], v[200:203], v[44:47], v[72:75]
    s_waitcnt lgkmcnt(10)
    buffer_store_dwordx4 v[248:251], v234, s[36:39], s56 offen offset:2048 sc1
    s_add_u32 s56, s78, 768
    ds_read_b128 v[44:47], v230 offset:25088
    v_mfma_f32_16x16x32_bf16 v[72:75], v[224:227], v[48:51], v[72:75]
    ds_read_b128 v[48:51], v231 offset:25088
    s_waitcnt lgkmcnt(10)
    v_mfma_f32_16x16x32_bf16 v[52:55], a[0:3], v[4:7], v[184:187]
    v_mfma_f32_16x16x32_bf16 v[52:55], a[24:27], v[8:11], v[52:55]
    v_mfma_f32_16x16x32_bf16 v[52:55], a[48:51], v[12:15], v[52:55]
    s_waitcnt lgkmcnt(6)
    v_mfma_f32_16x16x32_bf16 v[52:55], a[72:75], v[16:19], v[52:55]
    v_cvt_pk_bf16_f32 v0, v68, v69
    v_cvt_pk_bf16_f32 v1, v70, v71
    v_mfma_f32_16x16x32_bf16 v[52:55], a[96:99], v[20:23], v[52:55]
    v_mfma_f32_16x16x32_bf16 v[52:55], a[120:123], v[24:27], v[52:55]
    s_waitcnt lgkmcnt(3)
    v_mfma_f32_16x16x32_bf16 v[52:55], a[144:147], v[28:31], v[52:55]
    v_mfma_f32_16x16x32_bf16 v[52:55], a[168:171], v[32:35], v[52:55]
    v_mfma_f32_16x16x32_bf16 v[52:55], a[192:195], v[36:39], v[52:55]
    s_waitcnt lgkmcnt(0)
    v_mfma_f32_16x16x32_bf16 v[52:55], a[216:219], v[40:43], v[52:55]
    v_cvt_pk_bf16_f32 v2, v72, v73
    v_cvt_pk_bf16_f32 v3, v74, v75
    v_mfma_f32_16x16x32_bf16 v[52:55], a[240:243], v[44:47], v[52:55]
    ds_write_b128 v237, v[0:3] offset:12288
    v_mfma_f32_16x16x32_bf16 v[52:55], v[204:207], v[48:51], v[52:55]
    v_mfma_f32_16x16x32_bf16 v[56:59], a[4:7], v[4:7], v[188:191]
    s_add_u32 s55, s81, 0
    v_mfma_f32_16x16x32_bf16 v[56:59], a[28:31], v[8:11], v[56:59]
    s_add_u32 m0, s82, 0
    v_mfma_f32_16x16x32_bf16 v[56:59], a[52:55], v[12:15], v[56:59]
    buffer_load_dwordx4 v232, s[20:23], s55 offen nt lds
    v_mfma_f32_16x16x32_bf16 v[56:59], a[76:79], v[16:19], v[56:59]
    v_mfma_f32_16x16x32_bf16 v[56:59], a[100:103], v[20:23], v[56:59]
    v_mfma_f32_16x16x32_bf16 v[56:59], a[124:127], v[24:27], v[56:59]
    buffer_load_dwordx4 v233, s[20:23], s55 offen offset:1024 nt lds
    v_mfma_f32_16x16x32_bf16 v[56:59], a[148:151], v[28:31], v[56:59]
    v_mfma_f32_16x16x32_bf16 v[56:59], a[172:175], v[32:35], v[56:59]
    v_mfma_f32_16x16x32_bf16 v[56:59], a[196:199], v[36:39], v[56:59]
    buffer_load_dwordx4 v234, s[20:23], s55 offen offset:2048 nt lds
    v_mfma_f32_16x16x32_bf16 v[56:59], a[220:223], v[40:43], v[56:59]
    s_cbranch_vccz L_lo2
    s_waitcnt vmcnt(6)
L_lo2:
    v_cvt_pk_bf16_f32 v0, v52, v53
    v_cvt_pk_bf16_f32 v1, v54, v55
    v_mfma_f32_16x16x32_bf16 v[56:59], a[244:247], v[44:47], v[56:59]
    v_mfma_f32_16x16x32_bf16 v[56:59], v[208:211], v[48:51], v[56:59]
    v_mfma_f32_16x16x32_bf16 v[60:63], a[8:11], v[4:7], v[192:195]
    v_mfma_f32_16x16x32_bf16 v[60:63], a[32:35], v[8:11], v[60:63]
    v_mfma_f32_16x16x32_bf16 v[60:63], a[56:59], v[12:15], v[60:63]
    v_mfma_f32_16x16x32_bf16 v[60:63], a[80:83], v[16:19], v[60:63]
    v_mfma_f32_16x16x32_bf16 v[60:63], a[104:107], v[20:23], v[60:63]
    v_mfma_f32_16x16x32_bf16 v[60:63], a[128:131], v[24:27], v[60:63]
    v_mfma_f32_16x16x32_bf16 v[60:63], a[152:155], v[28:31], v[60:63]
    v_mfma_f32_16x16x32_bf16 v[60:63], a[176:179], v[32:35], v[60:63]
    s_cmp_eq_u32 s65, 0
    s_cbranch_scc1 L_md2
    s_waitcnt vmcnt(6)
L_md2:
    v_mfma_f32_16x16x32_bf16 v[60:63], a[200:203], v[36:39], v[60:63]
    v_cvt_pk_bf16_f32 v2, v56, v57
    v_cvt_pk_bf16_f32 v3, v58, v59
    v_mfma_f32_16x16x32_bf16 v[60:63], a[224:227], v[40:43], v[60:63]
    ds_write_b128 v235, v[0:3] offset:24576
    v_mfma_f32_16x16x32_bf16 v[60:63], a[248:251], v[44:47], v[60:63]
    v_mfma_f32_16x16x32_bf16 v[60:63], v[212:215], v[48:51], v[60:63]
    v_mfma_f32_16x16x32_bf16 v[64:67], a[12:15], v[4:7], v[76:79]
    s_add_u32 s67, s67, 43
    s_and_b32 s67, s67, 255
    v_mfma_f32_16x16x32_bf16 v[64:67], a[36:39], v[8:11], v[64:67]
    s_add_u32 s19, s19, 1
    s_lshl_b32 s87, s19, 8
    v_mfma_f32_16x16x32_bf16 v[64:67], a[60:63], v[12:15], v[64:67]
    s_add_u32 s87, s87, s67
    s_mul_hi_u32 s57, s87, 0x15555556
    v_mfma_f32_16x16x32_bf16 v[64:67], a[84:87], v[16:19], v[64:67]
    s_mul_i32 s57, s57, 294912
    s_mul_i32 s58, s87, 24576
    v_mfma_f32_16x16x32_bf16 v[64:67], a[108:111], v[20:23], v[64:67]
    s_add_u32 s80, s57, s58
    v_mfma_f32_16x16x32_bf16 v[64:67], a[132:135], v[24:27], v[64:67]
    v_mfma_f32_16x16x32_bf16 v[64:67], a[156:159], v[28:31], v[64:67]
    v_mfma_f32_16x16x32_bf16 v[64:67], a[180:183], v[32:35], v[64:67]
    v_mfma_f32_16x16x32_bf16 v[64:67], a[204:207], v[36:39], v[64:67]
    v_cvt_pk_bf16_f32 v0, v60, v61
    v_cvt_pk_bf16_f32 v1, v62, v63
    v_mfma_f32_16x16x32_bf16 v[64:67], a[228:231], v[40:43], v[64:67]
    v_mfma_f32_16x16x32_bf16 v[64:67], a[252:255], v[44:47], v[64:67]
    v_mfma_f32_16x16x32_bf16 v[64:67], v[216:219], v[48:51], v[64:67]
    v_mfma_f32_16x16x32_bf16 v[68:71], a[16:19], v[4:7], v[80:83]
    v_mfma_f32_16x16x32_bf16 v[68:71], a[40:43], v[8:11], v[68:71]
    s_waitcnt vmcnt(6) lgkmcnt(1)
    s_barrier
    v_mfma_f32_16x16x32_bf16 v[68:71], a[64:67], v[12:15], v[68:71]
    ds_read_b128 v[240:243], v238 offset:12288
    v_mfma_f32_16x16x32_bf16 v[68:71], a[88:91], v[16:19], v[68:71]
    ds_read_b128 v[244:247], v238 offset:13312
    v_readfirstlane_b32 s57, v239
    v_mfma_f32_16x16x32_bf16 v[68:71], a[112:115], v[20:23], v[68:71]
    v_mfma_f32_16x16x32_bf16 v[68:71], a[136:139], v[24:27], v[68:71]
    v_mfma_f32_16x16x32_bf16 v[72:75], a[20:23], v[4:7], v[84:87]
    ds_read_b128 v[4:7], v228 offset:36864
    s_sub_u32 s57, s57, s73
    s_cmp_ge_i32 s57, 52
    s_cselect_b32 s65, 0, 1
    s_cselect_b64 vcc, 0, s[98:99]
    v_mfma_f32_16x16x32_bf16 v[72:75], a[44:47], v[8:11], v[72:75]
    ds_read_b128 v[248:251], v238 offset:14336
    v_mfma_f32_16x16x32_bf16 v[72:75], a[68:71], v[12:15], v[72:75]
    ds_read_b128 v[8:11], v229 offset:36864
    s_add_u32 s73, s73, 64
    v_mfma_f32_16x16x32_bf16 v[72:75], a[92:95], v[16:19], v[72:75]
    v_cvt_pk_bf16_f32 v2, v64, v65
    v_cvt_pk_bf16_f32 v3, v66, v67
    v_mfma_f32_16x16x32_bf16 v[72:75], a[116:119], v[20:23], v[72:75]
    ds_read_b128 v[12:15], v230 offset:36864
    v_mfma_f32_16x16x32_bf16 v[72:75], a[140:143], v[24:27], v[72:75]
    ds_write_b128 v236, v[0:3] offset:24576
    v_mfma_f32_16x16x32_bf16 v[68:71], a[160:163], v[28:31], v[68:71]
    ds_read_b128 v[16:19], v231 offset:36864
    v_mfma_f32_16x16x32_bf16 v[68:71], a[184:187], v[32:35], v[68:71]
    v_mfma_f32_16x16x32_bf16 v[68:71], a[208:211], v[36:39], v[68:71]
    s_waitcnt lgkmcnt(7)
    buffer_store_dwordx4 v[240:243], v232, s[36:39], s56 offen sc1
    ds_read_b128 v[20:23], v228 offset:37120
    v_mfma_f32_16x16x32_bf16 v[68:71], a[232:235], v[40:43], v[68:71]
    v_mfma_f32_16x16x32_bf16 v[68:71], v[196:199], v[44:47], v[68:71]
    ds_read_b128 v[24:27], v229 offset:37120
    v_mfma_f32_16x16x32_bf16 v[68:71], v[220:223], v[48:51], v[68:71]
    v_mfma_f32_16x16x32_bf16 v[72:75], a[164:167], v[28:31], v[72:75]
    s_waitcnt lgkmcnt(8)
    buffer_store_dwordx4 v[244:247], v233, s[36:39], s56 offen offset:1024 sc1
    ds_read_b128 v[28:31], v230 offset:37120
    v_mfma_f32_16x16x32_bf16 v[72:75], a[188:191], v[32:35], v[72:75]
    ds_read_b128 v[32:35], v231 offset:37120
    v_mfma_f32_16x16x32_bf16 v[72:75], a[212:215], v[36:39], v[72:75]
    ds_read_b128 v[36:39], v228 offset:37376
    v_mfma_f32_16x16x32_bf16 v[72:75], a[236:239], v[40:43], v[72:75]
    ds_read_b128 v[40:43], v229 offset:37376
    v_mfma_f32_16x16x32_bf16 v[72:75], v[200:203], v[44:47], v[72:75]
    s_waitcnt lgkmcnt(10)
    buffer_store_dwordx4 v[248:251], v234, s[36:39], s56 offen offset:2048 sc1
    s_add_u32 s56, s78, 294912
    ds_read_b128 v[44:47], v230 offset:37376
    v_mfma_f32_16x16x32_bf16 v[72:75], v[224:227], v[48:51], v[72:75]
    ds_read_b128 v[48:51], v231 offset:37376
    s_waitcnt lgkmcnt(10)
    v_mfma_f32_16x16x32_bf16 v[52:55], a[0:3], v[4:7], v[184:187]
    s_cmp_eq_u32 s83, s85
    s_cselect_b32 s53, -49152, 0
    v_mfma_f32_16x16x32_bf16 v[52:55], a[24:27], v[8:11], v[52:55]
    s_add_u32 s83, s83, 1
    v_mfma_f32_16x16x32_bf16 v[52:55], a[48:51], v[12:15], v[52:55]
    s_waitcnt lgkmcnt(6)
    v_mfma_f32_16x16x32_bf16 v[52:55], a[72:75], v[16:19], v[52:55]
    v_cvt_pk_bf16_f32 v0, v68, v69
    v_cvt_pk_bf16_f32 v1, v70, v71
    v_mfma_f32_16x16x32_bf16 v[52:55], a[96:99], v[20:23], v[52:55]
    s_cmp_eq_u32 s83, s85
    s_cselect_b32 s53, 49152, s53
    v_mfma_f32_16x16x32_bf16 v[52:55], a[120:123], v[24:27], v[52:55]
    s_waitcnt lgkmcnt(3)
    v_mfma_f32_16x16x32_bf16 v[52:55], a[144:147], v[28:31], v[52:55]
    v_mfma_f32_16x16x32_bf16 v[52:55], a[168:171], v[32:35], v[52:55]
    v_mfma_f32_16x16x32_bf16 v[52:55], a[192:195], v[36:39], v[52:55]
    s_waitcnt lgkmcnt(0)
    v_mfma_f32_16x16x32_bf16 v[52:55], a[216:219], v[40:43], v[52:55]
    v_cvt_pk_bf16_f32 v2, v72, v73
    v_cvt_pk_bf16_f32 v3, v74, v75
    v_mfma_f32_16x16x32_bf16 v[52:55], a[240:243], v[44:47], v[52:55]
    ds_write_b128 v237, v[0:3] offset:24576
    v_mfma_f32_16x16x32_bf16 v[52:55], v[204:207], v[48:51], v[52:55]
    v_mfma_f32_16x16x32_bf16 v[56:59], a[4:7], v[4:7], v[188:191]
    s_add_u32 s55, s81, 768
    v_mfma_f32_16x16x32_bf16 v[56:59], a[28:31], v[8:11], v[56:59]
    s_add_u32 m0, s82, 12288
    v_mfma_f32_16x16x32_bf16 v[56:59], a[52:55], v[12:15], v[56:59]
    buffer_load_dwordx4 v232, s[20:23], s55 offen nt lds
    v_mfma_f32_16x16x32_bf16 v[56:59], a[76:79], v[16:19], v[56:59]
    v_mfma_f32_16x16x32_bf16 v[56:59], a[100:103], v[20:23], v[56:59]
    v_mfma_f32_16x16x32_bf16 v[56:59], a[124:127], v[24:27], v[56:59]
    buffer_load_dwordx4 v233, s[20:23], s55 offen offset:1024 nt lds
    v_mfma_f32_16x16x32_bf16 v[56:59], a[148:151], v[28:31], v[56:59]
    v_mfma_f32_16x16x32_bf16 v[56:59], a[172:175], v[32:35], v[56:59]
    v_mfma_f32_16x16x32_bf16 v[56:59], a[196:199], v[36:39], v[56:59]
    buffer_load_dwordx4 v234, s[20:23], s55 offen offset:2048 nt lds
    v_mfma_f32_16x16x32_bf16 v[56:59], a[220:223], v[40:43], v[56:59]
    s_cbranch_vccz L_lo3
    s_waitcnt vmcnt(6)
L_lo3:
    v_cvt_pk_bf16_f32 v0, v52, v53
    v_cvt_pk_bf16_f32 v1, v54, v55
    v_mfma_f32_16x16x32_bf16 v[56:59], a[244:247], v[44:47], v[56:59]
    s_set_gpr_idx_on s54, gpr_idx(SRC0)
    v_mov_b64 v[252:253], v[76:77]
    v_mov_b64 v[254:255], v[78:79]
    s_set_gpr_idx_off
    v_mfma_f32_16x16x32_bf16 v[56:59], v[208:211], v[48:51], v[56:59]
    v_lshlrev_b32 v184, 16, v252
    v_and_b32 v185, s59, v252
    v_mfma_f32_16x16x32_bf16 v[60:63], a[8:11], v[4:7], v[192:195]
    v_lshlrev_b32 v186, 16, v253
    v_and_b32 v187, s59, v253
    v_mfma_f32_16x16x32_bf16 v[60:63], a[32:35], v[8:11], v[60:63]
    v_lshlrev_b32 v188, 16, v254
    v_and_b32 v189, s59, v254
    v_mfma_f32_16x16x32_bf16 v[60:63], a[56:59], v[12:15], v[60:63]
    v_lshlrev_b32 v190, 16, v255
    v_and_b32 v191, s59, v255
    v_mfma_f32_16x16x32_bf16 v[60:63], a[80:83], v[16:19], v[60:63]
    v_mfma_f32_16x16x32_bf16 v[60:63], a[104:107], v[20:23], v[60:63]
    v_mfma_f32_16x16x32_bf16 v[60:63], a[128:131], v[24:27], v[60:63]
    v_mfma_f32_16x16x32_bf16 v[60:63], a[152:155], v[28:31], v[60:63]
    v_mfma_f32_16x16x32_bf16 v[60:63], a[176:179], v[32:35], v[60:63]
    s_cmp_eq_u32 s65, 0
    s_cbranch_scc1 L_md3
    s_waitcnt vmcnt(6)
L_md3:
    v_mfma_f32_16x16x32_bf16 v[60:63], a[200:203], v[36:39], v[60:63]
    v_cvt_pk_bf16_f32 v2, v56, v57
    v_cvt_pk_bf16_f32 v3, v58, v59
    v_mfma_f32_16x16x32_bf16 v[60:63], a[224:227], v[40:43], v[60:63]
    ds_write_b128 v235, v[0:3] offset:36864
    v_mfma_f32_16x16x32_bf16 v[60:63], a[248:251], v[44:47], v[60:63]
    v_mfma_f32_16x16x32_bf16 v[60:63], v[212:215], v[48:51], v[60:63]
    v_mfma_f32_16x16x32_bf16 v[64:67], a[12:15], v[4:7], v[76:79]
    v_add_u32 v228, s53, v228
    v_add_u32 v229, s53, v229
    v_mfma_f32_16x16x32_bf16 v[64:67], a[36:39], v[8:11], v[64:67]
    v_add_u32 v230, s53, v230
    v_add_u32 v231, s53, v231
    v_mfma_f32_16x16x32_bf16 v[64:67], a[60:63], v[12:15], v[64:67]
    v_mfma_f32_16x16x32_bf16 v[64:67], a[84:87], v[16:19], v[64:67]
    v_mfma_f32_16x16x32_bf16 v[64:67], a[108:111], v[20:23], v[64:67]
    v_mfma_f32_16x16x32_bf16 v[64:67], a[132:135], v[24:27], v[64:67]
    v_mfma_f32_16x16x32_bf16 v[64:67], a[156:159], v[28:31], v[64:67]
    v_mfma_f32_16x16x32_bf16 v[64:67], a[180:183], v[32:35], v[64:67]
    v_mfma_f32_16x16x32_bf16 v[64:67], a[204:207], v[36:39], v[64:67]
    v_cvt_pk_bf16_f32 v0, v60, v61
    v_cvt_pk_bf16_f32 v1, v62, v63
    v_mfma_f32_16x16x32_bf16 v[64:67], a[228:231], v[40:43], v[64:67]
    s_set_gpr_idx_on s54, gpr_idx(SRC0)
    v_mov_b64 v[252:253], v[80:81]
    v_mov_b64 v[254:255], v[82:83]
    s_set_gpr_idx_off
    v_mfma_f32_16x16x32_bf16 v[64:67], a[252:255], v[44:47], v[64:67]
    v_lshlrev_b32 v192, 16, v252
    v_and_b32 v193, s59, v252
    v_mfma_f32_16x16x32_bf16 v[64:67], v[216:219], v[48:51], v[64:67]
    v_lshlrev_b32 v194, 16, v253
    v_and_b32 v195, s59, v253
    v_mfma_f32_16x16x32_bf16 v[68:71], a[16:19], v[4:7], v[80:83]
    v_lshlrev_b32 v76, 16, v254
    v_and_b32 v77, s59, v254
    v_mfma_f32_16x16x32_bf16 v[68:71], a[40:43], v[8:11], v[68:71]
    s_waitcnt vmcnt(6) lgkmcnt(1)
    s_barrier
    v_lshlrev_b32 v78, 16, v255
    v_and_b32 v79, s59, v255
    v_mfma_f32_16x16x32_bf16 v[68:71], a[64:67], v[12:15], v[68:71]
    ds_read_b128 v[240:243], v238 offset:24576
    v_mfma_f32_16x16x32_bf16 v[68:71], a[88:91], v[16:19], v[68:71]
    ds_read_b128 v[244:247], v238 offset:25600
    v_mfma_f32_16x16x32_bf16 v[68:71], a[112:115], v[20:23], v[68:71]
    v_mfma_f32_16x16x32_bf16 v[68:71], a[136:139], v[24:27], v[68:71]
    v_mfma_f32_16x16x32_bf16 v[72:75], a[20:23], v[4:7], v[84:87]
    ds_read_b128 v[4:7], v228 offset:0
    v_mfma_f32_16x16x32_bf16 v[72:75], a[44:47], v[8:11], v[72:75]
    ds_read_b128 v[248:251], v238 offset:26624
    v_mfma_f32_16x16x32_bf16 v[72:75], a[68:71], v[12:15], v[72:75]
    ds_read_b128 v[8:11], v229 offset:0
    v_mfma_f32_16x16x32_bf16 v[72:75], a[92:95], v[16:19], v[72:75]
    v_cvt_pk_bf16_f32 v2, v64, v65
    v_cvt_pk_bf16_f32 v3, v66, v67
    v_mfma_f32_16x16x32_bf16 v[72:75], a[116:119], v[20:23], v[72:75]
    ds_read_b128 v[12:15], v230 offset:0
    v_mfma_f32_16x16x32_bf16 v[72:75], a[140:143], v[24:27], v[72:75]
    ds_write_b128 v236, v[0:3] offset:36864
    v_mfma_f32_16x16x32_bf16 v[68:71], a[160:163], v[28:31], v[68:71]
    ds_read_b128 v[16:19], v231 offset:0
    v_mfma_f32_16x16x32_bf16 v[68:71], a[184:187], v[32:35], v[68:71]
    v_mfma_f32_16x16x32_bf16 v[68:71], a[208:211], v[36:39], v[68:71]
    s_waitcnt lgkmcnt(7)
    buffer_store_dwordx4 v[240:243], v232, s[36:39], s56 offen sc1
    ds_read_b128 v[20:23], v228 offset:256
    v_mfma_f32_16x16x32_bf16 v[68:71], a[232:235], v[40:43], v[68:71]
    v_mfma_f32_16x16x32_bf16 v[68:71], v[196:199], v[44:47], v[68:71]
    ds_read_b128 v[24:27], v229 offset:256
    v_mfma_f32_16x16x32_bf16 v[68:71], v[220:223], v[48:51], v[68:71]
    v_mfma_f32_16x16x32_bf16 v[72:75], a[164:167], v[28:31], v[72:75]
    s_waitcnt lgkmcnt(8)
    buffer_store_dwordx4 v[244:247], v233, s[36:39], s56 offen offset:1024 sc1
    ds_read_b128 v[28:31], v230 offset:256
    v_mfma_f32_16x16x32_bf16 v[72:75], a[188:191], v[32:35], v[72:75]
    ds_read_b128 v[32:35], v231 offset:256
    v_mfma_f32_16x16x32_bf16 v[72:75], a[212:215], v[36:39], v[72:75]
    ds_read_b128 v[36:39], v228 offset:512
    v_mfma_f32_16x16x32_bf16 v[72:75], a[236:239], v[40:43], v[72:75]
    ds_read_b128 v[40:43], v229 offset:512
    s_cmp_eq_u32 s83, 8
    s_cselect_b32 s65, vcc_lo, s65
    s_cselect_b64 vcc, 0, vcc
    v_mfma_f32_16x16x32_bf16 v[72:75], v[200:203], v[44:47], v[72:75]
    s_waitcnt lgkmcnt(10)
    buffer_store_dwordx4 v[248:251], v234, s[36:39], s56 offen offset:2048 sc1
    s_add_u32 s56, s78, 295680
    ds_read_b128 v[44:47], v230 offset:512
    v_mfma_f32_16x16x32_bf16 v[72:75], v[224:227], v[48:51], v[72:75]
    ds_read_b128 v[48:51], v231 offset:512
    s_mov_b32 s78, s79
    s_mov_b32 s79, s80
    s_cmp_lg_u32 s83, 8
    s_cbranch_scc1 L_p2
    s_waitcnt lgkmcnt(10)
    v_mfma_f32_16x16x32_bf16 v[52:55], a[0:3], v[4:7], v[184:187]
    v_mfma_f32_16x16x32_bf16 v[52:55], a[24:27], v[8:11], v[52:55]
    v_mfma_f32_16x16x32_bf16 v[52:55], a[48:51], v[12:15], v[52:55]
    s_waitcnt lgkmcnt(6)
    v_mfma_f32_16x16x32_bf16 v[52:55], a[72:75], v[16:19], v[52:55]
    v_cvt_pk_bf16_f32 v0, v68, v69
    v_cvt_pk_bf16_f32 v1, v70, v71
    v_mfma_f32_16x16x32_bf16 v[52:55], a[96:99], v[20:23], v[52:55]
    v_mfma_f32_16x16x32_bf16 v[52:55], a[120:123], v[24:27], v[52:55]
    s_waitcnt lgkmcnt(3)
    v_mfma_f32_16x16x32_bf16 v[52:55], a[144:147], v[28:31], v[52:55]
    v_mfma_f32_16x16x32_bf16 v[52:55], a[168:171], v[32:35], v[52:55]
    v_mfma_f32_16x16x32_bf16 v[52:55], a[192:195], v[36:39], v[52:55]
    s_waitcnt lgkmcnt(0)
    v_mfma_f32_16x16x32_bf16 v[52:55], a[216:219], v[40:43], v[52:55]
    v_cvt_pk_bf16_f32 v2, v72, v73
    v_cvt_pk_bf16_f32 v3, v74, v75
    v_mfma_f32_16x16x32_bf16 v[52:55], a[240:243], v[44:47], v[52:55]
    ds_write_b128 v237, v[0:3] offset:36864
    v_mfma_f32_16x16x32_bf16 v[52:55], v[204:207], v[48:51], v[52:55]
    v_mfma_f32_16x16x32_bf16 v[56:59], a[4:7], v[4:7], v[188:191]
    s_add_u32 s55, s81, 294912
    v_mfma_f32_16x16x32_bf16 v[56:59], a[28:31], v[8:11], v[56:59]
    s_add_u32 m0, s82, 24576
    v_mfma_f32_16x16x32_bf16 v[56:59], a[52:55], v[12:15], v[56:59]
    buffer_load_dwordx4 v232, s[20:23], s55 offen nt lds
    v_mfma_f32_16x16x32_bf16 v[56:59], a[76:79], v[16:19], v[56:59]
    v_mfma_f32_16x16x32_bf16 v[56:59], a[100:103], v[20:23], v[56:59]
    v_mfma_f32_16x16x32_bf16 v[56:59], a[124:127], v[24:27], v[56:59]
    buffer_load_dwordx4 v233, s[20:23], s55 offen offset:1024 nt lds
    v_mfma_f32_16x16x32_bf16 v[56:59], a[148:151], v[28:31], v[56:59]
    v_mfma_f32_16x16x32_bf16 v[56:59], a[172:175], v[32:35], v[56:59]
    v_mfma_f32_16x16x32_bf16 v[56:59], a[196:199], v[36:39], v[56:59]
    buffer_load_dwordx4 v234, s[20:23], s55 offen offset:2048 nt lds
    v_mfma_f32_16x16x32_bf16 v[56:59], a[220:223], v[40:43], v[56:59]
    v_cvt_pk_bf16_f32 v0, v52, v53
    v_cvt_pk_bf16_f32 v1, v54, v55
    v_mfma_f32_16x16x32_bf16 v[56:59], a[244:247], v[44:47], v[56:59]
    s_set_gpr_idx_on s54, gpr_idx(SRC0)
    v_mov_b64 v[252:253], v[84:85]
    v_mov_b64 v[254:255], v[86:87]
    s_set_gpr_idx_off
    v_mfma_f32_16x16x32_bf16 v[56:59], v[208:211], v[48:51], v[56:59]
    v_lshlrev_b32 v80, 16, v252
    v_and_b32 v81, s59, v252
    v_mfma_f32_16x16x32_bf16 v[60:63], a[8:11], v[4:7], v[192:195]
    v_lshlrev_b32 v82, 16, v253
    v_and_b32 v83, s59, v253
    v_mfma_f32_16x16x32_bf16 v[60:63], a[32:35], v[8:11], v[60:63]
    v_lshlrev_b32 v84, 16, v254
    v_and_b32 v85, s59, v254
    v_mfma_f32_16x16x32_bf16 v[60:63], a[56:59], v[12:15], v[60:63]
    v_lshlrev_b32 v86, 16, v255
    v_and_b32 v87, s59, v255
    v_mfma_f32_16x16x32_bf16 v[60:63], a[80:83], v[16:19], v[60:63]
    v_mfma_f32_16x16x32_bf16 v[60:63], a[104:107], v[20:23], v[60:63]
    v_mfma_f32_16x16x32_bf16 v[60:63], a[128:131], v[24:27], v[60:63]
    v_mfma_f32_16x16x32_bf16 v[60:63], a[152:155], v[28:31], v[60:63]
    v_mfma_f32_16x16x32_bf16 v[60:63], a[176:179], v[32:35], v[60:63]
    v_mfma_f32_16x16x32_bf16 v[60:63], a[200:203], v[36:39], v[60:63]
    v_cvt_pk_bf16_f32 v2, v56, v57
    v_cvt_pk_bf16_f32 v3, v58, v59
    v_mfma_f32_16x16x32_bf16 v[60:63], a[224:227], v[40:43], v[60:63]
    ds_write_b128 v235, v[0:3] offset:0
    v_mfma_f32_16x16x32_bf16 v[60:63], a[248:251], v[44:47], v[60:63]
    v_mfma_f32_16x16x32_bf16 v[60:63], v[212:215], v[48:51], v[60:63]
    v_mfma_f32_16x16x32_bf16 v[64:67], a[12:15], v[4:7], v[76:79]
    v_mfma_f32_16x16x32_bf16 v[64:67], a[36:39], v[8:11], v[64:67]
    v_mfma_f32_16x16x32_bf16 v[64:67], a[60:63], v[12:15], v[64:67]
    v_mfma_f32_16x16x32_bf16 v[64:67], a[84:87], v[16:19], v[64:67]
    v_mfma_f32_16x16x32_bf16 v[64:67], a[108:111], v[20:23], v[64:67]
    v_mfma_f32_16x16x32_bf16 v[64:67], a[132:135], v[24:27], v[64:67]
    v_mfma_f32_16x16x32_bf16 v[64:67], a[156:159], v[28:31], v[64:67]
    v_mfma_f32_16x16x32_bf16 v[64:67], a[180:183], v[32:35], v[64:67]
    v_mfma_f32_16x16x32_bf16 v[64:67], a[204:207], v[36:39], v[64:67]
    v_cvt_pk_bf16_f32 v0, v60, v61
    v_cvt_pk_bf16_f32 v1, v62, v63
    v_mfma_f32_16x16x32_bf16 v[64:67], a[228:231], v[40:43], v[64:67]
    v_mfma_f32_16x16x32_bf16 v[64:67], a[252:255], v[44:47], v[64:67]
    v_mfma_f32_16x16x32_bf16 v[64:67], v[216:219], v[48:51], v[64:67]
    v_mfma_f32_16x16x32_bf16 v[68:71], a[16:19], v[4:7], v[80:83]
    v_mfma_f32_16x16x32_bf16 v[68:71], a[40:43], v[8:11], v[68:71]
    s_waitcnt vmcnt(6) lgkmcnt(1)
    s_barrier
    v_mfma_f32_16x16x32_bf16 v[68:71], a[64:67], v[12:15], v[68:71]
    ds_read_b128 v[240:243], v238 offset:36864
    v_mfma_f32_16x16x32_bf16 v[68:71], a[88:91], v[16:19], v[68:71]
    ds_read_b128 v[244:247], v238 offset:37888
    v_mfma_f32_16x16x32_bf16 v[68:71], a[112:115], v[20:23], v[68:71]
    v_mfma_f32_16x16x32_bf16 v[68:71], a[136:139], v[24:27], v[68:71]
    v_mfma_f32_16x16x32_bf16 v[72:75], a[20:23], v[4:7], v[84:87]
    ds_read_b128 v[4:7], v228 offset:12288
    v_mfma_f32_16x16x32_bf16 v[72:75], a[44:47], v[8:11], v[72:75]
    ds_read_b128 v[248:251], v238 offset:38912
    v_mfma_f32_16x16x32_bf16 v[72:75], a[68:71], v[12:15], v[72:75]
    ds_read_b128 v[8:11], v229 offset:12288
    v_mfma_f32_16x16x32_bf16 v[72:75], a[92:95], v[16:19], v[72:75]
    v_cvt_pk_bf16_f32 v2, v64, v65
    v_cvt_pk_bf16_f32 v3, v66, v67
    v_mfma_f32_16x16x32_bf16 v[72:75], a[116:119], v[20:23], v[72:75]
    ds_read_b128 v[12:15], v230 offset:12288
    v_mfma_f32_16x16x32_bf16 v[72:75], a[140:143], v[24:27], v[72:75]
    ds_write_b128 v236, v[0:3] offset:0
    v_mfma_f32_16x16x32_bf16 v[68:71], a[160:163], v[28:31], v[68:71]
    ds_read_b128 v[16:19], v231 offset:12288
    v_mfma_f32_16x16x32_bf16 v[68:71], a[184:187], v[32:35], v[68:71]
    v_mfma_f32_16x16x32_bf16 v[68:71], a[208:211], v[36:39], v[68:71]
    s_waitcnt lgkmcnt(7)
    buffer_store_dwordx4 v[240:243], v232, s[36:39], s56 offen sc1
    ds_read_b128 v[20:23], v228 offset:12544
    v_mfma_f32_16x16x32_bf16 v[68:71], a[232:235], v[40:43], v[68:71]
    v_mfma_f32_16x16x32_bf16 v[68:71], v[196:199], v[44:47], v[68:71]
    ds_read_b128 v[24:27], v229 offset:12544
    v_mfma_f32_16x16x32_bf16 v[68:71], v[220:223], v[48:51], v[68:71]
    v_mfma_f32_16x16x32_bf16 v[72:75], a[164:167], v[28:31], v[72:75]
    s_waitcnt lgkmcnt(8)
    buffer_store_dwordx4 v[244:247], v233, s[36:39], s56 offen offset:1024 sc1
    ds_read_b128 v[28:31], v230 offset:12544
    v_mfma_f32_16x16x32_bf16 v[72:75], a[188:191], v[32:35], v[72:75]
    ds_read_b128 v[32:35], v231 offset:12544
    v_mfma_f32_16x16x32_bf16 v[72:75], a[212:215], v[36:39], v[72:75]
    ds_read_b128 v[36:39], v228 offset:12800
    v_mfma_f32_16x16x32_bf16 v[72:75], a[236:239], v[40:43], v[72:75]
    ds_read_b128 v[40:43], v229 offset:12800
    v_mfma_f32_16x16x32_bf16 v[72:75], v[200:203], v[44:47], v[72:75]
    s_waitcnt lgkmcnt(10)
    buffer_store_dwordx4 v[248:251], v234, s[36:39], s56 offen offset:2048 sc1
    s_add_u32 s56, s78, 0
    ds_read_b128 v[44:47], v230 offset:12800
    v_mfma_f32_16x16x32_bf16 v[72:75], v[224:227], v[48:51], v[72:75]
    ds_read_b128 v[48:51], v231 offset:12800
    s_waitcnt lgkmcnt(10)
    v_mfma_f32_16x16x32_bf16 v[52:55], a[0:3], v[4:7], v[184:187]
    v_mfma_f32_16x16x32_bf16 v[52:55], a[24:27], v[8:11], v[52:55]
    v_mfma_f32_16x16x32_bf16 v[52:55], a[48:51], v[12:15], v[52:55]
    s_waitcnt lgkmcnt(6)
    v_mfma_f32_16x16x32_bf16 v[52:55], a[72:75], v[16:19], v[52:55]
    v_cvt_pk_bf16_f32 v0, v68, v69
    v_cvt_pk_bf16_f32 v1, v70, v71
    v_mfma_f32_16x16x32_bf16 v[52:55], a[96:99], v[20:23], v[52:55]
    v_mfma_f32_16x16x32_bf16 v[52:55], a[120:123], v[24:27], v[52:55]
    s_waitcnt lgkmcnt(3)
    v_mfma_f32_16x16x32_bf16 v[52:55], a[144:147], v[28:31], v[52:55]
    v_mfma_f32_16x16x32_bf16 v[52:55], a[168:171], v[32:35], v[52:55]
    v_mfma_f32_16x16x32_bf16 v[52:55], a[192:195], v[36:39], v[52:55]
    s_waitcnt lgkmcnt(0)
    v_mfma_f32_16x16x32_bf16 v[52:55], a[216:219], v[40:43], v[52:55]
    v_cvt_pk_bf16_f32 v2, v72, v73
    v_cvt_pk_bf16_f32 v3, v74, v75
    v_mfma_f32_16x16x32_bf16 v[52:55], a[240:243], v[44:47], v[52:55]
    ds_write_b128 v237, v[0:3] offset:0
    v_mfma_f32_16x16x32_bf16 v[52:55], v[204:207], v[48:51], v[52:55]
    v_mfma_f32_16x16x32_bf16 v[56:59], a[4:7], v[4:7], v[188:191]
    s_add_u32 s55, s81, 295680
    v_mfma_f32_16x16x32_bf16 v[56:59], a[28:31], v[8:11], v[56:59]
    s_add_u32 m0, s82, 36864
    v_mfma_f32_16x16x32_bf16 v[56:59], a[52:55], v[12:15], v[56:59]
    buffer_load_dwordx4 v232, s[20:23], s55 offen nt lds
    v_mfma_f32_16x16x32_bf16 v[56:59], a[76:79], v[16:19], v[56:59]
    v_mfma_f32_16x16x32_bf16 v[56:59], a[100:103], v[20:23], v[56:59]
    v_mfma_f32_16x16x32_bf16 v[56:59], a[124:127], v[24:27], v[56:59]
    buffer_load_dwordx4 v233, s[20:23], s55 offen offset:1024 nt lds
    v_mfma_f32_16x16x32_bf16 v[56:59], a[148:151], v[28:31], v[56:59]
    v_mfma_f32_16x16x32_bf16 v[56:59], a[172:175], v[32:35], v[56:59]
    v_mfma_f32_16x16x32_bf16 v[56:59], a[196:199], v[36:39], v[56:59]
    buffer_load_dwordx4 v234, s[20:23], s55 offen offset:2048 nt lds
    v_mfma_f32_16x16x32_bf16 v[56:59], a[220:223], v[40:43], v[56:59]
    v_cvt_pk_bf16_f32 v0, v52, v53
    v_cvt_pk_bf16_f32 v1, v54, v55
    v_mfma_f32_16x16x32_bf16 v[56:59], a[244:247], v[44:47], v[56:59]
    v_mfma_f32_16x16x32_bf16 v[56:59], v[208:211], v[48:51], v[56:59]
    s_add_u32 s54, s54, 12
    v_mfma_f32_16x16x32_bf16 v[60:63], a[8:11], v[4:7], v[192:195]
    v_mfma_f32_16x16x32_bf16 v[60:63], a[32:35], v[8:11], v[60:63]
    v_mfma_f32_16x16x32_bf16 v[60:63], a[56:59], v[12:15], v[60:63]
    v_mfma_f32_16x16x32_bf16 v[60:63], a[80:83], v[16:19], v[60:63]
    v_mfma_f32_16x16x32_bf16 v[60:63], a[104:107], v[20:23], v[60:63]
    v_mfma_f32_16x16x32_bf16 v[60:63], a[128:131], v[24:27], v[60:63]
    v_mfma_f32_16x16x32_bf16 v[60:63], a[152:155], v[28:31], v[60:63]
    v_mfma_f32_16x16x32_bf16 v[60:63], a[176:179], v[32:35], v[60:63]
    v_mfma_f32_16x16x32_bf16 v[60:63], a[200:203], v[36:39], v[60:63]
    v_cvt_pk_bf16_f32 v2, v56, v57
    v_cvt_pk_bf16_f32 v3, v58, v59
    v_mfma_f32_16x16x32_bf16 v[60:63], a[224:227], v[40:43], v[60:63]
    ds_write_b128 v235, v[0:3] offset:12288
    v_mfma_f32_16x16x32_bf16 v[60:63], a[248:251], v[44:47], v[60:63]
    v_mfma_f32_16x16x32_bf16 v[60:63], v[212:215], v[48:51], v[60:63]
    v_mfma_f32_16x16x32_bf16 v[64:67], a[12:15], v[4:7], v[76:79]
    v_mfma_f32_16x16x32_bf16 v[64:67], a[36:39], v[8:11], v[64:67]
    v_mfma_f32_16x16x32_bf16 v[64:67], a[60:63], v[12:15], v[64:67]
    v_mfma_f32_16x16x32_bf16 v[64:67], a[84:87], v[16:19], v[64:67]
    v_mfma_f32_16x16x32_bf16 v[64:67], a[108:111], v[20:23], v[64:67]
    v_mfma_f32_16x16x32_bf16 v[64:67], a[132:135], v[24:27], v[64:67]
    v_mfma_f32_16x16x32_bf16 v[64:67], a[156:159], v[28:31], v[64:67]
    v_mfma_f32_16x16x32_bf16 v[64:67], a[180:183], v[32:35], v[64:67]
    v_mfma_f32_16x16x32_bf16 v[64:67], a[204:207], v[36:39], v[64:67]
    v_cvt_pk_bf16_f32 v0, v60, v61
    v_cvt_pk_bf16_f32 v1, v62, v63
    v_mfma_f32_16x16x32_bf16 v[64:67], a[228:231], v[40:43], v[64:67]
    v_mfma_f32_16x16x32_bf16 v[64:67], a[252:255], v[44:47], v[64:67]
    v_mfma_f32_16x16x32_bf16 v[64:67], v[216:219], v[48:51], v[64:67]
    v_mfma_f32_16x16x32_bf16 v[68:71], a[16:19], v[4:7], v[80:83]
    v_mfma_f32_16x16x32_bf16 v[68:71], a[40:43], v[8:11], v[68:71]
    s_waitcnt vmcnt(6) lgkmcnt(1)
    s_barrier
    v_mfma_f32_16x16x32_bf16 v[68:71], a[64:67], v[12:15], v[68:71]
    ds_read_b128 v[240:243], v238 offset:0
    v_mfma_f32_16x16x32_bf16 v[68:71], a[88:91], v[16:19], v[68:71]
    ds_read_b128 v[244:247], v238 offset:1024
    v_mfma_f32_16x16x32_bf16 v[68:71], a[112:115], v[20:23], v[68:71]
    v_mfma_f32_16x16x32_bf16 v[68:71], a[136:139], v[24:27], v[68:71]
    v_mfma_f32_16x16x32_bf16 v[72:75], a[20:23], v[4:7], v[84:87]
    ds_read_b128 v[4:7], v228 offset:24576
    v_mfma_f32_16x16x32_bf16 v[72:75], a[44:47], v[8:11], v[72:75]
    ds_read_b128 v[248:251], v238 offset:2048
    v_mfma_f32_16x16x32_bf16 v[72:75], a[68:71], v[12:15], v[72:75]
    ds_read_b128 v[8:11], v229 offset:24576
    v_mfma_f32_16x16x32_bf16 v[72:75], a[92:95], v[16:19], v[72:75]
    v_cvt_pk_bf16_f32 v2, v64, v65
    v_cvt_pk_bf16_f32 v3, v66, v67
    v_mfma_f32_16x16x32_bf16 v[72:75], a[116:119], v[20:23], v[72:75]
    ds_read_b128 v[12:15], v230 offset:24576
    v_mfma_f32_16x16x32_bf16 v[72:75], a[140:143], v[24:27], v[72:75]
    ds_write_b128 v236, v[0:3] offset:12288
    v_mfma_f32_16x16x32_bf16 v[68:71], a[160:163], v[28:31], v[68:71]
    ds_read_b128 v[16:19], v231 offset:24576
    v_mfma_f32_16x16x32_bf16 v[68:71], a[184:187], v[32:35], v[68:71]
    v_mfma_f32_16x16x32_bf16 v[68:71], a[208:211], v[36:39], v[68:71]
    s_waitcnt lgkmcnt(7)
    buffer_store_dwordx4 v[240:243], v232, s[36:39], s56 offen sc1
    ds_read_b128 v[20:23], v228 offset:24832
    v_mfma_f32_16x16x32_bf16 v[68:71], a[232:235], v[40:43], v[68:71]
    v_mfma_f32_16x16x32_bf16 v[68:71], v[196:199], v[44:47], v[68:71]
    ds_read_b128 v[24:27], v229 offset:24832
    v_mfma_f32_16x16x32_bf16 v[68:71], v[220:223], v[48:51], v[68:71]
    v_mfma_f32_16x16x32_bf16 v[72:75], a[164:167], v[28:31], v[72:75]
    s_waitcnt lgkmcnt(8)
    buffer_store_dwordx4 v[244:247], v233, s[36:39], s56 offen offset:1024 sc1
    ds_read_b128 v[28:31], v230 offset:24832
    v_mfma_f32_16x16x32_bf16 v[72:75], a[188:191], v[32:35], v[72:75]
    ds_read_b128 v[32:35], v231 offset:24832
    v_mfma_f32_16x16x32_bf16 v[72:75], a[212:215], v[36:39], v[72:75]
    ds_read_b128 v[36:39], v228 offset:25088
    v_mfma_f32_16x16x32_bf16 v[72:75], a[236:239], v[40:43], v[72:75]
    ds_read_b128 v[40:43], v229 offset:25088
    v_mfma_f32_16x16x32_bf16 v[72:75], v[200:203], v[44:47], v[72:75]
    s_waitcnt lgkmcnt(10)
    buffer_store_dwordx4 v[248:251], v234, s[36:39], s56 offen offset:2048 sc1
    s_add_u32 s56, s78, 768
    ds_read_b128 v[44:47], v230 offset:25088
    v_mfma_f32_16x16x32_bf16 v[72:75], v[224:227], v[48:51], v[72:75]
    ds_read_b128 v[48:51], v231 offset:25088
    s_waitcnt lgkmcnt(10)
    v_mfma_f32_16x16x32_bf16 v[52:55], a[0:3], v[4:7], v[184:187]
    v_mfma_f32_16x16x32_bf16 v[52:55], a[24:27], v[8:11], v[52:55]
    v_mfma_f32_16x16x32_bf16 v[52:55], a[48:51], v[12:15], v[52:55]
    s_waitcnt lgkmcnt(6)
    v_mfma_f32_16x16x32_bf16 v[52:55], a[72:75], v[16:19], v[52:55]
    v_cvt_pk_bf16_f32 v0, v68, v69
    v_cvt_pk_bf16_f32 v1, v70, v71
    v_mfma_f32_16x16x32_bf16 v[52:55], a[96:99], v[20:23], v[52:55]
    v_mfma_f32_16x16x32_bf16 v[52:55], a[120:123], v[24:27], v[52:55]
    s_waitcnt lgkmcnt(3)
    v_mfma_f32_16x16x32_bf16 v[52:55], a[144:147], v[28:31], v[52:55]
    v_mfma_f32_16x16x32_bf16 v[52:55], a[168:171], v[32:35], v[52:55]
    v_mfma_f32_16x16x32_bf16 v[52:55], a[192:195], v[36:39], v[52:55]
    s_waitcnt lgkmcnt(0)
    v_mfma_f32_16x16x32_bf16 v[52:55], a[216:219], v[40:43], v[52:55]
    v_cvt_pk_bf16_f32 v2, v72, v73
    v_cvt_pk_bf16_f32 v3, v74, v75
    v_mfma_f32_16x16x32_bf16 v[52:55], a[240:243], v[44:47], v[52:55]
    ds_write_b128 v237, v[0:3] offset:12288
    v_mfma_f32_16x16x32_bf16 v[52:55], v[204:207], v[48:51], v[52:55]
    v_mfma_f32_16x16x32_bf16 v[56:59], a[4:7], v[4:7], v[188:191]
    s_add_u32 s55, s97, 0
    v_mfma_f32_16x16x32_bf16 v[56:59], a[28:31], v[8:11], v[56:59]
    s_add_u32 m0, s49, 147456
    v_mfma_f32_16x16x32_bf16 v[56:59], a[52:55], v[12:15], v[56:59]
    buffer_load_dwordx4 v232, s[20:23], s55 offen nt lds
    v_mfma_f32_16x16x32_bf16 v[56:59], a[76:79], v[16:19], v[56:59]
    v_mfma_f32_16x16x32_bf16 v[56:59], a[100:103], v[20:23], v[56:59]
    v_mfma_f32_16x16x32_bf16 v[56:59], a[124:127], v[24:27], v[56:59]
    buffer_load_dwordx4 v233, s[20:23], s55 offen offset:1024 nt lds
    v_mfma_f32_16x16x32_bf16 v[56:59], a[148:151], v[28:31], v[56:59]
    v_mfma_f32_16x16x32_bf16 v[56:59], a[172:175], v[32:35], v[56:59]
    v_mfma_f32_16x16x32_bf16 v[56:59], a[196:199], v[36:39], v[56:59]
    v_mfma_f32_16x16x32_bf16 v[56:59], a[220:223], v[40:43], v[56:59]
    v_cvt_pk_bf16_f32 v0, v52, v53
    v_cvt_pk_bf16_f32 v1, v54, v55
    v_mfma_f32_16x16x32_bf16 v[56:59], a[244:247], v[44:47], v[56:59]
    v_mfma_f32_16x16x32_bf16 v[56:59], v[208:211], v[48:51], v[56:59]
    v_mfma_f32_16x16x32_bf16 v[60:63], a[8:11], v[4:7], v[192:195]
    v_mfma_f32_16x16x32_bf16 v[60:63], a[32:35], v[8:11], v[60:63]
    v_mfma_f32_16x16x32_bf16 v[60:63], a[56:59], v[12:15], v[60:63]
    v_mfma_f32_16x16x32_bf16 v[60:63], a[80:83], v[16:19], v[60:63]
    v_mfma_f32_16x16x32_bf16 v[60:63], a[104:107], v[20:23], v[60:63]
    v_mfma_f32_16x16x32_bf16 v[60:63], a[128:131], v[24:27], v[60:63]
    v_mfma_f32_16x16x32_bf16 v[60:63], a[152:155], v[28:31], v[60:63]
    v_mfma_f32_16x16x32_bf16 v[60:63], a[176:179], v[32:35], v[60:63]
    v_mfma_f32_16x16x32_bf16 v[60:63], a[200:203], v[36:39], v[60:63]
    v_cvt_pk_bf16_f32 v2, v56, v57
    v_cvt_pk_bf16_f32 v3, v58, v59
    v_mfma_f32_16x16x32_bf16 v[60:63], a[224:227], v[40:43], v[60:63]
    ds_write_b128 v235, v[0:3] offset:24576
    v_mfma_f32_16x16x32_bf16 v[60:63], a[248:251], v[44:47], v[60:63]
    v_mfma_f32_16x16x32_bf16 v[60:63], v[212:215], v[48:51], v[60:63]
    v_mfma_f32_16x16x32_bf16 v[64:67], a[12:15], v[4:7], v[76:79]
    v_mfma_f32_16x16x32_bf16 v[64:67], a[36:39], v[8:11], v[64:67]
    v_mfma_f32_16x16x32_bf16 v[64:67], a[60:63], v[12:15], v[64:67]
    v_mfma_f32_16x16x32_bf16 v[64:67], a[84:87], v[16:19], v[64:67]
    v_mfma_f32_16x16x32_bf16 v[64:67], a[108:111], v[20:23], v[64:67]
    v_mfma_f32_16x16x32_bf16 v[64:67], a[132:135], v[24:27], v[64:67]
    v_mfma_f32_16x16x32_bf16 v[64:67], a[156:159], v[28:31], v[64:67]
    v_mfma_f32_16x16x32_bf16 v[64:67], a[180:183], v[32:35], v[64:67]
    v_mfma_f32_16x16x32_bf16 v[64:67], a[204:207], v[36:39], v[64:67]
    v_cvt_pk_bf16_f32 v0, v60, v61
    v_cvt_pk_bf16_f32 v1, v62, v63
    v_mfma_f32_16x16x32_bf16 v[64:67], a[228:231], v[40:43], v[64:67]
    v_mfma_f32_16x16x32_bf16 v[64:67], a[252:255], v[44:47], v[64:67]
    v_mfma_f32_16x16x32_bf16 v[64:67], v[216:219], v[48:51], v[64:67]
    v_mfma_f32_16x16x32_bf16 v[68:71], a[16:19], v[4:7], v[80:83]
    v_mfma_f32_16x16x32_bf16 v[68:71], a[40:43], v[8:11], v[68:71]
    s_waitcnt vmcnt(5) lgkmcnt(1)
    s_barrier
    v_mfma_f32_16x16x32_bf16 v[68:71], a[64:67], v[12:15], v[68:71]
    ds_read_b128 v[240:243], v238 offset:12288
    v_mfma_f32_16x16x32_bf16 v[68:71], a[88:91], v[16:19], v[68:71]
    ds_read_b128 v[244:247], v238 offset:13312
    v_mfma_f32_16x16x32_bf16 v[68:71], a[112:115], v[20:23], v[68:71]
    v_mfma_f32_16x16x32_bf16 v[68:71], a[136:139], v[24:27], v[68:71]
    v_mfma_f32_16x16x32_bf16 v[72:75], a[20:23], v[4:7], v[84:87]
    ds_read_b128 v[4:7], v228 offset:36864
    v_mfma_f32_16x16x32_bf16 v[72:75], a[44:47], v[8:11], v[72:75]
    ds_read_b128 v[248:251], v238 offset:14336
    v_mfma_f32_16x16x32_bf16 v[72:75], a[68:71], v[12:15], v[72:75]
    ds_read_b128 v[8:11], v229 offset:36864
    v_mfma_f32_16x16x32_bf16 v[72:75], a[92:95], v[16:19], v[72:75]
    v_cvt_pk_bf16_f32 v2, v64, v65
    v_cvt_pk_bf16_f32 v3, v66, v67
    v_mfma_f32_16x16x32_bf16 v[72:75], a[116:119], v[20:23], v[72:75]
    ds_read_b128 v[12:15], v230 offset:36864
    v_mfma_f32_16x16x32_bf16 v[72:75], a[140:143], v[24:27], v[72:75]
    ds_write_b128 v236, v[0:3] offset:24576
    v_mfma_f32_16x16x32_bf16 v[68:71], a[160:163], v[28:31], v[68:71]
    ds_read_b128 v[16:19], v231 offset:36864
    v_mfma_f32_16x16x32_bf16 v[68:71], a[184:187], v[32:35], v[68:71]
    v_mfma_f32_16x16x32_bf16 v[68:71], a[208:211], v[36:39], v[68:71]
    s_waitcnt lgkmcnt(7)
    buffer_store_dwordx4 v[240:243], v232, s[36:39], s56 offen sc1
    ds_read_b128 v[20:23], v228 offset:37120
    v_mfma_f32_16x16x32_bf16 v[68:71], a[232:235], v[40:43], v[68:71]
    v_mfma_f32_16x16x32_bf16 v[68:71], v[196:199], v[44:47], v[68:71]
    ds_read_b128 v[24:27], v229 offset:37120
    v_mfma_f32_16x16x32_bf16 v[68:71], v[220:223], v[48:51], v[68:71]
    v_mfma_f32_16x16x32_bf16 v[72:75], a[164:167], v[28:31], v[72:75]
    s_waitcnt lgkmcnt(8)
    buffer_store_dwordx4 v[244:247], v233, s[36:39], s56 offen offset:1024 sc1
    ds_read_b128 v[28:31], v230 offset:37120
    v_mfma_f32_16x16x32_bf16 v[72:75], a[188:191], v[32:35], v[72:75]
    ds_read_b128 v[32:35], v231 offset:37120
    v_mfma_f32_16x16x32_bf16 v[72:75], a[212:215], v[36:39], v[72:75]
    ds_read_b128 v[36:39], v228 offset:37376
    v_mfma_f32_16x16x32_bf16 v[72:75], a[236:239], v[40:43], v[72:75]
    ds_read_b128 v[40:43], v229 offset:37376
    v_mfma_f32_16x16x32_bf16 v[72:75], v[200:203], v[44:47], v[72:75]
    s_waitcnt lgkmcnt(10)
    buffer_store_dwordx4 v[248:251], v234, s[36:39], s56 offen offset:2048 sc1
    s_add_u32 s56, s78, 294912
    ds_read_b128 v[44:47], v230 offset:37376
    v_mfma_f32_16x16x32_bf16 v[72:75], v[224:227], v[48:51], v[72:75]
    ds_read_b128 v[48:51], v231 offset:37376
    s_waitcnt lgkmcnt(10)
    v_mfma_f32_16x16x32_bf16 v[52:55], a[0:3], v[4:7], v[184:187]
    v_mfma_f32_16x16x32_bf16 v[52:55], a[24:27], v[8:11], v[52:55]
    s_add_u32 s83, s83, 1
    v_mfma_f32_16x16x32_bf16 v[52:55], a[48:51], v[12:15], v[52:55]
    s_waitcnt lgkmcnt(6)
    v_mfma_f32_16x16x32_bf16 v[52:55], a[72:75], v[16:19], v[52:55]
    v_cvt_pk_bf16_f32 v0, v68, v69
    v_cvt_pk_bf16_f32 v1, v70, v71
    v_mfma_f32_16x16x32_bf16 v[52:55], a[96:99], v[20:23], v[52:55]
    v_mfma_f32_16x16x32_bf16 v[52:55], a[120:123], v[24:27], v[52:55]
    s_waitcnt lgkmcnt(3)
    v_mfma_f32_16x16x32_bf16 v[52:55], a[144:147], v[28:31], v[52:55]
    v_mfma_f32_16x16x32_bf16 v[52:55], a[168:171], v[32:35], v[52:55]
    v_mfma_f32_16x16x32_bf16 v[52:55], a[192:195], v[36:39], v[52:55]
    s_waitcnt lgkmcnt(0)
    v_mfma_f32_16x16x32_bf16 v[52:55], a[216:219], v[40:43], v[52:55]
    v_cvt_pk_bf16_f32 v2, v72, v73
    v_cvt_pk_bf16_f32 v3, v74, v75
    v_mfma_f32_16x16x32_bf16 v[52:55], a[240:243], v[44:47], v[52:55]
    ds_write_b128 v237, v[0:3] offset:24576
    v_mfma_f32_16x16x32_bf16 v[52:55], v[204:207], v[48:51], v[52:55]
    v_mfma_f32_16x16x32_bf16 v[56:59], a[4:7], v[4:7], v[188:191]
    s_add_u32 s55, s97, 768
    v_mfma_f32_16x16x32_bf16 v[56:59], a[28:31], v[8:11], v[56:59]
    s_add_u32 m0, s49, 147456
    v_mfma_f32_16x16x32_bf16 v[56:59], a[52:55], v[12:15], v[56:59]
    buffer_load_dwordx4 v232, s[20:23], s55 offen nt lds
    v_mfma_f32_16x16x32_bf16 v[56:59], a[76:79], v[16:19], v[56:59]
    v_mfma_f32_16x16x32_bf16 v[56:59], a[100:103], v[20:23], v[56:59]
    v_mfma_f32_16x16x32_bf16 v[56:59], a[124:127], v[24:27], v[56:59]
    buffer_load_dwordx4 v233, s[20:23], s55 offen offset:1024 nt lds
    v_mfma_f32_16x16x32_bf16 v[56:59], a[148:151], v[28:31], v[56:59]
    v_mfma_f32_16x16x32_bf16 v[56:59], a[172:175], v[32:35], v[56:59]
    v_mfma_f32_16x16x32_bf16 v[56:59], a[196:199], v[36:39], v[56:59]
    v_mfma_f32_16x16x32_bf16 v[56:59], a[220:223], v[40:43], v[56:59]
    v_cvt_pk_bf16_f32 v0, v52, v53
    v_cvt_pk_bf16_f32 v1, v54, v55
    v_mfma_f32_16x16x32_bf16 v[56:59], a[244:247], v[44:47], v[56:59]
    v_mfma_f32_16x16x32_bf16 v[56:59], v[208:211], v[48:51], v[56:59]
    v_mfma_f32_16x16x32_bf16 v[60:63], a[8:11], v[4:7], v[192:195]
    v_mfma_f32_16x16x32_bf16 v[60:63], a[32:35], v[8:11], v[60:63]
    v_mfma_f32_16x16x32_bf16 v[60:63], a[56:59], v[12:15], v[60:63]
    v_mfma_f32_16x16x32_bf16 v[60:63], a[80:83], v[16:19], v[60:63]
    v_mfma_f32_16x16x32_bf16 v[60:63], a[104:107], v[20:23], v[60:63]
    v_mfma_f32_16x16x32_bf16 v[60:63], a[128:131], v[24:27], v[60:63]
    v_mfma_f32_16x16x32_bf16 v[60:63], a[152:155], v[28:31], v[60:63]
    v_mfma_f32_16x16x32_bf16 v[60:63], a[176:179], v[32:35], v[60:63]
    v_mfma_f32_16x16x32_bf16 v[60:63], a[200:203], v[36:39], v[60:63]
    v_cvt_pk_bf16_f32 v2, v56, v57
    v_cvt_pk_bf16_f32 v3, v58, v59
    v_mfma_f32_16x16x32_bf16 v[60:63], a[224:227], v[40:43], v[60:63]
    ds_write_b128 v235, v[0:3] offset:36864
    v_mfma_f32_16x16x32_bf16 v[60:63], a[248:251], v[44:47], v[60:63]
    v_mfma_f32_16x16x32_bf16 v[60:63], v[212:215], v[48:51], v[60:63]
    v_mfma_f32_16x16x32_bf16 v[64:67], a[12:15], v[4:7], v[76:79]
    v_mfma_f32_16x16x32_bf16 v[64:67], a[36:39], v[8:11], v[64:67]
    v_mfma_f32_16x16x32_bf16 v[64:67], a[60:63], v[12:15], v[64:67]
    v_mfma_f32_16x16x32_bf16 v[64:67], a[84:87], v[16:19], v[64:67]
    v_mfma_f32_16x16x32_bf16 v[64:67], a[108:111], v[20:23], v[64:67]
    v_mfma_f32_16x16x32_bf16 v[64:67], a[132:135], v[24:27], v[64:67]
    v_mfma_f32_16x16x32_bf16 v[64:67], a[156:159], v[28:31], v[64:67]
    v_mfma_f32_16x16x32_bf16 v[64:67], a[180:183], v[32:35], v[64:67]
    v_mfma_f32_16x16x32_bf16 v[64:67], a[204:207], v[36:39], v[64:67]
    v_cvt_pk_bf16_f32 v0, v60, v61
    v_cvt_pk_bf16_f32 v1, v62, v63
    v_mfma_f32_16x16x32_bf16 v[64:67], a[228:231], v[40:43], v[64:67]
    v_mfma_f32_16x16x32_bf16 v[64:67], a[252:255], v[44:47], v[64:67]
    v_mfma_f32_16x16x32_bf16 v[64:67], v[216:219], v[48:51], v[64:67]
    v_mfma_f32_16x16x32_bf16 v[68:71], a[16:19], v[4:7], v[80:83]
    v_mfma_f32_16x16x32_bf16 v[68:71], a[40:43], v[8:11], v[68:71]
    s_waitcnt lgkmcnt(1)
    s_barrier
    v_mfma_f32_16x16x32_bf16 v[68:71], a[64:67], v[12:15], v[68:71]
    ds_read_b128 v[240:243], v238 offset:24576
    v_mfma_f32_16x16x32_bf16 v[68:71], a[88:91], v[16:19], v[68:71]
    ds_read_b128 v[244:247], v238 offset:25600
    v_mfma_f32_16x16x32_bf16 v[68:71], a[112:115], v[20:23], v[68:71]
    v_mfma_f32_16x16x32_bf16 v[68:71], a[136:139], v[24:27], v[68:71]
    v_mfma_f32_16x16x32_bf16 v[72:75], a[20:23], v[4:7], v[84:87]
    v_mfma_f32_16x16x32_bf16 v[72:75], a[44:47], v[8:11], v[72:75]
    ds_read_b128 v[248:251], v238 offset:26624
    v_mfma_f32_16x16x32_bf16 v[72:75], a[68:71], v[12:15], v[72:75]
    v_mfma_f32_16x16x32_bf16 v[72:75], a[92:95], v[16:19], v[72:75]
    v_cvt_pk_bf16_f32 v2, v64, v65
    v_cvt_pk_bf16_f32 v3, v66, v67
    v_mfma_f32_16x16x32_bf16 v[72:75], a[116:119], v[20:23], v[72:75]
    v_mfma_f32_16x16x32_bf16 v[72:75], a[140:143], v[24:27], v[72:75]
    ds_write_b128 v236, v[0:3] offset:36864
    v_mfma_f32_16x16x32_bf16 v[68:71], a[160:163], v[28:31], v[68:71]
    v_mfma_f32_16x16x32_bf16 v[68:71], a[184:187], v[32:35], v[68:71]
    v_mfma_f32_16x16x32_bf16 v[68:71], a[208:211], v[36:39], v[68:71]
    s_waitcnt lgkmcnt(3)
    buffer_store_dwordx4 v[240:243], v232, s[36:39], s56 offen sc1
    v_mfma_f32_16x16x32_bf16 v[68:71], a[232:235], v[40:43], v[68:71]
    v_mfma_f32_16x16x32_bf16 v[68:71], v[196:199], v[44:47], v[68:71]
    v_mfma_f32_16x16x32_bf16 v[68:71], v[220:223], v[48:51], v[68:71]
    v_mfma_f32_16x16x32_bf16 v[72:75], a[164:167], v[28:31], v[72:75]
    s_waitcnt lgkmcnt(2)
    buffer_store_dwordx4 v[244:247], v233, s[36:39], s56 offen offset:1024 sc1
    v_mfma_f32_16x16x32_bf16 v[72:75], a[188:191], v[32:35], v[72:75]
    v_mfma_f32_16x16x32_bf16 v[72:75], a[212:215], v[36:39], v[72:75]
    v_mfma_f32_16x16x32_bf16 v[72:75], a[236:239], v[40:43], v[72:75]
    v_mfma_f32_16x16x32_bf16 v[72:75], v[200:203], v[44:47], v[72:75]
    s_waitcnt lgkmcnt(1)
    buffer_store_dwordx4 v[248:251], v234, s[36:39], s56 offen offset:2048 sc1
    s_add_u32 s56, s78, 295680
    v_mfma_f32_16x16x32_bf16 v[72:75], v[224:227], v[48:51], v[72:75]
    s_nop 3
    v_cvt_pk_bf16_f32 v0, v68, v69
    v_cvt_pk_bf16_f32 v1, v70, v71
    s_nop 4
    v_cvt_pk_bf16_f32 v2, v72, v73
    v_cvt_pk_bf16_f32 v3, v74, v75
    ds_write_b128 v237, v[0:3] offset:36864
    s_waitcnt lgkmcnt(0)
    s_barrier
    ds_read_b128 v[240:243], v238 offset:36864
    ds_read_b128 v[244:247], v238 offset:37888
    ds_read_b128 v[248:251], v238 offset:38912
    s_waitcnt lgkmcnt(2)
    buffer_store_dwordx4 v[240:243], v232, s[36:39], s56 offen sc1
    s_waitcnt lgkmcnt(1)
    buffer_store_dwordx4 v[244:247], v233, s[36:39], s56 offen offset:1024 sc1
    s_waitcnt lgkmcnt(0)
    buffer_store_dwordx4 v[248:251], v234, s[36:39], s56 offen offset:2048 sc1
    s_endpgm
L_prod:
    v_mul_u32_u24 v136, 192, v2
    v_lshl_add_u32 v136, v3, 4, v136
    v_add_u32 v136, s71, v136
    v_and_b32 v137, 1, v3
    v_lshrrev_b32 v138, 1, v3
    v_bfe_u32 v139, v0, 2, 2
    v_lshl_add_u32 v139, v137, 3, v139
    v_mul_u32_u24 v139, 192, v139
    v_and_b32 v1, 3, v0
    v_lshl_add_u32 v139, v1, 4, v139
    v_lshl_add_u32 v139, v138, 3, v139
    v_add_u32 v139, s71, v139
    v_cvt_pk_bf16_f32 v112, v148, v149
    v_cvt_pk_bf16_f32 v113, v150, v151
    v_cvt_pk_bf16_f32 v114, v152, v153
    v_cvt_pk_bf16_f32 v115, v154, v155
    v_cvt_pk_bf16_f32 v116, v156, v157
    v_cvt_pk_bf16_f32 v117, v158, v159
    v_cvt_pk_bf16_f32 v118, v160, v161
    v_cvt_pk_bf16_f32 v119, v162, v163
    v_cvt_pk_bf16_f32 v120, v164, v165
    v_cvt_pk_bf16_f32 v121, v166, v167
    v_cvt_pk_bf16_f32 v122, v168, v169
    v_cvt_pk_bf16_f32 v123, v170, v171
    ds_write_b128 v136, v[112:115] offset:0
    ds_write_b128 v136, v[116:119] offset:64
    ds_write_b128 v136, v[120:123] offset:128
    ds_read_b64_tr_b16 v[124:125], v139 offset:0
    ds_read_b64_tr_b16 v[126:127], v139 offset:768
    ds_read_b64_tr_b16 v[128:129], v139 offset:64
    ds_read_b64_tr_b16 v[130:131], v139 offset:832
    ds_read_b64_tr_b16 v[132:133], v139 offset:128
    ds_read_b64_tr_b16 v[134:135], v139 offset:896
    v_lshl_add_u32 v1, v137, 4, v2
    v_lshlrev_b32 v1, 4, v1
    v_lshl_add_u32 v1, v138, 11, v1
    s_mul_i32 s57, s48, 73728
    v_add_u32 v1, s57, v1
    s_lshr_b32 s57, s60, 2
    s_mul_i32 s57, s57, 12288
    s_and_b32 s58, s60, 3
    s_lshl_b32 s58, s58, 9
    s_add_u32 s57, s57, s58
    s_add_u32 s58, s57, 4096
    s_add_u32 s68, s57, 8192
    s_waitcnt lgkmcnt(0)
    buffer_store_dwordx4 v[124:127], v1, s[40:43], s57 offen sc0 sc1
    buffer_store_dwordx4 v[128:131], v1, s[40:43], s58 offen sc0 sc1
    buffer_store_dwordx4 v[132:135], v1, s[40:43], s68 offen sc0 sc1
    s_waitcnt vmcnt(12)
    s_branch L_prod_ret
L_poll:
    s_load_dword s72, s[14:15], 64
    s_waitcnt lgkmcnt(0)
    s_cmp_ge_u32 s72, 24
    s_cbranch_scc1 L_got
    s_sleep 8
    s_load_dword s72, s[14:15], 128
    s_waitcnt lgkmcnt(0)
    s_cmp_ge_u32 s72, 24
    s_cbranch_scc1 L_got
    s_sleep 8
    s_load_dword s72, s[14:15], 192
    s_waitcnt lgkmcnt(0)
    s_cmp_ge_u32 s72, 24
    s_cbranch_scc1 L_got
    s_mov_b32 s58, 0
L_poll2:
    buffer_load_dword v254, off, s[44:47], 0 sc1
    s_waitcnt vmcnt(0)
    v_readfirstlane_b32 s72, v254
    s_nop 3
    s_cmp_ge_u32 s72, 24
    s_cbranch_scc1 L_got
    s_sleep 4
    s_add_u32 s58, s58, 1
    s_cmp_lt_u32 s58, 0x40000
    s_cbranch_scc1 L_poll2
L_got:
    s_mov_b32 exec_hi, 15
    buffer_load_dword v254, v253, s[40:43], 0 offen sc1
    s_mov_b64 exec, -1
    s_branch L_ready
L_end:
    s_endpgm
.section .rodata,"a"
.p2align 6
.amdhsa_kernel standalone__detection_seg_fpn_lateral__vision_kernel
  .amdhsa_next_free_vgpr 512
  .amdhsa_next_free_sgpr 102
  .amdhsa_accum_offset 256
  .amdhsa_group_segment_fixed_size 0
  .amdhsa_kernarg_size 56
  .amdhsa_user_sgpr_count 2
  .amdhsa_user_sgpr_kernarg_segment_ptr 1
  .amdhsa_system_sgpr_workgroup_id_x 1
.end_amdhsa_kernel
```

```asm
; @launch grid=(256,1,1) block=(256,1,1) lds=163840
.amdgcn_target "amdgcn-amd-amdhsa--gfx950"
.text
.globl standalone__detection_seg_fpn_lateral__vision_kernel
.p2align 8
.type standalone__detection_seg_fpn_lateral__vision_kernel,@function
standalone__detection_seg_fpn_lateral__vision_kernel:
    s_load_dwordx8 s[4:11], s[0:1], 0
    s_load_dwordx2 s[16:17], s[0:1], 48
    s_getpc_b64 s[18:19]
L_pc:
    s_cmp_ge_u32 s2, 256
    s_cbranch_scc1 L_end
    s_and_b32 s57, s2, 0x30
    s_cbranch_scc1 L_nocpf
    s_and_b32 s57, s2, 8
    s_lshl_b32 s57, s57, 12
    v_lshl_add_u32 v1, v0, 7, s57
    v_min_u32 v1, L_end-L_pc, v1
    global_load_dword v96, v1, s[18:19]
L_nocpf:
    v_lshrrev_b32 v1, 6, v0
    v_and_b32 v0, 63, v0
    v_readfirstlane_b32 s48, v1
    v_lshrrev_b32 v3, 4, v0
    v_lshlrev_b32 v85, 7, v0
    s_lshr_b32 s68, s2, 3
    s_lshl_b32 s68, s68, 2
    s_add_u32 s68, s68, s48
    s_mul_i32 s68, s68, 2304
    s_mul_i32 s49, s48, 3072
    s_mul_i32 s57, s48, 516
    v_mad_u32_u24 v80, v3, 43, s57
    v_lshl_add_u32 v81, v0, 4, s49
    v_lshrrev_b32 v1, 3, v80
    v_and_b32 v1, 0xf0, v1
    v_xor_b32 v244, v1, v81
    v_mad_u32_u24 v232, v1, 48, v244
    v_add_u32 v80, 172, v80
    v_lshrrev_b32 v1, 3, v80
    v_and_b32 v1, 0xf0, v1
    v_xor_b32 v245, v1, v81
    v_mad_u32_u24 v233, v1, 48, v245
    v_add_u32 v80, 172, v80
    v_lshrrev_b32 v1, 3, v80
    v_and_b32 v1, 0xf0, v1
    v_xor_b32 v246, v1, v81
    v_mad_u32_u24 v234, v1, 48, v246
    s_lshr_b32 s57, s2, 4
    s_lshl_b32 s60, s57, 2
    s_bfe_u32 s57, s2, 131073
    s_add_u32 s60, s60, s57
    s_and_b32 s57, s2, 9
    s_cselect_b32 s60, 99, s60
    s_bitcmp1_b32 s2, 3
    s_cselect_b32 s61, 2, 1
    s_cmp_lt_u32 s60, 24
    s_cselect_b32 s61, 0, s61
    s_mov_b32 s34, 294912
    s_mov_b32 s35, 0x20000
    s_mov_b32 s26, 28311552
    s_mov_b32 s27, 0x20000
    s_waitcnt lgkmcnt(0)
    s_mov_b64 s[32:33], s[10:11]
    s_mov_b64 exec, 0x3ffff
    buffer_load_dword v97, v85, s[32:35], s68 offen
    s_mov_b64 exec, -1
    s_mov_b64 s[24:25], s[6:7]
    s_mov_b32 s40, s16
    s_mov_b32 s41, s17
    s_mov_b32 s42, 1048576
    s_mov_b32 s43, 0x20000
    s_bfe_u32 s66, s2, 131076
    s_lshl_b32 s66, s66, 2
    s_add_u32 s66, s66, s48
    s_lshl_b32 s66, s66, 7
    s_add_u32 s66, s66, 0x80000
    buffer_load_dword v239, off, s[40:43], s66 sc1
    s_load_dwordx4 s[12:15], s[0:1], 32
    s_cmp_eq_u32 s61, 1
    s_cbranch_scc1 L_pre_done
    s_cmp_eq_u32 s61, 2
    s_cbranch_scc1 L_pre_2
    s_mov_b32 s28, s8
    s_mov_b32 s29, s9
    s_mov_b32 s30, 294912
    s_mov_b32 s31, 0x20000
    s_mul_i32 s57, s60, 12288
    s_add_u32 s75, s57, 0
    s_add_u32 m0, s49, 110592
    s_nop 0
    buffer_load_dwordx4 v244, s[28:31], s75 offen lds
    buffer_load_dwordx4 v245, s[28:31], s75 offen offset:1024 lds
    buffer_load_dwordx4 v246, s[28:31], s75 offen offset:2048 lds
    s_branch L_pre_done
L_pre_2:
    s_add_u32 s76, s2, 0
    s_and_b32 s76, s76, 255
    s_add_u32 s76, s76, 0
    s_mul_i32 s76, s76, 12288
    s_add_u32 m0, s49, 110592
    s_nop 0
    buffer_load_dwordx4 v244, s[24:27], s76 offen nt lds
    buffer_load_dwordx4 v245, s[24:27], s76 offen offset:1024 nt lds
    buffer_load_dwordx4 v246, s[24:27], s76 offen offset:2048 nt lds
    s_add_u32 s77, s2, 43
    s_and_b32 s77, s77, 255
    s_add_u32 s77, s77, 256
    s_mul_i32 s77, s77, 12288
    s_add_u32 m0, s49, 122880
    s_nop 0
    buffer_load_dwordx4 v244, s[24:27], s77 offen nt lds
    buffer_load_dwordx4 v245, s[24:27], s77 offen offset:1024 nt lds
    buffer_load_dwordx4 v246, s[24:27], s77 offen offset:2048 nt lds
    s_add_u32 s74, s2, 86
    s_and_b32 s74, s74, 255
    s_add_u32 s74, s74, 512
    s_mul_i32 s74, s74, 12288
    s_add_u32 m0, s49, 135168
    s_nop 0
    buffer_load_dwordx4 v244, s[24:27], s74 offen nt lds
    buffer_load_dwordx4 v245, s[24:27], s74 offen offset:1024 nt lds
    buffer_load_dwordx4 v246, s[24:27], s74 offen offset:2048 nt lds
    s_add_u32 s75, s2, 129
    s_and_b32 s75, s75, 255
    s_add_u32 s75, s75, 768
    s_mul_i32 s75, s75, 12288
    s_add_u32 m0, s49, 24576
    s_nop 0
    buffer_load_dwordx4 v244, s[24:27], s75 offen nt lds
    buffer_load_dwordx4 v245, s[24:27], s75 offen offset:1024 nt lds
    buffer_load_dwordx4 v246, s[24:27], s75 offen offset:2048 nt lds
    s_add_u32 s76, s2, 172
    s_and_b32 s76, s76, 255
    s_add_u32 s76, s76, 1024
    s_mul_i32 s76, s76, 12288
    s_add_u32 m0, s49, 36864
    s_nop 0
    buffer_load_dwordx4 v244, s[24:27], s76 offen nt lds
    buffer_load_dwordx4 v245, s[24:27], s76 offen offset:1024 nt lds
    buffer_load_dwordx4 v246, s[24:27], s76 offen offset:2048 nt lds
    s_add_u32 s77, s2, 215
    s_and_b32 s77, s77, 255
    s_add_u32 s77, s77, 1280
    s_mul_i32 s77, s77, 12288
    s_add_u32 m0, s49, 98304
    s_nop 0
    buffer_load_dwordx4 v244, s[24:27], s77 offen nt lds
    buffer_load_dwordx4 v245, s[24:27], s77 offen offset:1024 nt lds
    buffer_load_dwordx4 v246, s[24:27], s77 offen offset:2048 nt lds
L_pre_done:
    s_mul_i32 s57, s48, 192
    s_and_b32 s58, s48, 1
    s_lshl_b32 s50, s58, 6
    s_add_u32 s50, s50, s57
    s_xor_b32 s58, s58, 1
    s_lshl_b32 s51, s58, 7
    s_add_u32 s51, s51, s57
    v_lshrrev_b32 v76, 3, v0
    v_and_b32 v77, 7, v0
    v_lshrrev_b32 v78, 2, v0
    v_and_b32 v79, 3, v0
    v_and_b32 v1, 4, v78
    v_xor_b32 v1, v1, v77
    v_mul_u32_u24 v247, 768, v76
    v_lshl_add_u32 v247, v1, 4, v247
    v_add_u32 v247, s50, v247
    v_mul_u32_u24 v248, 768, v78
    v_lshl_add_u32 v248, v79, 4, v248
    v_add_u32 v248, s51, v248
    s_mul_i32 s70, s48, 12288
    s_add_u32 s70, s70, 49152
    s_lshl_b32 s71, s48, 12
    s_add_u32 s71, s71, 147456
    s_add_u32 m0, s70, 0
    s_mov_b32 s74, 0
    buffer_load_dwordx4 v247, s[32:35], s74 offen lds
    s_mov_b32 s75, 5120
    buffer_load_dwordx4 v247, s[32:35], s75 offen offset:1024 lds
    s_mov_b32 s76, 10240
    buffer_load_dwordx4 v247, s[32:35], s76 offen offset:2048 lds
    s_mov_b32 s77, 15360
    buffer_load_dwordx4 v247, s[32:35], s77 offen offset:3072 lds
    s_add_u32 m0, s71, 0
    s_mov_b32 s74, 0
    buffer_load_dwordx4 v248, s[32:35], s74 offen lds
    s_mov_b32 s75, 11264
    buffer_load_dwordx4 v248, s[32:35], s75 offen offset:1024 lds
    s_add_u32 m0, s70, 4096
    s_mov_b32 s76, 24576
    buffer_load_dwordx4 v247, s[32:35], s76 offen lds
    s_mov_b32 s77, 29696
    buffer_load_dwordx4 v247, s[32:35], s77 offen offset:1024 lds
    s_mov_b32 s74, 34816
    buffer_load_dwordx4 v247, s[32:35], s74 offen offset:2048 lds
    s_mov_b32 s75, 39936
    buffer_load_dwordx4 v247, s[32:35], s75 offen offset:3072 lds
    s_add_u32 m0, s71, 2048
    s_mov_b32 s76, 24576
    buffer_load_dwordx4 v248, s[32:35], s76 offen lds
    s_mov_b32 s77, 35840
    buffer_load_dwordx4 v248, s[32:35], s77 offen offset:1024 lds
    s_add_u32 m0, s70, 8192
    s_mov_b32 s74, 49152
    buffer_load_dwordx4 v247, s[32:35], s74 offen lds
    s_mov_b32 s75, 54272
    buffer_load_dwordx4 v247, s[32:35], s75 offen offset:1024 lds
    s_mov_b32 s76, 59392
    buffer_load_dwordx4 v247, s[32:35], s76 offen offset:2048 lds
    s_mov_b32 s77, 64512
    buffer_load_dwordx4 v247, s[32:35], s77 offen offset:3072 lds
    v_and_b32 v2, 15, v0
    s_mov_b32 s20, s4
    s_mov_b32 s21, s5
    s_mov_b32 s22, 113246208
    s_mov_b32 s23, 0x20000
    s_mul_hi_u32 s57, s2, 0x15555556
    s_mul_i32 s57, s57, 294912
    s_mul_i32 s78, s2, 24576
    s_add_u32 s78, s78, s57
    s_add_u32 s67, s2, 43
    s_and_b32 s67, s67, 255
    s_add_u32 s87, s67, 256
    s_mul_hi_u32 s57, s87, 0x15555556
    s_mul_i32 s57, s57, 294912
    s_mul_i32 s79, s87, 24576
    s_add_u32 s79, s79, s57
    s_bfe_u32 s85, s2, 196612
    s_add_u32 s85, s85, 1
    s_mul_i32 s68, s85, 43
    s_add_u32 s68, s68, s2
    s_and_b32 s68, s68, 255
    s_lshl_b32 s58, s85, 8
    s_add_u32 s68, s68, s58
    s_mul_hi_u32 s57, s68, 0x15555556
    s_mul_i32 s57, s57, 294912
    s_mul_i32 s84, s68, 24576
    s_add_u32 s84, s84, s57
    s_cmp_eq_u32 s61, 2
    s_cselect_b32 s85, 59, s85
    v_and_b32 v1, 3, v78
    v_lshl_add_u32 v80, v3, 3, v1
    v_and_b32 v1, 2, v1
    v_lshl_add_u32 v1, v1, 1, v79
    v_lshlrev_b32 v1, 4, v1
    v_lshl_add_u32 v249, v80, 7, v1
    v_add_u32 v249, s70, v249
    v_xor_b32 v250, 64, v249
    v_lshlrev_b32 v1, 4, v79
    v_lshl_add_u32 v251, v80, 6, v1
    v_add_u32 v251, s71, v251
    v_xor_b32 v1, v2, v3
    v_lshlrev_b32 v1, 4, v1
    v_mul_u32_u24 v80, 768, v2
    v_add_u32 v228, v80, v1
    v_xor_b32 v229, 64, v228
    v_xor_b32 v230, 128, v228
    v_xor_b32 v231, 192, v228
    s_mov_b32 s57, 73728
    s_cmp_eq_u32 s61, 1
    s_cselect_b32 s57, 163840, s57
    v_add_u32 v240, s57, v228
    v_add_u32 v241, s57, v229
    v_add_u32 v242, s57, v230
    v_add_u32 v243, s57, v231
    s_mov_b32 s57, s50
    s_and_b32 s58, s57, 0xc0
    s_andn2_b32 s57, s57, 0xff
    s_add_u32 s57, s57, 98304
    v_xor_b32 v235, s58, v228
    v_add_u32 v235, s57, v235
    s_add_u32 s57, s50, 64
    s_and_b32 s58, s57, 0xc0
    s_andn2_b32 s57, s57, 0xff
    s_add_u32 s57, s57, 98304
    v_xor_b32 v236, s58, v228
    v_add_u32 v236, s57, v236
    s_mov_b32 s57, s51
    s_and_b32 s58, s57, 0xc0
    s_andn2_b32 s57, s57, 0xff
    s_add_u32 s57, s57, 98304
    v_xor_b32 v237, s58, v228
    v_add_u32 v237, s57, v237
    s_add_u32 s57, s49, 98304
    v_lshlrev_b32 v1, 4, v0
    v_add_u32 v238, s57, v1
    s_mul_i32 s57, s48, 73728
    v_add_u32 v252, s57, v1
    s_lshr_b32 s58, s2, 4
    s_lshl_b32 s58, s58, 2
    s_add_u32 s58, s58, s48
    s_mul_i32 s58, s58, 4608
    v_add_u32 v253, s58, v85
    s_cmp_eq_u32 s61, 2
    s_cselect_b32 s62, 2147483648, 0
    s_cselect_b32 s63, 90112, s49
    s_cselect_b32 s64, 163840, s49
    s_mov_b32 s58, 1
    s_waitcnt lgkmcnt(0)
    s_mov_b32 s36, s12
    s_mov_b32 s37, s13
    s_mov_b32 s38, 113246208
    s_mov_b32 s39, 0x20000
    s_mov_b32 s44, s14
    s_mov_b32 s45, s15
    s_mov_b32 s46, 256
    s_mov_b32 s47, 0x20000
    s_mov_b32 s59, 0xffff0000
    s_mov_b32 s19, 1
    s_cmp_eq_u32 s58, 1
    s_cselect_b32 s81, s78, 2147483648
    s_cselect_b32 s82, s49, 163840
    s_mov_b32 s54, 0
    s_getreg_b32 s57, hwreg(HW_REG_XCC_ID)
    s_bitcmp0_b32 s57, 0
    s_cselect_b64 vcc, -1, 0
    s_cmp_eq_u32 s61, 0
    s_cselect_b64 vcc, 0, vcc
    s_mov_b32 s65, 1
    s_mov_b64 s[98:99], vcc
    s_mov_b32 s83, 0
    s_brev_b32 s56, 1
    s_mov_b32 s97, s78
    s_waitcnt vmcnt(10)
    s_barrier
    ds_read_b64_tr_b16 a[16:17], v251 offset:0
    ds_read_b64_tr_b16 a[18:19], v251 offset:256
    ds_read_b64_tr_b16 a[20:21], v251 offset:8
    ds_read_b64_tr_b16 a[22:23], v251 offset:264
    ds_read_b64_tr_b16 a[0:1], v249 offset:0
    ds_read_b64_tr_b16 a[2:3], v249 offset:512
    ds_read_b64_tr_b16 a[4:5], v249 offset:8
    ds_read_b64_tr_b16 a[6:7], v249 offset:520
    ds_read_b64_tr_b16 a[8:9], v250 offset:0
    ds_read_b64_tr_b16 a[10:11], v250 offset:512
    ds_read_b64_tr_b16 a[12:13], v250 offset:8
    ds_read_b64_tr_b16 a[14:15], v250 offset:520
    ds_read_b128 v[4:7], v240 offset:36864
    ds_read_b128 v[8:11], v240 offset:49152
    ds_read_b128 v[12:15], v240 offset:61440
    s_waitcnt lgkmcnt(11)
    s_add_u32 m0, s71, 0
    s_mov_b32 s74, 49152
    buffer_load_dwordx4 v248, s[32:35], s74 offen lds
    s_mov_b32 s75, 60416
    buffer_load_dwordx4 v248, s[32:35], s75 offen offset:1024 lds
    s_waitcnt lgkmcnt(0)
    s_add_u32 m0, s70, 0
    s_mov_b32 s76, 73728
    buffer_load_dwordx4 v247, s[32:35], s76 offen lds
    s_mov_b32 s77, 78848
    buffer_load_dwordx4 v247, s[32:35], s77 offen offset:1024 lds
    s_mov_b32 s74, 83968
    buffer_load_dwordx4 v247, s[32:35], s74 offen offset:2048 lds
    s_mov_b32 s75, 89088
    buffer_load_dwordx4 v247, s[32:35], s75 offen offset:3072 lds
    s_waitcnt vmcnt(10)
    ds_read_b64_tr_b16 a[40:41], v251 offset:2048
    ds_read_b64_tr_b16 a[42:43], v251 offset:2304
    v_mfma_f32_16x16x32_bf16 v[148:151], a[0:3], v[4:7], 0
    ds_read_b64_tr_b16 a[44:45], v251 offset:2056
    ds_read_b64_tr_b16 a[46:47], v251 offset:2312
    v_mfma_f32_16x16x32_bf16 v[172:175], a[0:3], v[8:11], 0
    ds_read_b64_tr_b16 a[24:25], v249 offset:4096
    ds_read_b64_tr_b16 a[26:27], v249 offset:4608
    v_mfma_f32_16x16x32_bf16 v[52:55], a[0:3], v[12:15], 0
    ds_read_b64_tr_b16 a[28:29], v249 offset:4104
    ds_read_b64_tr_b16 a[30:31], v249 offset:4616
    v_mfma_f32_16x16x32_bf16 v[152:155], a[4:7], v[4:7], 0
    ds_read_b64_tr_b16 a[32:33], v250 offset:4096
    ds_read_b64_tr_b16 a[34:35], v250 offset:4608
    v_mfma_f32_16x16x32_bf16 v[176:179], a[4:7], v[8:11], 0
    ds_read_b64_tr_b16 a[36:37], v250 offset:4104
    ds_read_b64_tr_b16 a[38:39], v250 offset:4616
    v_mfma_f32_16x16x32_bf16 v[56:59], a[4:7], v[12:15], 0
    ds_read_b128 v[16:19], v241 offset:36864
    ds_read_b128 v[20:23], v241 offset:49152
    s_waitcnt lgkmcnt(10)
    s_add_u32 m0, s71, 2048
    s_mov_b32 s76, 73728
    buffer_load_dwordx4 v248, s[32:35], s76 offen lds
    v_mfma_f32_16x16x32_bf16 v[156:159], a[8:11], v[4:7], 0
    ds_read_b128 v[24:27], v241 offset:61440
    v_mfma_f32_16x16x32_bf16 v[180:183], a[8:11], v[8:11], 0
    s_mov_b32 s77, 84992
    buffer_load_dwordx4 v248, s[32:35], s77 offen offset:1024 lds
    v_mfma_f32_16x16x32_bf16 v[60:63], a[8:11], v[12:15], 0
    v_mfma_f32_16x16x32_bf16 v[160:163], a[12:15], v[4:7], 0
    v_mfma_f32_16x16x32_bf16 v[184:187], a[12:15], v[8:11], 0
    v_mfma_f32_16x16x32_bf16 v[64:67], a[12:15], v[12:15], 0
    s_waitcnt lgkmcnt(0)
    s_add_u32 m0, s70, 4096
    s_mov_b32 s74, 98304
    buffer_load_dwordx4 v247, s[32:35], s74 offen lds
    v_mfma_f32_16x16x32_bf16 v[164:167], a[16:19], v[4:7], 0
    s_mov_b32 s75, 103424
    buffer_load_dwordx4 v247, s[32:35], s75 offen offset:1024 lds
    v_mfma_f32_16x16x32_bf16 v[188:191], a[16:19], v[8:11], 0
    s_mov_b32 s76, 108544
    buffer_load_dwordx4 v247, s[32:35], s76 offen offset:2048 lds
    v_mfma_f32_16x16x32_bf16 v[68:71], a[16:19], v[12:15], 0
    s_mov_b32 s77, 113664
    buffer_load_dwordx4 v247, s[32:35], s77 offen offset:3072 lds
    v_mfma_f32_16x16x32_bf16 v[168:171], a[20:23], v[4:7], 0
    v_mfma_f32_16x16x32_bf16 v[192:195], a[20:23], v[8:11], 0
    v_mfma_f32_16x16x32_bf16 v[72:75], a[20:23], v[12:15], 0
    s_waitcnt vmcnt(10)
    ds_read_b64_tr_b16 a[64:65], v251 offset:0
    ds_read_b64_tr_b16 a[66:67], v251 offset:256
    v_mfma_f32_16x16x32_bf16 v[148:151], a[24:27], v[16:19], v[148:151]
    ds_read_b64_tr_b16 a[68:69], v251 offset:8
    ds_read_b64_tr_b16 a[70:71], v251 offset:264
    v_mfma_f32_16x16x32_bf16 v[172:175], a[24:27], v[20:23], v[172:175]
    ds_read_b64_tr_b16 a[48:49], v249 offset:8192
    ds_read_b64_tr_b16 a[50:51], v249 offset:8704
    v_mfma_f32_16x16x32_bf16 v[52:55], a[24:27], v[24:27], v[52:55]
    ds_read_b64_tr_b16 a[52:53], v249 offset:8200
    ds_read_b64_tr_b16 a[54:55], v249 offset:8712
    v_mfma_f32_16x16x32_bf16 v[152:155], a[28:31], v[16:19], v[152:155]
    ds_read_b64_tr_b16 a[56:57], v250 offset:8192
    ds_read_b64_tr_b16 a[58:59], v250 offset:8704
    v_mfma_f32_16x16x32_bf16 v[176:179], a[28:31], v[20:23], v[176:179]
    ds_read_b64_tr_b16 a[60:61], v250 offset:8200
    ds_read_b64_tr_b16 a[62:63], v250 offset:8712
    v_mfma_f32_16x16x32_bf16 v[56:59], a[28:31], v[24:27], v[56:59]
    ds_read_b128 v[28:31], v242 offset:36864
    ds_read_b128 v[32:35], v242 offset:49152
    s_waitcnt lgkmcnt(10)
    s_add_u32 m0, s71, 0
    s_mov_b32 s74, 98304
    buffer_load_dwordx4 v248, s[32:35], s74 offen lds
    v_mfma_f32_16x16x32_bf16 v[156:159], a[32:35], v[16:19], v[156:159]
    ds_read_b128 v[36:39], v242 offset:61440
    v_mfma_f32_16x16x32_bf16 v[180:183], a[32:35], v[20:23], v[180:183]
    s_mov_b32 s75, 109568
    buffer_load_dwordx4 v248, s[32:35], s75 offen offset:1024 lds
    v_mfma_f32_16x16x32_bf16 v[60:63], a[32:35], v[24:27], v[60:63]
    v_mfma_f32_16x16x32_bf16 v[160:163], a[36:39], v[16:19], v[160:163]
    v_mfma_f32_16x16x32_bf16 v[184:187], a[36:39], v[20:23], v[184:187]
    v_mfma_f32_16x16x32_bf16 v[64:67], a[36:39], v[24:27], v[64:67]
    s_waitcnt lgkmcnt(0)
    s_add_u32 m0, s70, 8192
    s_mov_b32 s76, 122880
    buffer_load_dwordx4 v247, s[32:35], s76 offen lds
    v_mfma_f32_16x16x32_bf16 v[164:167], a[40:43], v[16:19], v[164:167]
    s_mov_b32 s77, 128000
    buffer_load_dwordx4 v247, s[32:35], s77 offen offset:1024 lds
    v_mfma_f32_16x16x32_bf16 v[188:191], a[40:43], v[20:23], v[188:191]
    s_mov_b32 s74, 133120
    buffer_load_dwordx4 v247, s[32:35], s74 offen offset:2048 lds
    v_mfma_f32_16x16x32_bf16 v[68:71], a[40:43], v[24:27], v[68:71]
    s_mov_b32 s75, 138240
    buffer_load_dwordx4 v247, s[32:35], s75 offen offset:3072 lds
    v_mfma_f32_16x16x32_bf16 v[168:171], a[44:47], v[16:19], v[168:171]
    v_mfma_f32_16x16x32_bf16 v[192:195], a[44:47], v[20:23], v[192:195]
    v_mfma_f32_16x16x32_bf16 v[72:75], a[44:47], v[24:27], v[72:75]
    s_waitcnt vmcnt(10)
    ds_read_b64_tr_b16 a[88:89], v251 offset:2048
    ds_read_b64_tr_b16 a[90:91], v251 offset:2304
    v_mfma_f32_16x16x32_bf16 v[148:151], a[48:51], v[28:31], v[148:151]
    ds_read_b64_tr_b16 a[92:93], v251 offset:2056
    ds_read_b64_tr_b16 a[94:95], v251 offset:2312
    v_mfma_f32_16x16x32_bf16 v[172:175], a[48:51], v[32:35], v[172:175]
    ds_read_b64_tr_b16 a[72:73], v249 offset:0
    ds_read_b64_tr_b16 a[74:75], v249 offset:512
    v_mfma_f32_16x16x32_bf16 v[52:55], a[48:51], v[36:39], v[52:55]
    ds_read_b64_tr_b16 a[76:77], v249 offset:8
    ds_read_b64_tr_b16 a[78:79], v249 offset:520
    v_mfma_f32_16x16x32_bf16 v[152:155], a[52:55], v[28:31], v[152:155]
    ds_read_b64_tr_b16 a[80:81], v250 offset:0
    ds_read_b64_tr_b16 a[82:83], v250 offset:512
    v_mfma_f32_16x16x32_bf16 v[176:179], a[52:55], v[32:35], v[176:179]
    ds_read_b64_tr_b16 a[84:85], v250 offset:8
    ds_read_b64_tr_b16 a[86:87], v250 offset:520
    v_mfma_f32_16x16x32_bf16 v[56:59], a[52:55], v[36:39], v[56:59]
    ds_read_b128 v[40:43], v243 offset:36864
    ds_read_b128 v[44:47], v243 offset:49152
    s_waitcnt lgkmcnt(10)
    s_add_u32 m0, s71, 2048
    s_mov_b32 s76, 122880
    buffer_load_dwordx4 v248, s[32:35], s76 offen lds
    v_mfma_f32_16x16x32_bf16 v[156:159], a[56:59], v[28:31], v[156:159]
    ds_read_b128 v[48:51], v243 offset:61440
    v_mfma_f32_16x16x32_bf16 v[180:183], a[56:59], v[32:35], v[180:183]
    s_mov_b32 s77, 134144
    buffer_load_dwordx4 v248, s[32:35], s77 offen offset:1024 lds
    v_mfma_f32_16x16x32_bf16 v[60:63], a[56:59], v[36:39], v[60:63]
    v_mfma_f32_16x16x32_bf16 v[160:163], a[60:63], v[28:31], v[160:163]
    v_mfma_f32_16x16x32_bf16 v[184:187], a[60:63], v[32:35], v[184:187]
    v_mfma_f32_16x16x32_bf16 v[64:67], a[60:63], v[36:39], v[64:67]
    s_waitcnt lgkmcnt(0)
    s_add_u32 m0, s70, 0
    s_mov_b32 s74, 147456
    buffer_load_dwordx4 v247, s[32:35], s74 offen lds
    v_mfma_f32_16x16x32_bf16 v[164:167], a[64:67], v[28:31], v[164:167]
    s_mov_b32 s75, 152576
    buffer_load_dwordx4 v247, s[32:35], s75 offen offset:1024 lds
    v_mfma_f32_16x16x32_bf16 v[188:191], a[64:67], v[32:35], v[188:191]
    s_mov_b32 s76, 157696
    buffer_load_dwordx4 v247, s[32:35], s76 offen offset:2048 lds
    v_mfma_f32_16x16x32_bf16 v[68:71], a[64:67], v[36:39], v[68:71]
    s_mov_b32 s77, 162816
    buffer_load_dwordx4 v247, s[32:35], s77 offen offset:3072 lds
    v_mfma_f32_16x16x32_bf16 v[168:171], a[68:71], v[28:31], v[168:171]
    v_mfma_f32_16x16x32_bf16 v[192:195], a[68:71], v[32:35], v[192:195]
    v_mfma_f32_16x16x32_bf16 v[72:75], a[68:71], v[36:39], v[72:75]
    s_waitcnt vmcnt(10)
    ds_read_b64_tr_b16 a[112:113], v251 offset:0
    ds_read_b64_tr_b16 a[114:115], v251 offset:256
    v_mfma_f32_16x16x32_bf16 v[148:151], a[72:75], v[40:43], v[148:151]
    ds_read_b64_tr_b16 a[116:117], v251 offset:8
    ds_read_b64_tr_b16 a[118:119], v251 offset:264
    v_mfma_f32_16x16x32_bf16 v[172:175], a[72:75], v[44:47], v[172:175]
    ds_read_b64_tr_b16 a[96:97], v249 offset:4096
    ds_read_b64_tr_b16 a[98:99], v249 offset:4608
    v_mfma_f32_16x16x32_bf16 v[52:55], a[72:75], v[48:51], v[52:55]
    ds_read_b64_tr_b16 a[100:101], v249 offset:4104
    ds_read_b64_tr_b16 a[102:103], v249 offset:4616
    v_mfma_f32_16x16x32_bf16 v[152:155], a[76:79], v[40:43], v[152:155]
    ds_read_b64_tr_b16 a[104:105], v250 offset:4096
    ds_read_b64_tr_b16 a[106:107], v250 offset:4608
    v_mfma_f32_16x16x32_bf16 v[176:179], a[76:79], v[44:47], v[176:179]
    ds_read_b64_tr_b16 a[108:109], v250 offset:4104
    ds_read_b64_tr_b16 a[110:111], v250 offset:4616
    v_mfma_f32_16x16x32_bf16 v[56:59], a[76:79], v[48:51], v[56:59]
    ds_read_b128 v[4:7], v240 offset:37120
    ds_read_b128 v[8:11], v240 offset:49408
    s_waitcnt lgkmcnt(10)
    s_add_u32 m0, s71, 0
    s_mov_b32 s74, 147456
    buffer_load_dwordx4 v248, s[32:35], s74 offen lds
    v_mfma_f32_16x16x32_bf16 v[156:159], a[80:83], v[40:43], v[156:159]
    ds_read_b128 v[12:15], v240 offset:61696
    v_mfma_f32_16x16x32_bf16 v[180:183], a[80:83], v[44:47], v[180:183]
    s_mov_b32 s75, 158720
    buffer_load_dwordx4 v248, s[32:35], s75 offen offset:1024 lds
    v_mfma_f32_16x16x32_bf16 v[60:63], a[80:83], v[48:51], v[60:63]
    v_mfma_f32_16x16x32_bf16 v[160:163], a[84:87], v[40:43], v[160:163]
    v_mfma_f32_16x16x32_bf16 v[184:187], a[84:87], v[44:47], v[184:187]
    v_mfma_f32_16x16x32_bf16 v[64:67], a[84:87], v[48:51], v[64:67]
    s_waitcnt lgkmcnt(0)
    s_add_u32 m0, s70, 4096
    s_mov_b32 s76, 172032
    buffer_load_dwordx4 v247, s[32:35], s76 offen lds
    v_mfma_f32_16x16x32_bf16 v[164:167], a[88:91], v[40:43], v[164:167]
    s_mov_b32 s77, 177152
    buffer_load_dwordx4 v247, s[32:35], s77 offen offset:1024 lds
    v_mfma_f32_16x16x32_bf16 v[188:191], a[88:91], v[44:47], v[188:191]
    s_mov_b32 s74, 182272
    buffer_load_dwordx4 v247, s[32:35], s74 offen offset:2048 lds
    v_mfma_f32_16x16x32_bf16 v[68:71], a[88:91], v[48:51], v[68:71]
    s_mov_b32 s75, 187392
    buffer_load_dwordx4 v247, s[32:35], s75 offen offset:3072 lds
    v_mfma_f32_16x16x32_bf16 v[168:171], a[92:95], v[40:43], v[168:171]
    v_mfma_f32_16x16x32_bf16 v[192:195], a[92:95], v[44:47], v[192:195]
    v_mfma_f32_16x16x32_bf16 v[72:75], a[92:95], v[48:51], v[72:75]
    s_waitcnt vmcnt(10)
    ds_read_b64_tr_b16 a[136:137], v251 offset:2048
    ds_read_b64_tr_b16 a[138:139], v251 offset:2304
    v_mfma_f32_16x16x32_bf16 v[148:151], a[96:99], v[4:7], v[148:151]
    ds_read_b64_tr_b16 a[140:141], v251 offset:2056
    ds_read_b64_tr_b16 a[142:143], v251 offset:2312
    v_mfma_f32_16x16x32_bf16 v[172:175], a[96:99], v[8:11], v[172:175]
    ds_read_b64_tr_b16 a[120:121], v249 offset:8192
    ds_read_b64_tr_b16 a[122:123], v249 offset:8704
    v_mfma_f32_16x16x32_bf16 v[52:55], a[96:99], v[12:15], v[52:55]
    ds_read_b64_tr_b16 a[124:125], v249 offset:8200
    ds_read_b64_tr_b16 a[126:127], v249 offset:8712
    v_mfma_f32_16x16x32_bf16 v[152:155], a[100:103], v[4:7], v[152:155]
    ds_read_b64_tr_b16 a[128:129], v250 offset:8192
    ds_read_b64_tr_b16 a[130:131], v250 offset:8704
    v_mfma_f32_16x16x32_bf16 v[176:179], a[100:103], v[8:11], v[176:179]
    ds_read_b64_tr_b16 a[132:133], v250 offset:8200
    ds_read_b64_tr_b16 a[134:135], v250 offset:8712
    v_mfma_f32_16x16x32_bf16 v[56:59], a[100:103], v[12:15], v[56:59]
    ds_read_b128 v[16:19], v241 offset:37120
    ds_read_b128 v[20:23], v241 offset:49408
    s_waitcnt lgkmcnt(10)
    s_add_u32 m0, s71, 2048
    s_mov_b32 s76, 172032
    buffer_load_dwordx4 v248, s[32:35], s76 offen lds
    v_mfma_f32_16x16x32_bf16 v[156:159], a[104:107], v[4:7], v[156:159]
    ds_read_b128 v[24:27], v241 offset:61696
    v_mfma_f32_16x16x32_bf16 v[180:183], a[104:107], v[8:11], v[180:183]
    s_mov_b32 s77, 183296
    buffer_load_dwordx4 v248, s[32:35], s77 offen offset:1024 lds
    v_mfma_f32_16x16x32_bf16 v[60:63], a[104:107], v[12:15], v[60:63]
    v_mfma_f32_16x16x32_bf16 v[160:163], a[108:111], v[4:7], v[160:163]
    v_mfma_f32_16x16x32_bf16 v[184:187], a[108:111], v[8:11], v[184:187]
    v_mfma_f32_16x16x32_bf16 v[64:67], a[108:111], v[12:15], v[64:67]
    s_waitcnt lgkmcnt(0)
    s_add_u32 m0, s70, 8192
    s_mov_b32 s74, 196608
    buffer_load_dwordx4 v247, s[32:35], s74 offen lds
    v_mfma_f32_16x16x32_bf16 v[164:167], a[112:115], v[4:7], v[164:167]
    s_mov_b32 s75, 201728
    buffer_load_dwordx4 v247, s[32:35], s75 offen offset:1024 lds
    v_mfma_f32_16x16x32_bf16 v[188:191], a[112:115], v[8:11], v[188:191]
    s_mov_b32 s76, 206848
    buffer_load_dwordx4 v247, s[32:35], s76 offen offset:2048 lds
    v_mfma_f32_16x16x32_bf16 v[68:71], a[112:115], v[12:15], v[68:71]
    s_mov_b32 s77, 211968
    buffer_load_dwordx4 v247, s[32:35], s77 offen offset:3072 lds
    v_mfma_f32_16x16x32_bf16 v[168:171], a[116:119], v[4:7], v[168:171]
    v_mfma_f32_16x16x32_bf16 v[192:195], a[116:119], v[8:11], v[192:195]
    v_mfma_f32_16x16x32_bf16 v[72:75], a[116:119], v[12:15], v[72:75]
    s_waitcnt vmcnt(10)
    ds_read_b64_tr_b16 a[160:161], v251 offset:0
    ds_read_b64_tr_b16 a[162:163], v251 offset:256
    v_mfma_f32_16x16x32_bf16 v[148:151], a[120:123], v[16:19], v[148:151]
    ds_read_b64_tr_b16 a[164:165], v251 offset:8
    ds_read_b64_tr_b16 a[166:167], v251 offset:264
    v_mfma_f32_16x16x32_bf16 v[172:175], a[120:123], v[20:23], v[172:175]
    ds_read_b64_tr_b16 a[144:145], v249 offset:0
    ds_read_b64_tr_b16 a[146:147], v249 offset:512
    v_mfma_f32_16x16x32_bf16 v[52:55], a[120:123], v[24:27], v[52:55]
    ds_read_b64_tr_b16 a[148:149], v249 offset:8
    ds_read_b64_tr_b16 a[150:151], v249 offset:520
    v_mfma_f32_16x16x32_bf16 v[152:155], a[124:127], v[16:19], v[152:155]
    ds_read_b64_tr_b16 a[152:153], v250 offset:0
    ds_read_b64_tr_b16 a[154:155], v250 offset:512
    v_mfma_f32_16x16x32_bf16 v[176:179], a[124:127], v[20:23], v[176:179]
    ds_read_b64_tr_b16 a[156:157], v250 offset:8
    ds_read_b64_tr_b16 a[158:159], v250 offset:520
    v_mfma_f32_16x16x32_bf16 v[56:59], a[124:127], v[24:27], v[56:59]
    ds_read_b128 v[28:31], v242 offset:37120
    ds_read_b128 v[32:35], v242 offset:49408
    s_waitcnt lgkmcnt(10)
    s_add_u32 m0, s71, 0
    s_mov_b32 s74, 196608
    buffer_load_dwordx4 v248, s[32:35], s74 offen lds
    v_mfma_f32_16x16x32_bf16 v[156:159], a[128:131], v[16:19], v[156:159]
    ds_read_b128 v[36:39], v242 offset:61696
    v_mfma_f32_16x16x32_bf16 v[180:183], a[128:131], v[20:23], v[180:183]
    s_mov_b32 s75, 207872
    buffer_load_dwordx4 v248, s[32:35], s75 offen offset:1024 lds
    v_mfma_f32_16x16x32_bf16 v[60:63], a[128:131], v[24:27], v[60:63]
    v_mfma_f32_16x16x32_bf16 v[160:163], a[132:135], v[16:19], v[160:163]
    v_mfma_f32_16x16x32_bf16 v[184:187], a[132:135], v[20:23], v[184:187]
    v_mfma_f32_16x16x32_bf16 v[64:67], a[132:135], v[24:27], v[64:67]
    s_waitcnt lgkmcnt(0)
    s_add_u32 m0, s70, 0
    s_mov_b32 s76, 221184
    buffer_load_dwordx4 v247, s[32:35], s76 offen lds
    v_mfma_f32_16x16x32_bf16 v[164:167], a[136:139], v[16:19], v[164:167]
    s_mov_b32 s77, 226304
    buffer_load_dwordx4 v247, s[32:35], s77 offen offset:1024 lds
    v_mfma_f32_16x16x32_bf16 v[188:191], a[136:139], v[20:23], v[188:191]
    s_mov_b32 s74, 231424
    buffer_load_dwordx4 v247, s[32:35], s74 offen offset:2048 lds
    v_mfma_f32_16x16x32_bf16 v[68:71], a[136:139], v[24:27], v[68:71]
    s_mov_b32 s75, 236544
    buffer_load_dwordx4 v247, s[32:35], s75 offen offset:3072 lds
    v_mfma_f32_16x16x32_bf16 v[168:171], a[140:143], v[16:19], v[168:171]
    v_mfma_f32_16x16x32_bf16 v[192:195], a[140:143], v[20:23], v[192:195]
    v_mfma_f32_16x16x32_bf16 v[72:75], a[140:143], v[24:27], v[72:75]
    s_waitcnt vmcnt(10)
    ds_read_b64_tr_b16 a[184:185], v251 offset:2048
    ds_read_b64_tr_b16 a[186:187], v251 offset:2304
    v_mfma_f32_16x16x32_bf16 v[148:151], a[144:147], v[28:31], v[148:151]
    ds_read_b64_tr_b16 a[188:189], v251 offset:2056
    ds_read_b64_tr_b16 a[190:191], v251 offset:2312
    v_mfma_f32_16x16x32_bf16 v[172:175], a[144:147], v[32:35], v[172:175]
    ds_read_b64_tr_b16 a[168:169], v249 offset:4096
    ds_read_b64_tr_b16 a[170:171], v249 offset:4608
    v_mfma_f32_16x16x32_bf16 v[52:55], a[144:147], v[36:39], v[52:55]
    ds_read_b64_tr_b16 a[172:173], v249 offset:4104
    ds_read_b64_tr_b16 a[174:175], v249 offset:4616
    v_mfma_f32_16x16x32_bf16 v[152:155], a[148:151], v[28:31], v[152:155]
    ds_read_b64_tr_b16 a[176:177], v250 offset:4096
    ds_read_b64_tr_b16 a[178:179], v250 offset:4608
    v_mfma_f32_16x16x32_bf16 v[176:179], a[148:151], v[32:35], v[176:179]
    ds_read_b64_tr_b16 a[180:181], v250 offset:4104
    ds_read_b64_tr_b16 a[182:183], v250 offset:4616
    v_mfma_f32_16x16x32_bf16 v[56:59], a[148:151], v[36:39], v[56:59]
    ds_read_b128 v[40:43], v243 offset:37120
    ds_read_b128 v[44:47], v243 offset:49408
    s_waitcnt lgkmcnt(10)
    s_add_u32 m0, s71, 2048
    s_mov_b32 s76, 221184
    buffer_load_dwordx4 v248, s[32:35], s76 offen lds
    v_mfma_f32_16x16x32_bf16 v[156:159], a[152:155], v[28:31], v[156:159]
    ds_read_b128 v[48:51], v243 offset:61696
    v_mfma_f32_16x16x32_bf16 v[180:183], a[152:155], v[32:35], v[180:183]
    s_mov_b32 s77, 232448
    buffer_load_dwordx4 v248, s[32:35], s77 offen offset:1024 lds
    v_mfma_f32_16x16x32_bf16 v[60:63], a[152:155], v[36:39], v[60:63]
    v_mfma_f32_16x16x32_bf16 v[160:163], a[156:159], v[28:31], v[160:163]
    v_mfma_f32_16x16x32_bf16 v[184:187], a[156:159], v[32:35], v[184:187]
    v_mfma_f32_16x16x32_bf16 v[64:67], a[156:159], v[36:39], v[64:67]
    s_waitcnt lgkmcnt(0)
    s_add_u32 m0, s70, 4096
    s_mov_b32 s74, 245760
    buffer_load_dwordx4 v247, s[32:35], s74 offen lds
    v_mfma_f32_16x16x32_bf16 v[164:167], a[160:163], v[28:31], v[164:167]
    s_mov_b32 s75, 250880
    buffer_load_dwordx4 v247, s[32:35], s75 offen offset:1024 lds
    v_mfma_f32_16x16x32_bf16 v[188:191], a[160:163], v[32:35], v[188:191]
    s_mov_b32 s76, 256000
    buffer_load_dwordx4 v247, s[32:35], s76 offen offset:2048 lds
    v_mfma_f32_16x16x32_bf16 v[68:71], a[160:163], v[36:39], v[68:71]
    s_mov_b32 s77, 261120
    buffer_load_dwordx4 v247, s[32:35], s77 offen offset:3072 lds
    v_mfma_f32_16x16x32_bf16 v[168:171], a[164:167], v[28:31], v[168:171]
    v_mfma_f32_16x16x32_bf16 v[192:195], a[164:167], v[32:35], v[192:195]
    v_mfma_f32_16x16x32_bf16 v[72:75], a[164:167], v[36:39], v[72:75]
    s_waitcnt vmcnt(10)
    ds_read_b64_tr_b16 a[208:209], v251 offset:0
    ds_read_b64_tr_b16 a[210:211], v251 offset:256
    v_mfma_f32_16x16x32_bf16 v[148:151], a[168:171], v[40:43], v[148:151]
    ds_read_b64_tr_b16 a[212:213], v251 offset:8
    ds_read_b64_tr_b16 a[214:215], v251 offset:264
    v_mfma_f32_16x16x32_bf16 v[172:175], a[168:171], v[44:47], v[172:175]
    ds_read_b64_tr_b16 a[192:193], v249 offset:8192
    ds_read_b64_tr_b16 a[194:195], v249 offset:8704
    v_mfma_f32_16x16x32_bf16 v[52:55], a[168:171], v[48:51], v[52:55]
    ds_read_b64_tr_b16 a[196:197], v249 offset:8200
    ds_read_b64_tr_b16 a[198:199], v249 offset:8712
    v_mfma_f32_16x16x32_bf16 v[152:155], a[172:175], v[40:43], v[152:155]
    ds_read_b64_tr_b16 a[200:201], v250 offset:8192
    ds_read_b64_tr_b16 a[202:203], v250 offset:8704
    v_mfma_f32_16x16x32_bf16 v[176:179], a[172:175], v[44:47], v[176:179]
    ds_read_b64_tr_b16 a[204:205], v250 offset:8200
    ds_read_b64_tr_b16 a[206:207], v250 offset:8712
    v_mfma_f32_16x16x32_bf16 v[56:59], a[172:175], v[48:51], v[56:59]
    ds_read_b128 v[4:7], v240 offset:37376
    ds_read_b128 v[8:11], v240 offset:49664
    s_waitcnt lgkmcnt(10)
    s_add_u32 m0, s71, 0
    s_mov_b32 s74, 245760
    buffer_load_dwordx4 v248, s[32:35], s74 offen lds
    v_mfma_f32_16x16x32_bf16 v[156:159], a[176:179], v[40:43], v[156:159]
    ds_read_b128 v[12:15], v240 offset:61952
    v_mfma_f32_16x16x32_bf16 v[180:183], a[176:179], v[44:47], v[180:183]
    s_mov_b32 s75, 257024
    buffer_load_dwordx4 v248, s[32:35], s75 offen offset:1024 lds
    v_mfma_f32_16x16x32_bf16 v[60:63], a[176:179], v[48:51], v[60:63]
    v_mfma_f32_16x16x32_bf16 v[160:163], a[180:183], v[40:43], v[160:163]
    v_mfma_f32_16x16x32_bf16 v[184:187], a[180:183], v[44:47], v[184:187]
    v_mfma_f32_16x16x32_bf16 v[64:67], a[180:183], v[48:51], v[64:67]
    s_waitcnt lgkmcnt(0)
    s_add_u32 m0, s70, 8192
    s_mov_b32 s76, 270336
    buffer_load_dwordx4 v247, s[32:35], s76 offen lds
    v_mfma_f32_16x16x32_bf16 v[164:167], a[184:187], v[40:43], v[164:167]
    s_mov_b32 s77, 275456
    buffer_load_dwordx4 v247, s[32:35], s77 offen offset:1024 lds
    v_mfma_f32_16x16x32_bf16 v[188:191], a[184:187], v[44:47], v[188:191]
    s_mov_b32 s74, 280576
    buffer_load_dwordx4 v247, s[32:35], s74 offen offset:2048 lds
    v_mfma_f32_16x16x32_bf16 v[68:71], a[184:187], v[48:51], v[68:71]
    s_mov_b32 s75, 285696
    buffer_load_dwordx4 v247, s[32:35], s75 offen offset:3072 lds
    v_mfma_f32_16x16x32_bf16 v[168:171], a[188:191], v[40:43], v[168:171]
    v_mfma_f32_16x16x32_bf16 v[192:195], a[188:191], v[44:47], v[192:195]
    v_mfma_f32_16x16x32_bf16 v[72:75], a[188:191], v[48:51], v[72:75]
    s_waitcnt vmcnt(10)
    ds_read_b64_tr_b16 a[232:233], v251 offset:2048
    ds_read_b64_tr_b16 a[234:235], v251 offset:2304
    v_mfma_f32_16x16x32_bf16 v[148:151], a[192:195], v[4:7], v[148:151]
    ds_read_b64_tr_b16 a[236:237], v251 offset:2056
    ds_read_b64_tr_b16 a[238:239], v251 offset:2312
    v_mfma_f32_16x16x32_bf16 v[172:175], a[192:195], v[8:11], v[172:175]
    ds_read_b64_tr_b16 a[216:217], v249 offset:0
    ds_read_b64_tr_b16 a[218:219], v249 offset:512
    v_mfma_f32_16x16x32_bf16 v[52:55], a[192:195], v[12:15], v[52:55]
    ds_read_b64_tr_b16 a[220:221], v249 offset:8
    ds_read_b64_tr_b16 a[222:223], v249 offset:520
    v_mfma_f32_16x16x32_bf16 v[152:155], a[196:199], v[4:7], v[152:155]
    ds_read_b64_tr_b16 a[224:225], v250 offset:0
    ds_read_b64_tr_b16 a[226:227], v250 offset:512
    v_mfma_f32_16x16x32_bf16 v[176:179], a[196:199], v[8:11], v[176:179]
    ds_read_b64_tr_b16 a[228:229], v250 offset:8
    ds_read_b64_tr_b16 a[230:231], v250 offset:520
    v_mfma_f32_16x16x32_bf16 v[56:59], a[196:199], v[12:15], v[56:59]
    ds_read_b128 v[16:19], v241 offset:37376
    ds_read_b128 v[20:23], v241 offset:49664
    s_waitcnt lgkmcnt(10)
    s_add_u32 m0, s71, 2048
    s_mov_b32 s76, 270336
    buffer_load_dwordx4 v248, s[32:35], s76 offen lds
    v_mfma_f32_16x16x32_bf16 v[156:159], a[200:203], v[4:7], v[156:159]
    ds_read_b128 v[24:27], v241 offset:61952
    v_mfma_f32_16x16x32_bf16 v[180:183], a[200:203], v[8:11], v[180:183]
    s_mov_b32 s77, 281600
    buffer_load_dwordx4 v248, s[32:35], s77 offen offset:1024 lds
    v_mfma_f32_16x16x32_bf16 v[60:63], a[200:203], v[12:15], v[60:63]
    s_add_u32 s74, s2, 0
    s_and_b32 s74, s74, 255
    s_add_u32 s74, s74, 0
    v_mfma_f32_16x16x32_bf16 v[160:163], a[204:207], v[4:7], v[160:163]
    s_mul_i32 s74, s74, 12288
    s_or_b32 s74, s74, s62
    s_add_u32 m0, s63, 122880
    v_mfma_f32_16x16x32_bf16 v[184:187], a[204:207], v[8:11], v[184:187]
    buffer_load_dwordx4 v244, s[24:27], s74 offen nt lds
    v_mfma_f32_16x16x32_bf16 v[64:67], a[204:207], v[12:15], v[64:67]
    s_waitcnt lgkmcnt(0)
    buffer_load_dwordx4 v245, s[24:27], s74 offen offset:1024 nt lds
    v_mfma_f32_16x16x32_bf16 v[164:167], a[208:211], v[4:7], v[164:167]
    buffer_load_dwordx4 v246, s[24:27], s74 offen offset:2048 nt lds
    v_mfma_f32_16x16x32_bf16 v[188:191], a[208:211], v[8:11], v[188:191]
    s_add_u32 s75, s2, 43
    s_and_b32 s75, s75, 255
    s_add_u32 s75, s75, 256
    s_mul_i32 s75, s75, 12288
    s_or_b32 s75, s75, s62
    s_add_u32 m0, s63, 135168
    v_mfma_f32_16x16x32_bf16 v[68:71], a[208:211], v[12:15], v[68:71]
    buffer_load_dwordx4 v244, s[24:27], s75 offen nt lds
    v_mfma_f32_16x16x32_bf16 v[168:171], a[212:215], v[4:7], v[168:171]
    buffer_load_dwordx4 v245, s[24:27], s75 offen offset:1024 nt lds
    v_mfma_f32_16x16x32_bf16 v[192:195], a[212:215], v[8:11], v[192:195]
    buffer_load_dwordx4 v246, s[24:27], s75 offen offset:2048 nt lds
    v_mfma_f32_16x16x32_bf16 v[72:75], a[212:215], v[12:15], v[72:75]
    s_waitcnt vmcnt(12)
    ds_read_b64_tr_b16 v[196:197], v251 offset:0
    ds_read_b64_tr_b16 v[198:199], v251 offset:256
    v_mfma_f32_16x16x32_bf16 v[148:151], a[216:219], v[16:19], v[148:151]
    ds_read_b64_tr_b16 v[200:201], v251 offset:8
    ds_read_b64_tr_b16 v[202:203], v251 offset:264
    v_mfma_f32_16x16x32_bf16 v[172:175], a[216:219], v[20:23], v[172:175]
    ds_read_b64_tr_b16 a[240:241], v249 offset:4096
    ds_read_b64_tr_b16 a[242:243], v249 offset:4608
    v_mfma_f32_16x16x32_bf16 v[52:55], a[216:219], v[24:27], v[52:55]
    ds_read_b64_tr_b16 a[244:245], v249 offset:4104
    ds_read_b64_tr_b16 a[246:247], v249 offset:4616
    v_mfma_f32_16x16x32_bf16 v[152:155], a[220:223], v[16:19], v[152:155]
    ds_read_b64_tr_b16 a[248:249], v250 offset:4096
    ds_read_b64_tr_b16 a[250:251], v250 offset:4608
    v_mfma_f32_16x16x32_bf16 v[176:179], a[220:223], v[20:23], v[176:179]
    ds_read_b64_tr_b16 a[252:253], v250 offset:4104
    ds_read_b64_tr_b16 a[254:255], v250 offset:4616
    v_mfma_f32_16x16x32_bf16 v[56:59], a[220:223], v[24:27], v[56:59]
    ds_read_b128 v[28:31], v242 offset:37376
    ds_read_b128 v[32:35], v242 offset:49664
    s_add_u32 s76, s2, 86
    s_and_b32 s76, s76, 255
    v_mfma_f32_16x16x32_bf16 v[156:159], a[224:227], v[16:19], v[156:159]
    ds_read_b128 v[36:39], v242 offset:61952
    s_add_u32 s76, s76, 512
    s_mul_i32 s76, s76, 12288
    v_mfma_f32_16x16x32_bf16 v[180:183], a[224:227], v[20:23], v[180:183]
    s_or_b32 s76, s76, s62
    s_add_u32 m0, s64, 12288
    v_mfma_f32_16x16x32_bf16 v[60:63], a[224:227], v[24:27], v[60:63]
    buffer_load_dwordx4 v244, s[24:27], s76 offen nt lds
    v_mfma_f32_16x16x32_bf16 v[160:163], a[228:231], v[16:19], v[160:163]
    buffer_load_dwordx4 v245, s[24:27], s76 offen offset:1024 nt lds
    v_mfma_f32_16x16x32_bf16 v[184:187], a[228:231], v[20:23], v[184:187]
    buffer_load_dwordx4 v246, s[24:27], s76 offen offset:2048 nt lds
    v_mfma_f32_16x16x32_bf16 v[64:67], a[228:231], v[24:27], v[64:67]
    s_waitcnt lgkmcnt(0)
    s_add_u32 s77, s2, 129
    s_and_b32 s77, s77, 255
    v_mfma_f32_16x16x32_bf16 v[164:167], a[232:235], v[16:19], v[164:167]
    s_add_u32 s77, s77, 768
    s_mul_i32 s77, s77, 12288
    v_mfma_f32_16x16x32_bf16 v[188:191], a[232:235], v[20:23], v[188:191]
    s_or_b32 s77, s77, s62
    s_add_u32 m0, s64, 24576
    v_mfma_f32_16x16x32_bf16 v[68:71], a[232:235], v[24:27], v[68:71]
    buffer_load_dwordx4 v244, s[24:27], s77 offen nt lds
    v_mfma_f32_16x16x32_bf16 v[168:171], a[236:239], v[16:19], v[168:171]
    buffer_load_dwordx4 v245, s[24:27], s77 offen offset:1024 nt lds
    v_mfma_f32_16x16x32_bf16 v[192:195], a[236:239], v[20:23], v[192:195]
    buffer_load_dwordx4 v246, s[24:27], s77 offen offset:2048 nt lds
    v_mfma_f32_16x16x32_bf16 v[72:75], a[236:239], v[24:27], v[72:75]
    s_waitcnt vmcnt(12)
    ds_read_b64_tr_b16 v[220:221], v251 offset:2048
    ds_read_b64_tr_b16 v[222:223], v251 offset:2304
    v_mfma_f32_16x16x32_bf16 v[148:151], a[240:243], v[28:31], v[148:151]
    ds_read_b64_tr_b16 v[224:225], v251 offset:2056
    ds_read_b64_tr_b16 v[226:227], v251 offset:2312
    v_mfma_f32_16x16x32_bf16 v[172:175], a[240:243], v[32:35], v[172:175]
    ds_read_b64_tr_b16 v[204:205], v249 offset:8192
    ds_read_b64_tr_b16 v[206:207], v249 offset:8704
    v_mfma_f32_16x16x32_bf16 v[52:55], a[240:243], v[36:39], v[52:55]
    ds_read_b64_tr_b16 v[208:209], v249 offset:8200
    ds_read_b64_tr_b16 v[210:211], v249 offset:8712
    v_mfma_f32_16x16x32_bf16 v[152:155], a[244:247], v[28:31], v[152:155]
    ds_read_b64_tr_b16 v[212:213], v250 offset:8192
    ds_read_b64_tr_b16 v[214:215], v250 offset:8704
    v_mfma_f32_16x16x32_bf16 v[176:179], a[244:247], v[32:35], v[176:179]
    ds_read_b64_tr_b16 v[216:217], v250 offset:8200
    ds_read_b64_tr_b16 v[218:219], v250 offset:8712
    v_mfma_f32_16x16x32_bf16 v[56:59], a[244:247], v[36:39], v[56:59]
    ds_read_b128 v[40:43], v243 offset:37376
    ds_read_b128 v[44:47], v243 offset:49664
    s_add_u32 s74, s2, 172
    s_and_b32 s74, s74, 255
    v_mfma_f32_16x16x32_bf16 v[156:159], a[248:251], v[28:31], v[156:159]
    ds_read_b128 v[48:51], v243 offset:61952
    s_add_u32 s74, s74, 1024
    s_mul_i32 s74, s74, 12288
    v_mfma_f32_16x16x32_bf16 v[180:183], a[248:251], v[32:35], v[180:183]
    s_or_b32 s74, s74, s62
    s_add_u32 m0, s64, 36864
    v_mfma_f32_16x16x32_bf16 v[60:63], a[248:251], v[36:39], v[60:63]
    buffer_load_dwordx4 v244, s[24:27], s74 offen nt lds
    v_mfma_f32_16x16x32_bf16 v[160:163], a[252:255], v[28:31], v[160:163]
    buffer_load_dwordx4 v245, s[24:27], s74 offen offset:1024 nt lds
    v_mfma_f32_16x16x32_bf16 v[184:187], a[252:255], v[32:35], v[184:187]
    buffer_load_dwordx4 v246, s[24:27], s74 offen offset:2048 nt lds
    v_mfma_f32_16x16x32_bf16 v[64:67], a[252:255], v[36:39], v[64:67]
    s_waitcnt lgkmcnt(0)
    s_add_u32 s75, s2, 215
    s_and_b32 s75, s75, 255
    v_mfma_f32_16x16x32_bf16 v[164:167], v[196:199], v[28:31], v[164:167]
    s_add_u32 s75, s75, 1280
    s_mul_i32 s75, s75, 12288
    v_mfma_f32_16x16x32_bf16 v[188:191], v[196:199], v[32:35], v[188:191]
    s_or_b32 s75, s75, s62
    s_add_u32 m0, s63, 98304
    v_mfma_f32_16x16x32_bf16 v[68:71], v[196:199], v[36:39], v[68:71]
    buffer_load_dwordx4 v244, s[24:27], s75 offen nt lds
    v_mfma_f32_16x16x32_bf16 v[168:171], v[200:203], v[28:31], v[168:171]
    buffer_load_dwordx4 v245, s[24:27], s75 offen offset:1024 nt lds
    v_mfma_f32_16x16x32_bf16 v[192:195], v[200:203], v[32:35], v[192:195]
    buffer_load_dwordx4 v246, s[24:27], s75 offen offset:2048 nt lds
    v_mfma_f32_16x16x32_bf16 v[72:75], v[200:203], v[36:39], v[72:75]
    v_mfma_f32_16x16x32_bf16 v[148:151], v[204:207], v[40:43], v[148:151]
    v_mfma_f32_16x16x32_bf16 v[172:175], v[204:207], v[44:47], v[172:175]
    s_cmp_lg_u32 s61, 2
    s_cbranch_scc1 L_nb
    s_barrier
    ds_read_b128 v[4:7], v228 offset:24576
    ds_read_b128 v[8:11], v228 offset:36864
    ds_read_b128 v[12:15], v240 offset:24576
    ds_read_b128 v[16:19], v229 offset:24576
    ds_read_b128 v[20:23], v229 offset:36864
    ds_read_b128 v[24:27], v241 offset:24576
L_nb:
    v_mfma_f32_16x16x32_bf16 v[52:55], v[204:207], v[48:51], v[52:55]
    v_mfma_f32_16x16x32_bf16 v[152:155], v[208:211], v[40:43], v[152:155]
    v_mfma_f32_16x16x32_bf16 v[176:179], v[208:211], v[44:47], v[176:179]
    v_mfma_f32_16x16x32_bf16 v[56:59], v[208:211], v[48:51], v[56:59]
    v_mfma_f32_16x16x32_bf16 v[156:159], v[212:215], v[40:43], v[156:159]
    v_mfma_f32_16x16x32_bf16 v[180:183], v[212:215], v[44:47], v[180:183]
    v_mfma_f32_16x16x32_bf16 v[60:63], v[212:215], v[48:51], v[60:63]
    v_mfma_f32_16x16x32_bf16 v[160:163], v[216:219], v[40:43], v[160:163]
    v_mfma_f32_16x16x32_bf16 v[184:187], v[216:219], v[44:47], v[184:187]
    v_mfma_f32_16x16x32_bf16 v[64:67], v[216:219], v[48:51], v[64:67]
    v_mfma_f32_16x16x32_bf16 v[164:167], v[220:223], v[40:43], v[164:167]
    v_mfma_f32_16x16x32_bf16 v[188:191], v[220:223], v[44:47], v[188:191]
    v_mfma_f32_16x16x32_bf16 v[68:71], v[220:223], v[48:51], v[68:71]
    v_mfma_f32_16x16x32_bf16 v[168:171], v[224:227], v[40:43], v[168:171]
    v_mfma_f32_16x16x32_bf16 v[192:195], v[224:227], v[44:47], v[192:195]
    v_mfma_f32_16x16x32_bf16 v[72:75], v[224:227], v[48:51], v[72:75]
    s_cmp_eq_u32 s61, 2
    s_cbranch_scc1 L_pass2t
    s_cmp_eq_u32 s61, 0
    s_cbranch_scc1 L_prod
    v_add_u32 v240, 73728, v228
    v_add_u32 v241, 73728, v229
    v_add_u32 v242, 73728, v230
    v_add_u32 v243, 73728, v231
    s_waitcnt vmcnt(9)
L_prod_ret:
    s_barrier
    ds_read_b128 v[4:7], v240 offset:49152
    ds_read_b128 v[8:11], v240 offset:61440
    ds_read_b128 v[12:15], v228 offset:12288
    ds_read_b128 v[16:19], v241 offset:49152
    ds_read_b128 v[20:23], v241 offset:61440
    ds_read_b128 v[24:27], v229 offset:12288
    s_waitcnt lgkmcnt(0)
    v_mfma_f32_16x16x32_bf16 v[148:151], a[0:3], v[4:7], 0
    v_mfma_f32_16x16x32_bf16 v[148:151], a[24:27], v[16:19], v[148:151]
    v_mfma_f32_16x16x32_bf16 v[172:175], a[0:3], v[8:11], 0
    ds_read_b128 v[28:31], v242 offset:49152
    v_mfma_f32_16x16x32_bf16 v[172:175], a[24:27], v[20:23], v[172:175]
    v_mfma_f32_16x16x32_bf16 v[52:55], a[0:3], v[12:15], 0
    v_mfma_f32_16x16x32_bf16 v[52:55], a[24:27], v[24:27], v[52:55]
    v_mfma_f32_16x16x32_bf16 v[152:155], a[4:7], v[4:7], 0
    ds_read_b128 v[32:35], v242 offset:61440
    s_add_u32 s76, s84, 0
    s_add_u32 m0, s49, 49152
    v_mfma_f32_16x16x32_bf16 v[152:155], a[28:31], v[16:19], v[152:155]
    buffer_load_dwordx4 v232, s[20:23], s76 offen nt lds
    v_mfma_f32_16x16x32_bf16 v[176:179], a[4:7], v[8:11], 0
    v_mfma_f32_16x16x32_bf16 v[176:179], a[28:31], v[20:23], v[176:179]
    v_mfma_f32_16x16x32_bf16 v[56:59], a[4:7], v[12:15], 0
    ds_read_b128 v[36:39], v230 offset:12288
    buffer_load_dwordx4 v233, s[20:23], s76 offen offset:1024 nt lds
    v_mfma_f32_16x16x32_bf16 v[56:59], a[28:31], v[24:27], v[56:59]
    v_mfma_f32_16x16x32_bf16 v[156:159], a[8:11], v[4:7], 0
    v_mfma_f32_16x16x32_bf16 v[156:159], a[32:35], v[16:19], v[156:159]
    buffer_load_dwordx4 v234, s[20:23], s76 offen offset:2048 nt lds
    v_mfma_f32_16x16x32_bf16 v[180:183], a[8:11], v[8:11], 0
    ds_read_b128 v[40:43], v243 offset:49152
    v_mfma_f32_16x16x32_bf16 v[180:183], a[32:35], v[20:23], v[180:183]
    v_mfma_f32_16x16x32_bf16 v[60:63], a[8:11], v[12:15], 0
    v_mfma_f32_16x16x32_bf16 v[60:63], a[32:35], v[24:27], v[60:63]
    v_mfma_f32_16x16x32_bf16 v[160:163], a[12:15], v[4:7], 0
    ds_read_b128 v[44:47], v243 offset:61440
    v_mfma_f32_16x16x32_bf16 v[160:163], a[36:39], v[16:19], v[160:163]
    v_mfma_f32_16x16x32_bf16 v[184:187], a[12:15], v[8:11], 0
    v_mfma_f32_16x16x32_bf16 v[184:187], a[36:39], v[20:23], v[184:187]
    v_mfma_f32_16x16x32_bf16 v[64:67], a[12:15], v[12:15], 0
    ds_read_b128 v[48:51], v231 offset:12288
    v_mfma_f32_16x16x32_bf16 v[64:67], a[36:39], v[24:27], v[64:67]
    v_mfma_f32_16x16x32_bf16 v[164:167], a[16:19], v[4:7], 0
    v_mfma_f32_16x16x32_bf16 v[164:167], a[40:43], v[16:19], v[164:167]
    v_mfma_f32_16x16x32_bf16 v[188:191], a[16:19], v[8:11], 0
    v_mfma_f32_16x16x32_bf16 v[188:191], a[40:43], v[20:23], v[188:191]
    v_mfma_f32_16x16x32_bf16 v[68:71], a[16:19], v[12:15], 0
    v_mfma_f32_16x16x32_bf16 v[68:71], a[40:43], v[24:27], v[68:71]
    v_mfma_f32_16x16x32_bf16 v[168:171], a[20:23], v[4:7], 0
    s_add_u32 s77, s84, 768
    s_add_u32 m0, s49, 61440
    v_mfma_f32_16x16x32_bf16 v[168:171], a[44:47], v[16:19], v[168:171]
    buffer_load_dwordx4 v232, s[20:23], s77 offen nt lds
    v_mfma_f32_16x16x32_bf16 v[192:195], a[20:23], v[8:11], 0
    v_mfma_f32_16x16x32_bf16 v[192:195], a[44:47], v[20:23], v[192:195]
    v_mfma_f32_16x16x32_bf16 v[72:75], a[20:23], v[12:15], 0
    buffer_load_dwordx4 v233, s[20:23], s77 offen offset:1024 nt lds
    v_mfma_f32_16x16x32_bf16 v[72:75], a[44:47], v[24:27], v[72:75]
    s_waitcnt lgkmcnt(0)
    v_mfma_f32_16x16x32_bf16 v[148:151], a[48:51], v[28:31], v[148:151]
    v_mfma_f32_16x16x32_bf16 v[148:151], a[72:75], v[40:43], v[148:151]
    buffer_load_dwordx4 v234, s[20:23], s77 offen offset:2048 nt lds
    v_mfma_f32_16x16x32_bf16 v[172:175], a[48:51], v[32:35], v[172:175]
    ds_read_b128 v[4:7], v240 offset:49408
    v_mfma_f32_16x16x32_bf16 v[172:175], a[72:75], v[44:47], v[172:175]
    v_mfma_f32_16x16x32_bf16 v[52:55], a[48:51], v[36:39], v[52:55]
    v_mfma_f32_16x16x32_bf16 v[52:55], a[72:75], v[48:51], v[52:55]
    v_mfma_f32_16x16x32_bf16 v[152:155], a[52:55], v[28:31], v[152:155]
    ds_read_b128 v[8:11], v240 offset:61696
    v_mfma_f32_16x16x32_bf16 v[152:155], a[76:79], v[40:43], v[152:155]
    v_mfma_f32_16x16x32_bf16 v[176:179], a[52:55], v[32:35], v[176:179]
    v_mfma_f32_16x16x32_bf16 v[176:179], a[76:79], v[44:47], v[176:179]
    v_mfma_f32_16x16x32_bf16 v[56:59], a[52:55], v[36:39], v[56:59]
    ds_read_b128 v[12:15], v228 offset:12544
    v_mfma_f32_16x16x32_bf16 v[56:59], a[76:79], v[48:51], v[56:59]
    s_cmp_lg_u32 s61, 0
    s_cbranch_scc1 L_pub_done
    s_waitcnt vmcnt(6)
    s_barrier
    s_cmp_lg_u32 s48, 0
    s_cbranch_scc1 L_pub_done
    v_mov_b32 v254, 1
    v_lshlrev_b32 v255, 6, v0
    s_mov_b64 exec, 15
    buffer_atomic_add v254, v255, s[44:47], 0 offen sc1
    s_mov_b64 exec, -1
L_pub_done:
    v_mfma_f32_16x16x32_bf16 v[156:159], a[56:59], v[28:31], v[156:159]
    v_mfma_f32_16x16x32_bf16 v[156:159], a[80:83], v[40:43], v[156:159]
    v_mfma_f32_16x16x32_bf16 v[180:183], a[56:59], v[32:35], v[180:183]
    ds_read_b128 v[16:19], v241 offset:49408
    v_mfma_f32_16x16x32_bf16 v[180:183], a[80:83], v[44:47], v[180:183]
    v_mfma_f32_16x16x32_bf16 v[60:63], a[56:59], v[36:39], v[60:63]
    v_mfma_f32_16x16x32_bf16 v[60:63], a[80:83], v[48:51], v[60:63]
    v_mfma_f32_16x16x32_bf16 v[160:163], a[60:63], v[28:31], v[160:163]
    ds_read_b128 v[20:23], v241 offset:61696
    v_mfma_f32_16x16x32_bf16 v[160:163], a[84:87], v[40:43], v[160:163]
    v_mfma_f32_16x16x32_bf16 v[184:187], a[60:63], v[32:35], v[184:187]
    v_mfma_f32_16x16x32_bf16 v[184:187], a[84:87], v[44:47], v[184:187]
    v_mfma_f32_16x16x32_bf16 v[64:67], a[60:63], v[36:39], v[64:67]
    ds_read_b128 v[24:27], v229 offset:12544
    v_mfma_f32_16x16x32_bf16 v[64:67], a[84:87], v[48:51], v[64:67]
    v_mfma_f32_16x16x32_bf16 v[164:167], a[64:67], v[28:31], v[164:167]
    v_mfma_f32_16x16x32_bf16 v[164:167], a[88:91], v[40:43], v[164:167]
    v_mfma_f32_16x16x32_bf16 v[188:191], a[64:67], v[32:35], v[188:191]
    v_mfma_f32_16x16x32_bf16 v[188:191], a[88:91], v[44:47], v[188:191]
    v_mfma_f32_16x16x32_bf16 v[68:71], a[64:67], v[36:39], v[68:71]
    v_mfma_f32_16x16x32_bf16 v[68:71], a[88:91], v[48:51], v[68:71]
    v_mfma_f32_16x16x32_bf16 v[168:171], a[68:71], v[28:31], v[168:171]
    v_mfma_f32_16x16x32_bf16 v[168:171], a[92:95], v[40:43], v[168:171]
    v_mfma_f32_16x16x32_bf16 v[192:195], a[68:71], v[32:35], v[192:195]
    v_mfma_f32_16x16x32_bf16 v[192:195], a[92:95], v[44:47], v[192:195]
    v_mfma_f32_16x16x32_bf16 v[72:75], a[68:71], v[36:39], v[72:75]
    v_mfma_f32_16x16x32_bf16 v[72:75], a[92:95], v[48:51], v[72:75]
    s_waitcnt lgkmcnt(0)
    v_mfma_f32_16x16x32_bf16 v[148:151], a[96:99], v[4:7], v[148:151]
    v_mfma_f32_16x16x32_bf16 v[148:151], a[120:123], v[16:19], v[148:151]
    v_mfma_f32_16x16x32_bf16 v[172:175], a[96:99], v[8:11], v[172:175]
    ds_read_b128 v[28:31], v242 offset:49408
    v_mfma_f32_16x16x32_bf16 v[172:175], a[120:123], v[20:23], v[172:175]
    v_mfma_f32_16x16x32_bf16 v[52:55], a[96:99], v[12:15], v[52:55]
    v_mfma_f32_16x16x32_bf16 v[52:55], a[120:123], v[24:27], v[52:55]
    v_mfma_f32_16x16x32_bf16 v[152:155], a[100:103], v[4:7], v[152:155]
    ds_read_b128 v[32:35], v242 offset:61696
    v_mfma_f32_16x16x32_bf16 v[152:155], a[124:127], v[16:19], v[152:155]
    v_mfma_f32_16x16x32_bf16 v[176:179], a[100:103], v[8:11], v[176:179]
    v_mfma_f32_16x16x32_bf16 v[176:179], a[124:127], v[20:23], v[176:179]
    v_mfma_f32_16x16x32_bf16 v[56:59], a[100:103], v[12:15], v[56:59]
    ds_read_b128 v[36:39], v230 offset:12544
    v_mfma_f32_16x16x32_bf16 v[56:59], a[124:127], v[24:27], v[56:59]
    v_mfma_f32_16x16x32_bf16 v[156:159], a[104:107], v[4:7], v[156:159]
    v_mfma_f32_16x16x32_bf16 v[156:159], a[128:131], v[16:19], v[156:159]
    v_mfma_f32_16x16x32_bf16 v[180:183], a[104:107], v[8:11], v[180:183]
    ds_read_b128 v[40:43], v243 offset:49408
    v_mfma_f32_16x16x32_bf16 v[180:183], a[128:131], v[20:23], v[180:183]
    v_mfma_f32_16x16x32_bf16 v[60:63], a[104:107], v[12:15], v[60:63]
    v_mfma_f32_16x16x32_bf16 v[60:63], a[128:131], v[24:27], v[60:63]
    v_mfma_f32_16x16x32_bf16 v[160:163], a[108:111], v[4:7], v[160:163]
    ds_read_b128 v[44:47], v243 offset:61696
    v_mfma_f32_16x16x32_bf16 v[160:163], a[132:135], v[16:19], v[160:163]
    v_mfma_f32_16x16x32_bf16 v[184:187], a[108:111], v[8:11], v[184:187]
    v_mfma_f32_16x16x32_bf16 v[184:187], a[132:135], v[20:23], v[184:187]
    v_mfma_f32_16x16x32_bf16 v[64:67], a[108:111], v[12:15], v[64:67]
    ds_read_b128 v[48:51], v231 offset:12544
    v_mfma_f32_16x16x32_bf16 v[64:67], a[132:135], v[24:27], v[64:67]
    v_mfma_f32_16x16x32_bf16 v[164:167], a[112:115], v[4:7], v[164:167]
    v_mfma_f32_16x16x32_bf16 v[164:167], a[136:139], v[16:19], v[164:167]
    v_mfma_f32_16x16x32_bf16 v[188:191], a[112:115], v[8:11], v[188:191]
    v_mfma_f32_16x16x32_bf16 v[188:191], a[136:139], v[20:23], v[188:191]
    v_mfma_f32_16x16x32_bf16 v[68:71], a[112:115], v[12:15], v[68:71]
    v_mfma_f32_16x16x32_bf16 v[68:71], a[136:139], v[24:27], v[68:71]
    v_mfma_f32_16x16x32_bf16 v[168:171], a[116:119], v[4:7], v[168:171]
    v_mfma_f32_16x16x32_bf16 v[168:171], a[140:143], v[16:19], v[168:171]
    v_mfma_f32_16x16x32_bf16 v[192:195], a[116:119], v[8:11], v[192:195]
    v_mfma_f32_16x16x32_bf16 v[192:195], a[140:143], v[20:23], v[192:195]
    v_mfma_f32_16x16x32_bf16 v[72:75], a[116:119], v[12:15], v[72:75]
    v_mfma_f32_16x16x32_bf16 v[72:75], a[140:143], v[24:27], v[72:75]
    s_waitcnt lgkmcnt(0)
    v_mfma_f32_16x16x32_bf16 v[148:151], a[144:147], v[28:31], v[148:151]
    v_mfma_f32_16x16x32_bf16 v[148:151], a[168:171], v[40:43], v[148:151]
    v_mfma_f32_16x16x32_bf16 v[172:175], a[144:147], v[32:35], v[172:175]
    ds_read_b128 v[4:7], v240 offset:49664
    v_mfma_f32_16x16x32_bf16 v[172:175], a[168:171], v[44:47], v[172:175]
    v_mfma_f32_16x16x32_bf16 v[52:55], a[144:147], v[36:39], v[52:55]
    v_mfma_f32_16x16x32_bf16 v[52:55], a[168:171], v[48:51], v[52:55]
    v_mfma_f32_16x16x32_bf16 v[152:155], a[148:151], v[28:31], v[152:155]
    ds_read_b128 v[8:11], v240 offset:61952
    v_mfma_f32_16x16x32_bf16 v[152:155], a[172:175], v[40:43], v[152:155]
    v_mfma_f32_16x16x32_bf16 v[176:179], a[148:151], v[32:35], v[176:179]
    v_mfma_f32_16x16x32_bf16 v[176:179], a[172:175], v[44:47], v[176:179]
    v_mfma_f32_16x16x32_bf16 v[56:59], a[148:151], v[36:39], v[56:59]
    ds_read_b128 v[12:15], v228 offset:12800
    v_mfma_f32_16x16x32_bf16 v[56:59], a[172:175], v[48:51], v[56:59]
    v_mfma_f32_16x16x32_bf16 v[156:159], a[152:155], v[28:31], v[156:159]
    v_mfma_f32_16x16x32_bf16 v[156:159], a[176:179], v[40:43], v[156:159]
    v_mfma_f32_16x16x32_bf16 v[180:183], a[152:155], v[32:35], v[180:183]
    ds_read_b128 v[16:19], v241 offset:49664
    v_mfma_f32_16x16x32_bf16 v[180:183], a[176:179], v[44:47], v[180:183]
    v_mfma_f32_16x16x32_bf16 v[60:63], a[152:155], v[36:39], v[60:63]
    v_mfma_f32_16x16x32_bf16 v[60:63], a[176:179], v[48:51], v[60:63]
    v_mfma_f32_16x16x32_bf16 v[160:163], a[156:159], v[28:31], v[160:163]
    ds_read_b128 v[20:23], v241 offset:61952
    v_mfma_f32_16x16x32_bf16 v[160:163], a[180:183], v[40:43], v[160:163]
    v_mfma_f32_16x16x32_bf16 v[184:187], a[156:159], v[32:35], v[184:187]
    v_mfma_f32_16x16x32_bf16 v[184:187], a[180:183], v[44:47], v[184:187]
    v_mfma_f32_16x16x32_bf16 v[64:67], a[156:159], v[36:39], v[64:67]
    ds_read_b128 v[24:27], v229 offset:12800
    v_mfma_f32_16x16x32_bf16 v[64:67], a[180:183], v[48:51], v[64:67]
    v_mfma_f32_16x16x32_bf16 v[164:167], a[160:163], v[28:31], v[164:167]
    v_mfma_f32_16x16x32_bf16 v[164:167], a[184:187], v[40:43], v[164:167]
    v_mfma_f32_16x16x32_bf16 v[188:191], a[160:163], v[32:35], v[188:191]
    v_mfma_f32_16x16x32_bf16 v[188:191], a[184:187], v[44:47], v[188:191]
    v_mfma_f32_16x16x32_bf16 v[68:71], a[160:163], v[36:39], v[68:71]
    v_mfma_f32_16x16x32_bf16 v[68:71], a[184:187], v[48:51], v[68:71]
    v_mfma_f32_16x16x32_bf16 v[168:171], a[164:167], v[28:31], v[168:171]
    v_mfma_f32_16x16x32_bf16 v[168:171], a[188:191], v[40:43], v[168:171]
    v_mfma_f32_16x16x32_bf16 v[192:195], a[164:167], v[32:35], v[192:195]
    v_mfma_f32_16x16x32_bf16 v[192:195], a[188:191], v[44:47], v[192:195]
    v_mfma_f32_16x16x32_bf16 v[72:75], a[164:167], v[36:39], v[72:75]
    v_mfma_f32_16x16x32_bf16 v[72:75], a[188:191], v[48:51], v[72:75]
    s_waitcnt lgkmcnt(0)
    v_mfma_f32_16x16x32_bf16 v[148:151], a[192:195], v[4:7], v[148:151]
    v_mfma_f32_16x16x32_bf16 v[148:151], a[216:219], v[16:19], v[148:151]
    v_mfma_f32_16x16x32_bf16 v[172:175], a[192:195], v[8:11], v[172:175]
    ds_read_b128 v[28:31], v242 offset:49664
    v_mfma_f32_16x16x32_bf16 v[172:175], a[216:219], v[20:23], v[172:175]
    v_mfma_f32_16x16x32_bf16 v[52:55], a[192:195], v[12:15], v[52:55]
    v_mfma_f32_16x16x32_bf16 v[52:55], a[216:219], v[24:27], v[52:55]
    v_mfma_f32_16x16x32_bf16 v[152:155], a[196:199], v[4:7], v[152:155]
    ds_read_b128 v[32:35], v242 offset:61952
    v_mfma_f32_16x16x32_bf16 v[152:155], a[220:223], v[16:19], v[152:155]
    v_mfma_f32_16x16x32_bf16 v[176:179], a[196:199], v[8:11], v[176:179]
    v_mfma_f32_16x16x32_bf16 v[176:179], a[220:223], v[20:23], v[176:179]
    v_mfma_f32_16x16x32_bf16 v[56:59], a[196:199], v[12:15], v[56:59]
    ds_read_b128 v[36:39], v230 offset:12800
    v_mfma_f32_16x16x32_bf16 v[56:59], a[220:223], v[24:27], v[56:59]
    v_mfma_f32_16x16x32_bf16 v[156:159], a[200:203], v[4:7], v[156:159]
    v_mfma_f32_16x16x32_bf16 v[156:159], a[224:227], v[16:19], v[156:159]
    v_mfma_f32_16x16x32_bf16 v[180:183], a[200:203], v[8:11], v[180:183]
    ds_read_b128 v[40:43], v243 offset:49664
    v_mfma_f32_16x16x32_bf16 v[180:183], a[224:227], v[20:23], v[180:183]
    v_mfma_f32_16x16x32_bf16 v[60:63], a[200:203], v[12:15], v[60:63]
    v_mfma_f32_16x16x32_bf16 v[60:63], a[224:227], v[24:27], v[60:63]
    v_mfma_f32_16x16x32_bf16 v[160:163], a[204:207], v[4:7], v[160:163]
    ds_read_b128 v[44:47], v243 offset:61952
    v_mfma_f32_16x16x32_bf16 v[160:163], a[228:231], v[16:19], v[160:163]
    v_mfma_f32_16x16x32_bf16 v[184:187], a[204:207], v[8:11], v[184:187]
    v_mfma_f32_16x16x32_bf16 v[184:187], a[228:231], v[20:23], v[184:187]
    v_mfma_f32_16x16x32_bf16 v[64:67], a[204:207], v[12:15], v[64:67]
    ds_read_b128 v[48:51], v231 offset:12800
    v_mfma_f32_16x16x32_bf16 v[64:67], a[228:231], v[24:27], v[64:67]
    v_mfma_f32_16x16x32_bf16 v[164:167], a[208:211], v[4:7], v[164:167]
    v_mfma_f32_16x16x32_bf16 v[164:167], a[232:235], v[16:19], v[164:167]
    v_mfma_f32_16x16x32_bf16 v[188:191], a[208:211], v[8:11], v[188:191]
    v_mfma_f32_16x16x32_bf16 v[188:191], a[232:235], v[20:23], v[188:191]
    v_mfma_f32_16x16x32_bf16 v[68:71], a[208:211], v[12:15], v[68:71]
    v_mfma_f32_16x16x32_bf16 v[68:71], a[232:235], v[24:27], v[68:71]
    v_mfma_f32_16x16x32_bf16 v[168:171], a[212:215], v[4:7], v[168:171]
    v_mfma_f32_16x16x32_bf16 v[168:171], a[236:239], v[16:19], v[168:171]
    v_mfma_f32_16x16x32_bf16 v[192:195], a[212:215], v[8:11], v[192:195]
    v_mfma_f32_16x16x32_bf16 v[192:195], a[236:239], v[20:23], v[192:195]
    v_mfma_f32_16x16x32_bf16 v[72:75], a[212:215], v[12:15], v[72:75]
    v_mfma_f32_16x16x32_bf16 v[72:75], a[236:239], v[24:27], v[72:75]
    s_waitcnt vmcnt(6) lgkmcnt(0)
    s_barrier
    v_mfma_f32_16x16x32_bf16 v[148:151], a[240:243], v[28:31], v[148:151]
    v_mfma_f32_16x16x32_bf16 v[148:151], v[204:207], v[40:43], v[148:151]
    v_mfma_f32_16x16x32_bf16 v[172:175], a[240:243], v[32:35], v[172:175]
    ds_read_b128 v[4:7], v228 offset:24576
    v_mfma_f32_16x16x32_bf16 v[172:175], v[204:207], v[44:47], v[172:175]
    v_mfma_f32_16x16x32_bf16 v[52:55], a[240:243], v[36:39], v[52:55]
    v_mfma_f32_16x16x32_bf16 v[52:55], v[204:207], v[48:51], v[52:55]
    v_mfma_f32_16x16x32_bf16 v[152:155], a[244:247], v[28:31], v[152:155]
    ds_read_b128 v[8:11], v228 offset:36864
    v_mfma_f32_16x16x32_bf16 v[152:155], v[208:211], v[40:43], v[152:155]
    v_mfma_f32_16x16x32_bf16 v[176:179], a[244:247], v[32:35], v[176:179]
    v_mfma_f32_16x16x32_bf16 v[176:179], v[208:211], v[44:47], v[176:179]
    v_mfma_f32_16x16x32_bf16 v[56:59], a[244:247], v[36:39], v[56:59]
    ds_read_b128 v[12:15], v240 offset:24576
    v_mfma_f32_16x16x32_bf16 v[56:59], v[208:211], v[48:51], v[56:59]
    v_mfma_f32_16x16x32_bf16 v[156:159], a[248:251], v[28:31], v[156:159]
    v_mfma_f32_16x16x32_bf16 v[156:159], v[212:215], v[40:43], v[156:159]
    v_mfma_f32_16x16x32_bf16 v[180:183], a[248:251], v[32:35], v[180:183]
    ds_read_b128 v[16:19], v229 offset:24576
    v_mfma_f32_16x16x32_bf16 v[180:183], v[212:215], v[44:47], v[180:183]
    v_mfma_f32_16x16x32_bf16 v[60:63], a[248:251], v[36:39], v[60:63]
    v_mfma_f32_16x16x32_bf16 v[60:63], v[212:215], v[48:51], v[60:63]
    v_mfma_f32_16x16x32_bf16 v[160:163], a[252:255], v[28:31], v[160:163]
    ds_read_b128 v[20:23], v229 offset:36864
    v_mfma_f32_16x16x32_bf16 v[160:163], v[216:219], v[40:43], v[160:163]
    v_mfma_f32_16x16x32_bf16 v[184:187], a[252:255], v[32:35], v[184:187]
    v_mfma_f32_16x16x32_bf16 v[184:187], v[216:219], v[44:47], v[184:187]
    v_mfma_f32_16x16x32_bf16 v[64:67], a[252:255], v[36:39], v[64:67]
    ds_read_b128 v[24:27], v241 offset:24576
    v_mfma_f32_16x16x32_bf16 v[64:67], v[216:219], v[48:51], v[64:67]
    v_mfma_f32_16x16x32_bf16 v[164:167], v[196:199], v[28:31], v[164:167]
    v_mfma_f32_16x16x32_bf16 v[164:167], v[220:223], v[40:43], v[164:167]
    v_mfma_f32_16x16x32_bf16 v[188:191], v[196:199], v[32:35], v[188:191]
    v_mfma_f32_16x16x32_bf16 v[188:191], v[220:223], v[44:47], v[188:191]
    v_mfma_f32_16x16x32_bf16 v[68:71], v[196:199], v[36:39], v[68:71]
    v_mfma_f32_16x16x32_bf16 v[68:71], v[220:223], v[48:51], v[68:71]
    v_mfma_f32_16x16x32_bf16 v[168:171], v[200:203], v[28:31], v[168:171]
    v_mfma_f32_16x16x32_bf16 v[168:171], v[224:227], v[40:43], v[168:171]
    v_mfma_f32_16x16x32_bf16 v[192:195], v[200:203], v[32:35], v[192:195]
    v_mfma_f32_16x16x32_bf16 v[192:195], v[224:227], v[44:47], v[192:195]
    v_mfma_f32_16x16x32_bf16 v[72:75], v[200:203], v[36:39], v[72:75]
    v_mfma_f32_16x16x32_bf16 v[72:75], v[224:227], v[48:51], v[72:75]
    s_waitcnt lgkmcnt(0)
    v_cvt_pk_bf16_f32 v76, v148, v149
    v_cvt_pk_bf16_f32 v77, v150, v151
    v_mfma_f32_16x16x32_bf16 v[148:151], a[0:3], v[4:7], 0
    s_add_u32 s74, s2, 258
    s_and_b32 s74, s74, 255
    v_mfma_f32_16x16x32_bf16 v[148:151], a[24:27], v[16:19], v[148:151]
    v_cvt_pk_bf16_f32 v88, v172, v173
    v_cvt_pk_bf16_f32 v89, v174, v175
    s_add_u32 s74, s74, 1536
    s_mul_i32 s74, s74, 12288
    v_mfma_f32_16x16x32_bf16 v[172:175], a[0:3], v[8:11], 0
    ds_read_b128 v[28:31], v230 offset:24576
    s_add_u32 m0, s49, 110592
    v_mfma_f32_16x16x32_bf16 v[172:175], a[24:27], v[20:23], v[172:175]
    v_cvt_pk_bf16_f32 v100, v52, v53
    v_cvt_pk_bf16_f32 v101, v54, v55
    buffer_load_dwordx4 v244, s[24:27], s74 offen nt lds
    v_mfma_f32_16x16x32_bf16 v[52:55], a[0:3], v[12:15], 0
    v_mfma_f32_16x16x32_bf16 v[52:55], a[24:27], v[24:27], v[52:55]
    v_cvt_pk_bf16_f32 v78, v152, v153
    v_cvt_pk_bf16_f32 v79, v154, v155
    v_mfma_f32_16x16x32_bf16 v[152:155], a[4:7], v[4:7], 0
    ds_read_b128 v[32:35], v230 offset:36864
    buffer_load_dwordx4 v245, s[24:27], s74 offen offset:1024 nt lds
    v_mfma_f32_16x16x32_bf16 v[152:155], a[28:31], v[16:19], v[152:155]
    v_cvt_pk_bf16_f32 v90, v176, v177
    v_cvt_pk_bf16_f32 v91, v178, v179
    v_mfma_f32_16x16x32_bf16 v[176:179], a[4:7], v[8:11], 0
    v_mfma_f32_16x16x32_bf16 v[176:179], a[28:31], v[20:23], v[176:179]
    v_cvt_pk_bf16_f32 v102, v56, v57
    v_cvt_pk_bf16_f32 v103, v58, v59
    buffer_load_dwordx4 v246, s[24:27], s74 offen offset:2048 nt lds
    v_mfma_f32_16x16x32_bf16 v[56:59], a[4:7], v[12:15], 0
    ds_read_b128 v[36:39], v242 offset:24576
    v_mfma_f32_16x16x32_bf16 v[56:59], a[28:31], v[24:27], v[56:59]
    v_cvt_pk_bf16_f32 v80, v156, v157
    v_cvt_pk_bf16_f32 v81, v158, v159
    v_mfma_f32_16x16x32_bf16 v[156:159], a[8:11], v[4:7], 0
    v_mfma_f32_16x16x32_bf16 v[156:159], a[32:35], v[16:19], v[156:159]
    v_cvt_pk_bf16_f32 v92, v180, v181
    v_cvt_pk_bf16_f32 v93, v182, v183
    v_mfma_f32_16x16x32_bf16 v[180:183], a[8:11], v[8:11], 0
    ds_read_b128 v[40:43], v231 offset:24576
    v_mfma_f32_16x16x32_bf16 v[180:183], a[32:35], v[20:23], v[180:183]
    v_cvt_pk_bf16_f32 v104, v60, v61
    v_cvt_pk_bf16_f32 v105, v62, v63
    v_mfma_f32_16x16x32_bf16 v[60:63], a[8:11], v[12:15], 0
    v_mfma_f32_16x16x32_bf16 v[60:63], a[32:35], v[24:27], v[60:63]
    v_cvt_pk_bf16_f32 v82, v160, v161
    v_cvt_pk_bf16_f32 v83, v162, v163
    v_mfma_f32_16x16x32_bf16 v[160:163], a[12:15], v[4:7], 0
    ds_read_b128 v[44:47], v231 offset:36864
    v_mfma_f32_16x16x32_bf16 v[160:163], a[36:39], v[16:19], v[160:163]
    v_cvt_pk_bf16_f32 v94, v184, v185
    v_cvt_pk_bf16_f32 v95, v186, v187
    v_mfma_f32_16x16x32_bf16 v[184:187], a[12:15], v[8:11], 0
    v_mfma_f32_16x16x32_bf16 v[184:187], a[36:39], v[20:23], v[184:187]
    v_cvt_pk_bf16_f32 v106, v64, v65
    v_cvt_pk_bf16_f32 v107, v66, v67
    v_mfma_f32_16x16x32_bf16 v[64:67], a[12:15], v[12:15], 0
    ds_read_b128 v[48:51], v243 offset:24576
    v_mfma_f32_16x16x32_bf16 v[64:67], a[36:39], v[24:27], v[64:67]
    v_cvt_pk_bf16_f32 v84, v164, v165
    v_cvt_pk_bf16_f32 v85, v166, v167
    v_mfma_f32_16x16x32_bf16 v[164:167], a[16:19], v[4:7], 0
    s_add_u32 s75, s2, 301
    s_and_b32 s75, s75, 255
    v_mfma_f32_16x16x32_bf16 v[164:167], a[40:43], v[16:19], v[164:167]
    v_cvt_pk_bf16_f32 v96, v188, v189
    v_cvt_pk_bf16_f32 v97, v190, v191
    s_add_u32 s75, s75, 1792
    s_mul_i32 s75, s75, 12288
    v_mfma_f32_16x16x32_bf16 v[188:191], a[16:19], v[8:11], 0
    s_add_u32 m0, s49, 122880
    v_mfma_f32_16x16x32_bf16 v[188:191], a[40:43], v[20:23], v[188:191]
    v_cvt_pk_bf16_f32 v108, v68, v69
    v_cvt_pk_bf16_f32 v109, v70, v71
    buffer_load_dwordx4 v244, s[24:27], s75 offen nt lds
    v_mfma_f32_16x16x32_bf16 v[68:71], a[16:19], v[12:15], 0
    v_mfma_f32_16x16x32_bf16 v[68:71], a[40:43], v[24:27], v[68:71]
    v_cvt_pk_bf16_f32 v86, v168, v169
    v_cvt_pk_bf16_f32 v87, v170, v171
    v_mfma_f32_16x16x32_bf16 v[168:171], a[20:23], v[4:7], 0
    buffer_load_dwordx4 v245, s[24:27], s75 offen offset:1024 nt lds
    v_mfma_f32_16x16x32_bf16 v[168:171], a[44:47], v[16:19], v[168:171]
    v_cvt_pk_bf16_f32 v98, v192, v193
    v_cvt_pk_bf16_f32 v99, v194, v195
    v_mfma_f32_16x16x32_bf16 v[192:195], a[20:23], v[8:11], 0
    v_mfma_f32_16x16x32_bf16 v[192:195], a[44:47], v[20:23], v[192:195]
    v_cvt_pk_bf16_f32 v110, v72, v73
    v_cvt_pk_bf16_f32 v111, v74, v75
    buffer_load_dwordx4 v246, s[24:27], s75 offen offset:2048 nt lds
    v_mfma_f32_16x16x32_bf16 v[72:75], a[20:23], v[12:15], 0
    v_mfma_f32_16x16x32_bf16 v[72:75], a[44:47], v[24:27], v[72:75]
    s_waitcnt lgkmcnt(0)
    v_mfma_f32_16x16x32_bf16 v[148:151], a[48:51], v[28:31], v[148:151]
    v_mfma_f32_16x16x32_bf16 v[148:151], a[72:75], v[40:43], v[148:151]
    v_mfma_f32_16x16x32_bf16 v[172:175], a[48:51], v[32:35], v[172:175]
    ds_read_b128 v[4:7], v228 offset:24832
    v_mfma_f32_16x16x32_bf16 v[172:175], a[72:75], v[44:47], v[172:175]
    v_mfma_f32_16x16x32_bf16 v[52:55], a[48:51], v[36:39], v[52:55]
    v_mfma_f32_16x16x32_bf16 v[52:55], a[72:75], v[48:51], v[52:55]
    v_mfma_f32_16x16x32_bf16 v[152:155], a[52:55], v[28:31], v[152:155]
    ds_read_b128 v[8:11], v228 offset:37120
    v_mfma_f32_16x16x32_bf16 v[152:155], a[76:79], v[40:43], v[152:155]
    v_mfma_f32_16x16x32_bf16 v[176:179], a[52:55], v[32:35], v[176:179]
    v_mfma_f32_16x16x32_bf16 v[176:179], a[76:79], v[44:47], v[176:179]
    v_mfma_f32_16x16x32_bf16 v[56:59], a[52:55], v[36:39], v[56:59]
    ds_read_b128 v[12:15], v240 offset:24832
    v_mfma_f32_16x16x32_bf16 v[56:59], a[76:79], v[48:51], v[56:59]
    v_mfma_f32_16x16x32_bf16 v[156:159], a[56:59], v[28:31], v[156:159]
    s_add_u32 s76, s2, 344
    s_and_b32 s76, s76, 255
    v_mfma_f32_16x16x32_bf16 v[156:159], a[80:83], v[40:43], v[156:159]
    s_add_u32 s76, s76, 2048
    s_mul_i32 s76, s76, 12288
    v_mfma_f32_16x16x32_bf16 v[180:183], a[56:59], v[32:35], v[180:183]
    ds_read_b128 v[16:19], v229 offset:24832
    s_add_u32 m0, s49, 135168
    v_mfma_f32_16x16x32_bf16 v[180:183], a[80:83], v[44:47], v[180:183]
    buffer_load_dwordx4 v244, s[24:27], s76 offen nt lds
    v_mfma_f32_16x16x32_bf16 v[60:63], a[56:59], v[36:39], v[60:63]
    v_mfma_f32_16x16x32_bf16 v[60:63], a[80:83], v[48:51], v[60:63]
    v_mfma_f32_16x16x32_bf16 v[160:163], a[60:63], v[28:31], v[160:163]
    ds_read_b128 v[20:23], v229 offset:37120
    buffer_load_dwordx4 v245, s[24:27], s76 offen offset:1024 nt lds
    v_mfma_f32_16x16x32_bf16 v[160:163], a[84:87], v[40:43], v[160:163]
    v_mfma_f32_16x16x32_bf16 v[184:187], a[60:63], v[32:35], v[184:187]
    v_mfma_f32_16x16x32_bf16 v[184:187], a[84:87], v[44:47], v[184:187]
    buffer_load_dwordx4 v246, s[24:27], s76 offen offset:2048 nt lds
    v_mfma_f32_16x16x32_bf16 v[64:67], a[60:63], v[36:39], v[64:67]
    ds_read_b128 v[24:27], v241 offset:24832
    v_mfma_f32_16x16x32_bf16 v[64:67], a[84:87], v[48:51], v[64:67]
    v_mfma_f32_16x16x32_bf16 v[164:167], a[64:67], v[28:31], v[164:167]
    v_mfma_f32_16x16x32_bf16 v[164:167], a[88:91], v[40:43], v[164:167]
    v_mfma_f32_16x16x32_bf16 v[188:191], a[64:67], v[32:35], v[188:191]
    v_mfma_f32_16x16x32_bf16 v[188:191], a[88:91], v[44:47], v[188:191]
    v_mfma_f32_16x16x32_bf16 v[68:71], a[64:67], v[36:39], v[68:71]
    v_mfma_f32_16x16x32_bf16 v[68:71], a[88:91], v[48:51], v[68:71]
    v_mfma_f32_16x16x32_bf16 v[168:171], a[68:71], v[28:31], v[168:171]
    v_mfma_f32_16x16x32_bf16 v[168:171], a[92:95], v[40:43], v[168:171]
    v_mfma_f32_16x16x32_bf16 v[192:195], a[68:71], v[32:35], v[192:195]
    v_mfma_f32_16x16x32_bf16 v[192:195], a[92:95], v[44:47], v[192:195]
    v_mfma_f32_16x16x32_bf16 v[72:75], a[68:71], v[36:39], v[72:75]
    v_mfma_f32_16x16x32_bf16 v[72:75], a[92:95], v[48:51], v[72:75]
    s_waitcnt lgkmcnt(0)
    v_mfma_f32_16x16x32_bf16 v[148:151], a[96:99], v[4:7], v[148:151]
    s_add_u32 s77, s78, 0
    s_add_u32 m0, s49, 0
    v_mfma_f32_16x16x32_bf16 v[148:151], a[120:123], v[16:19], v[148:151]
    buffer_load_dwordx4 v232, s[20:23], s77 offen nt lds
    v_mfma_f32_16x16x32_bf16 v[172:175], a[96:99], v[8:11], v[172:175]
    ds_read_b128 v[28:31], v230 offset:24832
    v_mfma_f32_16x16x32_bf16 v[172:175], a[120:123], v[20:23], v[172:175]
    v_mfma_f32_16x16x32_bf16 v[52:55], a[96:99], v[12:15], v[52:55]
    buffer_load_dwordx4 v233, s[20:23], s77 offen offset:1024 nt lds
    v_mfma_f32_16x16x32_bf16 v[52:55], a[120:123], v[24:27], v[52:55]
    v_mfma_f32_16x16x32_bf16 v[152:155], a[100:103], v[4:7], v[152:155]
    ds_read_b128 v[32:35], v230 offset:37120
    v_mfma_f32_16x16x32_bf16 v[152:155], a[124:127], v[16:19], v[152:155]
    buffer_load_dwordx4 v234, s[20:23], s77 offen offset:2048 nt lds
    v_mfma_f32_16x16x32_bf16 v[176:179], a[100:103], v[8:11], v[176:179]
    v_mfma_f32_16x16x32_bf16 v[176:179], a[124:127], v[20:23], v[176:179]
    v_mfma_f32_16x16x32_bf16 v[56:59], a[100:103], v[12:15], v[56:59]
    ds_read_b128 v[36:39], v242 offset:24832
    v_mfma_f32_16x16x32_bf16 v[56:59], a[124:127], v[24:27], v[56:59]
    v_mfma_f32_16x16x32_bf16 v[156:159], a[104:107], v[4:7], v[156:159]
    v_mfma_f32_16x16x32_bf16 v[156:159], a[128:131], v[16:19], v[156:159]
    v_mfma_f32_16x16x32_bf16 v[180:183], a[104:107], v[8:11], v[180:183]
    ds_read_b128 v[40:43], v231 offset:24832
    v_mfma_f32_16x16x32_bf16 v[180:183], a[128:131], v[20:23], v[180:183]
    v_mfma_f32_16x16x32_bf16 v[60:63], a[104:107], v[12:15], v[60:63]
    v_mfma_f32_16x16x32_bf16 v[60:63], a[128:131], v[24:27], v[60:63]
    v_mfma_f32_16x16x32_bf16 v[160:163], a[108:111], v[4:7], v[160:163]
    ds_read_b128 v[44:47], v231 offset:37120
    v_mfma_f32_16x16x32_bf16 v[160:163], a[132:135], v[16:19], v[160:163]
    v_mfma_f32_16x16x32_bf16 v[184:187], a[108:111], v[8:11], v[184:187]
    v_mfma_f32_16x16x32_bf16 v[184:187], a[132:135], v[20:23], v[184:187]
    v_mfma_f32_16x16x32_bf16 v[64:67], a[108:111], v[12:15], v[64:67]
    ds_read_b128 v[48:51], v243 offset:24832
    v_mfma_f32_16x16x32_bf16 v[64:67], a[132:135], v[24:27], v[64:67]
    v_mfma_f32_16x16x32_bf16 v[164:167], a[112:115], v[4:7], v[164:167]
    s_add_u32 s74, s78, 768
    s_add_u32 m0, s49, 12288
    v_mfma_f32_16x16x32_bf16 v[164:167], a[136:139], v[16:19], v[164:167]
    buffer_load_dwordx4 v232, s[20:23], s74 offen nt lds
    v_mfma_f32_16x16x32_bf16 v[188:191], a[112:115], v[8:11], v[188:191]
    v_mfma_f32_16x16x32_bf16 v[188:191], a[136:139], v[20:23], v[188:191]
    v_mfma_f32_16x16x32_bf16 v[68:71], a[112:115], v[12:15], v[68:71]
    buffer_load_dwordx4 v233, s[20:23], s74 offen offset:1024 nt lds
    v_mfma_f32_16x16x32_bf16 v[68:71], a[136:139], v[24:27], v[68:71]
    v_mfma_f32_16x16x32_bf16 v[168:171], a[116:119], v[4:7], v[168:171]
    v_mfma_f32_16x16x32_bf16 v[168:171], a[140:143], v[16:19], v[168:171]
    buffer_load_dwordx4 v234, s[20:23], s74 offen offset:2048 nt lds
    v_mfma_f32_16x16x32_bf16 v[192:195], a[116:119], v[8:11], v[192:195]
    v_mfma_f32_16x16x32_bf16 v[192:195], a[140:143], v[20:23], v[192:195]
    v_mfma_f32_16x16x32_bf16 v[72:75], a[116:119], v[12:15], v[72:75]
    v_mfma_f32_16x16x32_bf16 v[72:75], a[140:143], v[24:27], v[72:75]
    s_waitcnt lgkmcnt(0)
    v_mfma_f32_16x16x32_bf16 v[148:151], a[144:147], v[28:31], v[148:151]
    v_mfma_f32_16x16x32_bf16 v[148:151], a[168:171], v[40:43], v[148:151]
    v_mfma_f32_16x16x32_bf16 v[172:175], a[144:147], v[32:35], v[172:175]
    ds_read_b128 v[4:7], v228 offset:25088
    v_mfma_f32_16x16x32_bf16 v[172:175], a[168:171], v[44:47], v[172:175]
    v_mfma_f32_16x16x32_bf16 v[52:55], a[144:147], v[36:39], v[52:55]
    v_mfma_f32_16x16x32_bf16 v[52:55], a[168:171], v[48:51], v[52:55]
    v_mfma_f32_16x16x32_bf16 v[152:155], a[148:151], v[28:31], v[152:155]
    ds_read_b128 v[8:11], v228 offset:37376
    v_mfma_f32_16x16x32_bf16 v[152:155], a[172:175], v[40:43], v[152:155]
    v_mfma_f32_16x16x32_bf16 v[176:179], a[148:151], v[32:35], v[176:179]
    v_mfma_f32_16x16x32_bf16 v[176:179], a[172:175], v[44:47], v[176:179]
    v_mfma_f32_16x16x32_bf16 v[56:59], a[148:151], v[36:39], v[56:59]
    ds_read_b128 v[12:15], v240 offset:25088
    v_mfma_f32_16x16x32_bf16 v[56:59], a[172:175], v[48:51], v[56:59]
    v_mfma_f32_16x16x32_bf16 v[156:159], a[152:155], v[28:31], v[156:159]
    s_add_u32 s75, s84, 294912
    s_add_u32 m0, s49, 73728
    v_mfma_f32_16x16x32_bf16 v[156:159], a[176:179], v[40:43], v[156:159]
    buffer_load_dwordx4 v232, s[20:23], s75 offen nt lds
    v_mfma_f32_16x16x32_bf16 v[180:183], a[152:155], v[32:35], v[180:183]
    ds_read_b128 v[16:19], v229 offset:25088
    v_mfma_f32_16x16x32_bf16 v[180:183], a[176:179], v[44:47], v[180:183]
    v_mfma_f32_16x16x32_bf16 v[60:63], a[152:155], v[36:39], v[60:63]
    buffer_load_dwordx4 v233, s[20:23], s75 offen offset:1024 nt lds
    v_mfma_f32_16x16x32_bf16 v[60:63], a[176:179], v[48:51], v[60:63]
    v_mfma_f32_16x16x32_bf16 v[160:163], a[156:159], v[28:31], v[160:163]
    ds_read_b128 v[20:23], v229 offset:37376
    v_mfma_f32_16x16x32_bf16 v[160:163], a[180:183], v[40:43], v[160:163]
    buffer_load_dwordx4 v234, s[20:23], s75 offen offset:2048 nt lds
    v_mfma_f32_16x16x32_bf16 v[184:187], a[156:159], v[32:35], v[184:187]
    v_mfma_f32_16x16x32_bf16 v[184:187], a[180:183], v[44:47], v[184:187]
    v_mfma_f32_16x16x32_bf16 v[64:67], a[156:159], v[36:39], v[64:67]
    ds_read_b128 v[24:27], v241 offset:25088
    v_mfma_f32_16x16x32_bf16 v[64:67], a[180:183], v[48:51], v[64:67]
    v_mfma_f32_16x16x32_bf16 v[164:167], a[160:163], v[28:31], v[164:167]
    v_mfma_f32_16x16x32_bf16 v[164:167], a[184:187], v[40:43], v[164:167]
    v_mfma_f32_16x16x32_bf16 v[188:191], a[160:163], v[32:35], v[188:191]
    v_mfma_f32_16x16x32_bf16 v[188:191], a[184:187], v[44:47], v[188:191]
    v_mfma_f32_16x16x32_bf16 v[68:71], a[160:163], v[36:39], v[68:71]
    v_mfma_f32_16x16x32_bf16 v[68:71], a[184:187], v[48:51], v[68:71]
    v_mfma_f32_16x16x32_bf16 v[168:171], a[164:167], v[28:31], v[168:171]
    v_mfma_f32_16x16x32_bf16 v[168:171], a[188:191], v[40:43], v[168:171]
    v_mfma_f32_16x16x32_bf16 v[192:195], a[164:167], v[32:35], v[192:195]
    v_mfma_f32_16x16x32_bf16 v[192:195], a[188:191], v[44:47], v[192:195]
    v_mfma_f32_16x16x32_bf16 v[72:75], a[164:167], v[36:39], v[72:75]
    v_mfma_f32_16x16x32_bf16 v[72:75], a[188:191], v[48:51], v[72:75]
    s_waitcnt lgkmcnt(0)
    v_mfma_f32_16x16x32_bf16 v[148:151], a[192:195], v[4:7], v[148:151]
    s_add_u32 s76, s84, 295680
    s_add_u32 m0, s49, 86016
    s_load_dword s72, s[14:15], 0
    v_mfma_f32_16x16x32_bf16 v[148:151], a[216:219], v[16:19], v[148:151]
    buffer_load_dwordx4 v232, s[20:23], s76 offen nt lds
    v_mfma_f32_16x16x32_bf16 v[172:175], a[192:195], v[8:11], v[172:175]
    ds_read_b128 v[28:31], v230 offset:25088
    v_mfma_f32_16x16x32_bf16 v[172:175], a[216:219], v[20:23], v[172:175]
    v_mfma_f32_16x16x32_bf16 v[52:55], a[192:195], v[12:15], v[52:55]
    buffer_load_dwordx4 v233, s[20:23], s76 offen offset:1024 nt lds
    v_mfma_f32_16x16x32_bf16 v[52:55], a[216:219], v[24:27], v[52:55]
    v_mfma_f32_16x16x32_bf16 v[152:155], a[196:199], v[4:7], v[152:155]
    ds_read_b128 v[32:35], v230 offset:37376
    v_mfma_f32_16x16x32_bf16 v[152:155], a[220:223], v[16:19], v[152:155]
    buffer_load_dwordx4 v234, s[20:23], s76 offen offset:2048 nt lds
    v_mfma_f32_16x16x32_bf16 v[176:179], a[196:199], v[8:11], v[176:179]
    v_mfma_f32_16x16x32_bf16 v[176:179], a[220:223], v[20:23], v[176:179]
    v_mfma_f32_16x16x32_bf16 v[56:59], a[196:199], v[12:15], v[56:59]
    ds_read_b128 v[36:39], v242 offset:25088
    v_mfma_f32_16x16x32_bf16 v[56:59], a[220:223], v[24:27], v[56:59]
    v_mfma_f32_16x16x32_bf16 v[156:159], a[200:203], v[4:7], v[156:159]
    v_mfma_f32_16x16x32_bf16 v[156:159], a[224:227], v[16:19], v[156:159]
    v_mfma_f32_16x16x32_bf16 v[180:183], a[200:203], v[8:11], v[180:183]
    ds_read_b128 v[40:43], v231 offset:25088
    v_mfma_f32_16x16x32_bf16 v[180:183], a[224:227], v[20:23], v[180:183]
    v_mfma_f32_16x16x32_bf16 v[60:63], a[200:203], v[12:15], v[60:63]
    v_mfma_f32_16x16x32_bf16 v[60:63], a[224:227], v[24:27], v[60:63]
    v_mfma_f32_16x16x32_bf16 v[160:163], a[204:207], v[4:7], v[160:163]
    ds_read_b128 v[44:47], v231 offset:37376
    v_mfma_f32_16x16x32_bf16 v[160:163], a[228:231], v[16:19], v[160:163]
    v_mfma_f32_16x16x32_bf16 v[184:187], a[204:207], v[8:11], v[184:187]
    v_mfma_f32_16x16x32_bf16 v[184:187], a[228:231], v[20:23], v[184:187]
    v_mfma_f32_16x16x32_bf16 v[64:67], a[204:207], v[12:15], v[64:67]
    ds_read_b128 v[48:51], v243 offset:25088
    v_mfma_f32_16x16x32_bf16 v[64:67], a[228:231], v[24:27], v[64:67]
    v_mfma_f32_16x16x32_bf16 v[164:167], a[208:211], v[4:7], v[164:167]
    v_mfma_f32_16x16x32_bf16 v[164:167], a[232:235], v[16:19], v[164:167]
    v_mfma_f32_16x16x32_bf16 v[188:191], a[208:211], v[8:11], v[188:191]
    v_mfma_f32_16x16x32_bf16 v[188:191], a[232:235], v[20:23], v[188:191]
    v_mfma_f32_16x16x32_bf16 v[68:71], a[208:211], v[12:15], v[68:71]
    v_mfma_f32_16x16x32_bf16 v[68:71], a[232:235], v[24:27], v[68:71]
    v_mfma_f32_16x16x32_bf16 v[168:171], a[212:215], v[4:7], v[168:171]
    v_mfma_f32_16x16x32_bf16 v[168:171], a[236:239], v[16:19], v[168:171]
    v_mfma_f32_16x16x32_bf16 v[192:195], a[212:215], v[8:11], v[192:195]
    v_mfma_f32_16x16x32_bf16 v[192:195], a[236:239], v[20:23], v[192:195]
    v_mfma_f32_16x16x32_bf16 v[72:75], a[212:215], v[12:15], v[72:75]
    s_waitcnt lgkmcnt(0)
    s_cmp_ge_u32 s72, 24
    s_cbranch_scc0 L_nopfw
    s_mov_b32 exec_hi, 15
    buffer_load_dword v254, v253, s[40:43], 0 offen sc1
    s_mov_b64 exec, -1
L_nopfw:
    v_mfma_f32_16x16x32_bf16 v[72:75], a[236:239], v[24:27], v[72:75]
    s_waitcnt vmcnt(12) lgkmcnt(0)
    s_barrier
    v_mfma_f32_16x16x32_bf16 v[148:151], a[240:243], v[28:31], v[148:151]
    v_mfma_f32_16x16x32_bf16 v[148:151], v[204:207], v[40:43], v[148:151]
    v_mfma_f32_16x16x32_bf16 v[172:175], a[240:243], v[32:35], v[172:175]
    ds_read_b128 v[4:7], v240 offset:36864
    v_mfma_f32_16x16x32_bf16 v[172:175], v[204:207], v[44:47], v[172:175]
    v_mfma_f32_16x16x32_bf16 v[52:55], a[240:243], v[36:39], v[52:55]
    v_mfma_f32_16x16x32_bf16 v[52:55], v[204:207], v[48:51], v[52:55]
    v_mfma_f32_16x16x32_bf16 v[152:155], a[244:247], v[28:31], v[152:155]
    ds_read_b128 v[8:11], v240 offset:49152
    v_mfma_f32_16x16x32_bf16 v[152:155], v[208:211], v[40:43], v[152:155]
    v_mfma_f32_16x16x32_bf16 v[176:179], a[244:247], v[32:35], v[176:179]
    v_mfma_f32_16x16x32_bf16 v[176:179], v[208:211], v[44:47], v[176:179]
    v_mfma_f32_16x16x32_bf16 v[56:59], a[244:247], v[36:39], v[56:59]
    ds_read_b128 v[12:15], v240 offset:61440
    v_mfma_f32_16x16x32_bf16 v[56:59], v[208:211], v[48:51], v[56:59]
    v_mfma_f32_16x16x32_bf16 v[156:159], a[248:251], v[28:31], v[156:159]
    v_mfma_f32_16x16x32_bf16 v[156:159], v[212:215], v[40:43], v[156:159]
    v_mfma_f32_16x16x32_bf16 v[180:183], a[248:251], v[32:35], v[180:183]
    ds_read_b128 v[16:19], v241 offset:36864
    v_mfma_f32_16x16x32_bf16 v[180:183], v[212:215], v[44:47], v[180:183]
    v_mfma_f32_16x16x32_bf16 v[60:63], a[248:251], v[36:39], v[60:63]
    v_mfma_f32_16x16x32_bf16 v[60:63], v[212:215], v[48:51], v[60:63]
    v_mfma_f32_16x16x32_bf16 v[160:163], a[252:255], v[28:31], v[160:163]
    ds_read_b128 v[20:23], v241 offset:49152
    v_mfma_f32_16x16x32_bf16 v[160:163], v[216:219], v[40:43], v[160:163]
    v_mfma_f32_16x16x32_bf16 v[184:187], a[252:255], v[32:35], v[184:187]
    v_mfma_f32_16x16x32_bf16 v[184:187], v[216:219], v[44:47], v[184:187]
    v_mfma_f32_16x16x32_bf16 v[64:67], a[252:255], v[36:39], v[64:67]
    ds_read_b128 v[24:27], v241 offset:61440
    v_mfma_f32_16x16x32_bf16 v[64:67], v[216:219], v[48:51], v[64:67]
    v_mfma_f32_16x16x32_bf16 v[164:167], v[196:199], v[28:31], v[164:167]
    v_mfma_f32_16x16x32_bf16 v[164:167], v[220:223], v[40:43], v[164:167]
    v_mfma_f32_16x16x32_bf16 v[188:191], v[196:199], v[32:35], v[188:191]
    v_mfma_f32_16x16x32_bf16 v[188:191], v[220:223], v[44:47], v[188:191]
    v_mfma_f32_16x16x32_bf16 v[68:71], v[196:199], v[36:39], v[68:71]
    v_mfma_f32_16x16x32_bf16 v[68:71], v[220:223], v[48:51], v[68:71]
    v_mfma_f32_16x16x32_bf16 v[168:171], v[200:203], v[28:31], v[168:171]
    v_mfma_f32_16x16x32_bf16 v[168:171], v[224:227], v[40:43], v[168:171]
    v_mfma_f32_16x16x32_bf16 v[192:195], v[200:203], v[32:35], v[192:195]
    v_mfma_f32_16x16x32_bf16 v[192:195], v[224:227], v[44:47], v[192:195]
    v_mfma_f32_16x16x32_bf16 v[72:75], v[200:203], v[36:39], v[72:75]
    v_mfma_f32_16x16x32_bf16 v[72:75], v[224:227], v[48:51], v[72:75]
    s_branch L_p2done
L_pass2t:
    s_waitcnt lgkmcnt(0)
    v_cvt_pk_bf16_f32 v76, v148, v149
    v_cvt_pk_bf16_f32 v77, v150, v151
    v_mfma_f32_16x16x32_bf16 v[148:151], a[0:3], v[4:7], 0
    s_add_u32 s77, s2, 258
    s_and_b32 s77, s77, 255
    v_mfma_f32_16x16x32_bf16 v[148:151], a[24:27], v[16:19], v[148:151]
    v_cvt_pk_bf16_f32 v88, v172, v173
    v_cvt_pk_bf16_f32 v89, v174, v175
    s_add_u32 s77, s77, 1536
    s_mul_i32 s77, s77, 12288
    v_mfma_f32_16x16x32_bf16 v[172:175], a[0:3], v[8:11], 0
    ds_read_b128 v[28:31], v230 offset:24576
    s_add_u32 m0, s49, 110592
    v_mfma_f32_16x16x32_bf16 v[172:175], a[24:27], v[20:23], v[172:175]
    v_cvt_pk_bf16_f32 v100, v52, v53
    v_cvt_pk_bf16_f32 v101, v54, v55
    buffer_load_dwordx4 v244, s[24:27], s77 offen nt lds
    v_mfma_f32_16x16x32_bf16 v[52:55], a[0:3], v[12:15], 0
    v_mfma_f32_16x16x32_bf16 v[52:55], a[24:27], v[24:27], v[52:55]
    v_cvt_pk_bf16_f32 v78, v152, v153
    v_cvt_pk_bf16_f32 v79, v154, v155
    v_mfma_f32_16x16x32_bf16 v[152:155], a[4:7], v[4:7], 0
    ds_read_b128 v[32:35], v230 offset:36864
    buffer_load_dwordx4 v245, s[24:27], s77 offen offset:1024 nt lds
    v_mfma_f32_16x16x32_bf16 v[152:155], a[28:31], v[16:19], v[152:155]
    v_cvt_pk_bf16_f32 v90, v176, v177
    v_cvt_pk_bf16_f32 v91, v178, v179
    v_mfma_f32_16x16x32_bf16 v[176:179], a[4:7], v[8:11], 0
    v_mfma_f32_16x16x32_bf16 v[176:179], a[28:31], v[20:23], v[176:179]
    v_cvt_pk_bf16_f32 v102, v56, v57
    v_cvt_pk_bf16_f32 v103, v58, v59
    buffer_load_dwordx4 v246, s[24:27], s77 offen offset:2048 nt lds
    v_mfma_f32_16x16x32_bf16 v[56:59], a[4:7], v[12:15], 0
    ds_read_b128 v[36:39], v242 offset:24576
    v_mfma_f32_16x16x32_bf16 v[56:59], a[28:31], v[24:27], v[56:59]
    v_cvt_pk_bf16_f32 v80, v156, v157
    v_cvt_pk_bf16_f32 v81, v158, v159
    v_mfma_f32_16x16x32_bf16 v[156:159], a[8:11], v[4:7], 0
    v_mfma_f32_16x16x32_bf16 v[156:159], a[32:35], v[16:19], v[156:159]
    v_cvt_pk_bf16_f32 v92, v180, v181
    v_cvt_pk_bf16_f32 v93, v182, v183
    v_mfma_f32_16x16x32_bf16 v[180:183], a[8:11], v[8:11], 0
    ds_read_b128 v[40:43], v231 offset:24576
    v_mfma_f32_16x16x32_bf16 v[180:183], a[32:35], v[20:23], v[180:183]
    v_cvt_pk_bf16_f32 v104, v60, v61
    v_cvt_pk_bf16_f32 v105, v62, v63
    v_mfma_f32_16x16x32_bf16 v[60:63], a[8:11], v[12:15], 0
    v_mfma_f32_16x16x32_bf16 v[60:63], a[32:35], v[24:27], v[60:63]
    v_cvt_pk_bf16_f32 v82, v160, v161
    v_cvt_pk_bf16_f32 v83, v162, v163
    v_mfma_f32_16x16x32_bf16 v[160:163], a[12:15], v[4:7], 0
    ds_read_b128 v[44:47], v231 offset:36864
    v_mfma_f32_16x16x32_bf16 v[160:163], a[36:39], v[16:19], v[160:163]
    v_cvt_pk_bf16_f32 v94, v184, v185
    v_cvt_pk_bf16_f32 v95, v186, v187
    v_mfma_f32_16x16x32_bf16 v[184:187], a[12:15], v[8:11], 0
    s_add_u32 s74, s2, 301
    s_and_b32 s74, s74, 255
    v_mfma_f32_16x16x32_bf16 v[184:187], a[36:39], v[20:23], v[184:187]
    v_cvt_pk_bf16_f32 v106, v64, v65
    v_cvt_pk_bf16_f32 v107, v66, v67
    s_add_u32 s74, s74, 1792
    s_mul_i32 s74, s74, 12288
    v_mfma_f32_16x16x32_bf16 v[64:67], a[12:15], v[12:15], 0
    ds_read_b128 v[48:51], v243 offset:24576
    s_add_u32 m0, s49, 122880
    v_mfma_f32_16x16x32_bf16 v[64:67], a[36:39], v[24:27], v[64:67]
    v_cvt_pk_bf16_f32 v84, v164, v165
    v_cvt_pk_bf16_f32 v85, v166, v167
    buffer_load_dwordx4 v244, s[24:27], s74 offen nt lds
    v_mfma_f32_16x16x32_bf16 v[164:167], a[16:19], v[4:7], 0
    v_mfma_f32_16x16x32_bf16 v[164:167], a[40:43], v[16:19], v[164:167]
    v_cvt_pk_bf16_f32 v96, v188, v189
    v_cvt_pk_bf16_f32 v97, v190, v191
    v_mfma_f32_16x16x32_bf16 v[188:191], a[16:19], v[8:11], 0
    buffer_load_dwordx4 v245, s[24:27], s74 offen offset:1024 nt lds
    v_mfma_f32_16x16x32_bf16 v[188:191], a[40:43], v[20:23], v[188:191]
    v_cvt_pk_bf16_f32 v108, v68, v69
    v_cvt_pk_bf16_f32 v109, v70, v71
    v_mfma_f32_16x16x32_bf16 v[68:71], a[16:19], v[12:15], 0
    v_mfma_f32_16x16x32_bf16 v[68:71], a[40:43], v[24:27], v[68:71]
    v_cvt_pk_bf16_f32 v86, v168, v169
    v_cvt_pk_bf16_f32 v87, v170, v171
    buffer_load_dwordx4 v246, s[24:27], s74 offen offset:2048 nt lds
    v_mfma_f32_16x16x32_bf16 v[168:171], a[20:23], v[4:7], 0
    v_mfma_f32_16x16x32_bf16 v[168:171], a[44:47], v[16:19], v[168:171]
    v_cvt_pk_bf16_f32 v98, v192, v193
    v_cvt_pk_bf16_f32 v99, v194, v195
    v_mfma_f32_16x16x32_bf16 v[192:195], a[20:23], v[8:11], 0
    v_mfma_f32_16x16x32_bf16 v[192:195], a[44:47], v[20:23], v[192:195]
    v_cvt_pk_bf16_f32 v110, v72, v73
    v_cvt_pk_bf16_f32 v111, v74, v75
    v_mfma_f32_16x16x32_bf16 v[72:75], a[20:23], v[12:15], 0
    v_mfma_f32_16x16x32_bf16 v[72:75], a[44:47], v[24:27], v[72:75]
    s_waitcnt lgkmcnt(0)
    v_mfma_f32_16x16x32_bf16 v[148:151], a[48:51], v[28:31], v[148:151]
    v_mfma_f32_16x16x32_bf16 v[148:151], a[72:75], v[40:43], v[148:151]
    v_mfma_f32_16x16x32_bf16 v[172:175], a[48:51], v[32:35], v[172:175]
    ds_read_b128 v[4:7], v228 offset:24832
    v_mfma_f32_16x16x32_bf16 v[172:175], a[72:75], v[44:47], v[172:175]
    v_mfma_f32_16x16x32_bf16 v[52:55], a[48:51], v[36:39], v[52:55]
    s_add_u32 s75, s2, 344
    s_and_b32 s75, s75, 255
    v_mfma_f32_16x16x32_bf16 v[52:55], a[72:75], v[48:51], v[52:55]
    s_add_u32 s75, s75, 2048
    s_mul_i32 s75, s75, 12288
    v_mfma_f32_16x16x32_bf16 v[152:155], a[52:55], v[28:31], v[152:155]
    ds_read_b128 v[8:11], v228 offset:37120
    s_add_u32 m0, s49, 135168
    v_mfma_f32_16x16x32_bf16 v[152:155], a[76:79], v[40:43], v[152:155]
    buffer_load_dwordx4 v244, s[24:27], s75 offen nt lds
    v_mfma_f32_16x16x32_bf16 v[176:179], a[52:55], v[32:35], v[176:179]
    v_mfma_f32_16x16x32_bf16 v[176:179], a[76:79], v[44:47], v[176:179]
    v_mfma_f32_16x16x32_bf16 v[56:59], a[52:55], v[36:39], v[56:59]
    ds_read_b128 v[12:15], v240 offset:24832
    buffer_load_dwordx4 v245, s[24:27], s75 offen offset:1024 nt lds
    v_mfma_f32_16x16x32_bf16 v[56:59], a[76:79], v[48:51], v[56:59]
    v_mfma_f32_16x16x32_bf16 v[156:159], a[56:59], v[28:31], v[156:159]
    v_mfma_f32_16x16x32_bf16 v[156:159], a[80:83], v[40:43], v[156:159]
    buffer_load_dwordx4 v246, s[24:27], s75 offen offset:2048 nt lds
    v_mfma_f32_16x16x32_bf16 v[180:183], a[56:59], v[32:35], v[180:183]
    ds_read_b128 v[16:19], v229 offset:24832
    v_mfma_f32_16x16x32_bf16 v[180:183], a[80:83], v[44:47], v[180:183]
    v_mfma_f32_16x16x32_bf16 v[60:63], a[56:59], v[36:39], v[60:63]
    v_mfma_f32_16x16x32_bf16 v[60:63], a[80:83], v[48:51], v[60:63]
    v_mfma_f32_16x16x32_bf16 v[160:163], a[60:63], v[28:31], v[160:163]
    ds_read_b128 v[20:23], v229 offset:37120
    v_mfma_f32_16x16x32_bf16 v[160:163], a[84:87], v[40:43], v[160:163]
    v_mfma_f32_16x16x32_bf16 v[184:187], a[60:63], v[32:35], v[184:187]
    v_mfma_f32_16x16x32_bf16 v[184:187], a[84:87], v[44:47], v[184:187]
    v_mfma_f32_16x16x32_bf16 v[64:67], a[60:63], v[36:39], v[64:67]
    ds_read_b128 v[24:27], v241 offset:24832
    v_mfma_f32_16x16x32_bf16 v[64:67], a[84:87], v[48:51], v[64:67]
    v_mfma_f32_16x16x32_bf16 v[164:167], a[64:67], v[28:31], v[164:167]
    s_add_u32 s76, s78, 0
    s_add_u32 m0, s49, 0
    v_mfma_f32_16x16x32_bf16 v[164:167], a[88:91], v[40:43], v[164:167]
    buffer_load_dwordx4 v232, s[20:23], s76 offen nt lds
    v_mfma_f32_16x16x32_bf16 v[188:191], a[64:67], v[32:35], v[188:191]
    v_mfma_f32_16x16x32_bf16 v[188:191], a[88:91], v[44:47], v[188:191]
    v_mfma_f32_16x16x32_bf16 v[68:71], a[64:67], v[36:39], v[68:71]
    buffer_load_dwordx4 v233, s[20:23], s76 offen offset:1024 nt lds
    v_mfma_f32_16x16x32_bf16 v[68:71], a[88:91], v[48:51], v[68:71]
    v_mfma_f32_16x16x32_bf16 v[168:171], a[68:71], v[28:31], v[168:171]
    v_mfma_f32_16x16x32_bf16 v[168:171], a[92:95], v[40:43], v[168:171]
    buffer_load_dwordx4 v234, s[20:23], s76 offen offset:2048 nt lds
    v_mfma_f32_16x16x32_bf16 v[192:195], a[68:71], v[32:35], v[192:195]
    v_mfma_f32_16x16x32_bf16 v[192:195], a[92:95], v[44:47], v[192:195]
    v_mfma_f32_16x16x32_bf16 v[72:75], a[68:71], v[36:39], v[72:75]
    v_mfma_f32_16x16x32_bf16 v[72:75], a[92:95], v[48:51], v[72:75]
    s_waitcnt lgkmcnt(0)
    v_mfma_f32_16x16x32_bf16 v[148:151], a[96:99], v[4:7], v[148:151]
    v_mfma_f32_16x16x32_bf16 v[148:151], a[120:123], v[16:19], v[148:151]
    v_mfma_f32_16x16x32_bf16 v[172:175], a[96:99], v[8:11], v[172:175]
    ds_read_b128 v[28:31], v230 offset:24832
    v_mfma_f32_16x16x32_bf16 v[172:175], a[120:123], v[20:23], v[172:175]
    v_mfma_f32_16x16x32_bf16 v[52:55], a[96:99], v[12:15], v[52:55]
    v_mfma_f32_16x16x32_bf16 v[52:55], a[120:123], v[24:27], v[52:55]
    v_mfma_f32_16x16x32_bf16 v[152:155], a[100:103], v[4:7], v[152:155]
    ds_read_b128 v[32:35], v230 offset:37120
    v_mfma_f32_16x16x32_bf16 v[152:155], a[124:127], v[16:19], v[152:155]
    v_mfma_f32_16x16x32_bf16 v[176:179], a[100:103], v[8:11], v[176:179]
    s_add_u32 s77, s78, 768
    s_add_u32 m0, s49, 12288
    v_mfma_f32_16x16x32_bf16 v[176:179], a[124:127], v[20:23], v[176:179]
    buffer_load_dwordx4 v232, s[20:23], s77 offen nt lds
    v_mfma_f32_16x16x32_bf16 v[56:59], a[100:103], v[12:15], v[56:59]
    ds_read_b128 v[36:39], v242 offset:24832
    v_mfma_f32_16x16x32_bf16 v[56:59], a[124:127], v[24:27], v[56:59]
    v_mfma_f32_16x16x32_bf16 v[156:159], a[104:107], v[4:7], v[156:159]
    buffer_load_dwordx4 v233, s[20:23], s77 offen offset:1024 nt lds
    v_mfma_f32_16x16x32_bf16 v[156:159], a[128:131], v[16:19], v[156:159]
    v_mfma_f32_16x16x32_bf16 v[180:183], a[104:107], v[8:11], v[180:183]
    ds_read_b128 v[40:43], v231 offset:24832
    v_mfma_f32_16x16x32_bf16 v[180:183], a[128:131], v[20:23], v[180:183]
    buffer_load_dwordx4 v234, s[20:23], s77 offen offset:2048 nt lds
    v_mfma_f32_16x16x32_bf16 v[60:63], a[104:107], v[12:15], v[60:63]
    v_mfma_f32_16x16x32_bf16 v[60:63], a[128:131], v[24:27], v[60:63]
    v_mfma_f32_16x16x32_bf16 v[160:163], a[108:111], v[4:7], v[160:163]
    ds_read_b128 v[44:47], v231 offset:37120
    v_mfma_f32_16x16x32_bf16 v[160:163], a[132:135], v[16:19], v[160:163]
    v_mfma_f32_16x16x32_bf16 v[184:187], a[108:111], v[8:11], v[184:187]
    v_mfma_f32_16x16x32_bf16 v[184:187], a[132:135], v[20:23], v[184:187]
    v_mfma_f32_16x16x32_bf16 v[64:67], a[108:111], v[12:15], v[64:67]
    ds_read_b128 v[48:51], v243 offset:24832
    v_mfma_f32_16x16x32_bf16 v[64:67], a[132:135], v[24:27], v[64:67]
    v_mfma_f32_16x16x32_bf16 v[164:167], a[112:115], v[4:7], v[164:167]
    v_mfma_f32_16x16x32_bf16 v[164:167], a[136:139], v[16:19], v[164:167]
    v_mfma_f32_16x16x32_bf16 v[188:191], a[112:115], v[8:11], v[188:191]
    v_mfma_f32_16x16x32_bf16 v[188:191], a[136:139], v[20:23], v[188:191]
    v_mfma_f32_16x16x32_bf16 v[68:71], a[112:115], v[12:15], v[68:71]
    v_mfma_f32_16x16x32_bf16 v[68:71], a[136:139], v[24:27], v[68:71]
    v_mfma_f32_16x16x32_bf16 v[168:171], a[116:119], v[4:7], v[168:171]
    v_mfma_f32_16x16x32_bf16 v[168:171], a[140:143], v[16:19], v[168:171]
    v_mfma_f32_16x16x32_bf16 v[192:195], a[116:119], v[8:11], v[192:195]
    v_mfma_f32_16x16x32_bf16 v[192:195], a[140:143], v[20:23], v[192:195]
    v_mfma_f32_16x16x32_bf16 v[72:75], a[116:119], v[12:15], v[72:75]
    v_mfma_f32_16x16x32_bf16 v[72:75], a[140:143], v[24:27], v[72:75]
    s_waitcnt lgkmcnt(0)
    v_mfma_f32_16x16x32_bf16 v[148:151], a[144:147], v[28:31], v[148:151]
    v_mfma_f32_16x16x32_bf16 v[148:151], a[168:171], v[40:43], v[148:151]
    v_mfma_f32_16x16x32_bf16 v[172:175], a[144:147], v[32:35], v[172:175]
    ds_read_b128 v[4:7], v228 offset:25088
    v_mfma_f32_16x16x32_bf16 v[172:175], a[168:171], v[44:47], v[172:175]
    v_mfma_f32_16x16x32_bf16 v[52:55], a[144:147], v[36:39], v[52:55]
    v_mfma_f32_16x16x32_bf16 v[52:55], a[168:171], v[48:51], v[52:55]
    v_mfma_f32_16x16x32_bf16 v[152:155], a[148:151], v[28:31], v[152:155]
    ds_read_b128 v[8:11], v228 offset:37376
    v_mfma_f32_16x16x32_bf16 v[152:155], a[172:175], v[40:43], v[152:155]
    v_mfma_f32_16x16x32_bf16 v[176:179], a[148:151], v[32:35], v[176:179]
    v_mfma_f32_16x16x32_bf16 v[176:179], a[172:175], v[44:47], v[176:179]
    v_mfma_f32_16x16x32_bf16 v[56:59], a[148:151], v[36:39], v[56:59]
    ds_read_b128 v[12:15], v240 offset:25088
    v_mfma_f32_16x16x32_bf16 v[56:59], a[172:175], v[48:51], v[56:59]
    v_mfma_f32_16x16x32_bf16 v[156:159], a[152:155], v[28:31], v[156:159]
    v_mfma_f32_16x16x32_bf16 v[156:159], a[176:179], v[40:43], v[156:159]
    v_mfma_f32_16x16x32_bf16 v[180:183], a[152:155], v[32:35], v[180:183]
    ds_read_b128 v[16:19], v229 offset:25088
    v_mfma_f32_16x16x32_bf16 v[180:183], a[176:179], v[44:47], v[180:183]
    v_mfma_f32_16x16x32_bf16 v[60:63], a[152:155], v[36:39], v[60:63]
    v_mfma_f32_16x16x32_bf16 v[60:63], a[176:179], v[48:51], v[60:63]
    v_mfma_f32_16x16x32_bf16 v[160:163], a[156:159], v[28:31], v[160:163]
    ds_read_b128 v[20:23], v229 offset:37376
    v_mfma_f32_16x16x32_bf16 v[160:163], a[180:183], v[40:43], v[160:163]
    v_mfma_f32_16x16x32_bf16 v[184:187], a[156:159], v[32:35], v[184:187]
    v_mfma_f32_16x16x32_bf16 v[184:187], a[180:183], v[44:47], v[184:187]
    v_mfma_f32_16x16x32_bf16 v[64:67], a[156:159], v[36:39], v[64:67]
    ds_read_b128 v[24:27], v241 offset:25088
    v_mfma_f32_16x16x32_bf16 v[64:67], a[180:183], v[48:51], v[64:67]
    v_mfma_f32_16x16x32_bf16 v[164:167], a[160:163], v[28:31], v[164:167]
    v_mfma_f32_16x16x32_bf16 v[164:167], a[184:187], v[40:43], v[164:167]
    v_mfma_f32_16x16x32_bf16 v[188:191], a[160:163], v[32:35], v[188:191]
    v_mfma_f32_16x16x32_bf16 v[188:191], a[184:187], v[44:47], v[188:191]
    v_mfma_f32_16x16x32_bf16 v[68:71], a[160:163], v[36:39], v[68:71]
    v_mfma_f32_16x16x32_bf16 v[68:71], a[184:187], v[48:51], v[68:71]
    v_mfma_f32_16x16x32_bf16 v[168:171], a[164:167], v[28:31], v[168:171]
    v_mfma_f32_16x16x32_bf16 v[168:171], a[188:191], v[40:43], v[168:171]
    v_mfma_f32_16x16x32_bf16 v[192:195], a[164:167], v[32:35], v[192:195]
    v_mfma_f32_16x16x32_bf16 v[192:195], a[188:191], v[44:47], v[192:195]
    v_mfma_f32_16x16x32_bf16 v[72:75], a[164:167], v[36:39], v[72:75]
    v_mfma_f32_16x16x32_bf16 v[72:75], a[188:191], v[48:51], v[72:75]
    s_waitcnt lgkmcnt(0)
    v_mfma_f32_16x16x32_bf16 v[148:151], a[192:195], v[4:7], v[148:151]
    s_load_dword s72, s[14:15], 0
    v_mfma_f32_16x16x32_bf16 v[148:151], a[216:219], v[16:19], v[148:151]
    v_mfma_f32_16x16x32_bf16 v[172:175], a[192:195], v[8:11], v[172:175]
    ds_read_b128 v[28:31], v230 offset:25088
    v_mfma_f32_16x16x32_bf16 v[172:175], a[216:219], v[20:23], v[172:175]
    v_mfma_f32_16x16x32_bf16 v[52:55], a[192:195], v[12:15], v[52:55]
    v_mfma_f32_16x16x32_bf16 v[52:55], a[216:219], v[24:27], v[52:55]
    v_mfma_f32_16x16x32_bf16 v[152:155], a[196:199], v[4:7], v[152:155]
    ds_read_b128 v[32:35], v230 offset:37376
    v_mfma_f32_16x16x32_bf16 v[152:155], a[220:223], v[16:19], v[152:155]
    v_mfma_f32_16x16x32_bf16 v[176:179], a[196:199], v[8:11], v[176:179]
    v_mfma_f32_16x16x32_bf16 v[176:179], a[220:223], v[20:23], v[176:179]
    v_mfma_f32_16x16x32_bf16 v[56:59], a[196:199], v[12:15], v[56:59]
    ds_read_b128 v[36:39], v242 offset:25088
    v_mfma_f32_16x16x32_bf16 v[56:59], a[220:223], v[24:27], v[56:59]
    v_mfma_f32_16x16x32_bf16 v[156:159], a[200:203], v[4:7], v[156:159]
    v_mfma_f32_16x16x32_bf16 v[156:159], a[224:227], v[16:19], v[156:159]
    v_mfma_f32_16x16x32_bf16 v[180:183], a[200:203], v[8:11], v[180:183]
    ds_read_b128 v[40:43], v231 offset:25088
    v_mfma_f32_16x16x32_bf16 v[180:183], a[224:227], v[20:23], v[180:183]
    v_mfma_f32_16x16x32_bf16 v[60:63], a[200:203], v[12:15], v[60:63]
    v_mfma_f32_16x16x32_bf16 v[60:63], a[224:227], v[24:27], v[60:63]
    v_mfma_f32_16x16x32_bf16 v[160:163], a[204:207], v[4:7], v[160:163]
    ds_read_b128 v[44:47], v231 offset:37376
    v_mfma_f32_16x16x32_bf16 v[160:163], a[228:231], v[16:19], v[160:163]
    v_mfma_f32_16x16x32_bf16 v[184:187], a[204:207], v[8:11], v[184:187]
    v_mfma_f32_16x16x32_bf16 v[184:187], a[228:231], v[20:23], v[184:187]
    v_mfma_f32_16x16x32_bf16 v[64:67], a[204:207], v[12:15], v[64:67]
    ds_read_b128 v[48:51], v243 offset:25088
    v_mfma_f32_16x16x32_bf16 v[64:67], a[228:231], v[24:27], v[64:67]
    v_mfma_f32_16x16x32_bf16 v[164:167], a[208:211], v[4:7], v[164:167]
    v_mfma_f32_16x16x32_bf16 v[164:167], a[232:235], v[16:19], v[164:167]
    v_mfma_f32_16x16x32_bf16 v[188:191], a[208:211], v[8:11], v[188:191]
    v_mfma_f32_16x16x32_bf16 v[188:191], a[232:235], v[20:23], v[188:191]
    v_mfma_f32_16x16x32_bf16 v[68:71], a[208:211], v[12:15], v[68:71]
    v_mfma_f32_16x16x32_bf16 v[68:71], a[232:235], v[24:27], v[68:71]
    v_mfma_f32_16x16x32_bf16 v[168:171], a[212:215], v[4:7], v[168:171]
    v_mfma_f32_16x16x32_bf16 v[168:171], a[236:239], v[16:19], v[168:171]
    v_mfma_f32_16x16x32_bf16 v[192:195], a[212:215], v[8:11], v[192:195]
    v_mfma_f32_16x16x32_bf16 v[192:195], a[236:239], v[20:23], v[192:195]
    v_mfma_f32_16x16x32_bf16 v[72:75], a[212:215], v[12:15], v[72:75]
    s_waitcnt lgkmcnt(0)
    s_cmp_ge_u32 s72, 24
    s_cbranch_scc0 L_nopft
    s_mov_b32 exec_hi, 15
    buffer_load_dword v254, v253, s[40:43], 0 offen sc1
    s_mov_b64 exec, -1
L_nopft:
    v_mfma_f32_16x16x32_bf16 v[72:75], a[236:239], v[24:27], v[72:75]
    s_waitcnt vmcnt(6) lgkmcnt(0)
    s_barrier
    v_mfma_f32_16x16x32_bf16 v[148:151], a[240:243], v[28:31], v[148:151]
    v_mfma_f32_16x16x32_bf16 v[148:151], v[204:207], v[40:43], v[148:151]
    v_mfma_f32_16x16x32_bf16 v[172:175], a[240:243], v[32:35], v[172:175]
    ds_read_b128 v[4:7], v240 offset:36864
    v_mfma_f32_16x16x32_bf16 v[172:175], v[204:207], v[44:47], v[172:175]
    v_mfma_f32_16x16x32_bf16 v[52:55], a[240:243], v[36:39], v[52:55]
    v_mfma_f32_16x16x32_bf16 v[52:55], v[204:207], v[48:51], v[52:55]
    v_mfma_f32_16x16x32_bf16 v[152:155], a[244:247], v[28:31], v[152:155]
    ds_read_b128 v[8:11], v240 offset:49152
    v_mfma_f32_16x16x32_bf16 v[152:155], v[208:211], v[40:43], v[152:155]
    v_mfma_f32_16x16x32_bf16 v[176:179], a[244:247], v[32:35], v[176:179]
    v_mfma_f32_16x16x32_bf16 v[176:179], v[208:211], v[44:47], v[176:179]
    v_mfma_f32_16x16x32_bf16 v[56:59], a[244:247], v[36:39], v[56:59]
    ds_read_b128 v[12:15], v240 offset:61440
    v_mfma_f32_16x16x32_bf16 v[56:59], v[208:211], v[48:51], v[56:59]
    v_mfma_f32_16x16x32_bf16 v[156:159], a[248:251], v[28:31], v[156:159]
    v_mfma_f32_16x16x32_bf16 v[156:159], v[212:215], v[40:43], v[156:159]
    v_mfma_f32_16x16x32_bf16 v[180:183], a[248:251], v[32:35], v[180:183]
    ds_read_b128 v[16:19], v241 offset:36864
    v_mfma_f32_16x16x32_bf16 v[180:183], v[212:215], v[44:47], v[180:183]
    v_mfma_f32_16x16x32_bf16 v[60:63], a[248:251], v[36:39], v[60:63]
    v_mfma_f32_16x16x32_bf16 v[60:63], v[212:215], v[48:51], v[60:63]
    v_mfma_f32_16x16x32_bf16 v[160:163], a[252:255], v[28:31], v[160:163]
    ds_read_b128 v[20:23], v241 offset:49152
    v_mfma_f32_16x16x32_bf16 v[160:163], v[216:219], v[40:43], v[160:163]
    v_mfma_f32_16x16x32_bf16 v[184:187], a[252:255], v[32:35], v[184:187]
    v_mfma_f32_16x16x32_bf16 v[184:187], v[216:219], v[44:47], v[184:187]
    v_mfma_f32_16x16x32_bf16 v[64:67], a[252:255], v[36:39], v[64:67]
    ds_read_b128 v[24:27], v241 offset:61440
    v_mfma_f32_16x16x32_bf16 v[64:67], v[216:219], v[48:51], v[64:67]
    v_mfma_f32_16x16x32_bf16 v[164:167], v[196:199], v[28:31], v[164:167]
    v_mfma_f32_16x16x32_bf16 v[164:167], v[220:223], v[40:43], v[164:167]
    v_mfma_f32_16x16x32_bf16 v[188:191], v[196:199], v[32:35], v[188:191]
    v_mfma_f32_16x16x32_bf16 v[188:191], v[220:223], v[44:47], v[188:191]
    v_mfma_f32_16x16x32_bf16 v[68:71], v[196:199], v[36:39], v[68:71]
    v_mfma_f32_16x16x32_bf16 v[68:71], v[220:223], v[48:51], v[68:71]
    v_mfma_f32_16x16x32_bf16 v[168:171], v[200:203], v[28:31], v[168:171]
    v_mfma_f32_16x16x32_bf16 v[168:171], v[224:227], v[40:43], v[168:171]
    v_mfma_f32_16x16x32_bf16 v[192:195], v[200:203], v[32:35], v[192:195]
    v_mfma_f32_16x16x32_bf16 v[192:195], v[224:227], v[44:47], v[192:195]
    v_mfma_f32_16x16x32_bf16 v[72:75], v[200:203], v[36:39], v[72:75]
    v_mfma_f32_16x16x32_bf16 v[72:75], v[224:227], v[48:51], v[72:75]
L_p2done:
    s_cmp_ge_u32 s72, 24
    s_cbranch_scc0 L_poll
L_ready:
    s_waitcnt lgkmcnt(0)
    v_cvt_pk_bf16_f32 v112, v148, v149
    v_cvt_pk_bf16_f32 v113, v150, v151
    v_mfma_f32_16x16x32_bf16 v[148:151], a[0:3], v[4:7], 0
    v_mfma_f32_16x16x32_bf16 v[148:151], a[24:27], v[16:19], v[148:151]
    v_cvt_pk_bf16_f32 v124, v172, v173
    v_cvt_pk_bf16_f32 v125, v174, v175
    v_mfma_f32_16x16x32_bf16 v[172:175], a[0:3], v[8:11], 0
    ds_read_b128 v[28:31], v242 offset:36864
    s_mov_b32 s74, 0
    v_mfma_f32_16x16x32_bf16 v[172:175], a[24:27], v[20:23], v[172:175]
    v_cvt_pk_bf16_f32 v136, v52, v53
    v_cvt_pk_bf16_f32 v137, v54, v55
    v_mfma_f32_16x16x32_bf16 v[52:55], a[0:3], v[12:15], 0
    buffer_load_dwordx4 a[0:3], v252, s[40:43], s74 offen sc1
    v_mfma_f32_16x16x32_bf16 v[52:55], a[24:27], v[24:27], v[52:55]
    v_cvt_pk_bf16_f32 v114, v152, v153
    v_cvt_pk_bf16_f32 v115, v154, v155
    v_mfma_f32_16x16x32_bf16 v[152:155], a[4:7], v[4:7], 0
    ds_read_b128 v[32:35], v242 offset:49152
    v_mfma_f32_16x16x32_bf16 v[152:155], a[28:31], v[16:19], v[152:155]
    v_cvt_pk_bf16_f32 v126, v176, v177
    v_cvt_pk_bf16_f32 v127, v178, v179
    buffer_load_dwordx4 a[24:27], v252, s[40:43], s74 offen offset:1024 sc1
    v_mfma_f32_16x16x32_bf16 v[176:179], a[4:7], v[8:11], 0
    v_mfma_f32_16x16x32_bf16 v[176:179], a[28:31], v[20:23], v[176:179]
    v_cvt_pk_bf16_f32 v138, v56, v57
    v_cvt_pk_bf16_f32 v139, v58, v59
    v_mfma_f32_16x16x32_bf16 v[56:59], a[4:7], v[12:15], 0
    ds_read_b128 v[36:39], v242 offset:61440
    buffer_load_dwordx4 a[4:7], v252, s[40:43], s74 offen offset:2048 sc1
    v_mfma_f32_16x16x32_bf16 v[56:59], a[28:31], v[24:27], v[56:59]
    v_cvt_pk_bf16_f32 v116, v156, v157
    v_cvt_pk_bf16_f32 v117, v158, v159
    v_mfma_f32_16x16x32_bf16 v[156:159], a[8:11], v[4:7], 0
    v_mfma_f32_16x16x32_bf16 v[156:159], a[32:35], v[16:19], v[156:159]
    v_cvt_pk_bf16_f32 v128, v180, v181
    v_cvt_pk_bf16_f32 v129, v182, v183
    buffer_load_dwordx4 a[28:31], v252, s[40:43], s74 offen offset:3072 sc1
    v_mfma_f32_16x16x32_bf16 v[180:183], a[8:11], v[8:11], 0
    ds_read_b128 v[40:43], v243 offset:36864
    s_mov_b32 s75, 4096
    v_mfma_f32_16x16x32_bf16 v[180:183], a[32:35], v[20:23], v[180:183]
    v_cvt_pk_bf16_f32 v140, v60, v61
    v_cvt_pk_bf16_f32 v141, v62, v63
    v_mfma_f32_16x16x32_bf16 v[60:63], a[8:11], v[12:15], 0
    buffer_load_dwordx4 a[8:11], v252, s[40:43], s75 offen sc1
    v_mfma_f32_16x16x32_bf16 v[60:63], a[32:35], v[24:27], v[60:63]
    v_cvt_pk_bf16_f32 v118, v160, v161
    v_cvt_pk_bf16_f32 v119, v162, v163
    v_mfma_f32_16x16x32_bf16 v[160:163], a[12:15], v[4:7], 0
    ds_read_b128 v[44:47], v243 offset:49152
    v_mfma_f32_16x16x32_bf16 v[160:163], a[36:39], v[16:19], v[160:163]
    v_cvt_pk_bf16_f32 v130, v184, v185
    v_cvt_pk_bf16_f32 v131, v186, v187
    buffer_load_dwordx4 a[32:35], v252, s[40:43], s75 offen offset:1024 sc1
    v_mfma_f32_16x16x32_bf16 v[184:187], a[12:15], v[8:11], 0
    v_mfma_f32_16x16x32_bf16 v[184:187], a[36:39], v[20:23], v[184:187]
    v_cvt_pk_bf16_f32 v142, v64, v65
    v_cvt_pk_bf16_f32 v143, v66, v67
    v_mfma_f32_16x16x32_bf16 v[64:67], a[12:15], v[12:15], 0
    ds_read_b128 v[48:51], v243 offset:61440
    buffer_load_dwordx4 a[12:15], v252, s[40:43], s75 offen offset:2048 sc1
    v_mfma_f32_16x16x32_bf16 v[64:67], a[36:39], v[24:27], v[64:67]
    v_cvt_pk_bf16_f32 v120, v164, v165
    v_cvt_pk_bf16_f32 v121, v166, v167
    v_mfma_f32_16x16x32_bf16 v[164:167], a[16:19], v[4:7], 0
    v_mfma_f32_16x16x32_bf16 v[164:167], a[40:43], v[16:19], v[164:167]
    v_cvt_pk_bf16_f32 v132, v188, v189
    v_cvt_pk_bf16_f32 v133, v190, v191
    buffer_load_dwordx4 a[36:39], v252, s[40:43], s75 offen offset:3072 sc1
    v_mfma_f32_16x16x32_bf16 v[188:191], a[16:19], v[8:11], 0
    s_mov_b32 s76, 8192
    v_mfma_f32_16x16x32_bf16 v[188:191], a[40:43], v[20:23], v[188:191]
    v_cvt_pk_bf16_f32 v144, v68, v69
    v_cvt_pk_bf16_f32 v145, v70, v71
    v_mfma_f32_16x16x32_bf16 v[68:71], a[16:19], v[12:15], 0
    buffer_load_dwordx4 a[16:19], v252, s[40:43], s76 offen sc1
    v_mfma_f32_16x16x32_bf16 v[68:71], a[40:43], v[24:27], v[68:71]
    v_cvt_pk_bf16_f32 v122, v168, v169
    v_cvt_pk_bf16_f32 v123, v170, v171
    v_mfma_f32_16x16x32_bf16 v[168:171], a[20:23], v[4:7], 0
    v_mfma_f32_16x16x32_bf16 v[168:171], a[44:47], v[16:19], v[168:171]
    v_cvt_pk_bf16_f32 v134, v192, v193
    v_cvt_pk_bf16_f32 v135, v194, v195
    buffer_load_dwordx4 a[40:43], v252, s[40:43], s76 offen offset:1024 sc1
    v_mfma_f32_16x16x32_bf16 v[192:195], a[20:23], v[8:11], 0
    v_mfma_f32_16x16x32_bf16 v[192:195], a[44:47], v[20:23], v[192:195]
    v_cvt_pk_bf16_f32 v146, v72, v73
    v_cvt_pk_bf16_f32 v147, v74, v75
    v_mfma_f32_16x16x32_bf16 v[72:75], a[20:23], v[12:15], 0
    buffer_load_dwordx4 a[20:23], v252, s[40:43], s76 offen offset:2048 sc1
    v_mfma_f32_16x16x32_bf16 v[72:75], a[44:47], v[24:27], v[72:75]
    s_waitcnt lgkmcnt(0)
    v_mfma_f32_16x16x32_bf16 v[148:151], a[48:51], v[28:31], v[148:151]
    v_mfma_f32_16x16x32_bf16 v[148:151], a[72:75], v[40:43], v[148:151]
    buffer_load_dwordx4 a[44:47], v252, s[40:43], s76 offen offset:3072 sc1
    v_mfma_f32_16x16x32_bf16 v[172:175], a[48:51], v[32:35], v[172:175]
    ds_read_b128 v[4:7], v240 offset:37120
    s_mov_b32 s77, 12288
    v_mfma_f32_16x16x32_bf16 v[172:175], a[72:75], v[44:47], v[172:175]
    v_mfma_f32_16x16x32_bf16 v[52:55], a[48:51], v[36:39], v[52:55]
    buffer_load_dwordx4 a[48:51], v252, s[40:43], s77 offen sc1
    v_mfma_f32_16x16x32_bf16 v[52:55], a[72:75], v[48:51], v[52:55]
    v_mfma_f32_16x16x32_bf16 v[152:155], a[52:55], v[28:31], v[152:155]
    ds_read_b128 v[8:11], v240 offset:49408
    v_mfma_f32_16x16x32_bf16 v[152:155], a[76:79], v[40:43], v[152:155]
    buffer_load_dwordx4 a[72:75], v252, s[40:43], s77 offen offset:1024 sc1
    v_mfma_f32_16x16x32_bf16 v[176:179], a[52:55], v[32:35], v[176:179]
    v_mfma_f32_16x16x32_bf16 v[176:179], a[76:79], v[44:47], v[176:179]
    v_mfma_f32_16x16x32_bf16 v[56:59], a[52:55], v[36:39], v[56:59]
    ds_read_b128 v[12:15], v240 offset:61696
    buffer_load_dwordx4 a[52:55], v252, s[40:43], s77 offen offset:2048 sc1
    v_mfma_f32_16x16x32_bf16 v[56:59], a[76:79], v[48:51], v[56:59]
    v_mfma_f32_16x16x32_bf16 v[156:159], a[56:59], v[28:31], v[156:159]
    v_mfma_f32_16x16x32_bf16 v[156:159], a[80:83], v[40:43], v[156:159]
    buffer_load_dwordx4 a[76:79], v252, s[40:43], s77 offen offset:3072 sc1
    v_mfma_f32_16x16x32_bf16 v[180:183], a[56:59], v[32:35], v[180:183]
    ds_read_b128 v[16:19], v241 offset:37120
    s_mov_b32 s74, 16384
    v_mfma_f32_16x16x32_bf16 v[180:183], a[80:83], v[44:47], v[180:183]
    v_mfma_f32_16x16x32_bf16 v[60:63], a[56:59], v[36:39], v[60:63]
    buffer_load_dwordx4 a[56:59], v252, s[40:43], s74 offen sc1
    v_mfma_f32_16x16x32_bf16 v[60:63], a[80:83], v[48:51], v[60:63]
    v_mfma_f32_16x16x32_bf16 v[160:163], a[60:63], v[28:31], v[160:163]
    ds_read_b128 v[20:23], v241 offset:49408
    v_mfma_f32_16x16x32_bf16 v[160:163], a[84:87], v[40:43], v[160:163]
    buffer_load_dwordx4 a[80:83], v252, s[40:43], s74 offen offset:1024 sc1
    v_mfma_f32_16x16x32_bf16 v[184:187], a[60:63], v[32:35], v[184:187]
    v_mfma_f32_16x16x32_bf16 v[184:187], a[84:87], v[44:47], v[184:187]
    v_mfma_f32_16x16x32_bf16 v[64:67], a[60:63], v[36:39], v[64:67]
    ds_read_b128 v[24:27], v241 offset:61696
    buffer_load_dwordx4 a[60:63], v252, s[40:43], s74 offen offset:2048 sc1
    v_mfma_f32_16x16x32_bf16 v[64:67], a[84:87], v[48:51], v[64:67]
    v_mfma_f32_16x16x32_bf16 v[164:167], a[64:67], v[28:31], v[164:167]
    v_mfma_f32_16x16x32_bf16 v[164:167], a[88:91], v[40:43], v[164:167]
    buffer_load_dwordx4 a[84:87], v252, s[40:43], s74 offen offset:3072 sc1
    v_mfma_f32_16x16x32_bf16 v[188:191], a[64:67], v[32:35], v[188:191]
    s_mov_b32 s75, 20480
    v_mfma_f32_16x16x32_bf16 v[188:191], a[88:91], v[44:47], v[188:191]
    v_mfma_f32_16x16x32_bf16 v[68:71], a[64:67], v[36:39], v[68:71]
    buffer_load_dwordx4 a[64:67], v252, s[40:43], s75 offen sc1
    v_mfma_f32_16x16x32_bf16 v[68:71], a[88:91], v[48:51], v[68:71]
    v_mfma_f32_16x16x32_bf16 v[168:171], a[68:71], v[28:31], v[168:171]
    v_mfma_f32_16x16x32_bf16 v[168:171], a[92:95], v[40:43], v[168:171]
    buffer_load_dwordx4 a[88:91], v252, s[40:43], s75 offen offset:1024 sc1
    v_mfma_f32_16x16x32_bf16 v[192:195], a[68:71], v[32:35], v[192:195]
    v_mfma_f32_16x16x32_bf16 v[192:195], a[92:95], v[44:47], v[192:195]
    v_mfma_f32_16x16x32_bf16 v[72:75], a[68:71], v[36:39], v[72:75]
    buffer_load_dwordx4 a[68:71], v252, s[40:43], s75 offen offset:2048 sc1
    v_mfma_f32_16x16x32_bf16 v[72:75], a[92:95], v[48:51], v[72:75]
    s_waitcnt lgkmcnt(0)
    v_mfma_f32_16x16x32_bf16 v[148:151], a[96:99], v[4:7], v[148:151]
    v_mfma_f32_16x16x32_bf16 v[148:151], a[120:123], v[16:19], v[148:151]
    buffer_load_dwordx4 a[92:95], v252, s[40:43], s75 offen offset:3072 sc1
    v_mfma_f32_16x16x32_bf16 v[172:175], a[96:99], v[8:11], v[172:175]
    ds_read_b128 v[28:31], v242 offset:37120
    s_mov_b32 s76, 24576
    v_mfma_f32_16x16x32_bf16 v[172:175], a[120:123], v[20:23], v[172:175]
    v_mfma_f32_16x16x32_bf16 v[52:55], a[96:99], v[12:15], v[52:55]
    buffer_load_dwordx4 a[96:99], v252, s[40:43], s76 offen sc1
    v_mfma_f32_16x16x32_bf16 v[52:55], a[120:123], v[24:27], v[52:55]
    v_mfma_f32_16x16x32_bf16 v[152:155], a[100:103], v[4:7], v[152:155]
    ds_read_b128 v[32:35], v242 offset:49408
    v_mfma_f32_16x16x32_bf16 v[152:155], a[124:127], v[16:19], v[152:155]
    buffer_load_dwordx4 a[120:123], v252, s[40:43], s76 offen offset:1024 sc1
    v_mfma_f32_16x16x32_bf16 v[176:179], a[100:103], v[8:11], v[176:179]
    v_mfma_f32_16x16x32_bf16 v[176:179], a[124:127], v[20:23], v[176:179]
    v_mfma_f32_16x16x32_bf16 v[56:59], a[100:103], v[12:15], v[56:59]
    ds_read_b128 v[36:39], v242 offset:61696
    buffer_load_dwordx4 a[100:103], v252, s[40:43], s76 offen offset:2048 sc1
    v_mfma_f32_16x16x32_bf16 v[56:59], a[124:127], v[24:27], v[56:59]
    v_mfma_f32_16x16x32_bf16 v[156:159], a[104:107], v[4:7], v[156:159]
    v_mfma_f32_16x16x32_bf16 v[156:159], a[128:131], v[16:19], v[156:159]
    buffer_load_dwordx4 a[124:127], v252, s[40:43], s76 offen offset:3072 sc1
    v_mfma_f32_16x16x32_bf16 v[180:183], a[104:107], v[8:11], v[180:183]
    ds_read_b128 v[40:43], v243 offset:37120
    s_mov_b32 s77, 28672
    v_mfma_f32_16x16x32_bf16 v[180:183], a[128:131], v[20:23], v[180:183]
    v_mfma_f32_16x16x32_bf16 v[60:63], a[104:107], v[12:15], v[60:63]
    buffer_load_dwordx4 a[104:107], v252, s[40:43], s77 offen sc1
    v_mfma_f32_16x16x32_bf16 v[60:63], a[128:131], v[24:27], v[60:63]
    v_mfma_f32_16x16x32_bf16 v[160:163], a[108:111], v[4:7], v[160:163]
    ds_read_b128 v[44:47], v243 offset:49408
    v_mfma_f32_16x16x32_bf16 v[160:163], a[132:135], v[16:19], v[160:163]
    buffer_load_dwordx4 a[128:131], v252, s[40:43], s77 offen offset:1024 sc1
    v_mfma_f32_16x16x32_bf16 v[184:187], a[108:111], v[8:11], v[184:187]
    v_mfma_f32_16x16x32_bf16 v[184:187], a[132:135], v[20:23], v[184:187]
    v_mfma_f32_16x16x32_bf16 v[64:67], a[108:111], v[12:15], v[64:67]
    ds_read_b128 v[48:51], v243 offset:61696
    buffer_load_dwordx4 a[108:111], v252, s[40:43], s77 offen offset:2048 sc1
    v_mfma_f32_16x16x32_bf16 v[64:67], a[132:135], v[24:27], v[64:67]
    v_mfma_f32_16x16x32_bf16 v[164:167], a[112:115], v[4:7], v[164:167]
    v_mfma_f32_16x16x32_bf16 v[164:167], a[136:139], v[16:19], v[164:167]
    buffer_load_dwordx4 a[132:135], v252, s[40:43], s77 offen offset:3072 sc1
    v_mfma_f32_16x16x32_bf16 v[188:191], a[112:115], v[8:11], v[188:191]
    s_mov_b32 s74, 32768
    v_mfma_f32_16x16x32_bf16 v[188:191], a[136:139], v[20:23], v[188:191]
    v_mfma_f32_16x16x32_bf16 v[68:71], a[112:115], v[12:15], v[68:71]
    buffer_load_dwordx4 a[112:115], v252, s[40:43], s74 offen sc1
    v_mfma_f32_16x16x32_bf16 v[68:71], a[136:139], v[24:27], v[68:71]
    v_mfma_f32_16x16x32_bf16 v[168:171], a[116:119], v[4:7], v[168:171]
    v_mfma_f32_16x16x32_bf16 v[168:171], a[140:143], v[16:19], v[168:171]
    buffer_load_dwordx4 a[136:139], v252, s[40:43], s74 offen offset:1024 sc1
    v_mfma_f32_16x16x32_bf16 v[192:195], a[116:119], v[8:11], v[192:195]
    v_mfma_f32_16x16x32_bf16 v[192:195], a[140:143], v[20:23], v[192:195]
    v_mfma_f32_16x16x32_bf16 v[72:75], a[116:119], v[12:15], v[72:75]
    buffer_load_dwordx4 a[116:119], v252, s[40:43], s74 offen offset:2048 sc1
    v_mfma_f32_16x16x32_bf16 v[72:75], a[140:143], v[24:27], v[72:75]
    s_waitcnt lgkmcnt(0)
    v_mfma_f32_16x16x32_bf16 v[148:151], a[144:147], v[28:31], v[148:151]
    v_mfma_f32_16x16x32_bf16 v[148:151], a[168:171], v[40:43], v[148:151]
    buffer_load_dwordx4 a[140:143], v252, s[40:43], s74 offen offset:3072 sc1
    v_mfma_f32_16x16x32_bf16 v[172:175], a[144:147], v[32:35], v[172:175]
    ds_read_b128 v[4:7], v240 offset:37376
    s_mov_b32 s75, 36864
    v_mfma_f32_16x16x32_bf16 v[172:175], a[168:171], v[44:47], v[172:175]
    v_mfma_f32_16x16x32_bf16 v[52:55], a[144:147], v[36:39], v[52:55]
    buffer_load_dwordx4 a[144:147], v252, s[40:43], s75 offen sc1
    v_mfma_f32_16x16x32_bf16 v[52:55], a[168:171], v[48:51], v[52:55]
    v_mfma_f32_16x16x32_bf16 v[152:155], a[148:151], v[28:31], v[152:155]
    ds_read_b128 v[8:11], v240 offset:49664
    v_mfma_f32_16x16x32_bf16 v[152:155], a[172:175], v[40:43], v[152:155]
    buffer_load_dwordx4 a[168:171], v252, s[40:43], s75 offen offset:1024 sc1
    v_mfma_f32_16x16x32_bf16 v[176:179], a[148:151], v[32:35], v[176:179]
    v_mfma_f32_16x16x32_bf16 v[176:179], a[172:175], v[44:47], v[176:179]
    v_mfma_f32_16x16x32_bf16 v[56:59], a[148:151], v[36:39], v[56:59]
    ds_read_b128 v[12:15], v240 offset:61952
    buffer_load_dwordx4 a[148:151], v252, s[40:43], s75 offen offset:2048 sc1
    v_mfma_f32_16x16x32_bf16 v[56:59], a[172:175], v[48:51], v[56:59]
    v_mfma_f32_16x16x32_bf16 v[156:159], a[152:155], v[28:31], v[156:159]
    v_mfma_f32_16x16x32_bf16 v[156:159], a[176:179], v[40:43], v[156:159]
    buffer_load_dwordx4 a[172:175], v252, s[40:43], s75 offen offset:3072 sc1
    v_mfma_f32_16x16x32_bf16 v[180:183], a[152:155], v[32:35], v[180:183]
    ds_read_b128 v[16:19], v241 offset:37376
    s_mov_b32 s76, 40960
    v_mfma_f32_16x16x32_bf16 v[180:183], a[176:179], v[44:47], v[180:183]
    v_mfma_f32_16x16x32_bf16 v[60:63], a[152:155], v[36:39], v[60:63]
    buffer_load_dwordx4 a[152:155], v252, s[40:43], s76 offen sc1
    v_mfma_f32_16x16x32_bf16 v[60:63], a[176:179], v[48:51], v[60:63]
    v_mfma_f32_16x16x32_bf16 v[160:163], a[156:159], v[28:31], v[160:163]
    ds_read_b128 v[20:23], v241 offset:49664
    v_mfma_f32_16x16x32_bf16 v[160:163], a[180:183], v[40:43], v[160:163]
    buffer_load_dwordx4 a[176:179], v252, s[40:43], s76 offen offset:1024 sc1
    v_mfma_f32_16x16x32_bf16 v[184:187], a[156:159], v[32:35], v[184:187]
    v_mfma_f32_16x16x32_bf16 v[184:187], a[180:183], v[44:47], v[184:187]
    v_mfma_f32_16x16x32_bf16 v[64:67], a[156:159], v[36:39], v[64:67]
    ds_read_b128 v[24:27], v241 offset:61952
    buffer_load_dwordx4 a[156:159], v252, s[40:43], s76 offen offset:2048 sc1
    v_mfma_f32_16x16x32_bf16 v[64:67], a[180:183], v[48:51], v[64:67]
    v_mfma_f32_16x16x32_bf16 v[164:167], a[160:163], v[28:31], v[164:167]
    v_mfma_f32_16x16x32_bf16 v[164:167], a[184:187], v[40:43], v[164:167]
    buffer_load_dwordx4 a[180:183], v252, s[40:43], s76 offen offset:3072 sc1
    v_mfma_f32_16x16x32_bf16 v[188:191], a[160:163], v[32:35], v[188:191]
    s_mov_b32 s77, 45056
    v_mfma_f32_16x16x32_bf16 v[188:191], a[184:187], v[44:47], v[188:191]
    v_mfma_f32_16x16x32_bf16 v[68:71], a[160:163], v[36:39], v[68:71]
    buffer_load_dwordx4 a[160:163], v252, s[40:43], s77 offen sc1
    v_mfma_f32_16x16x32_bf16 v[68:71], a[184:187], v[48:51], v[68:71]
    v_mfma_f32_16x16x32_bf16 v[168:171], a[164:167], v[28:31], v[168:171]
    v_mfma_f32_16x16x32_bf16 v[168:171], a[188:191], v[40:43], v[168:171]
    buffer_load_dwordx4 a[184:187], v252, s[40:43], s77 offen offset:1024 sc1
    v_mfma_f32_16x16x32_bf16 v[192:195], a[164:167], v[32:35], v[192:195]
    v_mfma_f32_16x16x32_bf16 v[192:195], a[188:191], v[44:47], v[192:195]
    v_mfma_f32_16x16x32_bf16 v[72:75], a[164:167], v[36:39], v[72:75]
    buffer_load_dwordx4 a[164:167], v252, s[40:43], s77 offen offset:2048 sc1
    v_mfma_f32_16x16x32_bf16 v[72:75], a[188:191], v[48:51], v[72:75]
    s_waitcnt lgkmcnt(0)
    v_mfma_f32_16x16x32_bf16 v[148:151], a[192:195], v[4:7], v[148:151]
    v_mfma_f32_16x16x32_bf16 v[148:151], a[216:219], v[16:19], v[148:151]
    buffer_load_dwordx4 a[188:191], v252, s[40:43], s77 offen offset:3072 sc1
    v_mfma_f32_16x16x32_bf16 v[172:175], a[192:195], v[8:11], v[172:175]
    ds_read_b128 v[28:31], v242 offset:37376
    s_mov_b32 s74, 49152
    v_mfma_f32_16x16x32_bf16 v[172:175], a[216:219], v[20:23], v[172:175]
    v_mfma_f32_16x16x32_bf16 v[52:55], a[192:195], v[12:15], v[52:55]
    buffer_load_dwordx4 a[192:195], v252, s[40:43], s74 offen sc1
    v_mfma_f32_16x16x32_bf16 v[52:55], a[216:219], v[24:27], v[52:55]
    v_mfma_f32_16x16x32_bf16 v[152:155], a[196:199], v[4:7], v[152:155]
    ds_read_b128 v[32:35], v242 offset:49664
    v_mfma_f32_16x16x32_bf16 v[152:155], a[220:223], v[16:19], v[152:155]
    buffer_load_dwordx4 a[216:219], v252, s[40:43], s74 offen offset:1024 sc1
    v_mfma_f32_16x16x32_bf16 v[176:179], a[196:199], v[8:11], v[176:179]
    v_mfma_f32_16x16x32_bf16 v[176:179], a[220:223], v[20:23], v[176:179]
    v_mfma_f32_16x16x32_bf16 v[56:59], a[196:199], v[12:15], v[56:59]
    ds_read_b128 v[36:39], v242 offset:61952
    buffer_load_dwordx4 a[196:199], v252, s[40:43], s74 offen offset:2048 sc1
    v_mfma_f32_16x16x32_bf16 v[56:59], a[220:223], v[24:27], v[56:59]
    v_mfma_f32_16x16x32_bf16 v[156:159], a[200:203], v[4:7], v[156:159]
    v_mfma_f32_16x16x32_bf16 v[156:159], a[224:227], v[16:19], v[156:159]
    buffer_load_dwordx4 a[220:223], v252, s[40:43], s74 offen offset:3072 sc1
    v_mfma_f32_16x16x32_bf16 v[180:183], a[200:203], v[8:11], v[180:183]
    ds_read_b128 v[40:43], v243 offset:37376
    s_mov_b32 s75, 53248
    v_mfma_f32_16x16x32_bf16 v[180:183], a[224:227], v[20:23], v[180:183]
    v_mfma_f32_16x16x32_bf16 v[60:63], a[200:203], v[12:15], v[60:63]
    buffer_load_dwordx4 a[200:203], v252, s[40:43], s75 offen sc1
    v_mfma_f32_16x16x32_bf16 v[60:63], a[224:227], v[24:27], v[60:63]
    v_mfma_f32_16x16x32_bf16 v[160:163], a[204:207], v[4:7], v[160:163]
    ds_read_b128 v[44:47], v243 offset:49664
    v_mfma_f32_16x16x32_bf16 v[160:163], a[228:231], v[16:19], v[160:163]
    buffer_load_dwordx4 a[224:227], v252, s[40:43], s75 offen offset:1024 sc1
    v_mfma_f32_16x16x32_bf16 v[184:187], a[204:207], v[8:11], v[184:187]
    v_mfma_f32_16x16x32_bf16 v[184:187], a[228:231], v[20:23], v[184:187]
    v_mfma_f32_16x16x32_bf16 v[64:67], a[204:207], v[12:15], v[64:67]
    ds_read_b128 v[48:51], v243 offset:61952
    buffer_load_dwordx4 a[204:207], v252, s[40:43], s75 offen offset:2048 sc1
    v_mfma_f32_16x16x32_bf16 v[64:67], a[228:231], v[24:27], v[64:67]
    v_mfma_f32_16x16x32_bf16 v[164:167], a[208:211], v[4:7], v[164:167]
    v_mfma_f32_16x16x32_bf16 v[164:167], a[232:235], v[16:19], v[164:167]
    buffer_load_dwordx4 a[228:231], v252, s[40:43], s75 offen offset:3072 sc1
    v_mfma_f32_16x16x32_bf16 v[188:191], a[208:211], v[8:11], v[188:191]
    s_mov_b32 s76, 57344
    v_mfma_f32_16x16x32_bf16 v[188:191], a[232:235], v[20:23], v[188:191]
    v_mfma_f32_16x16x32_bf16 v[68:71], a[208:211], v[12:15], v[68:71]
    buffer_load_dwordx4 a[208:211], v252, s[40:43], s76 offen sc1
    v_mfma_f32_16x16x32_bf16 v[68:71], a[232:235], v[24:27], v[68:71]
    v_mfma_f32_16x16x32_bf16 v[168:171], a[212:215], v[4:7], v[168:171]
    v_mfma_f32_16x16x32_bf16 v[168:171], a[236:239], v[16:19], v[168:171]
    buffer_load_dwordx4 a[232:235], v252, s[40:43], s76 offen offset:1024 sc1
    v_mfma_f32_16x16x32_bf16 v[192:195], a[212:215], v[8:11], v[192:195]
    v_mfma_f32_16x16x32_bf16 v[192:195], a[236:239], v[20:23], v[192:195]
    v_mfma_f32_16x16x32_bf16 v[72:75], a[212:215], v[12:15], v[72:75]
    buffer_load_dwordx4 a[212:215], v252, s[40:43], s76 offen offset:2048 sc1
    v_mfma_f32_16x16x32_bf16 v[72:75], a[236:239], v[24:27], v[72:75]
    s_waitcnt vmcnt(59) lgkmcnt(0)
    s_barrier
    v_mfma_f32_16x16x32_bf16 v[148:151], a[240:243], v[28:31], v[148:151]
    v_mfma_f32_16x16x32_bf16 v[148:151], v[204:207], v[40:43], v[148:151]
    buffer_load_dwordx4 a[236:239], v252, s[40:43], s76 offen offset:3072 sc1
    v_mfma_f32_16x16x32_bf16 v[172:175], a[240:243], v[32:35], v[172:175]
    s_mov_b32 s77, 61440
    v_mfma_f32_16x16x32_bf16 v[172:175], v[204:207], v[44:47], v[172:175]
    v_mfma_f32_16x16x32_bf16 v[52:55], a[240:243], v[36:39], v[52:55]
    buffer_load_dwordx4 a[240:243], v252, s[40:43], s77 offen sc1
    v_mfma_f32_16x16x32_bf16 v[52:55], v[204:207], v[48:51], v[52:55]
    v_mfma_f32_16x16x32_bf16 v[152:155], a[244:247], v[28:31], v[152:155]
    v_mfma_f32_16x16x32_bf16 v[152:155], v[208:211], v[40:43], v[152:155]
    buffer_load_dwordx4 v[204:207], v252, s[40:43], s77 offen offset:1024 sc1
    v_mfma_f32_16x16x32_bf16 v[176:179], a[244:247], v[32:35], v[176:179]
    v_mfma_f32_16x16x32_bf16 v[176:179], v[208:211], v[44:47], v[176:179]
    v_mfma_f32_16x16x32_bf16 v[56:59], a[244:247], v[36:39], v[56:59]
    buffer_load_dwordx4 a[244:247], v252, s[40:43], s77 offen offset:2048 sc1
    v_mfma_f32_16x16x32_bf16 v[56:59], v[208:211], v[48:51], v[56:59]
    v_mfma_f32_16x16x32_bf16 v[156:159], a[248:251], v[28:31], v[156:159]
    v_mfma_f32_16x16x32_bf16 v[156:159], v[212:215], v[40:43], v[156:159]
    buffer_load_dwordx4 v[208:211], v252, s[40:43], s77 offen offset:3072 sc1
    v_mfma_f32_16x16x32_bf16 v[180:183], a[248:251], v[32:35], v[180:183]
    s_mov_b32 s74, 65536
    v_mfma_f32_16x16x32_bf16 v[180:183], v[212:215], v[44:47], v[180:183]
    v_mfma_f32_16x16x32_bf16 v[60:63], a[248:251], v[36:39], v[60:63]
    buffer_load_dwordx4 a[248:251], v252, s[40:43], s74 offen sc1
    v_mfma_f32_16x16x32_bf16 v[60:63], v[212:215], v[48:51], v[60:63]
    v_mfma_f32_16x16x32_bf16 v[160:163], a[252:255], v[28:31], v[160:163]
    v_mfma_f32_16x16x32_bf16 v[160:163], v[216:219], v[40:43], v[160:163]
    buffer_load_dwordx4 v[212:215], v252, s[40:43], s74 offen offset:1024 sc1
    v_mfma_f32_16x16x32_bf16 v[184:187], a[252:255], v[32:35], v[184:187]
    v_mfma_f32_16x16x32_bf16 v[184:187], v[216:219], v[44:47], v[184:187]
    v_mfma_f32_16x16x32_bf16 v[64:67], a[252:255], v[36:39], v[64:67]
    buffer_load_dwordx4 a[252:255], v252, s[40:43], s74 offen offset:2048 sc1
    v_mfma_f32_16x16x32_bf16 v[64:67], v[216:219], v[48:51], v[64:67]
    v_mfma_f32_16x16x32_bf16 v[164:167], v[196:199], v[28:31], v[164:167]
    v_mfma_f32_16x16x32_bf16 v[164:167], v[220:223], v[40:43], v[164:167]
    buffer_load_dwordx4 v[216:219], v252, s[40:43], s74 offen offset:3072 sc1
    v_mfma_f32_16x16x32_bf16 v[188:191], v[196:199], v[32:35], v[188:191]
    s_mov_b32 s75, 69632
    v_mfma_f32_16x16x32_bf16 v[188:191], v[220:223], v[44:47], v[188:191]
    v_mfma_f32_16x16x32_bf16 v[68:71], v[196:199], v[36:39], v[68:71]
    buffer_load_dwordx4 v[196:199], v252, s[40:43], s75 offen sc1
    v_mfma_f32_16x16x32_bf16 v[68:71], v[220:223], v[48:51], v[68:71]
    v_mfma_f32_16x16x32_bf16 v[168:171], v[200:203], v[28:31], v[168:171]
    v_mfma_f32_16x16x32_bf16 v[168:171], v[224:227], v[40:43], v[168:171]
    buffer_load_dwordx4 v[220:223], v252, s[40:43], s75 offen offset:1024 sc1
    v_mfma_f32_16x16x32_bf16 v[192:195], v[200:203], v[32:35], v[192:195]
    v_mfma_f32_16x16x32_bf16 v[192:195], v[224:227], v[44:47], v[192:195]
    v_mfma_f32_16x16x32_bf16 v[72:75], v[200:203], v[36:39], v[72:75]
    buffer_load_dwordx4 v[200:203], v252, s[40:43], s75 offen offset:2048 sc1
    v_mfma_f32_16x16x32_bf16 v[72:75], v[224:227], v[48:51], v[72:75]
    buffer_load_dwordx4 v[224:227], v252, s[40:43], s75 offen offset:3072 sc1
L_postd:
    ds_read_b128 v[4:7], v228 offset:0
    ds_read_b128 v[8:11], v229 offset:0
    ds_read_b128 v[12:15], v230 offset:0
    ds_read_b128 v[16:19], v231 offset:0
    ds_read_b128 v[20:23], v228 offset:256
    ds_read_b128 v[24:27], v229 offset:256
    ds_read_b128 v[28:31], v230 offset:256
    ds_read_b128 v[32:35], v231 offset:256
    ds_read_b128 v[36:39], v228 offset:512
    ds_read_b128 v[40:43], v229 offset:512
    ds_read_b128 v[44:47], v230 offset:512
    ds_read_b128 v[48:51], v231 offset:512
    v_cvt_pk_bf16_f32 v148, v148, v149
    v_cvt_pk_bf16_f32 v149, v150, v151
    v_cvt_pk_bf16_f32 v150, v152, v153
    v_cvt_pk_bf16_f32 v151, v154, v155
    v_cvt_pk_bf16_f32 v152, v156, v157
    v_cvt_pk_bf16_f32 v153, v158, v159
    v_cvt_pk_bf16_f32 v154, v160, v161
    v_cvt_pk_bf16_f32 v155, v162, v163
    v_cvt_pk_bf16_f32 v156, v164, v165
    v_cvt_pk_bf16_f32 v157, v166, v167
    v_cvt_pk_bf16_f32 v158, v168, v169
    v_cvt_pk_bf16_f32 v159, v170, v171
    v_cvt_pk_bf16_f32 v160, v172, v173
    v_cvt_pk_bf16_f32 v161, v174, v175
    v_cvt_pk_bf16_f32 v162, v176, v177
    v_cvt_pk_bf16_f32 v163, v178, v179
    v_cvt_pk_bf16_f32 v164, v180, v181
    v_cvt_pk_bf16_f32 v165, v182, v183
    v_cvt_pk_bf16_f32 v166, v184, v185
    v_cvt_pk_bf16_f32 v167, v186, v187
    v_cvt_pk_bf16_f32 v168, v188, v189
    v_cvt_pk_bf16_f32 v169, v190, v191
    v_cvt_pk_bf16_f32 v170, v192, v193
    v_cvt_pk_bf16_f32 v171, v194, v195
    v_cvt_pk_bf16_f32 v172, v52, v53
    v_cvt_pk_bf16_f32 v173, v54, v55
    v_cvt_pk_bf16_f32 v174, v56, v57
    v_cvt_pk_bf16_f32 v175, v58, v59
    v_cvt_pk_bf16_f32 v176, v60, v61
    v_cvt_pk_bf16_f32 v177, v62, v63
    v_cvt_pk_bf16_f32 v178, v64, v65
    v_cvt_pk_bf16_f32 v179, v66, v67
    v_cvt_pk_bf16_f32 v180, v68, v69
    v_cvt_pk_bf16_f32 v181, v70, v71
    v_cvt_pk_bf16_f32 v182, v72, v73
    v_cvt_pk_bf16_f32 v183, v74, v75
    v_lshlrev_b32 v184, 16, v76
    v_and_b32 v185, s59, v76
    v_lshlrev_b32 v186, 16, v77
    v_and_b32 v187, s59, v77
    v_lshlrev_b32 v188, 16, v78
    v_and_b32 v189, s59, v78
    v_lshlrev_b32 v190, 16, v79
    v_and_b32 v191, s59, v79
    v_lshlrev_b32 v192, 16, v80
    v_and_b32 v193, s59, v80
    v_lshlrev_b32 v194, 16, v81
    v_and_b32 v195, s59, v81
    v_lshlrev_b32 v76, 16, v82
    v_and_b32 v77, s59, v82
    v_lshlrev_b32 v78, 16, v83
    v_and_b32 v79, s59, v83
    s_waitcnt vmcnt(0)
    v_readfirstlane_b32 s73, v239
    s_waitcnt lgkmcnt(0)
.p2align 6
L_p2:
    s_waitcnt lgkmcnt(10)
    v_mfma_f32_16x16x32_bf16 v[52:55], a[0:3], v[4:7], v[184:187]
    v_mfma_f32_16x16x32_bf16 v[52:55], a[24:27], v[8:11], v[52:55]
    v_mfma_f32_16x16x32_bf16 v[52:55], a[48:51], v[12:15], v[52:55]
    s_waitcnt lgkmcnt(6)
    v_mfma_f32_16x16x32_bf16 v[52:55], a[72:75], v[16:19], v[52:55]
    v_cvt_pk_bf16_f32 v0, v68, v69
    v_cvt_pk_bf16_f32 v1, v70, v71
    v_mfma_f32_16x16x32_bf16 v[52:55], a[96:99], v[20:23], v[52:55]
    v_mfma_f32_16x16x32_bf16 v[52:55], a[120:123], v[24:27], v[52:55]
    s_waitcnt lgkmcnt(3)
    v_mfma_f32_16x16x32_bf16 v[52:55], a[144:147], v[28:31], v[52:55]
    v_mfma_f32_16x16x32_bf16 v[52:55], a[168:171], v[32:35], v[52:55]
    v_mfma_f32_16x16x32_bf16 v[52:55], a[192:195], v[36:39], v[52:55]
    s_waitcnt lgkmcnt(0)
    v_mfma_f32_16x16x32_bf16 v[52:55], a[216:219], v[40:43], v[52:55]
    v_cvt_pk_bf16_f32 v2, v72, v73
    v_cvt_pk_bf16_f32 v3, v74, v75
    v_mfma_f32_16x16x32_bf16 v[52:55], a[240:243], v[44:47], v[52:55]
    ds_write_b128 v237, v[0:3] offset:36864
    v_mfma_f32_16x16x32_bf16 v[52:55], v[204:207], v[48:51], v[52:55]
    v_mfma_f32_16x16x32_bf16 v[56:59], a[4:7], v[4:7], v[188:191]
    s_add_u32 s55, s81, 294912
    v_mfma_f32_16x16x32_bf16 v[56:59], a[28:31], v[8:11], v[56:59]
    s_add_u32 m0, s82, 24576
    v_mfma_f32_16x16x32_bf16 v[56:59], a[52:55], v[12:15], v[56:59]
    buffer_load_dwordx4 v232, s[20:23], s55 offen nt lds
    v_mfma_f32_16x16x32_bf16 v[56:59], a[76:79], v[16:19], v[56:59]
    v_mfma_f32_16x16x32_bf16 v[56:59], a[100:103], v[20:23], v[56:59]
    v_mfma_f32_16x16x32_bf16 v[56:59], a[124:127], v[24:27], v[56:59]
    buffer_load_dwordx4 v233, s[20:23], s55 offen offset:1024 nt lds
    v_mfma_f32_16x16x32_bf16 v[56:59], a[148:151], v[28:31], v[56:59]
    v_mfma_f32_16x16x32_bf16 v[56:59], a[172:175], v[32:35], v[56:59]
    v_mfma_f32_16x16x32_bf16 v[56:59], a[196:199], v[36:39], v[56:59]
    buffer_load_dwordx4 v234, s[20:23], s55 offen offset:2048 nt lds
    v_mfma_f32_16x16x32_bf16 v[56:59], a[220:223], v[40:43], v[56:59]
    s_cbranch_vccz L_lo0
    s_waitcnt vmcnt(6)
L_lo0:
    v_cvt_pk_bf16_f32 v0, v52, v53
    v_cvt_pk_bf16_f32 v1, v54, v55
    v_mfma_f32_16x16x32_bf16 v[56:59], a[244:247], v[44:47], v[56:59]
    s_set_gpr_idx_on s54, gpr_idx(SRC0)
    v_mov_b64 v[252:253], v[84:85]
    v_mov_b64 v[254:255], v[86:87]
    s_set_gpr_idx_off
    v_mfma_f32_16x16x32_bf16 v[56:59], v[208:211], v[48:51], v[56:59]
    v_lshlrev_b32 v80, 16, v252
    v_and_b32 v81, s59, v252
    v_mfma_f32_16x16x32_bf16 v[60:63], a[8:11], v[4:7], v[192:195]
    v_lshlrev_b32 v82, 16, v253
    v_and_b32 v83, s59, v253
    v_mfma_f32_16x16x32_bf16 v[60:63], a[32:35], v[8:11], v[60:63]
    v_lshlrev_b32 v84, 16, v254
    v_and_b32 v85, s59, v254
    v_mfma_f32_16x16x32_bf16 v[60:63], a[56:59], v[12:15], v[60:63]
    v_lshlrev_b32 v86, 16, v255
    v_and_b32 v87, s59, v255
    v_mfma_f32_16x16x32_bf16 v[60:63], a[80:83], v[16:19], v[60:63]
    v_mfma_f32_16x16x32_bf16 v[60:63], a[104:107], v[20:23], v[60:63]
    v_mfma_f32_16x16x32_bf16 v[60:63], a[128:131], v[24:27], v[60:63]
    s_mov_b64 exec, 1
    v_mov_b32 v239, 1
    buffer_atomic_add v239, off, s[40:43], s66 sc0
    s_mov_b64 exec, -1
    v_mfma_f32_16x16x32_bf16 v[60:63], a[152:155], v[28:31], v[60:63]
    v_mfma_f32_16x16x32_bf16 v[60:63], a[176:179], v[32:35], v[60:63]
    s_cmp_eq_u32 s65, 0
    s_cbranch_scc1 L_md0
    s_waitcnt vmcnt(7)
L_md0:
    v_mfma_f32_16x16x32_bf16 v[60:63], a[200:203], v[36:39], v[60:63]
    v_cvt_pk_bf16_f32 v2, v56, v57
    v_cvt_pk_bf16_f32 v3, v58, v59
    v_mfma_f32_16x16x32_bf16 v[60:63], a[224:227], v[40:43], v[60:63]
    ds_write_b128 v235, v[0:3] offset:0
    v_mfma_f32_16x16x32_bf16 v[60:63], a[248:251], v[44:47], v[60:63]
    v_mfma_f32_16x16x32_bf16 v[60:63], v[212:215], v[48:51], v[60:63]
    v_mfma_f32_16x16x32_bf16 v[64:67], a[12:15], v[4:7], v[76:79]
    v_mfma_f32_16x16x32_bf16 v[64:67], a[36:39], v[8:11], v[64:67]
    v_mfma_f32_16x16x32_bf16 v[64:67], a[60:63], v[12:15], v[64:67]
    v_mfma_f32_16x16x32_bf16 v[64:67], a[84:87], v[16:19], v[64:67]
    v_mfma_f32_16x16x32_bf16 v[64:67], a[108:111], v[20:23], v[64:67]
    v_mfma_f32_16x16x32_bf16 v[64:67], a[132:135], v[24:27], v[64:67]
    v_mfma_f32_16x16x32_bf16 v[64:67], a[156:159], v[28:31], v[64:67]
    v_mfma_f32_16x16x32_bf16 v[64:67], a[180:183], v[32:35], v[64:67]
    v_mfma_f32_16x16x32_bf16 v[64:67], a[204:207], v[36:39], v[64:67]
    v_cvt_pk_bf16_f32 v0, v60, v61
    v_cvt_pk_bf16_f32 v1, v62, v63
    v_mfma_f32_16x16x32_bf16 v[64:67], a[228:231], v[40:43], v[64:67]
    v_mfma_f32_16x16x32_bf16 v[64:67], a[252:255], v[44:47], v[64:67]
    v_mfma_f32_16x16x32_bf16 v[64:67], v[216:219], v[48:51], v[64:67]
    v_mfma_f32_16x16x32_bf16 v[68:71], a[16:19], v[4:7], v[80:83]
    v_mfma_f32_16x16x32_bf16 v[68:71], a[40:43], v[8:11], v[68:71]
    s_waitcnt vmcnt(7) lgkmcnt(1)
    s_barrier
    v_mfma_f32_16x16x32_bf16 v[68:71], a[64:67], v[12:15], v[68:71]
    ds_read_b128 v[240:243], v238 offset:36864
    v_mfma_f32_16x16x32_bf16 v[68:71], a[88:91], v[16:19], v[68:71]
    ds_read_b128 v[244:247], v238 offset:37888
    v_mfma_f32_16x16x32_bf16 v[68:71], a[112:115], v[20:23], v[68:71]
    v_mfma_f32_16x16x32_bf16 v[68:71], a[136:139], v[24:27], v[68:71]
    v_mfma_f32_16x16x32_bf16 v[72:75], a[20:23], v[4:7], v[84:87]
    ds_read_b128 v[4:7], v228 offset:12288
    v_mfma_f32_16x16x32_bf16 v[72:75], a[44:47], v[8:11], v[72:75]
    ds_read_b128 v[248:251], v238 offset:38912
    v_mfma_f32_16x16x32_bf16 v[72:75], a[68:71], v[12:15], v[72:75]
    ds_read_b128 v[8:11], v229 offset:12288
    v_mfma_f32_16x16x32_bf16 v[72:75], a[92:95], v[16:19], v[72:75]
    v_cvt_pk_bf16_f32 v2, v64, v65
    v_cvt_pk_bf16_f32 v3, v66, v67
    v_mfma_f32_16x16x32_bf16 v[72:75], a[116:119], v[20:23], v[72:75]
    ds_read_b128 v[12:15], v230 offset:12288
    v_mfma_f32_16x16x32_bf16 v[72:75], a[140:143], v[24:27], v[72:75]
    ds_write_b128 v236, v[0:3] offset:0
    v_mfma_f32_16x16x32_bf16 v[68:71], a[160:163], v[28:31], v[68:71]
    ds_read_b128 v[16:19], v231 offset:12288
    v_mfma_f32_16x16x32_bf16 v[68:71], a[184:187], v[32:35], v[68:71]
    v_mfma_f32_16x16x32_bf16 v[68:71], a[208:211], v[36:39], v[68:71]
    s_waitcnt lgkmcnt(7)
    buffer_store_dwordx4 v[240:243], v232, s[36:39], s56 offen sc1
    ds_read_b128 v[20:23], v228 offset:12544
    v_mfma_f32_16x16x32_bf16 v[68:71], a[232:235], v[40:43], v[68:71]
    v_mfma_f32_16x16x32_bf16 v[68:71], v[196:199], v[44:47], v[68:71]
    ds_read_b128 v[24:27], v229 offset:12544
    v_mfma_f32_16x16x32_bf16 v[68:71], v[220:223], v[48:51], v[68:71]
    v_mfma_f32_16x16x32_bf16 v[72:75], a[164:167], v[28:31], v[72:75]
    s_waitcnt lgkmcnt(8)
    buffer_store_dwordx4 v[244:247], v233, s[36:39], s56 offen offset:1024 sc1
    ds_read_b128 v[28:31], v230 offset:12544
    v_mfma_f32_16x16x32_bf16 v[72:75], a[188:191], v[32:35], v[72:75]
    ds_read_b128 v[32:35], v231 offset:12544
    v_mfma_f32_16x16x32_bf16 v[72:75], a[212:215], v[36:39], v[72:75]
    ds_read_b128 v[36:39], v228 offset:12800
    v_mfma_f32_16x16x32_bf16 v[72:75], a[236:239], v[40:43], v[72:75]
    ds_read_b128 v[40:43], v229 offset:12800
    v_mfma_f32_16x16x32_bf16 v[72:75], v[200:203], v[44:47], v[72:75]
    s_waitcnt lgkmcnt(10)
    buffer_store_dwordx4 v[248:251], v234, s[36:39], s56 offen offset:2048 sc1
    s_add_u32 s56, s78, 0
    ds_read_b128 v[44:47], v230 offset:12800
    v_mfma_f32_16x16x32_bf16 v[72:75], v[224:227], v[48:51], v[72:75]
    ds_read_b128 v[48:51], v231 offset:12800
    s_waitcnt lgkmcnt(10)
    v_mfma_f32_16x16x32_bf16 v[52:55], a[0:3], v[4:7], v[184:187]
    v_mfma_f32_16x16x32_bf16 v[52:55], a[24:27], v[8:11], v[52:55]
    v_mfma_f32_16x16x32_bf16 v[52:55], a[48:51], v[12:15], v[52:55]
    s_waitcnt lgkmcnt(6)
    v_mfma_f32_16x16x32_bf16 v[52:55], a[72:75], v[16:19], v[52:55]
    v_cvt_pk_bf16_f32 v0, v68, v69
    v_cvt_pk_bf16_f32 v1, v70, v71
    v_mfma_f32_16x16x32_bf16 v[52:55], a[96:99], v[20:23], v[52:55]
    v_mfma_f32_16x16x32_bf16 v[52:55], a[120:123], v[24:27], v[52:55]
    s_waitcnt lgkmcnt(3)
    v_mfma_f32_16x16x32_bf16 v[52:55], a[144:147], v[28:31], v[52:55]
    v_mfma_f32_16x16x32_bf16 v[52:55], a[168:171], v[32:35], v[52:55]
    v_mfma_f32_16x16x32_bf16 v[52:55], a[192:195], v[36:39], v[52:55]
    s_waitcnt lgkmcnt(0)
    v_mfma_f32_16x16x32_bf16 v[52:55], a[216:219], v[40:43], v[52:55]
    v_cvt_pk_bf16_f32 v2, v72, v73
    v_cvt_pk_bf16_f32 v3, v74, v75
    v_mfma_f32_16x16x32_bf16 v[52:55], a[240:243], v[44:47], v[52:55]
    ds_write_b128 v237, v[0:3] offset:0
    v_mfma_f32_16x16x32_bf16 v[52:55], v[204:207], v[48:51], v[52:55]
    v_mfma_f32_16x16x32_bf16 v[56:59], a[4:7], v[4:7], v[188:191]
    s_add_u32 s55, s81, 295680
    v_mfma_f32_16x16x32_bf16 v[56:59], a[28:31], v[8:11], v[56:59]
    s_add_u32 m0, s82, 36864
    v_mfma_f32_16x16x32_bf16 v[56:59], a[52:55], v[12:15], v[56:59]
    buffer_load_dwordx4 v232, s[20:23], s55 offen nt lds
    v_mfma_f32_16x16x32_bf16 v[56:59], a[76:79], v[16:19], v[56:59]
    v_mfma_f32_16x16x32_bf16 v[56:59], a[100:103], v[20:23], v[56:59]
    v_mfma_f32_16x16x32_bf16 v[56:59], a[124:127], v[24:27], v[56:59]
    buffer_load_dwordx4 v233, s[20:23], s55 offen offset:1024 nt lds
    v_mfma_f32_16x16x32_bf16 v[56:59], a[148:151], v[28:31], v[56:59]
    v_mfma_f32_16x16x32_bf16 v[56:59], a[172:175], v[32:35], v[56:59]
    v_mfma_f32_16x16x32_bf16 v[56:59], a[196:199], v[36:39], v[56:59]
    buffer_load_dwordx4 v234, s[20:23], s55 offen offset:2048 nt lds
    v_mfma_f32_16x16x32_bf16 v[56:59], a[220:223], v[40:43], v[56:59]
    s_cbranch_vccz L_lo1
    s_waitcnt vmcnt(7)
L_lo1:
    v_cvt_pk_bf16_f32 v0, v52, v53
    v_cvt_pk_bf16_f32 v1, v54, v55
    v_mfma_f32_16x16x32_bf16 v[56:59], a[244:247], v[44:47], v[56:59]
    v_mfma_f32_16x16x32_bf16 v[56:59], v[208:211], v[48:51], v[56:59]
    s_add_u32 s54, s54, 12
    v_mfma_f32_16x16x32_bf16 v[60:63], a[8:11], v[4:7], v[192:195]
    v_mfma_f32_16x16x32_bf16 v[60:63], a[32:35], v[8:11], v[60:63]
    v_mfma_f32_16x16x32_bf16 v[60:63], a[56:59], v[12:15], v[60:63]
    v_mfma_f32_16x16x32_bf16 v[60:63], a[80:83], v[16:19], v[60:63]
    v_mfma_f32_16x16x32_bf16 v[60:63], a[104:107], v[20:23], v[60:63]
    v_mfma_f32_16x16x32_bf16 v[60:63], a[128:131], v[24:27], v[60:63]
    v_mfma_f32_16x16x32_bf16 v[60:63], a[152:155], v[28:31], v[60:63]
    v_mfma_f32_16x16x32_bf16 v[60:63], a[176:179], v[32:35], v[60:63]
    s_cmp_eq_u32 s65, 0
    s_cbranch_scc1 L_md1
    s_waitcnt vmcnt(7)
L_md1:
    v_mfma_f32_16x16x32_bf16 v[60:63], a[200:203], v[36:39], v[60:63]
    v_cvt_pk_bf16_f32 v2, v56, v57
    v_cvt_pk_bf16_f32 v3, v58, v59
    v_mfma_f32_16x16x32_bf16 v[60:63], a[224:227], v[40:43], v[60:63]
    ds_write_b128 v235, v[0:3] offset:12288
    v_mfma_f32_16x16x32_bf16 v[60:63], a[248:251], v[44:47], v[60:63]
    v_mfma_f32_16x16x32_bf16 v[60:63], v[212:215], v[48:51], v[60:63]
    v_mfma_f32_16x16x32_bf16 v[64:67], a[12:15], v[4:7], v[76:79]
    s_cmp_eq_u32 s19, s85
    s_cselect_b32 s57, 99, s19
    v_mfma_f32_16x16x32_bf16 v[64:67], a[36:39], v[8:11], v[64:67]
    s_cmp_lt_u32 s57, 9
    s_cselect_b32 s81, s79, 2147483648
    s_cselect_b32 s82, s49, 163840
    v_mfma_f32_16x16x32_bf16 v[64:67], a[60:63], v[12:15], v[64:67]
    v_mfma_f32_16x16x32_bf16 v[64:67], a[84:87], v[16:19], v[64:67]
    v_mfma_f32_16x16x32_bf16 v[64:67], a[108:111], v[20:23], v[64:67]
    v_mfma_f32_16x16x32_bf16 v[64:67], a[132:135], v[24:27], v[64:67]
    v_mfma_f32_16x16x32_bf16 v[64:67], a[156:159], v[28:31], v[64:67]
    v_mfma_f32_16x16x32_bf16 v[64:67], a[180:183], v[32:35], v[64:67]
    v_mfma_f32_16x16x32_bf16 v[64:67], a[204:207], v[36:39], v[64:67]
    v_cvt_pk_bf16_f32 v0, v60, v61
    v_cvt_pk_bf16_f32 v1, v62, v63
    v_mfma_f32_16x16x32_bf16 v[64:67], a[228:231], v[40:43], v[64:67]
    v_mfma_f32_16x16x32_bf16 v[64:67], a[252:255], v[44:47], v[64:67]
    v_mfma_f32_16x16x32_bf16 v[64:67], v[216:219], v[48:51], v[64:67]
    v_mfma_f32_16x16x32_bf16 v[68:71], a[16:19], v[4:7], v[80:83]
    v_mfma_f32_16x16x32_bf16 v[68:71], a[40:43], v[8:11], v[68:71]
    s_waitcnt vmcnt(7) lgkmcnt(1)
    s_barrier
    v_mfma_f32_16x16x32_bf16 v[68:71], a[64:67], v[12:15], v[68:71]
    ds_read_b128 v[240:243], v238 offset:0
    v_mfma_f32_16x16x32_bf16 v[68:71], a[88:91], v[16:19], v[68:71]
    ds_read_b128 v[244:247], v238 offset:1024
    v_mfma_f32_16x16x32_bf16 v[68:71], a[112:115], v[20:23], v[68:71]
    v_mfma_f32_16x16x32_bf16 v[68:71], a[136:139], v[24:27], v[68:71]
    v_mfma_f32_16x16x32_bf16 v[72:75], a[20:23], v[4:7], v[84:87]
    ds_read_b128 v[4:7], v228 offset:24576
    v_mfma_f32_16x16x32_bf16 v[72:75], a[44:47], v[8:11], v[72:75]
    ds_read_b128 v[248:251], v238 offset:2048
    v_mfma_f32_16x16x32_bf16 v[72:75], a[68:71], v[12:15], v[72:75]
    ds_read_b128 v[8:11], v229 offset:24576
    v_mfma_f32_16x16x32_bf16 v[72:75], a[92:95], v[16:19], v[72:75]
    v_cvt_pk_bf16_f32 v2, v64, v65
    v_cvt_pk_bf16_f32 v3, v66, v67
    v_mfma_f32_16x16x32_bf16 v[72:75], a[116:119], v[20:23], v[72:75]
    ds_read_b128 v[12:15], v230 offset:24576
    v_mfma_f32_16x16x32_bf16 v[72:75], a[140:143], v[24:27], v[72:75]
    ds_write_b128 v236, v[0:3] offset:12288
    v_mfma_f32_16x16x32_bf16 v[68:71], a[160:163], v[28:31], v[68:71]
    ds_read_b128 v[16:19], v231 offset:24576
    v_mfma_f32_16x16x32_bf16 v[68:71], a[184:187], v[32:35], v[68:71]
    v_mfma_f32_16x16x32_bf16 v[68:71], a[208:211], v[36:39], v[68:71]
    s_waitcnt lgkmcnt(7)
    buffer_store_dwordx4 v[240:243], v232, s[36:39], s56 offen sc1
    ds_read_b128 v[20:23], v228 offset:24832
    v_mfma_f32_16x16x32_bf16 v[68:71], a[232:235], v[40:43], v[68:71]
    v_mfma_f32_16x16x32_bf16 v[68:71], v[196:199], v[44:47], v[68:71]
    ds_read_b128 v[24:27], v229 offset:24832
    v_mfma_f32_16x16x32_bf16 v[68:71], v[220:223], v[48:51], v[68:71]
    v_mfma_f32_16x16x32_bf16 v[72:75], a[164:167], v[28:31], v[72:75]
    s_waitcnt lgkmcnt(8)
    buffer_store_dwordx4 v[244:247], v233, s[36:39], s56 offen offset:1024 sc1
    ds_read_b128 v[28:31], v230 offset:24832
    v_mfma_f32_16x16x32_bf16 v[72:75], a[188:191], v[32:35], v[72:75]
    ds_read_b128 v[32:35], v231 offset:24832
    v_mfma_f32_16x16x32_bf16 v[72:75], a[212:215], v[36:39], v[72:75]
    ds_read_b128 v[36:39], v228 offset:25088
    v_mfma_f32_16x16x32_bf16 v[72:75], a[236:239], v[40:43], v[72:75]
    ds_read_b128 v[40:43], v229 offset:25088
    v_mfma_f32_16x16x32_bf16 v[72:75], v[200:203], v[44:47], v[72:75]
    s_waitcnt lgkmcnt(10)
    buffer_store_dwordx4 v[248:251], v234, s[36:39], s56 offen offset:2048 sc1
    s_add_u32 s56, s78, 768
    ds_read_b128 v[44:47], v230 offset:25088
    v_mfma_f32_16x16x32_bf16 v[72:75], v[224:227], v[48:51], v[72:75]
    ds_read_b128 v[48:51], v231 offset:25088
    s_waitcnt lgkmcnt(10)
    v_mfma_f32_16x16x32_bf16 v[52:55], a[0:3], v[4:7], v[184:187]
    v_mfma_f32_16x16x32_bf16 v[52:55], a[24:27], v[8:11], v[52:55]
    v_mfma_f32_16x16x32_bf16 v[52:55], a[48:51], v[12:15], v[52:55]
    s_waitcnt lgkmcnt(6)
    v_mfma_f32_16x16x32_bf16 v[52:55], a[72:75], v[16:19], v[52:55]
    v_cvt_pk_bf16_f32 v0, v68, v69
    v_cvt_pk_bf16_f32 v1, v70, v71
    v_mfma_f32_16x16x32_bf16 v[52:55], a[96:99], v[20:23], v[52:55]
    v_mfma_f32_16x16x32_bf16 v[52:55], a[120:123], v[24:27], v[52:55]
    s_waitcnt lgkmcnt(3)
    v_mfma_f32_16x16x32_bf16 v[52:55], a[144:147], v[28:31], v[52:55]
    v_mfma_f32_16x16x32_bf16 v[52:55], a[168:171], v[32:35], v[52:55]
    v_mfma_f32_16x16x32_bf16 v[52:55], a[192:195], v[36:39], v[52:55]
    s_waitcnt lgkmcnt(0)
    v_mfma_f32_16x16x32_bf16 v[52:55], a[216:219], v[40:43], v[52:55]
    v_cvt_pk_bf16_f32 v2, v72, v73
    v_cvt_pk_bf16_f32 v3, v74, v75
    v_mfma_f32_16x16x32_bf16 v[52:55], a[240:243], v[44:47], v[52:55]
    ds_write_b128 v237, v[0:3] offset:12288
    v_mfma_f32_16x16x32_bf16 v[52:55], v[204:207], v[48:51], v[52:55]
    v_mfma_f32_16x16x32_bf16 v[56:59], a[4:7], v[4:7], v[188:191]
    s_add_u32 s55, s81, 0
    v_mfma_f32_16x16x32_bf16 v[56:59], a[28:31], v[8:11], v[56:59]
    s_add_u32 m0, s82, 0
    v_mfma_f32_16x16x32_bf16 v[56:59], a[52:55], v[12:15], v[56:59]
    buffer_load_dwordx4 v232, s[20:23], s55 offen nt lds
    v_mfma_f32_16x16x32_bf16 v[56:59], a[76:79], v[16:19], v[56:59]
    v_mfma_f32_16x16x32_bf16 v[56:59], a[100:103], v[20:23], v[56:59]
    v_mfma_f32_16x16x32_bf16 v[56:59], a[124:127], v[24:27], v[56:59]
    buffer_load_dwordx4 v233, s[20:23], s55 offen offset:1024 nt lds
    v_mfma_f32_16x16x32_bf16 v[56:59], a[148:151], v[28:31], v[56:59]
    v_mfma_f32_16x16x32_bf16 v[56:59], a[172:175], v[32:35], v[56:59]
    v_mfma_f32_16x16x32_bf16 v[56:59], a[196:199], v[36:39], v[56:59]
    buffer_load_dwordx4 v234, s[20:23], s55 offen offset:2048 nt lds
    v_mfma_f32_16x16x32_bf16 v[56:59], a[220:223], v[40:43], v[56:59]
    s_cbranch_vccz L_lo2
    s_waitcnt vmcnt(6)
L_lo2:
    v_cvt_pk_bf16_f32 v0, v52, v53
    v_cvt_pk_bf16_f32 v1, v54, v55
    v_mfma_f32_16x16x32_bf16 v[56:59], a[244:247], v[44:47], v[56:59]
    v_mfma_f32_16x16x32_bf16 v[56:59], v[208:211], v[48:51], v[56:59]
    v_mfma_f32_16x16x32_bf16 v[60:63], a[8:11], v[4:7], v[192:195]
    v_mfma_f32_16x16x32_bf16 v[60:63], a[32:35], v[8:11], v[60:63]
    v_mfma_f32_16x16x32_bf16 v[60:63], a[56:59], v[12:15], v[60:63]
    v_mfma_f32_16x16x32_bf16 v[60:63], a[80:83], v[16:19], v[60:63]
    v_mfma_f32_16x16x32_bf16 v[60:63], a[104:107], v[20:23], v[60:63]
    v_mfma_f32_16x16x32_bf16 v[60:63], a[128:131], v[24:27], v[60:63]
    v_mfma_f32_16x16x32_bf16 v[60:63], a[152:155], v[28:31], v[60:63]
    v_mfma_f32_16x16x32_bf16 v[60:63], a[176:179], v[32:35], v[60:63]
    s_cmp_eq_u32 s65, 0
    s_cbranch_scc1 L_md2
    s_waitcnt vmcnt(6)
L_md2:
    v_mfma_f32_16x16x32_bf16 v[60:63], a[200:203], v[36:39], v[60:63]
    v_cvt_pk_bf16_f32 v2, v56, v57
    v_cvt_pk_bf16_f32 v3, v58, v59
    v_mfma_f32_16x16x32_bf16 v[60:63], a[224:227], v[40:43], v[60:63]
    ds_write_b128 v235, v[0:3] offset:24576
    v_mfma_f32_16x16x32_bf16 v[60:63], a[248:251], v[44:47], v[60:63]
    v_mfma_f32_16x16x32_bf16 v[60:63], v[212:215], v[48:51], v[60:63]
    v_mfma_f32_16x16x32_bf16 v[64:67], a[12:15], v[4:7], v[76:79]
    s_add_u32 s67, s67, 43
    s_and_b32 s67, s67, 255
    v_mfma_f32_16x16x32_bf16 v[64:67], a[36:39], v[8:11], v[64:67]
    s_add_u32 s19, s19, 1
    s_lshl_b32 s87, s19, 8
    v_mfma_f32_16x16x32_bf16 v[64:67], a[60:63], v[12:15], v[64:67]
    s_add_u32 s87, s87, s67
    s_mul_hi_u32 s57, s87, 0x15555556
    v_mfma_f32_16x16x32_bf16 v[64:67], a[84:87], v[16:19], v[64:67]
    s_mul_i32 s57, s57, 294912
    s_mul_i32 s58, s87, 24576
    v_mfma_f32_16x16x32_bf16 v[64:67], a[108:111], v[20:23], v[64:67]
    s_add_u32 s80, s57, s58
    v_mfma_f32_16x16x32_bf16 v[64:67], a[132:135], v[24:27], v[64:67]
    v_mfma_f32_16x16x32_bf16 v[64:67], a[156:159], v[28:31], v[64:67]
    v_mfma_f32_16x16x32_bf16 v[64:67], a[180:183], v[32:35], v[64:67]
    v_mfma_f32_16x16x32_bf16 v[64:67], a[204:207], v[36:39], v[64:67]
    v_cvt_pk_bf16_f32 v0, v60, v61
    v_cvt_pk_bf16_f32 v1, v62, v63
    v_mfma_f32_16x16x32_bf16 v[64:67], a[228:231], v[40:43], v[64:67]
    v_mfma_f32_16x16x32_bf16 v[64:67], a[252:255], v[44:47], v[64:67]
    v_mfma_f32_16x16x32_bf16 v[64:67], v[216:219], v[48:51], v[64:67]
    v_mfma_f32_16x16x32_bf16 v[68:71], a[16:19], v[4:7], v[80:83]
    v_mfma_f32_16x16x32_bf16 v[68:71], a[40:43], v[8:11], v[68:71]
    s_waitcnt vmcnt(6) lgkmcnt(1)
    s_barrier
    v_mfma_f32_16x16x32_bf16 v[68:71], a[64:67], v[12:15], v[68:71]
    ds_read_b128 v[240:243], v238 offset:12288
    v_mfma_f32_16x16x32_bf16 v[68:71], a[88:91], v[16:19], v[68:71]
    ds_read_b128 v[244:247], v238 offset:13312
    v_readlane_b32 s52, v239, 0
    v_mfma_f32_16x16x32_bf16 v[68:71], a[112:115], v[20:23], v[68:71]
    v_mfma_f32_16x16x32_bf16 v[68:71], a[136:139], v[24:27], v[68:71]
    v_mfma_f32_16x16x32_bf16 v[72:75], a[20:23], v[4:7], v[84:87]
    ds_read_b128 v[4:7], v228 offset:36864
    s_sub_u32 s52, s52, s73
    s_cmp_ge_i32 s52, 52
    s_cselect_b32 s65, 0, 1
    s_cselect_b64 vcc, 0, s[98:99]
    v_mfma_f32_16x16x32_bf16 v[72:75], a[44:47], v[8:11], v[72:75]
    ds_read_b128 v[248:251], v238 offset:14336
    v_mfma_f32_16x16x32_bf16 v[72:75], a[68:71], v[12:15], v[72:75]
    ds_read_b128 v[8:11], v229 offset:36864
    s_add_u32 s73, s73, 64
    v_mfma_f32_16x16x32_bf16 v[72:75], a[92:95], v[16:19], v[72:75]
    v_cvt_pk_bf16_f32 v2, v64, v65
    v_cvt_pk_bf16_f32 v3, v66, v67
    v_mfma_f32_16x16x32_bf16 v[72:75], a[116:119], v[20:23], v[72:75]
    ds_read_b128 v[12:15], v230 offset:36864
    v_mfma_f32_16x16x32_bf16 v[72:75], a[140:143], v[24:27], v[72:75]
    ds_write_b128 v236, v[0:3] offset:24576
    v_mfma_f32_16x16x32_bf16 v[68:71], a[160:163], v[28:31], v[68:71]
    ds_read_b128 v[16:19], v231 offset:36864
    v_mfma_f32_16x16x32_bf16 v[68:71], a[184:187], v[32:35], v[68:71]
    v_mfma_f32_16x16x32_bf16 v[68:71], a[208:211], v[36:39], v[68:71]
    s_waitcnt lgkmcnt(7)
    buffer_store_dwordx4 v[240:243], v232, s[36:39], s56 offen sc1
    ds_read_b128 v[20:23], v228 offset:37120
    v_mfma_f32_16x16x32_bf16 v[68:71], a[232:235], v[40:43], v[68:71]
    v_mfma_f32_16x16x32_bf16 v[68:71], v[196:199], v[44:47], v[68:71]
    ds_read_b128 v[24:27], v229 offset:37120
    v_mfma_f32_16x16x32_bf16 v[68:71], v[220:223], v[48:51], v[68:71]
    v_mfma_f32_16x16x32_bf16 v[72:75], a[164:167], v[28:31], v[72:75]
    s_waitcnt lgkmcnt(8)
    buffer_store_dwordx4 v[244:247], v233, s[36:39], s56 offen offset:1024 sc1
    ds_read_b128 v[28:31], v230 offset:37120
    v_mfma_f32_16x16x32_bf16 v[72:75], a[188:191], v[32:35], v[72:75]
    ds_read_b128 v[32:35], v231 offset:37120
    v_mfma_f32_16x16x32_bf16 v[72:75], a[212:215], v[36:39], v[72:75]
    ds_read_b128 v[36:39], v228 offset:37376
    v_mfma_f32_16x16x32_bf16 v[72:75], a[236:239], v[40:43], v[72:75]
    ds_read_b128 v[40:43], v229 offset:37376
    v_mfma_f32_16x16x32_bf16 v[72:75], v[200:203], v[44:47], v[72:75]
    s_waitcnt lgkmcnt(10)
    buffer_store_dwordx4 v[248:251], v234, s[36:39], s56 offen offset:2048 sc1
    s_add_u32 s56, s78, 294912
    ds_read_b128 v[44:47], v230 offset:37376
    v_mfma_f32_16x16x32_bf16 v[72:75], v[224:227], v[48:51], v[72:75]
    ds_read_b128 v[48:51], v231 offset:37376
    s_waitcnt lgkmcnt(10)
    v_mfma_f32_16x16x32_bf16 v[52:55], a[0:3], v[4:7], v[184:187]
    s_cmp_eq_u32 s83, s85
    s_cselect_b32 s53, -49152, 0
    v_mfma_f32_16x16x32_bf16 v[52:55], a[24:27], v[8:11], v[52:55]
    s_add_u32 s83, s83, 1
    v_mfma_f32_16x16x32_bf16 v[52:55], a[48:51], v[12:15], v[52:55]
    s_waitcnt lgkmcnt(6)
    v_mfma_f32_16x16x32_bf16 v[52:55], a[72:75], v[16:19], v[52:55]
    v_cvt_pk_bf16_f32 v0, v68, v69
    v_cvt_pk_bf16_f32 v1, v70, v71
    v_mfma_f32_16x16x32_bf16 v[52:55], a[96:99], v[20:23], v[52:55]
    s_cmp_eq_u32 s83, s85
    s_cselect_b32 s53, 49152, s53
    v_mfma_f32_16x16x32_bf16 v[52:55], a[120:123], v[24:27], v[52:55]
    s_waitcnt lgkmcnt(3)
    v_mfma_f32_16x16x32_bf16 v[52:55], a[144:147], v[28:31], v[52:55]
    v_mfma_f32_16x16x32_bf16 v[52:55], a[168:171], v[32:35], v[52:55]
    v_mfma_f32_16x16x32_bf16 v[52:55], a[192:195], v[36:39], v[52:55]
    s_waitcnt lgkmcnt(0)
    v_mfma_f32_16x16x32_bf16 v[52:55], a[216:219], v[40:43], v[52:55]
    v_cvt_pk_bf16_f32 v2, v72, v73
    v_cvt_pk_bf16_f32 v3, v74, v75
    v_mfma_f32_16x16x32_bf16 v[52:55], a[240:243], v[44:47], v[52:55]
    ds_write_b128 v237, v[0:3] offset:24576
    v_mfma_f32_16x16x32_bf16 v[52:55], v[204:207], v[48:51], v[52:55]
    v_mfma_f32_16x16x32_bf16 v[56:59], a[4:7], v[4:7], v[188:191]
    s_add_u32 s55, s81, 768
    v_mfma_f32_16x16x32_bf16 v[56:59], a[28:31], v[8:11], v[56:59]
    s_add_u32 m0, s82, 12288
    v_mfma_f32_16x16x32_bf16 v[56:59], a[52:55], v[12:15], v[56:59]
    buffer_load_dwordx4 v232, s[20:23], s55 offen nt lds
    v_mfma_f32_16x16x32_bf16 v[56:59], a[76:79], v[16:19], v[56:59]
    v_mfma_f32_16x16x32_bf16 v[56:59], a[100:103], v[20:23], v[56:59]
    v_mfma_f32_16x16x32_bf16 v[56:59], a[124:127], v[24:27], v[56:59]
    buffer_load_dwordx4 v233, s[20:23], s55 offen offset:1024 nt lds
    v_mfma_f32_16x16x32_bf16 v[56:59], a[148:151], v[28:31], v[56:59]
    v_mfma_f32_16x16x32_bf16 v[56:59], a[172:175], v[32:35], v[56:59]
    v_mfma_f32_16x16x32_bf16 v[56:59], a[196:199], v[36:39], v[56:59]
    buffer_load_dwordx4 v234, s[20:23], s55 offen offset:2048 nt lds
    v_mfma_f32_16x16x32_bf16 v[56:59], a[220:223], v[40:43], v[56:59]
    s_cbranch_vccz L_lo3
    s_waitcnt vmcnt(6)
L_lo3:
    v_cvt_pk_bf16_f32 v0, v52, v53
    v_cvt_pk_bf16_f32 v1, v54, v55
    v_mfma_f32_16x16x32_bf16 v[56:59], a[244:247], v[44:47], v[56:59]
    s_set_gpr_idx_on s54, gpr_idx(SRC0)
    v_mov_b64 v[252:253], v[76:77]
    v_mov_b64 v[254:255], v[78:79]
    s_set_gpr_idx_off
    v_mfma_f32_16x16x32_bf16 v[56:59], v[208:211], v[48:51], v[56:59]
    v_lshlrev_b32 v184, 16, v252
    v_and_b32 v185, s59, v252
    v_mfma_f32_16x16x32_bf16 v[60:63], a[8:11], v[4:7], v[192:195]
    v_lshlrev_b32 v186, 16, v253
    v_and_b32 v187, s59, v253
    v_mfma_f32_16x16x32_bf16 v[60:63], a[32:35], v[8:11], v[60:63]
    v_lshlrev_b32 v188, 16, v254
    v_and_b32 v189, s59, v254
    v_mfma_f32_16x16x32_bf16 v[60:63], a[56:59], v[12:15], v[60:63]
    v_lshlrev_b32 v190, 16, v255
    v_and_b32 v191, s59, v255
    v_mfma_f32_16x16x32_bf16 v[60:63], a[80:83], v[16:19], v[60:63]
    v_mfma_f32_16x16x32_bf16 v[60:63], a[104:107], v[20:23], v[60:63]
    v_mfma_f32_16x16x32_bf16 v[60:63], a[128:131], v[24:27], v[60:63]
    v_mfma_f32_16x16x32_bf16 v[60:63], a[152:155], v[28:31], v[60:63]
    v_mfma_f32_16x16x32_bf16 v[60:63], a[176:179], v[32:35], v[60:63]
    s_cmp_eq_u32 s65, 0
    s_cbranch_scc1 L_md3
    s_waitcnt vmcnt(6)
L_md3:
    v_mfma_f32_16x16x32_bf16 v[60:63], a[200:203], v[36:39], v[60:63]
    v_cvt_pk_bf16_f32 v2, v56, v57
    v_cvt_pk_bf16_f32 v3, v58, v59
    v_mfma_f32_16x16x32_bf16 v[60:63], a[224:227], v[40:43], v[60:63]
    ds_write_b128 v235, v[0:3] offset:36864
    v_mfma_f32_16x16x32_bf16 v[60:63], a[248:251], v[44:47], v[60:63]
    v_mfma_f32_16x16x32_bf16 v[60:63], v[212:215], v[48:51], v[60:63]
    v_mfma_f32_16x16x32_bf16 v[64:67], a[12:15], v[4:7], v[76:79]
    v_add_u32 v228, s53, v228
    v_add_u32 v229, s53, v229
    v_mfma_f32_16x16x32_bf16 v[64:67], a[36:39], v[8:11], v[64:67]
    v_add_u32 v230, s53, v230
    v_add_u32 v231, s53, v231
    v_mfma_f32_16x16x32_bf16 v[64:67], a[60:63], v[12:15], v[64:67]
    v_mfma_f32_16x16x32_bf16 v[64:67], a[84:87], v[16:19], v[64:67]
    v_mfma_f32_16x16x32_bf16 v[64:67], a[108:111], v[20:23], v[64:67]
    v_mfma_f32_16x16x32_bf16 v[64:67], a[132:135], v[24:27], v[64:67]
    v_mfma_f32_16x16x32_bf16 v[64:67], a[156:159], v[28:31], v[64:67]
    v_mfma_f32_16x16x32_bf16 v[64:67], a[180:183], v[32:35], v[64:67]
    v_mfma_f32_16x16x32_bf16 v[64:67], a[204:207], v[36:39], v[64:67]
    v_cvt_pk_bf16_f32 v0, v60, v61
    v_cvt_pk_bf16_f32 v1, v62, v63
    v_mfma_f32_16x16x32_bf16 v[64:67], a[228:231], v[40:43], v[64:67]
    s_set_gpr_idx_on s54, gpr_idx(SRC0)
    v_mov_b64 v[252:253], v[80:81]
    v_mov_b64 v[254:255], v[82:83]
    s_set_gpr_idx_off
    v_mfma_f32_16x16x32_bf16 v[64:67], a[252:255], v[44:47], v[64:67]
    v_lshlrev_b32 v192, 16, v252
    v_and_b32 v193, s59, v252
    v_mfma_f32_16x16x32_bf16 v[64:67], v[216:219], v[48:51], v[64:67]
    v_lshlrev_b32 v194, 16, v253
    v_and_b32 v195, s59, v253
    v_mfma_f32_16x16x32_bf16 v[68:71], a[16:19], v[4:7], v[80:83]
    v_lshlrev_b32 v76, 16, v254
    v_and_b32 v77, s59, v254
    v_mfma_f32_16x16x32_bf16 v[68:71], a[40:43], v[8:11], v[68:71]
    s_waitcnt vmcnt(6) lgkmcnt(1)
    s_barrier
    v_lshlrev_b32 v78, 16, v255
    v_and_b32 v79, s59, v255
    v_mfma_f32_16x16x32_bf16 v[68:71], a[64:67], v[12:15], v[68:71]
    ds_read_b128 v[240:243], v238 offset:24576
    v_mfma_f32_16x16x32_bf16 v[68:71], a[88:91], v[16:19], v[68:71]
    ds_read_b128 v[244:247], v238 offset:25600
    v_mfma_f32_16x16x32_bf16 v[68:71], a[112:115], v[20:23], v[68:71]
    v_mfma_f32_16x16x32_bf16 v[68:71], a[136:139], v[24:27], v[68:71]
    v_mfma_f32_16x16x32_bf16 v[72:75], a[20:23], v[4:7], v[84:87]
    ds_read_b128 v[4:7], v228 offset:0
    v_mfma_f32_16x16x32_bf16 v[72:75], a[44:47], v[8:11], v[72:75]
    ds_read_b128 v[248:251], v238 offset:26624
    v_mfma_f32_16x16x32_bf16 v[72:75], a[68:71], v[12:15], v[72:75]
    ds_read_b128 v[8:11], v229 offset:0
    v_mfma_f32_16x16x32_bf16 v[72:75], a[92:95], v[16:19], v[72:75]
    v_cvt_pk_bf16_f32 v2, v64, v65
    v_cvt_pk_bf16_f32 v3, v66, v67
    v_mfma_f32_16x16x32_bf16 v[72:75], a[116:119], v[20:23], v[72:75]
    ds_read_b128 v[12:15], v230 offset:0
    v_mfma_f32_16x16x32_bf16 v[72:75], a[140:143], v[24:27], v[72:75]
    ds_write_b128 v236, v[0:3] offset:36864
    v_mfma_f32_16x16x32_bf16 v[68:71], a[160:163], v[28:31], v[68:71]
    ds_read_b128 v[16:19], v231 offset:0
    v_mfma_f32_16x16x32_bf16 v[68:71], a[184:187], v[32:35], v[68:71]
    v_mfma_f32_16x16x32_bf16 v[68:71], a[208:211], v[36:39], v[68:71]
    s_waitcnt lgkmcnt(7)
    buffer_store_dwordx4 v[240:243], v232, s[36:39], s56 offen sc1
    ds_read_b128 v[20:23], v228 offset:256
    v_mfma_f32_16x16x32_bf16 v[68:71], a[232:235], v[40:43], v[68:71]
    v_mfma_f32_16x16x32_bf16 v[68:71], v[196:199], v[44:47], v[68:71]
    ds_read_b128 v[24:27], v229 offset:256
    v_mfma_f32_16x16x32_bf16 v[68:71], v[220:223], v[48:51], v[68:71]
    v_mfma_f32_16x16x32_bf16 v[72:75], a[164:167], v[28:31], v[72:75]
    s_waitcnt lgkmcnt(8)
    buffer_store_dwordx4 v[244:247], v233, s[36:39], s56 offen offset:1024 sc1
    ds_read_b128 v[28:31], v230 offset:256
    v_mfma_f32_16x16x32_bf16 v[72:75], a[188:191], v[32:35], v[72:75]
    ds_read_b128 v[32:35], v231 offset:256
    v_mfma_f32_16x16x32_bf16 v[72:75], a[212:215], v[36:39], v[72:75]
    ds_read_b128 v[36:39], v228 offset:512
    v_mfma_f32_16x16x32_bf16 v[72:75], a[236:239], v[40:43], v[72:75]
    ds_read_b128 v[40:43], v229 offset:512
    s_cmp_eq_u32 s83, 8
    s_cselect_b32 s65, vcc_lo, s65
    s_cselect_b64 vcc, 0, vcc
    v_mfma_f32_16x16x32_bf16 v[72:75], v[200:203], v[44:47], v[72:75]
    s_waitcnt lgkmcnt(10)
    buffer_store_dwordx4 v[248:251], v234, s[36:39], s56 offen offset:2048 sc1
    s_add_u32 s56, s78, 295680
    ds_read_b128 v[44:47], v230 offset:512
    v_mfma_f32_16x16x32_bf16 v[72:75], v[224:227], v[48:51], v[72:75]
    ds_read_b128 v[48:51], v231 offset:512
    s_mov_b32 s78, s79
    s_mov_b32 s79, s80
    s_cmp_lg_u32 s83, 8
    s_cbranch_scc1 L_p2
    s_waitcnt lgkmcnt(10)
    v_mfma_f32_16x16x32_bf16 v[52:55], a[0:3], v[4:7], v[184:187]
    v_mfma_f32_16x16x32_bf16 v[52:55], a[24:27], v[8:11], v[52:55]
    v_mfma_f32_16x16x32_bf16 v[52:55], a[48:51], v[12:15], v[52:55]
    s_waitcnt lgkmcnt(6)
    v_mfma_f32_16x16x32_bf16 v[52:55], a[72:75], v[16:19], v[52:55]
    v_cvt_pk_bf16_f32 v0, v68, v69
    v_cvt_pk_bf16_f32 v1, v70, v71
    v_mfma_f32_16x16x32_bf16 v[52:55], a[96:99], v[20:23], v[52:55]
    v_mfma_f32_16x16x32_bf16 v[52:55], a[120:123], v[24:27], v[52:55]
    s_waitcnt lgkmcnt(3)
    v_mfma_f32_16x16x32_bf16 v[52:55], a[144:147], v[28:31], v[52:55]
    v_mfma_f32_16x16x32_bf16 v[52:55], a[168:171], v[32:35], v[52:55]
    v_mfma_f32_16x16x32_bf16 v[52:55], a[192:195], v[36:39], v[52:55]
    s_waitcnt lgkmcnt(0)
    v_mfma_f32_16x16x32_bf16 v[52:55], a[216:219], v[40:43], v[52:55]
    v_cvt_pk_bf16_f32 v2, v72, v73
    v_cvt_pk_bf16_f32 v3, v74, v75
    v_mfma_f32_16x16x32_bf16 v[52:55], a[240:243], v[44:47], v[52:55]
    ds_write_b128 v237, v[0:3] offset:36864
    v_mfma_f32_16x16x32_bf16 v[52:55], v[204:207], v[48:51], v[52:55]
    v_mfma_f32_16x16x32_bf16 v[56:59], a[4:7], v[4:7], v[188:191]
    s_add_u32 s55, s81, 294912
    v_mfma_f32_16x16x32_bf16 v[56:59], a[28:31], v[8:11], v[56:59]
    s_add_u32 m0, s82, 24576
    v_mfma_f32_16x16x32_bf16 v[56:59], a[52:55], v[12:15], v[56:59]
    buffer_load_dwordx4 v232, s[20:23], s55 offen nt lds
    v_mfma_f32_16x16x32_bf16 v[56:59], a[76:79], v[16:19], v[56:59]
    v_mfma_f32_16x16x32_bf16 v[56:59], a[100:103], v[20:23], v[56:59]
    v_mfma_f32_16x16x32_bf16 v[56:59], a[124:127], v[24:27], v[56:59]
    buffer_load_dwordx4 v233, s[20:23], s55 offen offset:1024 nt lds
    v_mfma_f32_16x16x32_bf16 v[56:59], a[148:151], v[28:31], v[56:59]
    v_mfma_f32_16x16x32_bf16 v[56:59], a[172:175], v[32:35], v[56:59]
    v_mfma_f32_16x16x32_bf16 v[56:59], a[196:199], v[36:39], v[56:59]
    buffer_load_dwordx4 v234, s[20:23], s55 offen offset:2048 nt lds
    v_mfma_f32_16x16x32_bf16 v[56:59], a[220:223], v[40:43], v[56:59]
    v_cvt_pk_bf16_f32 v0, v52, v53
    v_cvt_pk_bf16_f32 v1, v54, v55
    v_mfma_f32_16x16x32_bf16 v[56:59], a[244:247], v[44:47], v[56:59]
    s_set_gpr_idx_on s54, gpr_idx(SRC0)
    v_mov_b64 v[252:253], v[84:85]
    v_mov_b64 v[254:255], v[86:87]
    s_set_gpr_idx_off
    v_mfma_f32_16x16x32_bf16 v[56:59], v[208:211], v[48:51], v[56:59]
    v_lshlrev_b32 v80, 16, v252
    v_and_b32 v81, s59, v252
    v_mfma_f32_16x16x32_bf16 v[60:63], a[8:11], v[4:7], v[192:195]
    v_lshlrev_b32 v82, 16, v253
    v_and_b32 v83, s59, v253
    v_mfma_f32_16x16x32_bf16 v[60:63], a[32:35], v[8:11], v[60:63]
    v_lshlrev_b32 v84, 16, v254
    v_and_b32 v85, s59, v254
    v_mfma_f32_16x16x32_bf16 v[60:63], a[56:59], v[12:15], v[60:63]
    v_lshlrev_b32 v86, 16, v255
    v_and_b32 v87, s59, v255
    v_mfma_f32_16x16x32_bf16 v[60:63], a[80:83], v[16:19], v[60:63]
    v_mfma_f32_16x16x32_bf16 v[60:63], a[104:107], v[20:23], v[60:63]
    v_mfma_f32_16x16x32_bf16 v[60:63], a[128:131], v[24:27], v[60:63]
    v_mfma_f32_16x16x32_bf16 v[60:63], a[152:155], v[28:31], v[60:63]
    v_mfma_f32_16x16x32_bf16 v[60:63], a[176:179], v[32:35], v[60:63]
    v_mfma_f32_16x16x32_bf16 v[60:63], a[200:203], v[36:39], v[60:63]
    v_cvt_pk_bf16_f32 v2, v56, v57
    v_cvt_pk_bf16_f32 v3, v58, v59
    v_mfma_f32_16x16x32_bf16 v[60:63], a[224:227], v[40:43], v[60:63]
    ds_write_b128 v235, v[0:3] offset:0
    v_mfma_f32_16x16x32_bf16 v[60:63], a[248:251], v[44:47], v[60:63]
    v_mfma_f32_16x16x32_bf16 v[60:63], v[212:215], v[48:51], v[60:63]
    v_mfma_f32_16x16x32_bf16 v[64:67], a[12:15], v[4:7], v[76:79]
    v_mfma_f32_16x16x32_bf16 v[64:67], a[36:39], v[8:11], v[64:67]
    v_mfma_f32_16x16x32_bf16 v[64:67], a[60:63], v[12:15], v[64:67]
    v_mfma_f32_16x16x32_bf16 v[64:67], a[84:87], v[16:19], v[64:67]
    v_mfma_f32_16x16x32_bf16 v[64:67], a[108:111], v[20:23], v[64:67]
    v_mfma_f32_16x16x32_bf16 v[64:67], a[132:135], v[24:27], v[64:67]
    v_mfma_f32_16x16x32_bf16 v[64:67], a[156:159], v[28:31], v[64:67]
    v_mfma_f32_16x16x32_bf16 v[64:67], a[180:183], v[32:35], v[64:67]
    v_mfma_f32_16x16x32_bf16 v[64:67], a[204:207], v[36:39], v[64:67]
    v_cvt_pk_bf16_f32 v0, v60, v61
    v_cvt_pk_bf16_f32 v1, v62, v63
    v_mfma_f32_16x16x32_bf16 v[64:67], a[228:231], v[40:43], v[64:67]
    v_mfma_f32_16x16x32_bf16 v[64:67], a[252:255], v[44:47], v[64:67]
    v_mfma_f32_16x16x32_bf16 v[64:67], v[216:219], v[48:51], v[64:67]
    v_mfma_f32_16x16x32_bf16 v[68:71], a[16:19], v[4:7], v[80:83]
    v_mfma_f32_16x16x32_bf16 v[68:71], a[40:43], v[8:11], v[68:71]
    s_waitcnt vmcnt(6) lgkmcnt(1)
    s_barrier
    v_mfma_f32_16x16x32_bf16 v[68:71], a[64:67], v[12:15], v[68:71]
    ds_read_b128 v[240:243], v238 offset:36864
    v_mfma_f32_16x16x32_bf16 v[68:71], a[88:91], v[16:19], v[68:71]
    ds_read_b128 v[244:247], v238 offset:37888
    v_mfma_f32_16x16x32_bf16 v[68:71], a[112:115], v[20:23], v[68:71]
    v_mfma_f32_16x16x32_bf16 v[68:71], a[136:139], v[24:27], v[68:71]
    v_mfma_f32_16x16x32_bf16 v[72:75], a[20:23], v[4:7], v[84:87]
    ds_read_b128 v[4:7], v228 offset:12288
    v_mfma_f32_16x16x32_bf16 v[72:75], a[44:47], v[8:11], v[72:75]
    ds_read_b128 v[248:251], v238 offset:38912
    v_mfma_f32_16x16x32_bf16 v[72:75], a[68:71], v[12:15], v[72:75]
    ds_read_b128 v[8:11], v229 offset:12288
    v_mfma_f32_16x16x32_bf16 v[72:75], a[92:95], v[16:19], v[72:75]
    v_cvt_pk_bf16_f32 v2, v64, v65
    v_cvt_pk_bf16_f32 v3, v66, v67
    v_mfma_f32_16x16x32_bf16 v[72:75], a[116:119], v[20:23], v[72:75]
    ds_read_b128 v[12:15], v230 offset:12288
    v_mfma_f32_16x16x32_bf16 v[72:75], a[140:143], v[24:27], v[72:75]
    ds_write_b128 v236, v[0:3] offset:0
    v_mfma_f32_16x16x32_bf16 v[68:71], a[160:163], v[28:31], v[68:71]
    ds_read_b128 v[16:19], v231 offset:12288
    v_mfma_f32_16x16x32_bf16 v[68:71], a[184:187], v[32:35], v[68:71]
    v_mfma_f32_16x16x32_bf16 v[68:71], a[208:211], v[36:39], v[68:71]
    s_waitcnt lgkmcnt(7)
    buffer_store_dwordx4 v[240:243], v232, s[36:39], s56 offen sc1
    ds_read_b128 v[20:23], v228 offset:12544
    v_mfma_f32_16x16x32_bf16 v[68:71], a[232:235], v[40:43], v[68:71]
    v_mfma_f32_16x16x32_bf16 v[68:71], v[196:199], v[44:47], v[68:71]
    ds_read_b128 v[24:27], v229 offset:12544
    v_mfma_f32_16x16x32_bf16 v[68:71], v[220:223], v[48:51], v[68:71]
    v_mfma_f32_16x16x32_bf16 v[72:75], a[164:167], v[28:31], v[72:75]
    s_waitcnt lgkmcnt(8)
    buffer_store_dwordx4 v[244:247], v233, s[36:39], s56 offen offset:1024 sc1
    ds_read_b128 v[28:31], v230 offset:12544
    v_mfma_f32_16x16x32_bf16 v[72:75], a[188:191], v[32:35], v[72:75]
    ds_read_b128 v[32:35], v231 offset:12544
    v_mfma_f32_16x16x32_bf16 v[72:75], a[212:215], v[36:39], v[72:75]
    ds_read_b128 v[36:39], v228 offset:12800
    v_mfma_f32_16x16x32_bf16 v[72:75], a[236:239], v[40:43], v[72:75]
    ds_read_b128 v[40:43], v229 offset:12800
    v_mfma_f32_16x16x32_bf16 v[72:75], v[200:203], v[44:47], v[72:75]
    s_waitcnt lgkmcnt(10)
    buffer_store_dwordx4 v[248:251], v234, s[36:39], s56 offen offset:2048 sc1
    s_add_u32 s56, s78, 0
    ds_read_b128 v[44:47], v230 offset:12800
    v_mfma_f32_16x16x32_bf16 v[72:75], v[224:227], v[48:51], v[72:75]
    ds_read_b128 v[48:51], v231 offset:12800
    s_waitcnt lgkmcnt(10)
    v_mfma_f32_16x16x32_bf16 v[52:55], a[0:3], v[4:7], v[184:187]
    v_mfma_f32_16x16x32_bf16 v[52:55], a[24:27], v[8:11], v[52:55]
    v_mfma_f32_16x16x32_bf16 v[52:55], a[48:51], v[12:15], v[52:55]
    s_waitcnt lgkmcnt(6)
    v_mfma_f32_16x16x32_bf16 v[52:55], a[72:75], v[16:19], v[52:55]
    v_cvt_pk_bf16_f32 v0, v68, v69
    v_cvt_pk_bf16_f32 v1, v70, v71
    v_mfma_f32_16x16x32_bf16 v[52:55], a[96:99], v[20:23], v[52:55]
    v_mfma_f32_16x16x32_bf16 v[52:55], a[120:123], v[24:27], v[52:55]
    s_waitcnt lgkmcnt(3)
    v_mfma_f32_16x16x32_bf16 v[52:55], a[144:147], v[28:31], v[52:55]
    v_mfma_f32_16x16x32_bf16 v[52:55], a[168:171], v[32:35], v[52:55]
    v_mfma_f32_16x16x32_bf16 v[52:55], a[192:195], v[36:39], v[52:55]
    s_waitcnt lgkmcnt(0)
    v_mfma_f32_16x16x32_bf16 v[52:55], a[216:219], v[40:43], v[52:55]
    v_cvt_pk_bf16_f32 v2, v72, v73
    v_cvt_pk_bf16_f32 v3, v74, v75
    v_mfma_f32_16x16x32_bf16 v[52:55], a[240:243], v[44:47], v[52:55]
    ds_write_b128 v237, v[0:3] offset:0
    v_mfma_f32_16x16x32_bf16 v[52:55], v[204:207], v[48:51], v[52:55]
    v_mfma_f32_16x16x32_bf16 v[56:59], a[4:7], v[4:7], v[188:191]
    s_add_u32 s55, s81, 295680
    v_mfma_f32_16x16x32_bf16 v[56:59], a[28:31], v[8:11], v[56:59]
    s_add_u32 m0, s82, 36864
    v_mfma_f32_16x16x32_bf16 v[56:59], a[52:55], v[12:15], v[56:59]
    buffer_load_dwordx4 v232, s[20:23], s55 offen nt lds
    v_mfma_f32_16x16x32_bf16 v[56:59], a[76:79], v[16:19], v[56:59]
    v_mfma_f32_16x16x32_bf16 v[56:59], a[100:103], v[20:23], v[56:59]
    v_mfma_f32_16x16x32_bf16 v[56:59], a[124:127], v[24:27], v[56:59]
    buffer_load_dwordx4 v233, s[20:23], s55 offen offset:1024 nt lds
    v_mfma_f32_16x16x32_bf16 v[56:59], a[148:151], v[28:31], v[56:59]
    v_mfma_f32_16x16x32_bf16 v[56:59], a[172:175], v[32:35], v[56:59]
    v_mfma_f32_16x16x32_bf16 v[56:59], a[196:199], v[36:39], v[56:59]
    buffer_load_dwordx4 v234, s[20:23], s55 offen offset:2048 nt lds
    v_mfma_f32_16x16x32_bf16 v[56:59], a[220:223], v[40:43], v[56:59]
    v_cvt_pk_bf16_f32 v0, v52, v53
    v_cvt_pk_bf16_f32 v1, v54, v55
    v_mfma_f32_16x16x32_bf16 v[56:59], a[244:247], v[44:47], v[56:59]
    v_mfma_f32_16x16x32_bf16 v[56:59], v[208:211], v[48:51], v[56:59]
    s_add_u32 s54, s54, 12
    v_mfma_f32_16x16x32_bf16 v[60:63], a[8:11], v[4:7], v[192:195]
    v_mfma_f32_16x16x32_bf16 v[60:63], a[32:35], v[8:11], v[60:63]
    v_mfma_f32_16x16x32_bf16 v[60:63], a[56:59], v[12:15], v[60:63]
    v_mfma_f32_16x16x32_bf16 v[60:63], a[80:83], v[16:19], v[60:63]
    v_mfma_f32_16x16x32_bf16 v[60:63], a[104:107], v[20:23], v[60:63]
    v_mfma_f32_16x16x32_bf16 v[60:63], a[128:131], v[24:27], v[60:63]
    v_mfma_f32_16x16x32_bf16 v[60:63], a[152:155], v[28:31], v[60:63]
    v_mfma_f32_16x16x32_bf16 v[60:63], a[176:179], v[32:35], v[60:63]
    v_mfma_f32_16x16x32_bf16 v[60:63], a[200:203], v[36:39], v[60:63]
    v_cvt_pk_bf16_f32 v2, v56, v57
    v_cvt_pk_bf16_f32 v3, v58, v59
    v_mfma_f32_16x16x32_bf16 v[60:63], a[224:227], v[40:43], v[60:63]
    ds_write_b128 v235, v[0:3] offset:12288
    v_mfma_f32_16x16x32_bf16 v[60:63], a[248:251], v[44:47], v[60:63]
    v_mfma_f32_16x16x32_bf16 v[60:63], v[212:215], v[48:51], v[60:63]
    v_mfma_f32_16x16x32_bf16 v[64:67], a[12:15], v[4:7], v[76:79]
    v_mfma_f32_16x16x32_bf16 v[64:67], a[36:39], v[8:11], v[64:67]
    v_mfma_f32_16x16x32_bf16 v[64:67], a[60:63], v[12:15], v[64:67]
    v_mfma_f32_16x16x32_bf16 v[64:67], a[84:87], v[16:19], v[64:67]
    v_mfma_f32_16x16x32_bf16 v[64:67], a[108:111], v[20:23], v[64:67]
    v_mfma_f32_16x16x32_bf16 v[64:67], a[132:135], v[24:27], v[64:67]
    v_mfma_f32_16x16x32_bf16 v[64:67], a[156:159], v[28:31], v[64:67]
    v_mfma_f32_16x16x32_bf16 v[64:67], a[180:183], v[32:35], v[64:67]
    v_mfma_f32_16x16x32_bf16 v[64:67], a[204:207], v[36:39], v[64:67]
    v_cvt_pk_bf16_f32 v0, v60, v61
    v_cvt_pk_bf16_f32 v1, v62, v63
    v_mfma_f32_16x16x32_bf16 v[64:67], a[228:231], v[40:43], v[64:67]
    v_mfma_f32_16x16x32_bf16 v[64:67], a[252:255], v[44:47], v[64:67]
    v_mfma_f32_16x16x32_bf16 v[64:67], v[216:219], v[48:51], v[64:67]
    v_mfma_f32_16x16x32_bf16 v[68:71], a[16:19], v[4:7], v[80:83]
    v_mfma_f32_16x16x32_bf16 v[68:71], a[40:43], v[8:11], v[68:71]
    s_waitcnt vmcnt(6) lgkmcnt(1)
    s_barrier
    v_mfma_f32_16x16x32_bf16 v[68:71], a[64:67], v[12:15], v[68:71]
    ds_read_b128 v[240:243], v238 offset:0
    v_mfma_f32_16x16x32_bf16 v[68:71], a[88:91], v[16:19], v[68:71]
    ds_read_b128 v[244:247], v238 offset:1024
    v_mfma_f32_16x16x32_bf16 v[68:71], a[112:115], v[20:23], v[68:71]
    v_mfma_f32_16x16x32_bf16 v[68:71], a[136:139], v[24:27], v[68:71]
    v_mfma_f32_16x16x32_bf16 v[72:75], a[20:23], v[4:7], v[84:87]
    ds_read_b128 v[4:7], v228 offset:24576
    v_mfma_f32_16x16x32_bf16 v[72:75], a[44:47], v[8:11], v[72:75]
    ds_read_b128 v[248:251], v238 offset:2048
    v_mfma_f32_16x16x32_bf16 v[72:75], a[68:71], v[12:15], v[72:75]
    ds_read_b128 v[8:11], v229 offset:24576
    v_mfma_f32_16x16x32_bf16 v[72:75], a[92:95], v[16:19], v[72:75]
    v_cvt_pk_bf16_f32 v2, v64, v65
    v_cvt_pk_bf16_f32 v3, v66, v67
    v_mfma_f32_16x16x32_bf16 v[72:75], a[116:119], v[20:23], v[72:75]
    ds_read_b128 v[12:15], v230 offset:24576
    v_mfma_f32_16x16x32_bf16 v[72:75], a[140:143], v[24:27], v[72:75]
    ds_write_b128 v236, v[0:3] offset:12288
    v_mfma_f32_16x16x32_bf16 v[68:71], a[160:163], v[28:31], v[68:71]
    ds_read_b128 v[16:19], v231 offset:24576
    v_mfma_f32_16x16x32_bf16 v[68:71], a[184:187], v[32:35], v[68:71]
    v_mfma_f32_16x16x32_bf16 v[68:71], a[208:211], v[36:39], v[68:71]
    s_waitcnt lgkmcnt(7)
    buffer_store_dwordx4 v[240:243], v232, s[36:39], s56 offen sc1
    ds_read_b128 v[20:23], v228 offset:24832
    v_mfma_f32_16x16x32_bf16 v[68:71], a[232:235], v[40:43], v[68:71]
    v_mfma_f32_16x16x32_bf16 v[68:71], v[196:199], v[44:47], v[68:71]
    ds_read_b128 v[24:27], v229 offset:24832
    v_mfma_f32_16x16x32_bf16 v[68:71], v[220:223], v[48:51], v[68:71]
    v_mfma_f32_16x16x32_bf16 v[72:75], a[164:167], v[28:31], v[72:75]
    s_waitcnt lgkmcnt(8)
    buffer_store_dwordx4 v[244:247], v233, s[36:39], s56 offen offset:1024 sc1
    ds_read_b128 v[28:31], v230 offset:24832
    v_mfma_f32_16x16x32_bf16 v[72:75], a[188:191], v[32:35], v[72:75]
    ds_read_b128 v[32:35], v231 offset:24832
    v_mfma_f32_16x16x32_bf16 v[72:75], a[212:215], v[36:39], v[72:75]
    ds_read_b128 v[36:39], v228 offset:25088
    v_mfma_f32_16x16x32_bf16 v[72:75], a[236:239], v[40:43], v[72:75]
    ds_read_b128 v[40:43], v229 offset:25088
    v_mfma_f32_16x16x32_bf16 v[72:75], v[200:203], v[44:47], v[72:75]
    s_waitcnt lgkmcnt(10)
    buffer_store_dwordx4 v[248:251], v234, s[36:39], s56 offen offset:2048 sc1
    s_add_u32 s56, s78, 768
    ds_read_b128 v[44:47], v230 offset:25088
    v_mfma_f32_16x16x32_bf16 v[72:75], v[224:227], v[48:51], v[72:75]
    ds_read_b128 v[48:51], v231 offset:25088
    s_waitcnt lgkmcnt(10)
    v_mfma_f32_16x16x32_bf16 v[52:55], a[0:3], v[4:7], v[184:187]
    v_mfma_f32_16x16x32_bf16 v[52:55], a[24:27], v[8:11], v[52:55]
    v_mfma_f32_16x16x32_bf16 v[52:55], a[48:51], v[12:15], v[52:55]
    s_waitcnt lgkmcnt(6)
    v_mfma_f32_16x16x32_bf16 v[52:55], a[72:75], v[16:19], v[52:55]
    v_cvt_pk_bf16_f32 v0, v68, v69
    v_cvt_pk_bf16_f32 v1, v70, v71
    v_mfma_f32_16x16x32_bf16 v[52:55], a[96:99], v[20:23], v[52:55]
    v_mfma_f32_16x16x32_bf16 v[52:55], a[120:123], v[24:27], v[52:55]
    s_waitcnt lgkmcnt(3)
    v_mfma_f32_16x16x32_bf16 v[52:55], a[144:147], v[28:31], v[52:55]
    v_mfma_f32_16x16x32_bf16 v[52:55], a[168:171], v[32:35], v[52:55]
    v_mfma_f32_16x16x32_bf16 v[52:55], a[192:195], v[36:39], v[52:55]
    s_waitcnt lgkmcnt(0)
    v_mfma_f32_16x16x32_bf16 v[52:55], a[216:219], v[40:43], v[52:55]
    v_cvt_pk_bf16_f32 v2, v72, v73
    v_cvt_pk_bf16_f32 v3, v74, v75
    v_mfma_f32_16x16x32_bf16 v[52:55], a[240:243], v[44:47], v[52:55]
    ds_write_b128 v237, v[0:3] offset:12288
    v_mfma_f32_16x16x32_bf16 v[52:55], v[204:207], v[48:51], v[52:55]
    v_mfma_f32_16x16x32_bf16 v[56:59], a[4:7], v[4:7], v[188:191]
    s_add_u32 s55, s97, 0
    v_mfma_f32_16x16x32_bf16 v[56:59], a[28:31], v[8:11], v[56:59]
    s_add_u32 m0, s49, 147456
    v_mfma_f32_16x16x32_bf16 v[56:59], a[52:55], v[12:15], v[56:59]
    buffer_load_dwordx4 v232, s[20:23], s55 offen nt lds
    v_mfma_f32_16x16x32_bf16 v[56:59], a[76:79], v[16:19], v[56:59]
    v_mfma_f32_16x16x32_bf16 v[56:59], a[100:103], v[20:23], v[56:59]
    v_mfma_f32_16x16x32_bf16 v[56:59], a[124:127], v[24:27], v[56:59]
    buffer_load_dwordx4 v233, s[20:23], s55 offen offset:1024 nt lds
    v_mfma_f32_16x16x32_bf16 v[56:59], a[148:151], v[28:31], v[56:59]
    v_mfma_f32_16x16x32_bf16 v[56:59], a[172:175], v[32:35], v[56:59]
    v_mfma_f32_16x16x32_bf16 v[56:59], a[196:199], v[36:39], v[56:59]
    v_mfma_f32_16x16x32_bf16 v[56:59], a[220:223], v[40:43], v[56:59]
    v_cvt_pk_bf16_f32 v0, v52, v53
    v_cvt_pk_bf16_f32 v1, v54, v55
    v_mfma_f32_16x16x32_bf16 v[56:59], a[244:247], v[44:47], v[56:59]
    v_mfma_f32_16x16x32_bf16 v[56:59], v[208:211], v[48:51], v[56:59]
    v_mfma_f32_16x16x32_bf16 v[60:63], a[8:11], v[4:7], v[192:195]
    v_mfma_f32_16x16x32_bf16 v[60:63], a[32:35], v[8:11], v[60:63]
    v_mfma_f32_16x16x32_bf16 v[60:63], a[56:59], v[12:15], v[60:63]
    v_mfma_f32_16x16x32_bf16 v[60:63], a[80:83], v[16:19], v[60:63]
    v_mfma_f32_16x16x32_bf16 v[60:63], a[104:107], v[20:23], v[60:63]
    v_mfma_f32_16x16x32_bf16 v[60:63], a[128:131], v[24:27], v[60:63]
    v_mfma_f32_16x16x32_bf16 v[60:63], a[152:155], v[28:31], v[60:63]
    v_mfma_f32_16x16x32_bf16 v[60:63], a[176:179], v[32:35], v[60:63]
    v_mfma_f32_16x16x32_bf16 v[60:63], a[200:203], v[36:39], v[60:63]
    v_cvt_pk_bf16_f32 v2, v56, v57
    v_cvt_pk_bf16_f32 v3, v58, v59
    v_mfma_f32_16x16x32_bf16 v[60:63], a[224:227], v[40:43], v[60:63]
    ds_write_b128 v235, v[0:3] offset:24576
    v_mfma_f32_16x16x32_bf16 v[60:63], a[248:251], v[44:47], v[60:63]
    v_mfma_f32_16x16x32_bf16 v[60:63], v[212:215], v[48:51], v[60:63]
    v_mfma_f32_16x16x32_bf16 v[64:67], a[12:15], v[4:7], v[76:79]
    v_mfma_f32_16x16x32_bf16 v[64:67], a[36:39], v[8:11], v[64:67]
    v_mfma_f32_16x16x32_bf16 v[64:67], a[60:63], v[12:15], v[64:67]
    v_mfma_f32_16x16x32_bf16 v[64:67], a[84:87], v[16:19], v[64:67]
    v_mfma_f32_16x16x32_bf16 v[64:67], a[108:111], v[20:23], v[64:67]
    v_mfma_f32_16x16x32_bf16 v[64:67], a[132:135], v[24:27], v[64:67]
    v_mfma_f32_16x16x32_bf16 v[64:67], a[156:159], v[28:31], v[64:67]
    v_mfma_f32_16x16x32_bf16 v[64:67], a[180:183], v[32:35], v[64:67]
    v_mfma_f32_16x16x32_bf16 v[64:67], a[204:207], v[36:39], v[64:67]
    v_cvt_pk_bf16_f32 v0, v60, v61
    v_cvt_pk_bf16_f32 v1, v62, v63
    v_mfma_f32_16x16x32_bf16 v[64:67], a[228:231], v[40:43], v[64:67]
    v_mfma_f32_16x16x32_bf16 v[64:67], a[252:255], v[44:47], v[64:67]
    v_mfma_f32_16x16x32_bf16 v[64:67], v[216:219], v[48:51], v[64:67]
    v_mfma_f32_16x16x32_bf16 v[68:71], a[16:19], v[4:7], v[80:83]
    v_mfma_f32_16x16x32_bf16 v[68:71], a[40:43], v[8:11], v[68:71]
    s_waitcnt vmcnt(5) lgkmcnt(1)
    s_barrier
    v_mfma_f32_16x16x32_bf16 v[68:71], a[64:67], v[12:15], v[68:71]
    ds_read_b128 v[240:243], v238 offset:12288
    v_mfma_f32_16x16x32_bf16 v[68:71], a[88:91], v[16:19], v[68:71]
    ds_read_b128 v[244:247], v238 offset:13312
    v_mfma_f32_16x16x32_bf16 v[68:71], a[112:115], v[20:23], v[68:71]
    v_mfma_f32_16x16x32_bf16 v[68:71], a[136:139], v[24:27], v[68:71]
    v_mfma_f32_16x16x32_bf16 v[72:75], a[20:23], v[4:7], v[84:87]
    ds_read_b128 v[4:7], v228 offset:36864
    v_mfma_f32_16x16x32_bf16 v[72:75], a[44:47], v[8:11], v[72:75]
    ds_read_b128 v[248:251], v238 offset:14336
    v_mfma_f32_16x16x32_bf16 v[72:75], a[68:71], v[12:15], v[72:75]
    ds_read_b128 v[8:11], v229 offset:36864
    v_mfma_f32_16x16x32_bf16 v[72:75], a[92:95], v[16:19], v[72:75]
    v_cvt_pk_bf16_f32 v2, v64, v65
    v_cvt_pk_bf16_f32 v3, v66, v67
    v_mfma_f32_16x16x32_bf16 v[72:75], a[116:119], v[20:23], v[72:75]
    ds_read_b128 v[12:15], v230 offset:36864
    v_mfma_f32_16x16x32_bf16 v[72:75], a[140:143], v[24:27], v[72:75]
    ds_write_b128 v236, v[0:3] offset:24576
    v_mfma_f32_16x16x32_bf16 v[68:71], a[160:163], v[28:31], v[68:71]
    ds_read_b128 v[16:19], v231 offset:36864
    v_mfma_f32_16x16x32_bf16 v[68:71], a[184:187], v[32:35], v[68:71]
    v_mfma_f32_16x16x32_bf16 v[68:71], a[208:211], v[36:39], v[68:71]
    s_waitcnt lgkmcnt(7)
    buffer_store_dwordx4 v[240:243], v232, s[36:39], s56 offen sc1
    ds_read_b128 v[20:23], v228 offset:37120
    v_mfma_f32_16x16x32_bf16 v[68:71], a[232:235], v[40:43], v[68:71]
    v_mfma_f32_16x16x32_bf16 v[68:71], v[196:199], v[44:47], v[68:71]
    ds_read_b128 v[24:27], v229 offset:37120
    v_mfma_f32_16x16x32_bf16 v[68:71], v[220:223], v[48:51], v[68:71]
    v_mfma_f32_16x16x32_bf16 v[72:75], a[164:167], v[28:31], v[72:75]
    s_waitcnt lgkmcnt(8)
    buffer_store_dwordx4 v[244:247], v233, s[36:39], s56 offen offset:1024 sc1
    ds_read_b128 v[28:31], v230 offset:37120
    v_mfma_f32_16x16x32_bf16 v[72:75], a[188:191], v[32:35], v[72:75]
    ds_read_b128 v[32:35], v231 offset:37120
    v_mfma_f32_16x16x32_bf16 v[72:75], a[212:215], v[36:39], v[72:75]
    ds_read_b128 v[36:39], v228 offset:37376
    v_mfma_f32_16x16x32_bf16 v[72:75], a[236:239], v[40:43], v[72:75]
    ds_read_b128 v[40:43], v229 offset:37376
    v_mfma_f32_16x16x32_bf16 v[72:75], v[200:203], v[44:47], v[72:75]
    s_waitcnt lgkmcnt(10)
    buffer_store_dwordx4 v[248:251], v234, s[36:39], s56 offen offset:2048 sc1
    s_add_u32 s56, s78, 294912
    ds_read_b128 v[44:47], v230 offset:37376
    v_mfma_f32_16x16x32_bf16 v[72:75], v[224:227], v[48:51], v[72:75]
    ds_read_b128 v[48:51], v231 offset:37376
    s_waitcnt lgkmcnt(10)
    v_mfma_f32_16x16x32_bf16 v[52:55], a[0:3], v[4:7], v[184:187]
    v_mfma_f32_16x16x32_bf16 v[52:55], a[24:27], v[8:11], v[52:55]
    s_add_u32 s83, s83, 1
    v_mfma_f32_16x16x32_bf16 v[52:55], a[48:51], v[12:15], v[52:55]
    s_waitcnt lgkmcnt(6)
    v_mfma_f32_16x16x32_bf16 v[52:55], a[72:75], v[16:19], v[52:55]
    v_cvt_pk_bf16_f32 v0, v68, v69
    v_cvt_pk_bf16_f32 v1, v70, v71
    v_mfma_f32_16x16x32_bf16 v[52:55], a[96:99], v[20:23], v[52:55]
    v_mfma_f32_16x16x32_bf16 v[52:55], a[120:123], v[24:27], v[52:55]
    s_waitcnt lgkmcnt(3)
    v_mfma_f32_16x16x32_bf16 v[52:55], a[144:147], v[28:31], v[52:55]
    v_mfma_f32_16x16x32_bf16 v[52:55], a[168:171], v[32:35], v[52:55]
    v_mfma_f32_16x16x32_bf16 v[52:55], a[192:195], v[36:39], v[52:55]
    s_waitcnt lgkmcnt(0)
    v_mfma_f32_16x16x32_bf16 v[52:55], a[216:219], v[40:43], v[52:55]
    v_cvt_pk_bf16_f32 v2, v72, v73
    v_cvt_pk_bf16_f32 v3, v74, v75
    v_mfma_f32_16x16x32_bf16 v[52:55], a[240:243], v[44:47], v[52:55]
    ds_write_b128 v237, v[0:3] offset:24576
    v_mfma_f32_16x16x32_bf16 v[52:55], v[204:207], v[48:51], v[52:55]
    v_mfma_f32_16x16x32_bf16 v[56:59], a[4:7], v[4:7], v[188:191]
    s_add_u32 s55, s97, 768
    v_mfma_f32_16x16x32_bf16 v[56:59], a[28:31], v[8:11], v[56:59]
    s_add_u32 m0, s49, 147456
    v_mfma_f32_16x16x32_bf16 v[56:59], a[52:55], v[12:15], v[56:59]
    buffer_load_dwordx4 v232, s[20:23], s55 offen nt lds
    v_mfma_f32_16x16x32_bf16 v[56:59], a[76:79], v[16:19], v[56:59]
    v_mfma_f32_16x16x32_bf16 v[56:59], a[100:103], v[20:23], v[56:59]
    v_mfma_f32_16x16x32_bf16 v[56:59], a[124:127], v[24:27], v[56:59]
    buffer_load_dwordx4 v233, s[20:23], s55 offen offset:1024 nt lds
    v_mfma_f32_16x16x32_bf16 v[56:59], a[148:151], v[28:31], v[56:59]
    v_mfma_f32_16x16x32_bf16 v[56:59], a[172:175], v[32:35], v[56:59]
    v_mfma_f32_16x16x32_bf16 v[56:59], a[196:199], v[36:39], v[56:59]
    v_mfma_f32_16x16x32_bf16 v[56:59], a[220:223], v[40:43], v[56:59]
    v_cvt_pk_bf16_f32 v0, v52, v53
    v_cvt_pk_bf16_f32 v1, v54, v55
    v_mfma_f32_16x16x32_bf16 v[56:59], a[244:247], v[44:47], v[56:59]
    v_mfma_f32_16x16x32_bf16 v[56:59], v[208:211], v[48:51], v[56:59]
    v_mfma_f32_16x16x32_bf16 v[60:63], a[8:11], v[4:7], v[192:195]
    v_mfma_f32_16x16x32_bf16 v[60:63], a[32:35], v[8:11], v[60:63]
    v_mfma_f32_16x16x32_bf16 v[60:63], a[56:59], v[12:15], v[60:63]
    v_mfma_f32_16x16x32_bf16 v[60:63], a[80:83], v[16:19], v[60:63]
    v_mfma_f32_16x16x32_bf16 v[60:63], a[104:107], v[20:23], v[60:63]
    v_mfma_f32_16x16x32_bf16 v[60:63], a[128:131], v[24:27], v[60:63]
    v_mfma_f32_16x16x32_bf16 v[60:63], a[152:155], v[28:31], v[60:63]
    v_mfma_f32_16x16x32_bf16 v[60:63], a[176:179], v[32:35], v[60:63]
    v_mfma_f32_16x16x32_bf16 v[60:63], a[200:203], v[36:39], v[60:63]
    v_cvt_pk_bf16_f32 v2, v56, v57
    v_cvt_pk_bf16_f32 v3, v58, v59
    v_mfma_f32_16x16x32_bf16 v[60:63], a[224:227], v[40:43], v[60:63]
    ds_write_b128 v235, v[0:3] offset:36864
    v_mfma_f32_16x16x32_bf16 v[60:63], a[248:251], v[44:47], v[60:63]
    v_mfma_f32_16x16x32_bf16 v[60:63], v[212:215], v[48:51], v[60:63]
    v_mfma_f32_16x16x32_bf16 v[64:67], a[12:15], v[4:7], v[76:79]
    v_mfma_f32_16x16x32_bf16 v[64:67], a[36:39], v[8:11], v[64:67]
    v_mfma_f32_16x16x32_bf16 v[64:67], a[60:63], v[12:15], v[64:67]
    v_mfma_f32_16x16x32_bf16 v[64:67], a[84:87], v[16:19], v[64:67]
    v_mfma_f32_16x16x32_bf16 v[64:67], a[108:111], v[20:23], v[64:67]
    v_mfma_f32_16x16x32_bf16 v[64:67], a[132:135], v[24:27], v[64:67]
    v_mfma_f32_16x16x32_bf16 v[64:67], a[156:159], v[28:31], v[64:67]
    v_mfma_f32_16x16x32_bf16 v[64:67], a[180:183], v[32:35], v[64:67]
    v_mfma_f32_16x16x32_bf16 v[64:67], a[204:207], v[36:39], v[64:67]
    v_cvt_pk_bf16_f32 v0, v60, v61
    v_cvt_pk_bf16_f32 v1, v62, v63
    v_mfma_f32_16x16x32_bf16 v[64:67], a[228:231], v[40:43], v[64:67]
    v_mfma_f32_16x16x32_bf16 v[64:67], a[252:255], v[44:47], v[64:67]
    v_mfma_f32_16x16x32_bf16 v[64:67], v[216:219], v[48:51], v[64:67]
    v_mfma_f32_16x16x32_bf16 v[68:71], a[16:19], v[4:7], v[80:83]
    v_mfma_f32_16x16x32_bf16 v[68:71], a[40:43], v[8:11], v[68:71]
    s_waitcnt lgkmcnt(1)
    s_barrier
    v_mfma_f32_16x16x32_bf16 v[68:71], a[64:67], v[12:15], v[68:71]
    ds_read_b128 v[240:243], v238 offset:24576
    v_mfma_f32_16x16x32_bf16 v[68:71], a[88:91], v[16:19], v[68:71]
    ds_read_b128 v[244:247], v238 offset:25600
    v_mfma_f32_16x16x32_bf16 v[68:71], a[112:115], v[20:23], v[68:71]
    v_mfma_f32_16x16x32_bf16 v[68:71], a[136:139], v[24:27], v[68:71]
    v_mfma_f32_16x16x32_bf16 v[72:75], a[20:23], v[4:7], v[84:87]
    v_mfma_f32_16x16x32_bf16 v[72:75], a[44:47], v[8:11], v[72:75]
    ds_read_b128 v[248:251], v238 offset:26624
    v_mfma_f32_16x16x32_bf16 v[72:75], a[68:71], v[12:15], v[72:75]
    v_mfma_f32_16x16x32_bf16 v[72:75], a[92:95], v[16:19], v[72:75]
    v_cvt_pk_bf16_f32 v2, v64, v65
    v_cvt_pk_bf16_f32 v3, v66, v67
    v_mfma_f32_16x16x32_bf16 v[72:75], a[116:119], v[20:23], v[72:75]
    v_mfma_f32_16x16x32_bf16 v[72:75], a[140:143], v[24:27], v[72:75]
    ds_write_b128 v236, v[0:3] offset:36864
    v_mfma_f32_16x16x32_bf16 v[68:71], a[160:163], v[28:31], v[68:71]
    v_mfma_f32_16x16x32_bf16 v[68:71], a[184:187], v[32:35], v[68:71]
    v_mfma_f32_16x16x32_bf16 v[68:71], a[208:211], v[36:39], v[68:71]
    s_waitcnt lgkmcnt(3)
    buffer_store_dwordx4 v[240:243], v232, s[36:39], s56 offen sc1
    v_mfma_f32_16x16x32_bf16 v[68:71], a[232:235], v[40:43], v[68:71]
    v_mfma_f32_16x16x32_bf16 v[68:71], v[196:199], v[44:47], v[68:71]
    v_mfma_f32_16x16x32_bf16 v[68:71], v[220:223], v[48:51], v[68:71]
    v_mfma_f32_16x16x32_bf16 v[72:75], a[164:167], v[28:31], v[72:75]
    s_waitcnt lgkmcnt(2)
    buffer_store_dwordx4 v[244:247], v233, s[36:39], s56 offen offset:1024 sc1
    v_mfma_f32_16x16x32_bf16 v[72:75], a[188:191], v[32:35], v[72:75]
    v_mfma_f32_16x16x32_bf16 v[72:75], a[212:215], v[36:39], v[72:75]
    v_mfma_f32_16x16x32_bf16 v[72:75], a[236:239], v[40:43], v[72:75]
    v_mfma_f32_16x16x32_bf16 v[72:75], v[200:203], v[44:47], v[72:75]
    s_waitcnt lgkmcnt(1)
    buffer_store_dwordx4 v[248:251], v234, s[36:39], s56 offen offset:2048 sc1
    s_add_u32 s56, s78, 295680
    v_mfma_f32_16x16x32_bf16 v[72:75], v[224:227], v[48:51], v[72:75]
    s_nop 3
    v_cvt_pk_bf16_f32 v0, v68, v69
    v_cvt_pk_bf16_f32 v1, v70, v71
    s_nop 4
    v_cvt_pk_bf16_f32 v2, v72, v73
    v_cvt_pk_bf16_f32 v3, v74, v75
    ds_write_b128 v237, v[0:3] offset:36864
    s_waitcnt lgkmcnt(0)
    s_barrier
    ds_read_b128 v[240:243], v238 offset:36864
    ds_read_b128 v[244:247], v238 offset:37888
    ds_read_b128 v[248:251], v238 offset:38912
    s_waitcnt lgkmcnt(2)
    buffer_store_dwordx4 v[240:243], v232, s[36:39], s56 offen sc1
    s_waitcnt lgkmcnt(1)
    buffer_store_dwordx4 v[244:247], v233, s[36:39], s56 offen offset:1024 sc1
    s_waitcnt lgkmcnt(0)
    buffer_store_dwordx4 v[248:251], v234, s[36:39], s56 offen offset:2048 sc1
    s_endpgm
L_prod:
    v_mul_u32_u24 v136, 192, v2
    v_lshl_add_u32 v136, v3, 4, v136
    v_add_u32 v136, s71, v136
    v_and_b32 v137, 1, v3
    v_lshrrev_b32 v138, 1, v3
    v_bfe_u32 v139, v0, 2, 2
    v_lshl_add_u32 v139, v137, 3, v139
    v_mul_u32_u24 v139, 192, v139
    v_and_b32 v1, 3, v0
    v_lshl_add_u32 v139, v1, 4, v139
    v_lshl_add_u32 v139, v138, 3, v139
    v_add_u32 v139, s71, v139
    v_cvt_pk_bf16_f32 v112, v148, v149
    v_cvt_pk_bf16_f32 v113, v150, v151
    v_cvt_pk_bf16_f32 v114, v152, v153
    v_cvt_pk_bf16_f32 v115, v154, v155
    v_cvt_pk_bf16_f32 v116, v156, v157
    v_cvt_pk_bf16_f32 v117, v158, v159
    v_cvt_pk_bf16_f32 v118, v160, v161
    v_cvt_pk_bf16_f32 v119, v162, v163
    v_cvt_pk_bf16_f32 v120, v164, v165
    v_cvt_pk_bf16_f32 v121, v166, v167
    v_cvt_pk_bf16_f32 v122, v168, v169
    v_cvt_pk_bf16_f32 v123, v170, v171
    ds_write_b128 v136, v[112:115] offset:0
    ds_write_b128 v136, v[116:119] offset:64
    ds_write_b128 v136, v[120:123] offset:128
    ds_read_b64_tr_b16 v[124:125], v139 offset:0
    ds_read_b64_tr_b16 v[126:127], v139 offset:768
    ds_read_b64_tr_b16 v[128:129], v139 offset:64
    ds_read_b64_tr_b16 v[130:131], v139 offset:832
    ds_read_b64_tr_b16 v[132:133], v139 offset:128
    ds_read_b64_tr_b16 v[134:135], v139 offset:896
    v_lshl_add_u32 v1, v137, 4, v2
    v_lshlrev_b32 v1, 4, v1
    v_lshl_add_u32 v1, v138, 11, v1
    s_mul_i32 s57, s48, 73728
    v_add_u32 v1, s57, v1
    s_lshr_b32 s57, s60, 2
    s_mul_i32 s57, s57, 12288
    s_and_b32 s58, s60, 3
    s_lshl_b32 s58, s58, 9
    s_add_u32 s57, s57, s58
    s_add_u32 s58, s57, 4096
    s_add_u32 s68, s57, 8192
    s_waitcnt lgkmcnt(0)
    buffer_store_dwordx4 v[124:127], v1, s[40:43], s57 offen sc0 sc1
    buffer_store_dwordx4 v[128:131], v1, s[40:43], s58 offen sc0 sc1
    buffer_store_dwordx4 v[132:135], v1, s[40:43], s68 offen sc0 sc1
    s_waitcnt vmcnt(12)
    s_branch L_prod_ret
L_poll:
    s_load_dword s72, s[14:15], 64
    s_waitcnt lgkmcnt(0)
    s_cmp_ge_u32 s72, 24
    s_cbranch_scc1 L_got
    s_sleep 8
    s_load_dword s72, s[14:15], 128
    s_waitcnt lgkmcnt(0)
    s_cmp_ge_u32 s72, 24
    s_cbranch_scc1 L_got
    s_sleep 8
    s_load_dword s72, s[14:15], 192
    s_waitcnt lgkmcnt(0)
    s_cmp_ge_u32 s72, 24
    s_cbranch_scc1 L_got
    s_mov_b32 s58, 0
L_poll2:
    buffer_load_dword v254, off, s[44:47], 0 sc1
    s_waitcnt vmcnt(0)
    v_readfirstlane_b32 s72, v254
    s_nop 3
    s_cmp_ge_u32 s72, 24
    s_cbranch_scc1 L_got
    s_sleep 4
    s_add_u32 s58, s58, 1
    s_cmp_lt_u32 s58, 0x40000
    s_cbranch_scc1 L_poll2
L_got:
    s_mov_b32 exec_hi, 15
    buffer_load_dword v254, v253, s[40:43], 0 offen sc1
    s_mov_b64 exec, -1
    s_branch L_ready
L_end:
    s_endpgm
.section .rodata,"a"
.p2align 6
.amdhsa_kernel standalone__detection_seg_fpn_lateral__vision_kernel
  .amdhsa_next_free_vgpr 512
  .amdhsa_next_free_sgpr 102
  .amdhsa_accum_offset 256
  .amdhsa_group_segment_fixed_size 0
  .amdhsa_kernarg_size 56
  .amdhsa_user_sgpr_count 2
  .amdhsa_user_sgpr_kernarg_segment_ptr 1
  .amdhsa_system_sgpr_workgroup_id_x 1
.end_amdhsa_kernel
```

```asm
; @launch grid=(256,1,1) block=(256,1,1) lds=163840
.amdgcn_target "amdgcn-amd-amdhsa--gfx950"
.text
.globl standalone__detection_seg_fpn_lateral__vision_kernel
.p2align 8
.type standalone__detection_seg_fpn_lateral__vision_kernel,@function
standalone__detection_seg_fpn_lateral__vision_kernel:
    s_load_dwordx8 s[4:11], s[0:1], 0
    s_load_dwordx2 s[16:17], s[0:1], 48
    s_getpc_b64 s[18:19]
L_pc:
    s_cmp_ge_u32 s2, 256
    s_cbranch_scc1 L_end
    s_and_b32 s57, s2, 0x30
    s_cbranch_scc1 L_nocpf
    s_and_b32 s57, s2, 8
    s_lshl_b32 s57, s57, 12
    v_lshl_add_u32 v1, v0, 7, s57
    v_min_u32 v1, L_end-L_pc, v1
    global_load_dword v96, v1, s[18:19]
L_nocpf:
    v_lshrrev_b32 v1, 6, v0
    v_and_b32 v0, 63, v0
    v_readfirstlane_b32 s48, v1
    v_lshrrev_b32 v3, 4, v0
    v_lshlrev_b32 v85, 7, v0
    s_lshr_b32 s68, s2, 3
    s_lshl_b32 s68, s68, 2
    s_add_u32 s68, s68, s48
    s_mul_i32 s68, s68, 2304
    s_mul_i32 s49, s48, 3072
    s_mul_i32 s57, s48, 516
    v_mad_u32_u24 v80, v3, 43, s57
    v_lshl_add_u32 v81, v0, 4, s49
    v_lshrrev_b32 v1, 3, v80
    v_and_b32 v1, 0xf0, v1
    v_xor_b32 v244, v1, v81
    v_mad_u32_u24 v232, v1, 48, v244
    v_add_u32 v80, 172, v80
    v_lshrrev_b32 v1, 3, v80
    v_and_b32 v1, 0xf0, v1
    v_xor_b32 v245, v1, v81
    v_mad_u32_u24 v233, v1, 48, v245
    v_add_u32 v80, 172, v80
    v_lshrrev_b32 v1, 3, v80
    v_and_b32 v1, 0xf0, v1
    v_xor_b32 v246, v1, v81
    v_mad_u32_u24 v234, v1, 48, v246
    s_lshr_b32 s57, s2, 4
    s_lshl_b32 s60, s57, 2
    s_bfe_u32 s57, s2, 131073
    s_add_u32 s60, s60, s57
    s_and_b32 s57, s2, 9
    s_cselect_b32 s60, 99, s60
    s_bitcmp1_b32 s2, 3
    s_cselect_b32 s61, 2, 1
    s_cmp_lt_u32 s60, 24
    s_cselect_b32 s61, 0, s61
    s_mov_b32 s34, 294912
    s_mov_b32 s35, 0x20000
    s_mov_b32 s26, 28311552
    s_mov_b32 s27, 0x20000
    s_waitcnt lgkmcnt(0)
    s_mov_b64 s[32:33], s[10:11]
    s_mov_b64 exec, 0x3ffff
    buffer_load_dword v97, v85, s[32:35], s68 offen
    s_mov_b64 exec, -1
    s_mov_b64 s[24:25], s[6:7]
    s_mov_b32 s40, s16
    s_mov_b32 s41, s17
    s_mov_b32 s42, 1048576
    s_mov_b32 s43, 0x20000
    s_bfe_u32 s66, s2, 131076
    s_lshl_b32 s66, s66, 2
    s_add_u32 s66, s66, s48
    s_lshl_b32 s66, s66, 7
    s_add_u32 s66, s66, 0x80000
    buffer_load_dword v239, off, s[40:43], s66 sc1
    s_load_dwordx4 s[12:15], s[0:1], 32
    s_cmp_eq_u32 s61, 1
    s_cbranch_scc1 L_pre_done
    s_cmp_eq_u32 s61, 2
    s_cbranch_scc1 L_pre_2
    s_mov_b32 s28, s8
    s_mov_b32 s29, s9
    s_mov_b32 s30, 294912
    s_mov_b32 s31, 0x20000
    s_mul_i32 s57, s60, 12288
    s_add_u32 s75, s57, 0
    s_add_u32 m0, s49, 110592
    s_nop 0
    buffer_load_dwordx4 v244, s[28:31], s75 offen lds
    buffer_load_dwordx4 v245, s[28:31], s75 offen offset:1024 lds
    buffer_load_dwordx4 v246, s[28:31], s75 offen offset:2048 lds
    s_branch L_pre_done
L_pre_2:
    s_add_u32 s76, s2, 0
    s_and_b32 s76, s76, 255
    s_add_u32 s76, s76, 0
    s_mul_i32 s76, s76, 12288
    s_add_u32 m0, s49, 110592
    s_nop 0
    buffer_load_dwordx4 v244, s[24:27], s76 offen nt lds
    buffer_load_dwordx4 v245, s[24:27], s76 offen offset:1024 nt lds
    buffer_load_dwordx4 v246, s[24:27], s76 offen offset:2048 nt lds
    s_add_u32 s77, s2, 43
    s_and_b32 s77, s77, 255
    s_add_u32 s77, s77, 256
    s_mul_i32 s77, s77, 12288
    s_add_u32 m0, s49, 122880
    s_nop 0
    buffer_load_dwordx4 v244, s[24:27], s77 offen nt lds
    buffer_load_dwordx4 v245, s[24:27], s77 offen offset:1024 nt lds
    buffer_load_dwordx4 v246, s[24:27], s77 offen offset:2048 nt lds
    s_add_u32 s74, s2, 86
    s_and_b32 s74, s74, 255
    s_add_u32 s74, s74, 512
    s_mul_i32 s74, s74, 12288
    s_add_u32 m0, s49, 135168
    s_nop 0
    buffer_load_dwordx4 v244, s[24:27], s74 offen nt lds
    buffer_load_dwordx4 v245, s[24:27], s74 offen offset:1024 nt lds
    buffer_load_dwordx4 v246, s[24:27], s74 offen offset:2048 nt lds
    s_add_u32 s75, s2, 129
    s_and_b32 s75, s75, 255
    s_add_u32 s75, s75, 768
    s_mul_i32 s75, s75, 12288
    s_add_u32 m0, s49, 24576
    s_nop 0
    buffer_load_dwordx4 v244, s[24:27], s75 offen nt lds
    buffer_load_dwordx4 v245, s[24:27], s75 offen offset:1024 nt lds
    buffer_load_dwordx4 v246, s[24:27], s75 offen offset:2048 nt lds
    s_add_u32 s76, s2, 172
    s_and_b32 s76, s76, 255
    s_add_u32 s76, s76, 1024
    s_mul_i32 s76, s76, 12288
    s_add_u32 m0, s49, 36864
    s_nop 0
    buffer_load_dwordx4 v244, s[24:27], s76 offen nt lds
    buffer_load_dwordx4 v245, s[24:27], s76 offen offset:1024 nt lds
    buffer_load_dwordx4 v246, s[24:27], s76 offen offset:2048 nt lds
    s_add_u32 s77, s2, 215
    s_and_b32 s77, s77, 255
    s_add_u32 s77, s77, 1280
    s_mul_i32 s77, s77, 12288
    s_add_u32 m0, s49, 98304
    s_nop 0
    buffer_load_dwordx4 v244, s[24:27], s77 offen nt lds
    buffer_load_dwordx4 v245, s[24:27], s77 offen offset:1024 nt lds
    buffer_load_dwordx4 v246, s[24:27], s77 offen offset:2048 nt lds
L_pre_done:
    s_mul_i32 s57, s48, 192
    s_and_b32 s58, s48, 1
    s_lshl_b32 s50, s58, 6
    s_add_u32 s50, s50, s57
    s_xor_b32 s58, s58, 1
    s_lshl_b32 s51, s58, 7
    s_add_u32 s51, s51, s57
    v_lshrrev_b32 v76, 3, v0
    v_and_b32 v77, 7, v0
    v_lshrrev_b32 v78, 2, v0
    v_and_b32 v79, 3, v0
    v_and_b32 v1, 4, v78
    v_xor_b32 v1, v1, v77
    v_mul_u32_u24 v247, 768, v76
    v_lshl_add_u32 v247, v1, 4, v247
    v_add_u32 v247, s50, v247
    v_mul_u32_u24 v248, 768, v78
    v_lshl_add_u32 v248, v79, 4, v248
    v_add_u32 v248, s51, v248
    s_mul_i32 s70, s48, 12288
    s_add_u32 s70, s70, 49152
    s_lshl_b32 s71, s48, 12
    s_add_u32 s71, s71, 147456
    s_add_u32 m0, s70, 0
    s_mov_b32 s74, 0
    buffer_load_dwordx4 v247, s[32:35], s74 offen lds
    s_mov_b32 s75, 5120
    buffer_load_dwordx4 v247, s[32:35], s75 offen offset:1024 lds
    s_mov_b32 s76, 10240
    buffer_load_dwordx4 v247, s[32:35], s76 offen offset:2048 lds
    s_mov_b32 s77, 15360
    buffer_load_dwordx4 v247, s[32:35], s77 offen offset:3072 lds
    s_add_u32 m0, s71, 0
    s_mov_b32 s74, 0
    buffer_load_dwordx4 v248, s[32:35], s74 offen lds
    s_mov_b32 s75, 11264
    buffer_load_dwordx4 v248, s[32:35], s75 offen offset:1024 lds
    s_add_u32 m0, s70, 4096
    s_mov_b32 s76, 24576
    buffer_load_dwordx4 v247, s[32:35], s76 offen lds
    s_mov_b32 s77, 29696
    buffer_load_dwordx4 v247, s[32:35], s77 offen offset:1024 lds
    s_mov_b32 s74, 34816
    buffer_load_dwordx4 v247, s[32:35], s74 offen offset:2048 lds
    s_mov_b32 s75, 39936
    buffer_load_dwordx4 v247, s[32:35], s75 offen offset:3072 lds
    s_add_u32 m0, s71, 2048
    s_mov_b32 s76, 24576
    buffer_load_dwordx4 v248, s[32:35], s76 offen lds
    s_mov_b32 s77, 35840
    buffer_load_dwordx4 v248, s[32:35], s77 offen offset:1024 lds
    s_add_u32 m0, s70, 8192
    s_mov_b32 s74, 49152
    buffer_load_dwordx4 v247, s[32:35], s74 offen lds
    s_mov_b32 s75, 54272
    buffer_load_dwordx4 v247, s[32:35], s75 offen offset:1024 lds
    s_mov_b32 s76, 59392
    buffer_load_dwordx4 v247, s[32:35], s76 offen offset:2048 lds
    s_mov_b32 s77, 64512
    buffer_load_dwordx4 v247, s[32:35], s77 offen offset:3072 lds
    v_and_b32 v2, 15, v0
    s_mov_b32 s20, s4
    s_mov_b32 s21, s5
    s_mov_b32 s22, 113246208
    s_mov_b32 s23, 0x20000
    s_mul_hi_u32 s57, s2, 0x15555556
    s_mul_i32 s57, s57, 294912
    s_mul_i32 s78, s2, 24576
    s_add_u32 s78, s78, s57
    s_add_u32 s67, s2, 43
    s_and_b32 s67, s67, 255
    s_add_u32 s87, s67, 256
    s_mul_hi_u32 s57, s87, 0x15555556
    s_mul_i32 s57, s57, 294912
    s_mul_i32 s79, s87, 24576
    s_add_u32 s79, s79, s57
    s_bfe_u32 s85, s2, 196612
    s_add_u32 s85, s85, 1
    s_mul_i32 s68, s85, 43
    s_add_u32 s68, s68, s2
    s_and_b32 s68, s68, 255
    s_lshl_b32 s58, s85, 8
    s_add_u32 s68, s68, s58
    s_mul_hi_u32 s57, s68, 0x15555556
    s_mul_i32 s57, s57, 294912
    s_mul_i32 s84, s68, 24576
    s_add_u32 s84, s84, s57
    s_cmp_eq_u32 s61, 2
    s_cselect_b32 s85, 59, s85
    v_and_b32 v1, 3, v78
    v_lshl_add_u32 v80, v3, 3, v1
    v_and_b32 v1, 2, v1
    v_lshl_add_u32 v1, v1, 1, v79
    v_lshlrev_b32 v1, 4, v1
    v_lshl_add_u32 v249, v80, 7, v1
    v_add_u32 v249, s70, v249
    v_xor_b32 v250, 64, v249
    v_lshlrev_b32 v1, 4, v79
    v_lshl_add_u32 v251, v80, 6, v1
    v_add_u32 v251, s71, v251
    v_xor_b32 v1, v2, v3
    v_lshlrev_b32 v1, 4, v1
    v_mul_u32_u24 v80, 768, v2
    v_add_u32 v228, v80, v1
    v_xor_b32 v229, 64, v228
    v_xor_b32 v230, 128, v228
    v_xor_b32 v231, 192, v228
    s_mov_b32 s57, 73728
    s_cmp_eq_u32 s61, 1
    s_cselect_b32 s57, 163840, s57
    v_add_u32 v240, s57, v228
    v_add_u32 v241, s57, v229
    v_add_u32 v242, s57, v230
    v_add_u32 v243, s57, v231
    s_mov_b32 s57, s50
    s_and_b32 s58, s57, 0xc0
    s_andn2_b32 s57, s57, 0xff
    s_add_u32 s57, s57, 98304
    v_xor_b32 v235, s58, v228
    v_add_u32 v235, s57, v235
    s_add_u32 s57, s50, 64
    s_and_b32 s58, s57, 0xc0
    s_andn2_b32 s57, s57, 0xff
    s_add_u32 s57, s57, 98304
    v_xor_b32 v236, s58, v228
    v_add_u32 v236, s57, v236
    s_mov_b32 s57, s51
    s_and_b32 s58, s57, 0xc0
    s_andn2_b32 s57, s57, 0xff
    s_add_u32 s57, s57, 98304
    v_xor_b32 v237, s58, v228
    v_add_u32 v237, s57, v237
    s_add_u32 s57, s49, 98304
    v_lshlrev_b32 v1, 4, v0
    v_add_u32 v238, s57, v1
    s_mul_i32 s57, s48, 73728
    v_add_u32 v252, s57, v1
    s_lshr_b32 s58, s2, 4
    s_lshl_b32 s58, s58, 2
    s_add_u32 s58, s58, s48
    s_mul_i32 s58, s58, 4608
    v_add_u32 v253, s58, v85
    s_cmp_eq_u32 s61, 2
    s_cselect_b32 s62, 2147483648, 0
    s_cselect_b32 s63, 90112, s49
    s_cselect_b32 s64, 163840, s49
    s_mov_b32 s58, 1
    s_waitcnt lgkmcnt(0)
    s_mov_b32 s36, s12
    s_mov_b32 s37, s13
    s_mov_b32 s38, 113246208
    s_mov_b32 s39, 0x20000
    s_mov_b32 s44, s14
    s_mov_b32 s45, s15
    s_mov_b32 s46, 256
    s_mov_b32 s47, 0x20000
    s_mov_b32 s59, 0xffff0000
    s_mov_b32 s19, 1
    s_cmp_eq_u32 s58, 1
    s_cselect_b32 s81, s78, 2147483648
    s_cselect_b32 s82, s49, 163840
    s_mov_b32 s54, 0
    s_getreg_b32 s57, hwreg(HW_REG_XCC_ID)
    s_bitcmp0_b32 s57, 0
    s_cselect_b64 vcc, -1, 0
    s_cmp_eq_u32 s61, 0
    s_cselect_b64 vcc, 0, vcc
    s_mov_b32 s65, 1
    s_mov_b64 s[98:99], vcc
    s_mov_b64 vcc, -1
    s_mov_b32 s83, 0
    s_brev_b32 s56, 1
    s_mov_b32 s97, s78
    s_waitcnt vmcnt(10)
    s_barrier
    ds_read_b64_tr_b16 a[16:17], v251 offset:0
    ds_read_b64_tr_b16 a[18:19], v251 offset:256
    ds_read_b64_tr_b16 a[20:21], v251 offset:8
    ds_read_b64_tr_b16 a[22:23], v251 offset:264
    ds_read_b64_tr_b16 a[0:1], v249 offset:0
    ds_read_b64_tr_b16 a[2:3], v249 offset:512
    ds_read_b64_tr_b16 a[4:5], v249 offset:8
    ds_read_b64_tr_b16 a[6:7], v249 offset:520
    ds_read_b64_tr_b16 a[8:9], v250 offset:0
    ds_read_b64_tr_b16 a[10:11], v250 offset:512
    ds_read_b64_tr_b16 a[12:13], v250 offset:8
    ds_read_b64_tr_b16 a[14:15], v250 offset:520
    ds_read_b128 v[4:7], v240 offset:36864
    ds_read_b128 v[8:11], v240 offset:49152
    ds_read_b128 v[12:15], v240 offset:61440
    s_waitcnt lgkmcnt(11)
    s_add_u32 m0, s71, 0
    s_mov_b32 s74, 49152
    buffer_load_dwordx4 v248, s[32:35], s74 offen lds
    s_mov_b32 s75, 60416
    buffer_load_dwordx4 v248, s[32:35], s75 offen offset:1024 lds
    s_waitcnt lgkmcnt(0)
    s_add_u32 m0, s70, 0
    s_mov_b32 s76, 73728
    buffer_load_dwordx4 v247, s[32:35], s76 offen lds
    s_mov_b32 s77, 78848
    buffer_load_dwordx4 v247, s[32:35], s77 offen offset:1024 lds
    s_mov_b32 s74, 83968
    buffer_load_dwordx4 v247, s[32:35], s74 offen offset:2048 lds
    s_mov_b32 s75, 89088
    buffer_load_dwordx4 v247, s[32:35], s75 offen offset:3072 lds
    s_waitcnt vmcnt(10)
    ds_read_b64_tr_b16 a[40:41], v251 offset:2048
    ds_read_b64_tr_b16 a[42:43], v251 offset:2304
    v_mfma_f32_16x16x32_bf16 v[148:151], a[0:3], v[4:7], 0
    ds_read_b64_tr_b16 a[44:45], v251 offset:2056
    ds_read_b64_tr_b16 a[46:47], v251 offset:2312
    v_mfma_f32_16x16x32_bf16 v[172:175], a[0:3], v[8:11], 0
    ds_read_b64_tr_b16 a[24:25], v249 offset:4096
    ds_read_b64_tr_b16 a[26:27], v249 offset:4608
    v_mfma_f32_16x16x32_bf16 v[52:55], a[0:3], v[12:15], 0
    ds_read_b64_tr_b16 a[28:29], v249 offset:4104
    ds_read_b64_tr_b16 a[30:31], v249 offset:4616
    v_mfma_f32_16x16x32_bf16 v[152:155], a[4:7], v[4:7], 0
    ds_read_b64_tr_b16 a[32:33], v250 offset:4096
    ds_read_b64_tr_b16 a[34:35], v250 offset:4608
    v_mfma_f32_16x16x32_bf16 v[176:179], a[4:7], v[8:11], 0
    ds_read_b64_tr_b16 a[36:37], v250 offset:4104
    ds_read_b64_tr_b16 a[38:39], v250 offset:4616
    v_mfma_f32_16x16x32_bf16 v[56:59], a[4:7], v[12:15], 0
    ds_read_b128 v[16:19], v241 offset:36864
    ds_read_b128 v[20:23], v241 offset:49152
    s_waitcnt lgkmcnt(10)
    s_add_u32 m0, s71, 2048
    s_mov_b32 s76, 73728
    buffer_load_dwordx4 v248, s[32:35], s76 offen lds
    v_mfma_f32_16x16x32_bf16 v[156:159], a[8:11], v[4:7], 0
    ds_read_b128 v[24:27], v241 offset:61440
    v_mfma_f32_16x16x32_bf16 v[180:183], a[8:11], v[8:11], 0
    s_mov_b32 s77, 84992
    buffer_load_dwordx4 v248, s[32:35], s77 offen offset:1024 lds
    v_mfma_f32_16x16x32_bf16 v[60:63], a[8:11], v[12:15], 0
    v_mfma_f32_16x16x32_bf16 v[160:163], a[12:15], v[4:7], 0
    v_mfma_f32_16x16x32_bf16 v[184:187], a[12:15], v[8:11], 0
    v_mfma_f32_16x16x32_bf16 v[64:67], a[12:15], v[12:15], 0
    s_waitcnt lgkmcnt(0)
    s_add_u32 m0, s70, 4096
    s_mov_b32 s74, 98304
    buffer_load_dwordx4 v247, s[32:35], s74 offen lds
    v_mfma_f32_16x16x32_bf16 v[164:167], a[16:19], v[4:7], 0
    s_mov_b32 s75, 103424
    buffer_load_dwordx4 v247, s[32:35], s75 offen offset:1024 lds
    v_mfma_f32_16x16x32_bf16 v[188:191], a[16:19], v[8:11], 0
    s_mov_b32 s76, 108544
    buffer_load_dwordx4 v247, s[32:35], s76 offen offset:2048 lds
    v_mfma_f32_16x16x32_bf16 v[68:71], a[16:19], v[12:15], 0
    s_mov_b32 s77, 113664
    buffer_load_dwordx4 v247, s[32:35], s77 offen offset:3072 lds
    v_mfma_f32_16x16x32_bf16 v[168:171], a[20:23], v[4:7], 0
    v_mfma_f32_16x16x32_bf16 v[192:195], a[20:23], v[8:11], 0
    v_mfma_f32_16x16x32_bf16 v[72:75], a[20:23], v[12:15], 0
    s_waitcnt vmcnt(10)
    ds_read_b64_tr_b16 a[64:65], v251 offset:0
    ds_read_b64_tr_b16 a[66:67], v251 offset:256
    v_mfma_f32_16x16x32_bf16 v[148:151], a[24:27], v[16:19], v[148:151]
    ds_read_b64_tr_b16 a[68:69], v251 offset:8
    ds_read_b64_tr_b16 a[70:71], v251 offset:264
    v_mfma_f32_16x16x32_bf16 v[172:175], a[24:27], v[20:23], v[172:175]
    ds_read_b64_tr_b16 a[48:49], v249 offset:8192
    ds_read_b64_tr_b16 a[50:51], v249 offset:8704
    v_mfma_f32_16x16x32_bf16 v[52:55], a[24:27], v[24:27], v[52:55]
    ds_read_b64_tr_b16 a[52:53], v249 offset:8200
    ds_read_b64_tr_b16 a[54:55], v249 offset:8712
    v_mfma_f32_16x16x32_bf16 v[152:155], a[28:31], v[16:19], v[152:155]
    ds_read_b64_tr_b16 a[56:57], v250 offset:8192
    ds_read_b64_tr_b16 a[58:59], v250 offset:8704
    v_mfma_f32_16x16x32_bf16 v[176:179], a[28:31], v[20:23], v[176:179]
    ds_read_b64_tr_b16 a[60:61], v250 offset:8200
    ds_read_b64_tr_b16 a[62:63], v250 offset:8712
    v_mfma_f32_16x16x32_bf16 v[56:59], a[28:31], v[24:27], v[56:59]
    ds_read_b128 v[28:31], v242 offset:36864
    ds_read_b128 v[32:35], v242 offset:49152
    s_waitcnt lgkmcnt(10)
    s_add_u32 m0, s71, 0
    s_mov_b32 s74, 98304
    buffer_load_dwordx4 v248, s[32:35], s74 offen lds
    v_mfma_f32_16x16x32_bf16 v[156:159], a[32:35], v[16:19], v[156:159]
    ds_read_b128 v[36:39], v242 offset:61440
    v_mfma_f32_16x16x32_bf16 v[180:183], a[32:35], v[20:23], v[180:183]
    s_mov_b32 s75, 109568
    buffer_load_dwordx4 v248, s[32:35], s75 offen offset:1024 lds
    v_mfma_f32_16x16x32_bf16 v[60:63], a[32:35], v[24:27], v[60:63]
    v_mfma_f32_16x16x32_bf16 v[160:163], a[36:39], v[16:19], v[160:163]
    v_mfma_f32_16x16x32_bf16 v[184:187], a[36:39], v[20:23], v[184:187]
    v_mfma_f32_16x16x32_bf16 v[64:67], a[36:39], v[24:27], v[64:67]
    s_waitcnt lgkmcnt(0)
    s_add_u32 m0, s70, 8192
    s_mov_b32 s76, 122880
    buffer_load_dwordx4 v247, s[32:35], s76 offen lds
    v_mfma_f32_16x16x32_bf16 v[164:167], a[40:43], v[16:19], v[164:167]
    s_mov_b32 s77, 128000
    buffer_load_dwordx4 v247, s[32:35], s77 offen offset:1024 lds
    v_mfma_f32_16x16x32_bf16 v[188:191], a[40:43], v[20:23], v[188:191]
    s_mov_b32 s74, 133120
    buffer_load_dwordx4 v247, s[32:35], s74 offen offset:2048 lds
    v_mfma_f32_16x16x32_bf16 v[68:71], a[40:43], v[24:27], v[68:71]
    s_mov_b32 s75, 138240
    buffer_load_dwordx4 v247, s[32:35], s75 offen offset:3072 lds
    v_mfma_f32_16x16x32_bf16 v[168:171], a[44:47], v[16:19], v[168:171]
    v_mfma_f32_16x16x32_bf16 v[192:195], a[44:47], v[20:23], v[192:195]
    v_mfma_f32_16x16x32_bf16 v[72:75], a[44:47], v[24:27], v[72:75]
    s_waitcnt vmcnt(10)
    ds_read_b64_tr_b16 a[88:89], v251 offset:2048
    ds_read_b64_tr_b16 a[90:91], v251 offset:2304
    v_mfma_f32_16x16x32_bf16 v[148:151], a[48:51], v[28:31], v[148:151]
    ds_read_b64_tr_b16 a[92:93], v251 offset:2056
    ds_read_b64_tr_b16 a[94:95], v251 offset:2312
    v_mfma_f32_16x16x32_bf16 v[172:175], a[48:51], v[32:35], v[172:175]
    ds_read_b64_tr_b16 a[72:73], v249 offset:0
    ds_read_b64_tr_b16 a[74:75], v249 offset:512
    v_mfma_f32_16x16x32_bf16 v[52:55], a[48:51], v[36:39], v[52:55]
    ds_read_b64_tr_b16 a[76:77], v249 offset:8
    ds_read_b64_tr_b16 a[78:79], v249 offset:520
    v_mfma_f32_16x16x32_bf16 v[152:155], a[52:55], v[28:31], v[152:155]
    ds_read_b64_tr_b16 a[80:81], v250 offset:0
    ds_read_b64_tr_b16 a[82:83], v250 offset:512
    v_mfma_f32_16x16x32_bf16 v[176:179], a[52:55], v[32:35], v[176:179]
    ds_read_b64_tr_b16 a[84:85], v250 offset:8
    ds_read_b64_tr_b16 a[86:87], v250 offset:520
    v_mfma_f32_16x16x32_bf16 v[56:59], a[52:55], v[36:39], v[56:59]
    ds_read_b128 v[40:43], v243 offset:36864
    ds_read_b128 v[44:47], v243 offset:49152
    s_waitcnt lgkmcnt(10)
    s_add_u32 m0, s71, 2048
    s_mov_b32 s76, 122880
    buffer_load_dwordx4 v248, s[32:35], s76 offen lds
    v_mfma_f32_16x16x32_bf16 v[156:159], a[56:59], v[28:31], v[156:159]
    ds_read_b128 v[48:51], v243 offset:61440
    v_mfma_f32_16x16x32_bf16 v[180:183], a[56:59], v[32:35], v[180:183]
    s_mov_b32 s77, 134144
    buffer_load_dwordx4 v248, s[32:35], s77 offen offset:1024 lds
    v_mfma_f32_16x16x32_bf16 v[60:63], a[56:59], v[36:39], v[60:63]
    v_mfma_f32_16x16x32_bf16 v[160:163], a[60:63], v[28:31], v[160:163]
    v_mfma_f32_16x16x32_bf16 v[184:187], a[60:63], v[32:35], v[184:187]
    v_mfma_f32_16x16x32_bf16 v[64:67], a[60:63], v[36:39], v[64:67]
    s_waitcnt lgkmcnt(0)
    s_add_u32 m0, s70, 0
    s_mov_b32 s74, 147456
    buffer_load_dwordx4 v247, s[32:35], s74 offen lds
    v_mfma_f32_16x16x32_bf16 v[164:167], a[64:67], v[28:31], v[164:167]
    s_mov_b32 s75, 152576
    buffer_load_dwordx4 v247, s[32:35], s75 offen offset:1024 lds
    v_mfma_f32_16x16x32_bf16 v[188:191], a[64:67], v[32:35], v[188:191]
    s_mov_b32 s76, 157696
    buffer_load_dwordx4 v247, s[32:35], s76 offen offset:2048 lds
    v_mfma_f32_16x16x32_bf16 v[68:71], a[64:67], v[36:39], v[68:71]
    s_mov_b32 s77, 162816
    buffer_load_dwordx4 v247, s[32:35], s77 offen offset:3072 lds
    v_mfma_f32_16x16x32_bf16 v[168:171], a[68:71], v[28:31], v[168:171]
    v_mfma_f32_16x16x32_bf16 v[192:195], a[68:71], v[32:35], v[192:195]
    v_mfma_f32_16x16x32_bf16 v[72:75], a[68:71], v[36:39], v[72:75]
    s_waitcnt vmcnt(10)
    ds_read_b64_tr_b16 a[112:113], v251 offset:0
    ds_read_b64_tr_b16 a[114:115], v251 offset:256
    v_mfma_f32_16x16x32_bf16 v[148:151], a[72:75], v[40:43], v[148:151]
    ds_read_b64_tr_b16 a[116:117], v251 offset:8
    ds_read_b64_tr_b16 a[118:119], v251 offset:264
    v_mfma_f32_16x16x32_bf16 v[172:175], a[72:75], v[44:47], v[172:175]
    ds_read_b64_tr_b16 a[96:97], v249 offset:4096
    ds_read_b64_tr_b16 a[98:99], v249 offset:4608
    v_mfma_f32_16x16x32_bf16 v[52:55], a[72:75], v[48:51], v[52:55]
    ds_read_b64_tr_b16 a[100:101], v249 offset:4104
    ds_read_b64_tr_b16 a[102:103], v249 offset:4616
    v_mfma_f32_16x16x32_bf16 v[152:155], a[76:79], v[40:43], v[152:155]
    ds_read_b64_tr_b16 a[104:105], v250 offset:4096
    ds_read_b64_tr_b16 a[106:107], v250 offset:4608
    v_mfma_f32_16x16x32_bf16 v[176:179], a[76:79], v[44:47], v[176:179]
    ds_read_b64_tr_b16 a[108:109], v250 offset:4104
    ds_read_b64_tr_b16 a[110:111], v250 offset:4616
    v_mfma_f32_16x16x32_bf16 v[56:59], a[76:79], v[48:51], v[56:59]
    ds_read_b128 v[4:7], v240 offset:37120
    ds_read_b128 v[8:11], v240 offset:49408
    s_waitcnt lgkmcnt(10)
    s_add_u32 m0, s71, 0
    s_mov_b32 s74, 147456
    buffer_load_dwordx4 v248, s[32:35], s74 offen lds
    v_mfma_f32_16x16x32_bf16 v[156:159], a[80:83], v[40:43], v[156:159]
    ds_read_b128 v[12:15], v240 offset:61696
    v_mfma_f32_16x16x32_bf16 v[180:183], a[80:83], v[44:47], v[180:183]
    s_mov_b32 s75, 158720
    buffer_load_dwordx4 v248, s[32:35], s75 offen offset:1024 lds
    v_mfma_f32_16x16x32_bf16 v[60:63], a[80:83], v[48:51], v[60:63]
    v_mfma_f32_16x16x32_bf16 v[160:163], a[84:87], v[40:43], v[160:163]
    v_mfma_f32_16x16x32_bf16 v[184:187], a[84:87], v[44:47], v[184:187]
    v_mfma_f32_16x16x32_bf16 v[64:67], a[84:87], v[48:51], v[64:67]
    s_waitcnt lgkmcnt(0)
    s_add_u32 m0, s70, 4096
    s_mov_b32 s76, 172032
    buffer_load_dwordx4 v247, s[32:35], s76 offen lds
    v_mfma_f32_16x16x32_bf16 v[164:167], a[88:91], v[40:43], v[164:167]
    s_mov_b32 s77, 177152
    buffer_load_dwordx4 v247, s[32:35], s77 offen offset:1024 lds
    v_mfma_f32_16x16x32_bf16 v[188:191], a[88:91], v[44:47], v[188:191]
    s_mov_b32 s74, 182272
    buffer_load_dwordx4 v247, s[32:35], s74 offen offset:2048 lds
    v_mfma_f32_16x16x32_bf16 v[68:71], a[88:91], v[48:51], v[68:71]
    s_mov_b32 s75, 187392
    buffer_load_dwordx4 v247, s[32:35], s75 offen offset:3072 lds
    v_mfma_f32_16x16x32_bf16 v[168:171], a[92:95], v[40:43], v[168:171]
    v_mfma_f32_16x16x32_bf16 v[192:195], a[92:95], v[44:47], v[192:195]
    v_mfma_f32_16x16x32_bf16 v[72:75], a[92:95], v[48:51], v[72:75]
    s_waitcnt vmcnt(10)
    ds_read_b64_tr_b16 a[136:137], v251 offset:2048
    ds_read_b64_tr_b16 a[138:139], v251 offset:2304
    v_mfma_f32_16x16x32_bf16 v[148:151], a[96:99], v[4:7], v[148:151]
    ds_read_b64_tr_b16 a[140:141], v251 offset:2056
    ds_read_b64_tr_b16 a[142:143], v251 offset:2312
    v_mfma_f32_16x16x32_bf16 v[172:175], a[96:99], v[8:11], v[172:175]
    ds_read_b64_tr_b16 a[120:121], v249 offset:8192
    ds_read_b64_tr_b16 a[122:123], v249 offset:8704
    v_mfma_f32_16x16x32_bf16 v[52:55], a[96:99], v[12:15], v[52:55]
    ds_read_b64_tr_b16 a[124:125], v249 offset:8200
    ds_read_b64_tr_b16 a[126:127], v249 offset:8712
    v_mfma_f32_16x16x32_bf16 v[152:155], a[100:103], v[4:7], v[152:155]
    ds_read_b64_tr_b16 a[128:129], v250 offset:8192
    ds_read_b64_tr_b16 a[130:131], v250 offset:8704
    v_mfma_f32_16x16x32_bf16 v[176:179], a[100:103], v[8:11], v[176:179]
    ds_read_b64_tr_b16 a[132:133], v250 offset:8200
    ds_read_b64_tr_b16 a[134:135], v250 offset:8712
    v_mfma_f32_16x16x32_bf16 v[56:59], a[100:103], v[12:15], v[56:59]
    ds_read_b128 v[16:19], v241 offset:37120
    ds_read_b128 v[20:23], v241 offset:49408
    s_waitcnt lgkmcnt(10)
    s_add_u32 m0, s71, 2048
    s_mov_b32 s76, 172032
    buffer_load_dwordx4 v248, s[32:35], s76 offen lds
    v_mfma_f32_16x16x32_bf16 v[156:159], a[104:107], v[4:7], v[156:159]
    ds_read_b128 v[24:27], v241 offset:61696
    v_mfma_f32_16x16x32_bf16 v[180:183], a[104:107], v[8:11], v[180:183]
    s_mov_b32 s77, 183296
    buffer_load_dwordx4 v248, s[32:35], s77 offen offset:1024 lds
    v_mfma_f32_16x16x32_bf16 v[60:63], a[104:107], v[12:15], v[60:63]
    v_mfma_f32_16x16x32_bf16 v[160:163], a[108:111], v[4:7], v[160:163]
    v_mfma_f32_16x16x32_bf16 v[184:187], a[108:111], v[8:11], v[184:187]
    v_mfma_f32_16x16x32_bf16 v[64:67], a[108:111], v[12:15], v[64:67]
    s_waitcnt lgkmcnt(0)
    s_add_u32 m0, s70, 8192
    s_mov_b32 s74, 196608
    buffer_load_dwordx4 v247, s[32:35], s74 offen lds
    v_mfma_f32_16x16x32_bf16 v[164:167], a[112:115], v[4:7], v[164:167]
    s_mov_b32 s75, 201728
    buffer_load_dwordx4 v247, s[32:35], s75 offen offset:1024 lds
    v_mfma_f32_16x16x32_bf16 v[188:191], a[112:115], v[8:11], v[188:191]
    s_mov_b32 s76, 206848
    buffer_load_dwordx4 v247, s[32:35], s76 offen offset:2048 lds
    v_mfma_f32_16x16x32_bf16 v[68:71], a[112:115], v[12:15], v[68:71]
    s_mov_b32 s77, 211968
    buffer_load_dwordx4 v247, s[32:35], s77 offen offset:3072 lds
    v_mfma_f32_16x16x32_bf16 v[168:171], a[116:119], v[4:7], v[168:171]
    v_mfma_f32_16x16x32_bf16 v[192:195], a[116:119], v[8:11], v[192:195]
    v_mfma_f32_16x16x32_bf16 v[72:75], a[116:119], v[12:15], v[72:75]
    s_waitcnt vmcnt(10)
    ds_read_b64_tr_b16 a[160:161], v251 offset:0
    ds_read_b64_tr_b16 a[162:163], v251 offset:256
    v_mfma_f32_16x16x32_bf16 v[148:151], a[120:123], v[16:19], v[148:151]
    ds_read_b64_tr_b16 a[164:165], v251 offset:8
    ds_read_b64_tr_b16 a[166:167], v251 offset:264
    v_mfma_f32_16x16x32_bf16 v[172:175], a[120:123], v[20:23], v[172:175]
    ds_read_b64_tr_b16 a[144:145], v249 offset:0
    ds_read_b64_tr_b16 a[146:147], v249 offset:512
    v_mfma_f32_16x16x32_bf16 v[52:55], a[120:123], v[24:27], v[52:55]
    ds_read_b64_tr_b16 a[148:149], v249 offset:8
    ds_read_b64_tr_b16 a[150:151], v249 offset:520
    v_mfma_f32_16x16x32_bf16 v[152:155], a[124:127], v[16:19], v[152:155]
    ds_read_b64_tr_b16 a[152:153], v250 offset:0
    ds_read_b64_tr_b16 a[154:155], v250 offset:512
    v_mfma_f32_16x16x32_bf16 v[176:179], a[124:127], v[20:23], v[176:179]
    ds_read_b64_tr_b16 a[156:157], v250 offset:8
    ds_read_b64_tr_b16 a[158:159], v250 offset:520
    v_mfma_f32_16x16x32_bf16 v[56:59], a[124:127], v[24:27], v[56:59]
    ds_read_b128 v[28:31], v242 offset:37120
    ds_read_b128 v[32:35], v242 offset:49408
    s_waitcnt lgkmcnt(10)
    s_add_u32 m0, s71, 0
    s_mov_b32 s74, 196608
    buffer_load_dwordx4 v248, s[32:35], s74 offen lds
    v_mfma_f32_16x16x32_bf16 v[156:159], a[128:131], v[16:19], v[156:159]
    ds_read_b128 v[36:39], v242 offset:61696
    v_mfma_f32_16x16x32_bf16 v[180:183], a[128:131], v[20:23], v[180:183]
    s_mov_b32 s75, 207872
    buffer_load_dwordx4 v248, s[32:35], s75 offen offset:1024 lds
    v_mfma_f32_16x16x32_bf16 v[60:63], a[128:131], v[24:27], v[60:63]
    v_mfma_f32_16x16x32_bf16 v[160:163], a[132:135], v[16:19], v[160:163]
    v_mfma_f32_16x16x32_bf16 v[184:187], a[132:135], v[20:23], v[184:187]
    v_mfma_f32_16x16x32_bf16 v[64:67], a[132:135], v[24:27], v[64:67]
    s_waitcnt lgkmcnt(0)
    s_add_u32 m0, s70, 0
    s_mov_b32 s76, 221184
    buffer_load_dwordx4 v247, s[32:35], s76 offen lds
    v_mfma_f32_16x16x32_bf16 v[164:167], a[136:139], v[16:19], v[164:167]
    s_mov_b32 s77, 226304
    buffer_load_dwordx4 v247, s[32:35], s77 offen offset:1024 lds
    v_mfma_f32_16x16x32_bf16 v[188:191], a[136:139], v[20:23], v[188:191]
    s_mov_b32 s74, 231424
    buffer_load_dwordx4 v247, s[32:35], s74 offen offset:2048 lds
    v_mfma_f32_16x16x32_bf16 v[68:71], a[136:139], v[24:27], v[68:71]
    s_mov_b32 s75, 236544
    buffer_load_dwordx4 v247, s[32:35], s75 offen offset:3072 lds
    v_mfma_f32_16x16x32_bf16 v[168:171], a[140:143], v[16:19], v[168:171]
    v_mfma_f32_16x16x32_bf16 v[192:195], a[140:143], v[20:23], v[192:195]
    v_mfma_f32_16x16x32_bf16 v[72:75], a[140:143], v[24:27], v[72:75]
    s_waitcnt vmcnt(10)
    ds_read_b64_tr_b16 a[184:185], v251 offset:2048
    ds_read_b64_tr_b16 a[186:187], v251 offset:2304
    v_mfma_f32_16x16x32_bf16 v[148:151], a[144:147], v[28:31], v[148:151]
    ds_read_b64_tr_b16 a[188:189], v251 offset:2056
    ds_read_b64_tr_b16 a[190:191], v251 offset:2312
    v_mfma_f32_16x16x32_bf16 v[172:175], a[144:147], v[32:35], v[172:175]
    ds_read_b64_tr_b16 a[168:169], v249 offset:4096
    ds_read_b64_tr_b16 a[170:171], v249 offset:4608
    v_mfma_f32_16x16x32_bf16 v[52:55], a[144:147], v[36:39], v[52:55]
    ds_read_b64_tr_b16 a[172:173], v249 offset:4104
    ds_read_b64_tr_b16 a[174:175], v249 offset:4616
    v_mfma_f32_16x16x32_bf16 v[152:155], a[148:151], v[28:31], v[152:155]
    ds_read_b64_tr_b16 a[176:177], v250 offset:4096
    ds_read_b64_tr_b16 a[178:179], v250 offset:4608
    v_mfma_f32_16x16x32_bf16 v[176:179], a[148:151], v[32:35], v[176:179]
    ds_read_b64_tr_b16 a[180:181], v250 offset:4104
    ds_read_b64_tr_b16 a[182:183], v250 offset:4616
    v_mfma_f32_16x16x32_bf16 v[56:59], a[148:151], v[36:39], v[56:59]
    ds_read_b128 v[40:43], v243 offset:37120
    ds_read_b128 v[44:47], v243 offset:49408
    s_waitcnt lgkmcnt(10)
    s_add_u32 m0, s71, 2048
    s_mov_b32 s76, 221184
    buffer_load_dwordx4 v248, s[32:35], s76 offen lds
    v_mfma_f32_16x16x32_bf16 v[156:159], a[152:155], v[28:31], v[156:159]
    ds_read_b128 v[48:51], v243 offset:61696
    v_mfma_f32_16x16x32_bf16 v[180:183], a[152:155], v[32:35], v[180:183]
    s_mov_b32 s77, 232448
    buffer_load_dwordx4 v248, s[32:35], s77 offen offset:1024 lds
    v_mfma_f32_16x16x32_bf16 v[60:63], a[152:155], v[36:39], v[60:63]
    v_mfma_f32_16x16x32_bf16 v[160:163], a[156:159], v[28:31], v[160:163]
    v_mfma_f32_16x16x32_bf16 v[184:187], a[156:159], v[32:35], v[184:187]
    v_mfma_f32_16x16x32_bf16 v[64:67], a[156:159], v[36:39], v[64:67]
    s_waitcnt lgkmcnt(0)
    s_add_u32 m0, s70, 4096
    s_mov_b32 s74, 245760
    buffer_load_dwordx4 v247, s[32:35], s74 offen lds
    v_mfma_f32_16x16x32_bf16 v[164:167], a[160:163], v[28:31], v[164:167]
    s_mov_b32 s75, 250880
    buffer_load_dwordx4 v247, s[32:35], s75 offen offset:1024 lds
    v_mfma_f32_16x16x32_bf16 v[188:191], a[160:163], v[32:35], v[188:191]
    s_mov_b32 s76, 256000
    buffer_load_dwordx4 v247, s[32:35], s76 offen offset:2048 lds
    v_mfma_f32_16x16x32_bf16 v[68:71], a[160:163], v[36:39], v[68:71]
    s_mov_b32 s77, 261120
    buffer_load_dwordx4 v247, s[32:35], s77 offen offset:3072 lds
    v_mfma_f32_16x16x32_bf16 v[168:171], a[164:167], v[28:31], v[168:171]
    v_mfma_f32_16x16x32_bf16 v[192:195], a[164:167], v[32:35], v[192:195]
    v_mfma_f32_16x16x32_bf16 v[72:75], a[164:167], v[36:39], v[72:75]
    s_waitcnt vmcnt(10)
    ds_read_b64_tr_b16 a[208:209], v251 offset:0
    ds_read_b64_tr_b16 a[210:211], v251 offset:256
    v_mfma_f32_16x16x32_bf16 v[148:151], a[168:171], v[40:43], v[148:151]
    ds_read_b64_tr_b16 a[212:213], v251 offset:8
    ds_read_b64_tr_b16 a[214:215], v251 offset:264
    v_mfma_f32_16x16x32_bf16 v[172:175], a[168:171], v[44:47], v[172:175]
    ds_read_b64_tr_b16 a[192:193], v249 offset:8192
    ds_read_b64_tr_b16 a[194:195], v249 offset:8704
    v_mfma_f32_16x16x32_bf16 v[52:55], a[168:171], v[48:51], v[52:55]
    ds_read_b64_tr_b16 a[196:197], v249 offset:8200
    ds_read_b64_tr_b16 a[198:199], v249 offset:8712
    v_mfma_f32_16x16x32_bf16 v[152:155], a[172:175], v[40:43], v[152:155]
    ds_read_b64_tr_b16 a[200:201], v250 offset:8192
    ds_read_b64_tr_b16 a[202:203], v250 offset:8704
    v_mfma_f32_16x16x32_bf16 v[176:179], a[172:175], v[44:47], v[176:179]
    ds_read_b64_tr_b16 a[204:205], v250 offset:8200
    ds_read_b64_tr_b16 a[206:207], v250 offset:8712
    v_mfma_f32_16x16x32_bf16 v[56:59], a[172:175], v[48:51], v[56:59]
    ds_read_b128 v[4:7], v240 offset:37376
    ds_read_b128 v[8:11], v240 offset:49664
    s_waitcnt lgkmcnt(10)
    s_add_u32 m0, s71, 0
    s_mov_b32 s74, 245760
    buffer_load_dwordx4 v248, s[32:35], s74 offen lds
    v_mfma_f32_16x16x32_bf16 v[156:159], a[176:179], v[40:43], v[156:159]
    ds_read_b128 v[12:15], v240 offset:61952
    v_mfma_f32_16x16x32_bf16 v[180:183], a[176:179], v[44:47], v[180:183]
    s_mov_b32 s75, 257024
    buffer_load_dwordx4 v248, s[32:35], s75 offen offset:1024 lds
    v_mfma_f32_16x16x32_bf16 v[60:63], a[176:179], v[48:51], v[60:63]
    v_mfma_f32_16x16x32_bf16 v[160:163], a[180:183], v[40:43], v[160:163]
    v_mfma_f32_16x16x32_bf16 v[184:187], a[180:183], v[44:47], v[184:187]
    v_mfma_f32_16x16x32_bf16 v[64:67], a[180:183], v[48:51], v[64:67]
    s_waitcnt lgkmcnt(0)
    s_add_u32 m0, s70, 8192
    s_mov_b32 s76, 270336
    buffer_load_dwordx4 v247, s[32:35], s76 offen lds
    v_mfma_f32_16x16x32_bf16 v[164:167], a[184:187], v[40:43], v[164:167]
    s_mov_b32 s77, 275456
    buffer_load_dwordx4 v247, s[32:35], s77 offen offset:1024 lds
    v_mfma_f32_16x16x32_bf16 v[188:191], a[184:187], v[44:47], v[188:191]
    s_mov_b32 s74, 280576
    buffer_load_dwordx4 v247, s[32:35], s74 offen offset:2048 lds
    v_mfma_f32_16x16x32_bf16 v[68:71], a[184:187], v[48:51], v[68:71]
    s_mov_b32 s75, 285696
    buffer_load_dwordx4 v247, s[32:35], s75 offen offset:3072 lds
    v_mfma_f32_16x16x32_bf16 v[168:171], a[188:191], v[40:43], v[168:171]
    v_mfma_f32_16x16x32_bf16 v[192:195], a[188:191], v[44:47], v[192:195]
    v_mfma_f32_16x16x32_bf16 v[72:75], a[188:191], v[48:51], v[72:75]
    s_waitcnt vmcnt(10)
    ds_read_b64_tr_b16 a[232:233], v251 offset:2048
    ds_read_b64_tr_b16 a[234:235], v251 offset:2304
    v_mfma_f32_16x16x32_bf16 v[148:151], a[192:195], v[4:7], v[148:151]
    ds_read_b64_tr_b16 a[236:237], v251 offset:2056
    ds_read_b64_tr_b16 a[238:239], v251 offset:2312
    v_mfma_f32_16x16x32_bf16 v[172:175], a[192:195], v[8:11], v[172:175]
    ds_read_b64_tr_b16 a[216:217], v249 offset:0
    ds_read_b64_tr_b16 a[218:219], v249 offset:512
    v_mfma_f32_16x16x32_bf16 v[52:55], a[192:195], v[12:15], v[52:55]
    ds_read_b64_tr_b16 a[220:221], v249 offset:8
    ds_read_b64_tr_b16 a[222:223], v249 offset:520
    v_mfma_f32_16x16x32_bf16 v[152:155], a[196:199], v[4:7], v[152:155]
    ds_read_b64_tr_b16 a[224:225], v250 offset:0
    ds_read_b64_tr_b16 a[226:227], v250 offset:512
    v_mfma_f32_16x16x32_bf16 v[176:179], a[196:199], v[8:11], v[176:179]
    ds_read_b64_tr_b16 a[228:229], v250 offset:8
    ds_read_b64_tr_b16 a[230:231], v250 offset:520
    v_mfma_f32_16x16x32_bf16 v[56:59], a[196:199], v[12:15], v[56:59]
    ds_read_b128 v[16:19], v241 offset:37376
    ds_read_b128 v[20:23], v241 offset:49664
    s_waitcnt lgkmcnt(10)
    s_add_u32 m0, s71, 2048
    s_mov_b32 s76, 270336
    buffer_load_dwordx4 v248, s[32:35], s76 offen lds
    v_mfma_f32_16x16x32_bf16 v[156:159], a[200:203], v[4:7], v[156:159]
    ds_read_b128 v[24:27], v241 offset:61952
    v_mfma_f32_16x16x32_bf16 v[180:183], a[200:203], v[8:11], v[180:183]
    s_mov_b32 s77, 281600
    buffer_load_dwordx4 v248, s[32:35], s77 offen offset:1024 lds
    v_mfma_f32_16x16x32_bf16 v[60:63], a[200:203], v[12:15], v[60:63]
    s_add_u32 s74, s2, 0
    s_and_b32 s74, s74, 255
    s_add_u32 s74, s74, 0
    v_mfma_f32_16x16x32_bf16 v[160:163], a[204:207], v[4:7], v[160:163]
    s_mul_i32 s74, s74, 12288
    s_or_b32 s74, s74, s62
    s_add_u32 m0, s63, 122880
    v_mfma_f32_16x16x32_bf16 v[184:187], a[204:207], v[8:11], v[184:187]
    buffer_load_dwordx4 v244, s[24:27], s74 offen nt lds
    v_mfma_f32_16x16x32_bf16 v[64:67], a[204:207], v[12:15], v[64:67]
    s_waitcnt lgkmcnt(0)
    buffer_load_dwordx4 v245, s[24:27], s74 offen offset:1024 nt lds
    v_mfma_f32_16x16x32_bf16 v[164:167], a[208:211], v[4:7], v[164:167]
    buffer_load_dwordx4 v246, s[24:27], s74 offen offset:2048 nt lds
    v_mfma_f32_16x16x32_bf16 v[188:191], a[208:211], v[8:11], v[188:191]
    s_add_u32 s75, s2, 43
    s_and_b32 s75, s75, 255
    s_add_u32 s75, s75, 256
    s_mul_i32 s75, s75, 12288
    s_or_b32 s75, s75, s62
    s_add_u32 m0, s63, 135168
    v_mfma_f32_16x16x32_bf16 v[68:71], a[208:211], v[12:15], v[68:71]
    buffer_load_dwordx4 v244, s[24:27], s75 offen nt lds
    v_mfma_f32_16x16x32_bf16 v[168:171], a[212:215], v[4:7], v[168:171]
    buffer_load_dwordx4 v245, s[24:27], s75 offen offset:1024 nt lds
    v_mfma_f32_16x16x32_bf16 v[192:195], a[212:215], v[8:11], v[192:195]
    buffer_load_dwordx4 v246, s[24:27], s75 offen offset:2048 nt lds
    v_mfma_f32_16x16x32_bf16 v[72:75], a[212:215], v[12:15], v[72:75]
    s_waitcnt vmcnt(12)
    ds_read_b64_tr_b16 v[196:197], v251 offset:0
    ds_read_b64_tr_b16 v[198:199], v251 offset:256
    v_mfma_f32_16x16x32_bf16 v[148:151], a[216:219], v[16:19], v[148:151]
    ds_read_b64_tr_b16 v[200:201], v251 offset:8
    ds_read_b64_tr_b16 v[202:203], v251 offset:264
    v_mfma_f32_16x16x32_bf16 v[172:175], a[216:219], v[20:23], v[172:175]
    ds_read_b64_tr_b16 a[240:241], v249 offset:4096
    ds_read_b64_tr_b16 a[242:243], v249 offset:4608
    v_mfma_f32_16x16x32_bf16 v[52:55], a[216:219], v[24:27], v[52:55]
    ds_read_b64_tr_b16 a[244:245], v249 offset:4104
    ds_read_b64_tr_b16 a[246:247], v249 offset:4616
    v_mfma_f32_16x16x32_bf16 v[152:155], a[220:223], v[16:19], v[152:155]
    ds_read_b64_tr_b16 a[248:249], v250 offset:4096
    ds_read_b64_tr_b16 a[250:251], v250 offset:4608
    v_mfma_f32_16x16x32_bf16 v[176:179], a[220:223], v[20:23], v[176:179]
    ds_read_b64_tr_b16 a[252:253], v250 offset:4104
    ds_read_b64_tr_b16 a[254:255], v250 offset:4616
    v_mfma_f32_16x16x32_bf16 v[56:59], a[220:223], v[24:27], v[56:59]
    ds_read_b128 v[28:31], v242 offset:37376
    ds_read_b128 v[32:35], v242 offset:49664
    s_add_u32 s76, s2, 86
    s_and_b32 s76, s76, 255
    v_mfma_f32_16x16x32_bf16 v[156:159], a[224:227], v[16:19], v[156:159]
    ds_read_b128 v[36:39], v242 offset:61952
    s_add_u32 s76, s76, 512
    s_mul_i32 s76, s76, 12288
    v_mfma_f32_16x16x32_bf16 v[180:183], a[224:227], v[20:23], v[180:183]
    s_or_b32 s76, s76, s62
    s_add_u32 m0, s64, 12288
    v_mfma_f32_16x16x32_bf16 v[60:63], a[224:227], v[24:27], v[60:63]
    buffer_load_dwordx4 v244, s[24:27], s76 offen nt lds
    v_mfma_f32_16x16x32_bf16 v[160:163], a[228:231], v[16:19], v[160:163]
    buffer_load_dwordx4 v245, s[24:27], s76 offen offset:1024 nt lds
    v_mfma_f32_16x16x32_bf16 v[184:187], a[228:231], v[20:23], v[184:187]
    buffer_load_dwordx4 v246, s[24:27], s76 offen offset:2048 nt lds
    v_mfma_f32_16x16x32_bf16 v[64:67], a[228:231], v[24:27], v[64:67]
    s_waitcnt lgkmcnt(0)
    s_add_u32 s77, s2, 129
    s_and_b32 s77, s77, 255
    v_mfma_f32_16x16x32_bf16 v[164:167], a[232:235], v[16:19], v[164:167]
    s_add_u32 s77, s77, 768
    s_mul_i32 s77, s77, 12288
    v_mfma_f32_16x16x32_bf16 v[188:191], a[232:235], v[20:23], v[188:191]
    s_or_b32 s77, s77, s62
    s_add_u32 m0, s64, 24576
    v_mfma_f32_16x16x32_bf16 v[68:71], a[232:235], v[24:27], v[68:71]
    buffer_load_dwordx4 v244, s[24:27], s77 offen nt lds
    v_mfma_f32_16x16x32_bf16 v[168:171], a[236:239], v[16:19], v[168:171]
    buffer_load_dwordx4 v245, s[24:27], s77 offen offset:1024 nt lds
    v_mfma_f32_16x16x32_bf16 v[192:195], a[236:239], v[20:23], v[192:195]
    buffer_load_dwordx4 v246, s[24:27], s77 offen offset:2048 nt lds
    v_mfma_f32_16x16x32_bf16 v[72:75], a[236:239], v[24:27], v[72:75]
    s_waitcnt vmcnt(12)
    ds_read_b64_tr_b16 v[220:221], v251 offset:2048
    ds_read_b64_tr_b16 v[222:223], v251 offset:2304
    v_mfma_f32_16x16x32_bf16 v[148:151], a[240:243], v[28:31], v[148:151]
    ds_read_b64_tr_b16 v[224:225], v251 offset:2056
    ds_read_b64_tr_b16 v[226:227], v251 offset:2312
    v_mfma_f32_16x16x32_bf16 v[172:175], a[240:243], v[32:35], v[172:175]
    ds_read_b64_tr_b16 v[204:205], v249 offset:8192
    ds_read_b64_tr_b16 v[206:207], v249 offset:8704
    v_mfma_f32_16x16x32_bf16 v[52:55], a[240:243], v[36:39], v[52:55]
    ds_read_b64_tr_b16 v[208:209], v249 offset:8200
    ds_read_b64_tr_b16 v[210:211], v249 offset:8712
    v_mfma_f32_16x16x32_bf16 v[152:155], a[244:247], v[28:31], v[152:155]
    ds_read_b64_tr_b16 v[212:213], v250 offset:8192
    ds_read_b64_tr_b16 v[214:215], v250 offset:8704
    v_mfma_f32_16x16x32_bf16 v[176:179], a[244:247], v[32:35], v[176:179]
    ds_read_b64_tr_b16 v[216:217], v250 offset:8200
    ds_read_b64_tr_b16 v[218:219], v250 offset:8712
    v_mfma_f32_16x16x32_bf16 v[56:59], a[244:247], v[36:39], v[56:59]
    ds_read_b128 v[40:43], v243 offset:37376
    ds_read_b128 v[44:47], v243 offset:49664
    s_add_u32 s74, s2, 172
    s_and_b32 s74, s74, 255
    v_mfma_f32_16x16x32_bf16 v[156:159], a[248:251], v[28:31], v[156:159]
    ds_read_b128 v[48:51], v243 offset:61952
    s_add_u32 s74, s74, 1024
    s_mul_i32 s74, s74, 12288
    v_mfma_f32_16x16x32_bf16 v[180:183], a[248:251], v[32:35], v[180:183]
    s_or_b32 s74, s74, s62
    s_add_u32 m0, s64, 36864
    v_mfma_f32_16x16x32_bf16 v[60:63], a[248:251], v[36:39], v[60:63]
    buffer_load_dwordx4 v244, s[24:27], s74 offen nt lds
    v_mfma_f32_16x16x32_bf16 v[160:163], a[252:255], v[28:31], v[160:163]
    buffer_load_dwordx4 v245, s[24:27], s74 offen offset:1024 nt lds
    v_mfma_f32_16x16x32_bf16 v[184:187], a[252:255], v[32:35], v[184:187]
    buffer_load_dwordx4 v246, s[24:27], s74 offen offset:2048 nt lds
    v_mfma_f32_16x16x32_bf16 v[64:67], a[252:255], v[36:39], v[64:67]
    s_waitcnt lgkmcnt(0)
    s_add_u32 s75, s2, 215
    s_and_b32 s75, s75, 255
    v_mfma_f32_16x16x32_bf16 v[164:167], v[196:199], v[28:31], v[164:167]
    s_add_u32 s75, s75, 1280
    s_mul_i32 s75, s75, 12288
    v_mfma_f32_16x16x32_bf16 v[188:191], v[196:199], v[32:35], v[188:191]
    s_or_b32 s75, s75, s62
    s_add_u32 m0, s63, 98304
    v_mfma_f32_16x16x32_bf16 v[68:71], v[196:199], v[36:39], v[68:71]
    buffer_load_dwordx4 v244, s[24:27], s75 offen nt lds
    v_mfma_f32_16x16x32_bf16 v[168:171], v[200:203], v[28:31], v[168:171]
    buffer_load_dwordx4 v245, s[24:27], s75 offen offset:1024 nt lds
    v_mfma_f32_16x16x32_bf16 v[192:195], v[200:203], v[32:35], v[192:195]
    buffer_load_dwordx4 v246, s[24:27], s75 offen offset:2048 nt lds
    v_mfma_f32_16x16x32_bf16 v[72:75], v[200:203], v[36:39], v[72:75]
    v_mfma_f32_16x16x32_bf16 v[148:151], v[204:207], v[40:43], v[148:151]
    v_mfma_f32_16x16x32_bf16 v[172:175], v[204:207], v[44:47], v[172:175]
    s_cmp_lg_u32 s61, 2
    s_cbranch_scc1 L_nb
    s_barrier
    ds_read_b128 v[4:7], v228 offset:24576
    ds_read_b128 v[8:11], v228 offset:36864
    ds_read_b128 v[12:15], v240 offset:24576
    ds_read_b128 v[16:19], v229 offset:24576
    ds_read_b128 v[20:23], v229 offset:36864
    ds_read_b128 v[24:27], v241 offset:24576
L_nb:
    v_mfma_f32_16x16x32_bf16 v[52:55], v[204:207], v[48:51], v[52:55]
    v_mfma_f32_16x16x32_bf16 v[152:155], v[208:211], v[40:43], v[152:155]
    v_mfma_f32_16x16x32_bf16 v[176:179], v[208:211], v[44:47], v[176:179]
    v_mfma_f32_16x16x32_bf16 v[56:59], v[208:211], v[48:51], v[56:59]
    v_mfma_f32_16x16x32_bf16 v[156:159], v[212:215], v[40:43], v[156:159]
    v_mfma_f32_16x16x32_bf16 v[180:183], v[212:215], v[44:47], v[180:183]
    v_mfma_f32_16x16x32_bf16 v[60:63], v[212:215], v[48:51], v[60:63]
    v_mfma_f32_16x16x32_bf16 v[160:163], v[216:219], v[40:43], v[160:163]
    v_mfma_f32_16x16x32_bf16 v[184:187], v[216:219], v[44:47], v[184:187]
    v_mfma_f32_16x16x32_bf16 v[64:67], v[216:219], v[48:51], v[64:67]
    v_mfma_f32_16x16x32_bf16 v[164:167], v[220:223], v[40:43], v[164:167]
    v_mfma_f32_16x16x32_bf16 v[188:191], v[220:223], v[44:47], v[188:191]
    v_mfma_f32_16x16x32_bf16 v[68:71], v[220:223], v[48:51], v[68:71]
    v_mfma_f32_16x16x32_bf16 v[168:171], v[224:227], v[40:43], v[168:171]
    v_mfma_f32_16x16x32_bf16 v[192:195], v[224:227], v[44:47], v[192:195]
    v_mfma_f32_16x16x32_bf16 v[72:75], v[224:227], v[48:51], v[72:75]
    s_cmp_eq_u32 s61, 2
    s_cbranch_scc1 L_pass2t
    s_cmp_eq_u32 s61, 0
    s_cbranch_scc1 L_prod
    v_add_u32 v240, 73728, v228
    v_add_u32 v241, 73728, v229
    v_add_u32 v242, 73728, v230
    v_add_u32 v243, 73728, v231
    s_waitcnt vmcnt(9)
L_prod_ret:
    s_barrier
    ds_read_b128 v[4:7], v240 offset:49152
    ds_read_b128 v[8:11], v240 offset:61440
    ds_read_b128 v[12:15], v228 offset:12288
    ds_read_b128 v[16:19], v241 offset:49152
    ds_read_b128 v[20:23], v241 offset:61440
    ds_read_b128 v[24:27], v229 offset:12288
    s_waitcnt lgkmcnt(0)
    v_mfma_f32_16x16x32_bf16 v[148:151], a[0:3], v[4:7], 0
    v_mfma_f32_16x16x32_bf16 v[148:151], a[24:27], v[16:19], v[148:151]
    v_mfma_f32_16x16x32_bf16 v[172:175], a[0:3], v[8:11], 0
    ds_read_b128 v[28:31], v242 offset:49152
    v_mfma_f32_16x16x32_bf16 v[172:175], a[24:27], v[20:23], v[172:175]
    v_mfma_f32_16x16x32_bf16 v[52:55], a[0:3], v[12:15], 0
    v_mfma_f32_16x16x32_bf16 v[52:55], a[24:27], v[24:27], v[52:55]
    v_mfma_f32_16x16x32_bf16 v[152:155], a[4:7], v[4:7], 0
    ds_read_b128 v[32:35], v242 offset:61440
    s_add_u32 s76, s84, 0
    s_add_u32 m0, s49, 49152
    v_mfma_f32_16x16x32_bf16 v[152:155], a[28:31], v[16:19], v[152:155]
    buffer_load_dwordx4 v232, s[20:23], s76 offen nt lds
    v_mfma_f32_16x16x32_bf16 v[176:179], a[4:7], v[8:11], 0
    v_mfma_f32_16x16x32_bf16 v[176:179], a[28:31], v[20:23], v[176:179]
    v_mfma_f32_16x16x32_bf16 v[56:59], a[4:7], v[12:15], 0
    ds_read_b128 v[36:39], v230 offset:12288
    buffer_load_dwordx4 v233, s[20:23], s76 offen offset:1024 nt lds
    v_mfma_f32_16x16x32_bf16 v[56:59], a[28:31], v[24:27], v[56:59]
    v_mfma_f32_16x16x32_bf16 v[156:159], a[8:11], v[4:7], 0
    v_mfma_f32_16x16x32_bf16 v[156:159], a[32:35], v[16:19], v[156:159]
    buffer_load_dwordx4 v234, s[20:23], s76 offen offset:2048 nt lds
    v_mfma_f32_16x16x32_bf16 v[180:183], a[8:11], v[8:11], 0
    ds_read_b128 v[40:43], v243 offset:49152
    v_mfma_f32_16x16x32_bf16 v[180:183], a[32:35], v[20:23], v[180:183]
    v_mfma_f32_16x16x32_bf16 v[60:63], a[8:11], v[12:15], 0
    v_mfma_f32_16x16x32_bf16 v[60:63], a[32:35], v[24:27], v[60:63]
    v_mfma_f32_16x16x32_bf16 v[160:163], a[12:15], v[4:7], 0
    ds_read_b128 v[44:47], v243 offset:61440
    v_mfma_f32_16x16x32_bf16 v[160:163], a[36:39], v[16:19], v[160:163]
    v_mfma_f32_16x16x32_bf16 v[184:187], a[12:15], v[8:11], 0
    v_mfma_f32_16x16x32_bf16 v[184:187], a[36:39], v[20:23], v[184:187]
    v_mfma_f32_16x16x32_bf16 v[64:67], a[12:15], v[12:15], 0
    ds_read_b128 v[48:51], v231 offset:12288
    v_mfma_f32_16x16x32_bf16 v[64:67], a[36:39], v[24:27], v[64:67]
    v_mfma_f32_16x16x32_bf16 v[164:167], a[16:19], v[4:7], 0
    v_mfma_f32_16x16x32_bf16 v[164:167], a[40:43], v[16:19], v[164:167]
    v_mfma_f32_16x16x32_bf16 v[188:191], a[16:19], v[8:11], 0
    v_mfma_f32_16x16x32_bf16 v[188:191], a[40:43], v[20:23], v[188:191]
    v_mfma_f32_16x16x32_bf16 v[68:71], a[16:19], v[12:15], 0
    v_mfma_f32_16x16x32_bf16 v[68:71], a[40:43], v[24:27], v[68:71]
    v_mfma_f32_16x16x32_bf16 v[168:171], a[20:23], v[4:7], 0
    s_add_u32 s77, s84, 768
    s_add_u32 m0, s49, 61440
    v_mfma_f32_16x16x32_bf16 v[168:171], a[44:47], v[16:19], v[168:171]
    buffer_load_dwordx4 v232, s[20:23], s77 offen nt lds
    v_mfma_f32_16x16x32_bf16 v[192:195], a[20:23], v[8:11], 0
    v_mfma_f32_16x16x32_bf16 v[192:195], a[44:47], v[20:23], v[192:195]
    v_mfma_f32_16x16x32_bf16 v[72:75], a[20:23], v[12:15], 0
    buffer_load_dwordx4 v233, s[20:23], s77 offen offset:1024 nt lds
    v_mfma_f32_16x16x32_bf16 v[72:75], a[44:47], v[24:27], v[72:75]
    s_waitcnt lgkmcnt(0)
    v_mfma_f32_16x16x32_bf16 v[148:151], a[48:51], v[28:31], v[148:151]
    v_mfma_f32_16x16x32_bf16 v[148:151], a[72:75], v[40:43], v[148:151]
    buffer_load_dwordx4 v234, s[20:23], s77 offen offset:2048 nt lds
    v_mfma_f32_16x16x32_bf16 v[172:175], a[48:51], v[32:35], v[172:175]
    ds_read_b128 v[4:7], v240 offset:49408
    v_mfma_f32_16x16x32_bf16 v[172:175], a[72:75], v[44:47], v[172:175]
    v_mfma_f32_16x16x32_bf16 v[52:55], a[48:51], v[36:39], v[52:55]
    v_mfma_f32_16x16x32_bf16 v[52:55], a[72:75], v[48:51], v[52:55]
    v_mfma_f32_16x16x32_bf16 v[152:155], a[52:55], v[28:31], v[152:155]
    ds_read_b128 v[8:11], v240 offset:61696
    v_mfma_f32_16x16x32_bf16 v[152:155], a[76:79], v[40:43], v[152:155]
    v_mfma_f32_16x16x32_bf16 v[176:179], a[52:55], v[32:35], v[176:179]
    v_mfma_f32_16x16x32_bf16 v[176:179], a[76:79], v[44:47], v[176:179]
    v_mfma_f32_16x16x32_bf16 v[56:59], a[52:55], v[36:39], v[56:59]
    ds_read_b128 v[12:15], v228 offset:12544
    v_mfma_f32_16x16x32_bf16 v[56:59], a[76:79], v[48:51], v[56:59]
    s_cmp_lg_u32 s61, 0
    s_cbranch_scc1 L_pub_done
    s_waitcnt vmcnt(6)
    s_barrier
    s_cmp_lg_u32 s48, 0
    s_cbranch_scc1 L_pub_done
    v_mov_b32 v254, 1
    v_lshlrev_b32 v255, 6, v0
    s_mov_b64 exec, 15
    buffer_atomic_add v254, v255, s[44:47], 0 offen sc1
    s_mov_b64 exec, -1
L_pub_done:
    v_mfma_f32_16x16x32_bf16 v[156:159], a[56:59], v[28:31], v[156:159]
    v_mfma_f32_16x16x32_bf16 v[156:159], a[80:83], v[40:43], v[156:159]
    v_mfma_f32_16x16x32_bf16 v[180:183], a[56:59], v[32:35], v[180:183]
    ds_read_b128 v[16:19], v241 offset:49408
    v_mfma_f32_16x16x32_bf16 v[180:183], a[80:83], v[44:47], v[180:183]
    v_mfma_f32_16x16x32_bf16 v[60:63], a[56:59], v[36:39], v[60:63]
    v_mfma_f32_16x16x32_bf16 v[60:63], a[80:83], v[48:51], v[60:63]
    v_mfma_f32_16x16x32_bf16 v[160:163], a[60:63], v[28:31], v[160:163]
    ds_read_b128 v[20:23], v241 offset:61696
    v_mfma_f32_16x16x32_bf16 v[160:163], a[84:87], v[40:43], v[160:163]
    v_mfma_f32_16x16x32_bf16 v[184:187], a[60:63], v[32:35], v[184:187]
    v_mfma_f32_16x16x32_bf16 v[184:187], a[84:87], v[44:47], v[184:187]
    v_mfma_f32_16x16x32_bf16 v[64:67], a[60:63], v[36:39], v[64:67]
    ds_read_b128 v[24:27], v229 offset:12544
    v_mfma_f32_16x16x32_bf16 v[64:67], a[84:87], v[48:51], v[64:67]
    v_mfma_f32_16x16x32_bf16 v[164:167], a[64:67], v[28:31], v[164:167]
    v_mfma_f32_16x16x32_bf16 v[164:167], a[88:91], v[40:43], v[164:167]
    v_mfma_f32_16x16x32_bf16 v[188:191], a[64:67], v[32:35], v[188:191]
    v_mfma_f32_16x16x32_bf16 v[188:191], a[88:91], v[44:47], v[188:191]
    v_mfma_f32_16x16x32_bf16 v[68:71], a[64:67], v[36:39], v[68:71]
    v_mfma_f32_16x16x32_bf16 v[68:71], a[88:91], v[48:51], v[68:71]
    v_mfma_f32_16x16x32_bf16 v[168:171], a[68:71], v[28:31], v[168:171]
    v_mfma_f32_16x16x32_bf16 v[168:171], a[92:95], v[40:43], v[168:171]
    v_mfma_f32_16x16x32_bf16 v[192:195], a[68:71], v[32:35], v[192:195]
    v_mfma_f32_16x16x32_bf16 v[192:195], a[92:95], v[44:47], v[192:195]
    v_mfma_f32_16x16x32_bf16 v[72:75], a[68:71], v[36:39], v[72:75]
    v_mfma_f32_16x16x32_bf16 v[72:75], a[92:95], v[48:51], v[72:75]
    s_waitcnt lgkmcnt(0)
    v_mfma_f32_16x16x32_bf16 v[148:151], a[96:99], v[4:7], v[148:151]
    v_mfma_f32_16x16x32_bf16 v[148:151], a[120:123], v[16:19], v[148:151]
    v_mfma_f32_16x16x32_bf16 v[172:175], a[96:99], v[8:11], v[172:175]
    ds_read_b128 v[28:31], v242 offset:49408
    v_mfma_f32_16x16x32_bf16 v[172:175], a[120:123], v[20:23], v[172:175]
    v_mfma_f32_16x16x32_bf16 v[52:55], a[96:99], v[12:15], v[52:55]
    v_mfma_f32_16x16x32_bf16 v[52:55], a[120:123], v[24:27], v[52:55]
    v_mfma_f32_16x16x32_bf16 v[152:155], a[100:103], v[4:7], v[152:155]
    ds_read_b128 v[32:35], v242 offset:61696
    v_mfma_f32_16x16x32_bf16 v[152:155], a[124:127], v[16:19], v[152:155]
    v_mfma_f32_16x16x32_bf16 v[176:179], a[100:103], v[8:11], v[176:179]
    v_mfma_f32_16x16x32_bf16 v[176:179], a[124:127], v[20:23], v[176:179]
    v_mfma_f32_16x16x32_bf16 v[56:59], a[100:103], v[12:15], v[56:59]
    ds_read_b128 v[36:39], v230 offset:12544
    v_mfma_f32_16x16x32_bf16 v[56:59], a[124:127], v[24:27], v[56:59]
    v_mfma_f32_16x16x32_bf16 v[156:159], a[104:107], v[4:7], v[156:159]
    v_mfma_f32_16x16x32_bf16 v[156:159], a[128:131], v[16:19], v[156:159]
    v_mfma_f32_16x16x32_bf16 v[180:183], a[104:107], v[8:11], v[180:183]
    ds_read_b128 v[40:43], v243 offset:49408
    v_mfma_f32_16x16x32_bf16 v[180:183], a[128:131], v[20:23], v[180:183]
    v_mfma_f32_16x16x32_bf16 v[60:63], a[104:107], v[12:15], v[60:63]
    v_mfma_f32_16x16x32_bf16 v[60:63], a[128:131], v[24:27], v[60:63]
    v_mfma_f32_16x16x32_bf16 v[160:163], a[108:111], v[4:7], v[160:163]
    ds_read_b128 v[44:47], v243 offset:61696
    v_mfma_f32_16x16x32_bf16 v[160:163], a[132:135], v[16:19], v[160:163]
    v_mfma_f32_16x16x32_bf16 v[184:187], a[108:111], v[8:11], v[184:187]
    v_mfma_f32_16x16x32_bf16 v[184:187], a[132:135], v[20:23], v[184:187]
    v_mfma_f32_16x16x32_bf16 v[64:67], a[108:111], v[12:15], v[64:67]
    ds_read_b128 v[48:51], v231 offset:12544
    v_mfma_f32_16x16x32_bf16 v[64:67], a[132:135], v[24:27], v[64:67]
    v_mfma_f32_16x16x32_bf16 v[164:167], a[112:115], v[4:7], v[164:167]
    v_mfma_f32_16x16x32_bf16 v[164:167], a[136:139], v[16:19], v[164:167]
    v_mfma_f32_16x16x32_bf16 v[188:191], a[112:115], v[8:11], v[188:191]
    v_mfma_f32_16x16x32_bf16 v[188:191], a[136:139], v[20:23], v[188:191]
    v_mfma_f32_16x16x32_bf16 v[68:71], a[112:115], v[12:15], v[68:71]
    v_mfma_f32_16x16x32_bf16 v[68:71], a[136:139], v[24:27], v[68:71]
    v_mfma_f32_16x16x32_bf16 v[168:171], a[116:119], v[4:7], v[168:171]
    v_mfma_f32_16x16x32_bf16 v[168:171], a[140:143], v[16:19], v[168:171]
    v_mfma_f32_16x16x32_bf16 v[192:195], a[116:119], v[8:11], v[192:195]
    v_mfma_f32_16x16x32_bf16 v[192:195], a[140:143], v[20:23], v[192:195]
    v_mfma_f32_16x16x32_bf16 v[72:75], a[116:119], v[12:15], v[72:75]
    v_mfma_f32_16x16x32_bf16 v[72:75], a[140:143], v[24:27], v[72:75]
    s_waitcnt lgkmcnt(0)
    v_mfma_f32_16x16x32_bf16 v[148:151], a[144:147], v[28:31], v[148:151]
    v_mfma_f32_16x16x32_bf16 v[148:151], a[168:171], v[40:43], v[148:151]
    v_mfma_f32_16x16x32_bf16 v[172:175], a[144:147], v[32:35], v[172:175]
    ds_read_b128 v[4:7], v240 offset:49664
    v_mfma_f32_16x16x32_bf16 v[172:175], a[168:171], v[44:47], v[172:175]
    v_mfma_f32_16x16x32_bf16 v[52:55], a[144:147], v[36:39], v[52:55]
    v_mfma_f32_16x16x32_bf16 v[52:55], a[168:171], v[48:51], v[52:55]
    v_mfma_f32_16x16x32_bf16 v[152:155], a[148:151], v[28:31], v[152:155]
    ds_read_b128 v[8:11], v240 offset:61952
    v_mfma_f32_16x16x32_bf16 v[152:155], a[172:175], v[40:43], v[152:155]
    v_mfma_f32_16x16x32_bf16 v[176:179], a[148:151], v[32:35], v[176:179]
    v_mfma_f32_16x16x32_bf16 v[176:179], a[172:175], v[44:47], v[176:179]
    v_mfma_f32_16x16x32_bf16 v[56:59], a[148:151], v[36:39], v[56:59]
    ds_read_b128 v[12:15], v228 offset:12800
    v_mfma_f32_16x16x32_bf16 v[56:59], a[172:175], v[48:51], v[56:59]
    v_mfma_f32_16x16x32_bf16 v[156:159], a[152:155], v[28:31], v[156:159]
    v_mfma_f32_16x16x32_bf16 v[156:159], a[176:179], v[40:43], v[156:159]
    v_mfma_f32_16x16x32_bf16 v[180:183], a[152:155], v[32:35], v[180:183]
    ds_read_b128 v[16:19], v241 offset:49664
    v_mfma_f32_16x16x32_bf16 v[180:183], a[176:179], v[44:47], v[180:183]
    v_mfma_f32_16x16x32_bf16 v[60:63], a[152:155], v[36:39], v[60:63]
    v_mfma_f32_16x16x32_bf16 v[60:63], a[176:179], v[48:51], v[60:63]
    v_mfma_f32_16x16x32_bf16 v[160:163], a[156:159], v[28:31], v[160:163]
    ds_read_b128 v[20:23], v241 offset:61952
    v_mfma_f32_16x16x32_bf16 v[160:163], a[180:183], v[40:43], v[160:163]
    v_mfma_f32_16x16x32_bf16 v[184:187], a[156:159], v[32:35], v[184:187]
    v_mfma_f32_16x16x32_bf16 v[184:187], a[180:183], v[44:47], v[184:187]
    v_mfma_f32_16x16x32_bf16 v[64:67], a[156:159], v[36:39], v[64:67]
    ds_read_b128 v[24:27], v229 offset:12800
    v_mfma_f32_16x16x32_bf16 v[64:67], a[180:183], v[48:51], v[64:67]
    v_mfma_f32_16x16x32_bf16 v[164:167], a[160:163], v[28:31], v[164:167]
    v_mfma_f32_16x16x32_bf16 v[164:167], a[184:187], v[40:43], v[164:167]
    v_mfma_f32_16x16x32_bf16 v[188:191], a[160:163], v[32:35], v[188:191]
    v_mfma_f32_16x16x32_bf16 v[188:191], a[184:187], v[44:47], v[188:191]
    v_mfma_f32_16x16x32_bf16 v[68:71], a[160:163], v[36:39], v[68:71]
    v_mfma_f32_16x16x32_bf16 v[68:71], a[184:187], v[48:51], v[68:71]
    v_mfma_f32_16x16x32_bf16 v[168:171], a[164:167], v[28:31], v[168:171]
    v_mfma_f32_16x16x32_bf16 v[168:171], a[188:191], v[40:43], v[168:171]
    v_mfma_f32_16x16x32_bf16 v[192:195], a[164:167], v[32:35], v[192:195]
    v_mfma_f32_16x16x32_bf16 v[192:195], a[188:191], v[44:47], v[192:195]
    v_mfma_f32_16x16x32_bf16 v[72:75], a[164:167], v[36:39], v[72:75]
    v_mfma_f32_16x16x32_bf16 v[72:75], a[188:191], v[48:51], v[72:75]
    s_waitcnt lgkmcnt(0)
    v_mfma_f32_16x16x32_bf16 v[148:151], a[192:195], v[4:7], v[148:151]
    v_mfma_f32_16x16x32_bf16 v[148:151], a[216:219], v[16:19], v[148:151]
    v_mfma_f32_16x16x32_bf16 v[172:175], a[192:195], v[8:11], v[172:175]
    ds_read_b128 v[28:31], v242 offset:49664
    v_mfma_f32_16x16x32_bf16 v[172:175], a[216:219], v[20:23], v[172:175]
    v_mfma_f32_16x16x32_bf16 v[52:55], a[192:195], v[12:15], v[52:55]
    v_mfma_f32_16x16x32_bf16 v[52:55], a[216:219], v[24:27], v[52:55]
    v_mfma_f32_16x16x32_bf16 v[152:155], a[196:199], v[4:7], v[152:155]
    ds_read_b128 v[32:35], v242 offset:61952
    v_mfma_f32_16x16x32_bf16 v[152:155], a[220:223], v[16:19], v[152:155]
    v_mfma_f32_16x16x32_bf16 v[176:179], a[196:199], v[8:11], v[176:179]
    v_mfma_f32_16x16x32_bf16 v[176:179], a[220:223], v[20:23], v[176:179]
    v_mfma_f32_16x16x32_bf16 v[56:59], a[196:199], v[12:15], v[56:59]
    ds_read_b128 v[36:39], v230 offset:12800
    v_mfma_f32_16x16x32_bf16 v[56:59], a[220:223], v[24:27], v[56:59]
    v_mfma_f32_16x16x32_bf16 v[156:159], a[200:203], v[4:7], v[156:159]
    v_mfma_f32_16x16x32_bf16 v[156:159], a[224:227], v[16:19], v[156:159]
    v_mfma_f32_16x16x32_bf16 v[180:183], a[200:203], v[8:11], v[180:183]
    ds_read_b128 v[40:43], v243 offset:49664
    v_mfma_f32_16x16x32_bf16 v[180:183], a[224:227], v[20:23], v[180:183]
    v_mfma_f32_16x16x32_bf16 v[60:63], a[200:203], v[12:15], v[60:63]
    v_mfma_f32_16x16x32_bf16 v[60:63], a[224:227], v[24:27], v[60:63]
    v_mfma_f32_16x16x32_bf16 v[160:163], a[204:207], v[4:7], v[160:163]
    ds_read_b128 v[44:47], v243 offset:61952
    v_mfma_f32_16x16x32_bf16 v[160:163], a[228:231], v[16:19], v[160:163]
    v_mfma_f32_16x16x32_bf16 v[184:187], a[204:207], v[8:11], v[184:187]
    v_mfma_f32_16x16x32_bf16 v[184:187], a[228:231], v[20:23], v[184:187]
    v_mfma_f32_16x16x32_bf16 v[64:67], a[204:207], v[12:15], v[64:67]
    ds_read_b128 v[48:51], v231 offset:12800
    v_mfma_f32_16x16x32_bf16 v[64:67], a[228:231], v[24:27], v[64:67]
    v_mfma_f32_16x16x32_bf16 v[164:167], a[208:211], v[4:7], v[164:167]
    v_mfma_f32_16x16x32_bf16 v[164:167], a[232:235], v[16:19], v[164:167]
    v_mfma_f32_16x16x32_bf16 v[188:191], a[208:211], v[8:11], v[188:191]
    v_mfma_f32_16x16x32_bf16 v[188:191], a[232:235], v[20:23], v[188:191]
    v_mfma_f32_16x16x32_bf16 v[68:71], a[208:211], v[12:15], v[68:71]
    v_mfma_f32_16x16x32_bf16 v[68:71], a[232:235], v[24:27], v[68:71]
    v_mfma_f32_16x16x32_bf16 v[168:171], a[212:215], v[4:7], v[168:171]
    v_mfma_f32_16x16x32_bf16 v[168:171], a[236:239], v[16:19], v[168:171]
    v_mfma_f32_16x16x32_bf16 v[192:195], a[212:215], v[8:11], v[192:195]
    v_mfma_f32_16x16x32_bf16 v[192:195], a[236:239], v[20:23], v[192:195]
    v_mfma_f32_16x16x32_bf16 v[72:75], a[212:215], v[12:15], v[72:75]
    v_mfma_f32_16x16x32_bf16 v[72:75], a[236:239], v[24:27], v[72:75]
    s_waitcnt vmcnt(6) lgkmcnt(0)
    s_barrier
    v_mfma_f32_16x16x32_bf16 v[148:151], a[240:243], v[28:31], v[148:151]
    v_mfma_f32_16x16x32_bf16 v[148:151], v[204:207], v[40:43], v[148:151]
    v_mfma_f32_16x16x32_bf16 v[172:175], a[240:243], v[32:35], v[172:175]
    ds_read_b128 v[4:7], v228 offset:24576
    v_mfma_f32_16x16x32_bf16 v[172:175], v[204:207], v[44:47], v[172:175]
    v_mfma_f32_16x16x32_bf16 v[52:55], a[240:243], v[36:39], v[52:55]
    v_mfma_f32_16x16x32_bf16 v[52:55], v[204:207], v[48:51], v[52:55]
    v_mfma_f32_16x16x32_bf16 v[152:155], a[244:247], v[28:31], v[152:155]
    ds_read_b128 v[8:11], v228 offset:36864
    v_mfma_f32_16x16x32_bf16 v[152:155], v[208:211], v[40:43], v[152:155]
    v_mfma_f32_16x16x32_bf16 v[176:179], a[244:247], v[32:35], v[176:179]
    v_mfma_f32_16x16x32_bf16 v[176:179], v[208:211], v[44:47], v[176:179]
    v_mfma_f32_16x16x32_bf16 v[56:59], a[244:247], v[36:39], v[56:59]
    ds_read_b128 v[12:15], v240 offset:24576
    v_mfma_f32_16x16x32_bf16 v[56:59], v[208:211], v[48:51], v[56:59]
    v_mfma_f32_16x16x32_bf16 v[156:159], a[248:251], v[28:31], v[156:159]
    v_mfma_f32_16x16x32_bf16 v[156:159], v[212:215], v[40:43], v[156:159]
    v_mfma_f32_16x16x32_bf16 v[180:183], a[248:251], v[32:35], v[180:183]
    ds_read_b128 v[16:19], v229 offset:24576
    v_mfma_f32_16x16x32_bf16 v[180:183], v[212:215], v[44:47], v[180:183]
    v_mfma_f32_16x16x32_bf16 v[60:63], a[248:251], v[36:39], v[60:63]
    v_mfma_f32_16x16x32_bf16 v[60:63], v[212:215], v[48:51], v[60:63]
    v_mfma_f32_16x16x32_bf16 v[160:163], a[252:255], v[28:31], v[160:163]
    ds_read_b128 v[20:23], v229 offset:36864
    v_mfma_f32_16x16x32_bf16 v[160:163], v[216:219], v[40:43], v[160:163]
    v_mfma_f32_16x16x32_bf16 v[184:187], a[252:255], v[32:35], v[184:187]
    v_mfma_f32_16x16x32_bf16 v[184:187], v[216:219], v[44:47], v[184:187]
    v_mfma_f32_16x16x32_bf16 v[64:67], a[252:255], v[36:39], v[64:67]
    ds_read_b128 v[24:27], v241 offset:24576
    v_mfma_f32_16x16x32_bf16 v[64:67], v[216:219], v[48:51], v[64:67]
    v_mfma_f32_16x16x32_bf16 v[164:167], v[196:199], v[28:31], v[164:167]
    v_mfma_f32_16x16x32_bf16 v[164:167], v[220:223], v[40:43], v[164:167]
    v_mfma_f32_16x16x32_bf16 v[188:191], v[196:199], v[32:35], v[188:191]
    v_mfma_f32_16x16x32_bf16 v[188:191], v[220:223], v[44:47], v[188:191]
    v_mfma_f32_16x16x32_bf16 v[68:71], v[196:199], v[36:39], v[68:71]
    v_mfma_f32_16x16x32_bf16 v[68:71], v[220:223], v[48:51], v[68:71]
    v_mfma_f32_16x16x32_bf16 v[168:171], v[200:203], v[28:31], v[168:171]
    v_mfma_f32_16x16x32_bf16 v[168:171], v[224:227], v[40:43], v[168:171]
    v_mfma_f32_16x16x32_bf16 v[192:195], v[200:203], v[32:35], v[192:195]
    v_mfma_f32_16x16x32_bf16 v[192:195], v[224:227], v[44:47], v[192:195]
    v_mfma_f32_16x16x32_bf16 v[72:75], v[200:203], v[36:39], v[72:75]
    v_mfma_f32_16x16x32_bf16 v[72:75], v[224:227], v[48:51], v[72:75]
    s_waitcnt lgkmcnt(0)
    v_cvt_pk_bf16_f32 v76, v148, v149
    v_cvt_pk_bf16_f32 v77, v150, v151
    v_mfma_f32_16x16x32_bf16 v[148:151], a[0:3], v[4:7], 0
    s_add_u32 s74, s2, 258
    s_and_b32 s74, s74, 255
    v_mfma_f32_16x16x32_bf16 v[148:151], a[24:27], v[16:19], v[148:151]
    v_cvt_pk_bf16_f32 v88, v172, v173
    v_cvt_pk_bf16_f32 v89, v174, v175
    s_add_u32 s74, s74, 1536
    s_mul_i32 s74, s74, 12288
    v_mfma_f32_16x16x32_bf16 v[172:175], a[0:3], v[8:11], 0
    ds_read_b128 v[28:31], v230 offset:24576
    s_add_u32 m0, s49, 110592
    v_mfma_f32_16x16x32_bf16 v[172:175], a[24:27], v[20:23], v[172:175]
    v_cvt_pk_bf16_f32 v100, v52, v53
    v_cvt_pk_bf16_f32 v101, v54, v55
    buffer_load_dwordx4 v244, s[24:27], s74 offen nt lds
    v_mfma_f32_16x16x32_bf16 v[52:55], a[0:3], v[12:15], 0
    v_mfma_f32_16x16x32_bf16 v[52:55], a[24:27], v[24:27], v[52:55]
    v_cvt_pk_bf16_f32 v78, v152, v153
    v_cvt_pk_bf16_f32 v79, v154, v155
    v_mfma_f32_16x16x32_bf16 v[152:155], a[4:7], v[4:7], 0
    ds_read_b128 v[32:35], v230 offset:36864
    buffer_load_dwordx4 v245, s[24:27], s74 offen offset:1024 nt lds
    v_mfma_f32_16x16x32_bf16 v[152:155], a[28:31], v[16:19], v[152:155]
    v_cvt_pk_bf16_f32 v90, v176, v177
    v_cvt_pk_bf16_f32 v91, v178, v179
    v_mfma_f32_16x16x32_bf16 v[176:179], a[4:7], v[8:11], 0
    v_mfma_f32_16x16x32_bf16 v[176:179], a[28:31], v[20:23], v[176:179]
    v_cvt_pk_bf16_f32 v102, v56, v57
    v_cvt_pk_bf16_f32 v103, v58, v59
    buffer_load_dwordx4 v246, s[24:27], s74 offen offset:2048 nt lds
    v_mfma_f32_16x16x32_bf16 v[56:59], a[4:7], v[12:15], 0
    ds_read_b128 v[36:39], v242 offset:24576
    v_mfma_f32_16x16x32_bf16 v[56:59], a[28:31], v[24:27], v[56:59]
    v_cvt_pk_bf16_f32 v80, v156, v157
    v_cvt_pk_bf16_f32 v81, v158, v159
    v_mfma_f32_16x16x32_bf16 v[156:159], a[8:11], v[4:7], 0
    v_mfma_f32_16x16x32_bf16 v[156:159], a[32:35], v[16:19], v[156:159]
    v_cvt_pk_bf16_f32 v92, v180, v181
    v_cvt_pk_bf16_f32 v93, v182, v183
    v_mfma_f32_16x16x32_bf16 v[180:183], a[8:11], v[8:11], 0
    ds_read_b128 v[40:43], v231 offset:24576
    v_mfma_f32_16x16x32_bf16 v[180:183], a[32:35], v[20:23], v[180:183]
    v_cvt_pk_bf16_f32 v104, v60, v61
    v_cvt_pk_bf16_f32 v105, v62, v63
    v_mfma_f32_16x16x32_bf16 v[60:63], a[8:11], v[12:15], 0
    v_mfma_f32_16x16x32_bf16 v[60:63], a[32:35], v[24:27], v[60:63]
    v_cvt_pk_bf16_f32 v82, v160, v161
    v_cvt_pk_bf16_f32 v83, v162, v163
    v_mfma_f32_16x16x32_bf16 v[160:163], a[12:15], v[4:7], 0
    ds_read_b128 v[44:47], v231 offset:36864
    v_mfma_f32_16x16x32_bf16 v[160:163], a[36:39], v[16:19], v[160:163]
    v_cvt_pk_bf16_f32 v94, v184, v185
    v_cvt_pk_bf16_f32 v95, v186, v187
    v_mfma_f32_16x16x32_bf16 v[184:187], a[12:15], v[8:11], 0
    v_mfma_f32_16x16x32_bf16 v[184:187], a[36:39], v[20:23], v[184:187]
    v_cvt_pk_bf16_f32 v106, v64, v65
    v_cvt_pk_bf16_f32 v107, v66, v67
    v_mfma_f32_16x16x32_bf16 v[64:67], a[12:15], v[12:15], 0
    ds_read_b128 v[48:51], v243 offset:24576
    v_mfma_f32_16x16x32_bf16 v[64:67], a[36:39], v[24:27], v[64:67]
    v_cvt_pk_bf16_f32 v84, v164, v165
    v_cvt_pk_bf16_f32 v85, v166, v167
    v_mfma_f32_16x16x32_bf16 v[164:167], a[16:19], v[4:7], 0
    s_add_u32 s75, s2, 301
    s_and_b32 s75, s75, 255
    v_mfma_f32_16x16x32_bf16 v[164:167], a[40:43], v[16:19], v[164:167]
    v_cvt_pk_bf16_f32 v96, v188, v189
    v_cvt_pk_bf16_f32 v97, v190, v191
    s_add_u32 s75, s75, 1792
    s_mul_i32 s75, s75, 12288
    v_mfma_f32_16x16x32_bf16 v[188:191], a[16:19], v[8:11], 0
    s_add_u32 m0, s49, 122880
    v_mfma_f32_16x16x32_bf16 v[188:191], a[40:43], v[20:23], v[188:191]
    v_cvt_pk_bf16_f32 v108, v68, v69
    v_cvt_pk_bf16_f32 v109, v70, v71
    buffer_load_dwordx4 v244, s[24:27], s75 offen nt lds
    v_mfma_f32_16x16x32_bf16 v[68:71], a[16:19], v[12:15], 0
    v_mfma_f32_16x16x32_bf16 v[68:71], a[40:43], v[24:27], v[68:71]
    v_cvt_pk_bf16_f32 v86, v168, v169
    v_cvt_pk_bf16_f32 v87, v170, v171
    v_mfma_f32_16x16x32_bf16 v[168:171], a[20:23], v[4:7], 0
    buffer_load_dwordx4 v245, s[24:27], s75 offen offset:1024 nt lds
    v_mfma_f32_16x16x32_bf16 v[168:171], a[44:47], v[16:19], v[168:171]
    v_cvt_pk_bf16_f32 v98, v192, v193
    v_cvt_pk_bf16_f32 v99, v194, v195
    v_mfma_f32_16x16x32_bf16 v[192:195], a[20:23], v[8:11], 0
    v_mfma_f32_16x16x32_bf16 v[192:195], a[44:47], v[20:23], v[192:195]
    v_cvt_pk_bf16_f32 v110, v72, v73
    v_cvt_pk_bf16_f32 v111, v74, v75
    buffer_load_dwordx4 v246, s[24:27], s75 offen offset:2048 nt lds
    v_mfma_f32_16x16x32_bf16 v[72:75], a[20:23], v[12:15], 0
    v_mfma_f32_16x16x32_bf16 v[72:75], a[44:47], v[24:27], v[72:75]
    s_waitcnt lgkmcnt(0)
    v_mfma_f32_16x16x32_bf16 v[148:151], a[48:51], v[28:31], v[148:151]
    v_mfma_f32_16x16x32_bf16 v[148:151], a[72:75], v[40:43], v[148:151]
    v_mfma_f32_16x16x32_bf16 v[172:175], a[48:51], v[32:35], v[172:175]
    ds_read_b128 v[4:7], v228 offset:24832
    v_mfma_f32_16x16x32_bf16 v[172:175], a[72:75], v[44:47], v[172:175]
    v_mfma_f32_16x16x32_bf16 v[52:55], a[48:51], v[36:39], v[52:55]
    v_mfma_f32_16x16x32_bf16 v[52:55], a[72:75], v[48:51], v[52:55]
    v_mfma_f32_16x16x32_bf16 v[152:155], a[52:55], v[28:31], v[152:155]
    ds_read_b128 v[8:11], v228 offset:37120
    v_mfma_f32_16x16x32_bf16 v[152:155], a[76:79], v[40:43], v[152:155]
    v_mfma_f32_16x16x32_bf16 v[176:179], a[52:55], v[32:35], v[176:179]
    v_mfma_f32_16x16x32_bf16 v[176:179], a[76:79], v[44:47], v[176:179]
    v_mfma_f32_16x16x32_bf16 v[56:59], a[52:55], v[36:39], v[56:59]
    ds_read_b128 v[12:15], v240 offset:24832
    v_mfma_f32_16x16x32_bf16 v[56:59], a[76:79], v[48:51], v[56:59]
    v_mfma_f32_16x16x32_bf16 v[156:159], a[56:59], v[28:31], v[156:159]
    s_add_u32 s76, s2, 344
    s_and_b32 s76, s76, 255
    v_mfma_f32_16x16x32_bf16 v[156:159], a[80:83], v[40:43], v[156:159]
    s_add_u32 s76, s76, 2048
    s_mul_i32 s76, s76, 12288
    v_mfma_f32_16x16x32_bf16 v[180:183], a[56:59], v[32:35], v[180:183]
    ds_read_b128 v[16:19], v229 offset:24832
    s_add_u32 m0, s49, 135168
    v_mfma_f32_16x16x32_bf16 v[180:183], a[80:83], v[44:47], v[180:183]
    buffer_load_dwordx4 v244, s[24:27], s76 offen nt lds
    v_mfma_f32_16x16x32_bf16 v[60:63], a[56:59], v[36:39], v[60:63]
    v_mfma_f32_16x16x32_bf16 v[60:63], a[80:83], v[48:51], v[60:63]
    v_mfma_f32_16x16x32_bf16 v[160:163], a[60:63], v[28:31], v[160:163]
    ds_read_b128 v[20:23], v229 offset:37120
    buffer_load_dwordx4 v245, s[24:27], s76 offen offset:1024 nt lds
    v_mfma_f32_16x16x32_bf16 v[160:163], a[84:87], v[40:43], v[160:163]
    v_mfma_f32_16x16x32_bf16 v[184:187], a[60:63], v[32:35], v[184:187]
    v_mfma_f32_16x16x32_bf16 v[184:187], a[84:87], v[44:47], v[184:187]
    buffer_load_dwordx4 v246, s[24:27], s76 offen offset:2048 nt lds
    v_mfma_f32_16x16x32_bf16 v[64:67], a[60:63], v[36:39], v[64:67]
    ds_read_b128 v[24:27], v241 offset:24832
    v_mfma_f32_16x16x32_bf16 v[64:67], a[84:87], v[48:51], v[64:67]
    v_mfma_f32_16x16x32_bf16 v[164:167], a[64:67], v[28:31], v[164:167]
    v_mfma_f32_16x16x32_bf16 v[164:167], a[88:91], v[40:43], v[164:167]
    v_mfma_f32_16x16x32_bf16 v[188:191], a[64:67], v[32:35], v[188:191]
    v_mfma_f32_16x16x32_bf16 v[188:191], a[88:91], v[44:47], v[188:191]
    v_mfma_f32_16x16x32_bf16 v[68:71], a[64:67], v[36:39], v[68:71]
    v_mfma_f32_16x16x32_bf16 v[68:71], a[88:91], v[48:51], v[68:71]
    v_mfma_f32_16x16x32_bf16 v[168:171], a[68:71], v[28:31], v[168:171]
    v_mfma_f32_16x16x32_bf16 v[168:171], a[92:95], v[40:43], v[168:171]
    v_mfma_f32_16x16x32_bf16 v[192:195], a[68:71], v[32:35], v[192:195]
    v_mfma_f32_16x16x32_bf16 v[192:195], a[92:95], v[44:47], v[192:195]
    v_mfma_f32_16x16x32_bf16 v[72:75], a[68:71], v[36:39], v[72:75]
    v_mfma_f32_16x16x32_bf16 v[72:75], a[92:95], v[48:51], v[72:75]
    s_waitcnt lgkmcnt(0)
    v_mfma_f32_16x16x32_bf16 v[148:151], a[96:99], v[4:7], v[148:151]
    s_add_u32 s77, s78, 0
    s_add_u32 m0, s49, 0
    v_mfma_f32_16x16x32_bf16 v[148:151], a[120:123], v[16:19], v[148:151]
    buffer_load_dwordx4 v232, s[20:23], s77 offen nt lds
    v_mfma_f32_16x16x32_bf16 v[172:175], a[96:99], v[8:11], v[172:175]
    ds_read_b128 v[28:31], v230 offset:24832
    v_mfma_f32_16x16x32_bf16 v[172:175], a[120:123], v[20:23], v[172:175]
    v_mfma_f32_16x16x32_bf16 v[52:55], a[96:99], v[12:15], v[52:55]
    buffer_load_dwordx4 v233, s[20:23], s77 offen offset:1024 nt lds
    v_mfma_f32_16x16x32_bf16 v[52:55], a[120:123], v[24:27], v[52:55]
    v_mfma_f32_16x16x32_bf16 v[152:155], a[100:103], v[4:7], v[152:155]
    ds_read_b128 v[32:35], v230 offset:37120
    v_mfma_f32_16x16x32_bf16 v[152:155], a[124:127], v[16:19], v[152:155]
    buffer_load_dwordx4 v234, s[20:23], s77 offen offset:2048 nt lds
    v_mfma_f32_16x16x32_bf16 v[176:179], a[100:103], v[8:11], v[176:179]
    v_mfma_f32_16x16x32_bf16 v[176:179], a[124:127], v[20:23], v[176:179]
    v_mfma_f32_16x16x32_bf16 v[56:59], a[100:103], v[12:15], v[56:59]
    ds_read_b128 v[36:39], v242 offset:24832
    v_mfma_f32_16x16x32_bf16 v[56:59], a[124:127], v[24:27], v[56:59]
    v_mfma_f32_16x16x32_bf16 v[156:159], a[104:107], v[4:7], v[156:159]
    v_mfma_f32_16x16x32_bf16 v[156:159], a[128:131], v[16:19], v[156:159]
    v_mfma_f32_16x16x32_bf16 v[180:183], a[104:107], v[8:11], v[180:183]
    ds_read_b128 v[40:43], v231 offset:24832
    v_mfma_f32_16x16x32_bf16 v[180:183], a[128:131], v[20:23], v[180:183]
    v_mfma_f32_16x16x32_bf16 v[60:63], a[104:107], v[12:15], v[60:63]
    v_mfma_f32_16x16x32_bf16 v[60:63], a[128:131], v[24:27], v[60:63]
    v_mfma_f32_16x16x32_bf16 v[160:163], a[108:111], v[4:7], v[160:163]
    ds_read_b128 v[44:47], v231 offset:37120
    v_mfma_f32_16x16x32_bf16 v[160:163], a[132:135], v[16:19], v[160:163]
    v_mfma_f32_16x16x32_bf16 v[184:187], a[108:111], v[8:11], v[184:187]
    v_mfma_f32_16x16x32_bf16 v[184:187], a[132:135], v[20:23], v[184:187]
    v_mfma_f32_16x16x32_bf16 v[64:67], a[108:111], v[12:15], v[64:67]
    ds_read_b128 v[48:51], v243 offset:24832
    v_mfma_f32_16x16x32_bf16 v[64:67], a[132:135], v[24:27], v[64:67]
    v_mfma_f32_16x16x32_bf16 v[164:167], a[112:115], v[4:7], v[164:167]
    s_add_u32 s74, s78, 768
    s_add_u32 m0, s49, 12288
    v_mfma_f32_16x16x32_bf16 v[164:167], a[136:139], v[16:19], v[164:167]
    buffer_load_dwordx4 v232, s[20:23], s74 offen nt lds
    v_mfma_f32_16x16x32_bf16 v[188:191], a[112:115], v[8:11], v[188:191]
    v_mfma_f32_16x16x32_bf16 v[188:191], a[136:139], v[20:23], v[188:191]
    v_mfma_f32_16x16x32_bf16 v[68:71], a[112:115], v[12:15], v[68:71]
    buffer_load_dwordx4 v233, s[20:23], s74 offen offset:1024 nt lds
    v_mfma_f32_16x16x32_bf16 v[68:71], a[136:139], v[24:27], v[68:71]
    v_mfma_f32_16x16x32_bf16 v[168:171], a[116:119], v[4:7], v[168:171]
    v_mfma_f32_16x16x32_bf16 v[168:171], a[140:143], v[16:19], v[168:171]
    buffer_load_dwordx4 v234, s[20:23], s74 offen offset:2048 nt lds
    v_mfma_f32_16x16x32_bf16 v[192:195], a[116:119], v[8:11], v[192:195]
    v_mfma_f32_16x16x32_bf16 v[192:195], a[140:143], v[20:23], v[192:195]
    v_mfma_f32_16x16x32_bf16 v[72:75], a[116:119], v[12:15], v[72:75]
    v_mfma_f32_16x16x32_bf16 v[72:75], a[140:143], v[24:27], v[72:75]
    s_waitcnt lgkmcnt(0)
    v_mfma_f32_16x16x32_bf16 v[148:151], a[144:147], v[28:31], v[148:151]
    v_mfma_f32_16x16x32_bf16 v[148:151], a[168:171], v[40:43], v[148:151]
    v_mfma_f32_16x16x32_bf16 v[172:175], a[144:147], v[32:35], v[172:175]
    ds_read_b128 v[4:7], v228 offset:25088
    v_mfma_f32_16x16x32_bf16 v[172:175], a[168:171], v[44:47], v[172:175]
    v_mfma_f32_16x16x32_bf16 v[52:55], a[144:147], v[36:39], v[52:55]
    v_mfma_f32_16x16x32_bf16 v[52:55], a[168:171], v[48:51], v[52:55]
    v_mfma_f32_16x16x32_bf16 v[152:155], a[148:151], v[28:31], v[152:155]
    ds_read_b128 v[8:11], v228 offset:37376
    v_mfma_f32_16x16x32_bf16 v[152:155], a[172:175], v[40:43], v[152:155]
    v_mfma_f32_16x16x32_bf16 v[176:179], a[148:151], v[32:35], v[176:179]
    v_mfma_f32_16x16x32_bf16 v[176:179], a[172:175], v[44:47], v[176:179]
    v_mfma_f32_16x16x32_bf16 v[56:59], a[148:151], v[36:39], v[56:59]
    ds_read_b128 v[12:15], v240 offset:25088
    v_mfma_f32_16x16x32_bf16 v[56:59], a[172:175], v[48:51], v[56:59]
    v_mfma_f32_16x16x32_bf16 v[156:159], a[152:155], v[28:31], v[156:159]
    s_add_u32 s75, s84, 294912
    s_add_u32 m0, s49, 73728
    v_mfma_f32_16x16x32_bf16 v[156:159], a[176:179], v[40:43], v[156:159]
    buffer_load_dwordx4 v232, s[20:23], s75 offen nt lds
    v_mfma_f32_16x16x32_bf16 v[180:183], a[152:155], v[32:35], v[180:183]
    ds_read_b128 v[16:19], v229 offset:25088
    v_mfma_f32_16x16x32_bf16 v[180:183], a[176:179], v[44:47], v[180:183]
    v_mfma_f32_16x16x32_bf16 v[60:63], a[152:155], v[36:39], v[60:63]
    buffer_load_dwordx4 v233, s[20:23], s75 offen offset:1024 nt lds
    v_mfma_f32_16x16x32_bf16 v[60:63], a[176:179], v[48:51], v[60:63]
    v_mfma_f32_16x16x32_bf16 v[160:163], a[156:159], v[28:31], v[160:163]
    ds_read_b128 v[20:23], v229 offset:37376
    v_mfma_f32_16x16x32_bf16 v[160:163], a[180:183], v[40:43], v[160:163]
    buffer_load_dwordx4 v234, s[20:23], s75 offen offset:2048 nt lds
    v_mfma_f32_16x16x32_bf16 v[184:187], a[156:159], v[32:35], v[184:187]
    v_mfma_f32_16x16x32_bf16 v[184:187], a[180:183], v[44:47], v[184:187]
    v_mfma_f32_16x16x32_bf16 v[64:67], a[156:159], v[36:39], v[64:67]
    ds_read_b128 v[24:27], v241 offset:25088
    v_mfma_f32_16x16x32_bf16 v[64:67], a[180:183], v[48:51], v[64:67]
    v_mfma_f32_16x16x32_bf16 v[164:167], a[160:163], v[28:31], v[164:167]
    v_mfma_f32_16x16x32_bf16 v[164:167], a[184:187], v[40:43], v[164:167]
    v_mfma_f32_16x16x32_bf16 v[188:191], a[160:163], v[32:35], v[188:191]
    v_mfma_f32_16x16x32_bf16 v[188:191], a[184:187], v[44:47], v[188:191]
    v_mfma_f32_16x16x32_bf16 v[68:71], a[160:163], v[36:39], v[68:71]
    v_mfma_f32_16x16x32_bf16 v[68:71], a[184:187], v[48:51], v[68:71]
    v_mfma_f32_16x16x32_bf16 v[168:171], a[164:167], v[28:31], v[168:171]
    v_mfma_f32_16x16x32_bf16 v[168:171], a[188:191], v[40:43], v[168:171]
    v_mfma_f32_16x16x32_bf16 v[192:195], a[164:167], v[32:35], v[192:195]
    v_mfma_f32_16x16x32_bf16 v[192:195], a[188:191], v[44:47], v[192:195]
    v_mfma_f32_16x16x32_bf16 v[72:75], a[164:167], v[36:39], v[72:75]
    v_mfma_f32_16x16x32_bf16 v[72:75], a[188:191], v[48:51], v[72:75]
    s_waitcnt lgkmcnt(0)
    v_mfma_f32_16x16x32_bf16 v[148:151], a[192:195], v[4:7], v[148:151]
    s_add_u32 s76, s84, 295680
    s_add_u32 m0, s49, 86016
    s_load_dword s72, s[14:15], 0
    v_mfma_f32_16x16x32_bf16 v[148:151], a[216:219], v[16:19], v[148:151]
    buffer_load_dwordx4 v232, s[20:23], s76 offen nt lds
    v_mfma_f32_16x16x32_bf16 v[172:175], a[192:195], v[8:11], v[172:175]
    ds_read_b128 v[28:31], v230 offset:25088
    v_mfma_f32_16x16x32_bf16 v[172:175], a[216:219], v[20:23], v[172:175]
    v_mfma_f32_16x16x32_bf16 v[52:55], a[192:195], v[12:15], v[52:55]
    buffer_load_dwordx4 v233, s[20:23], s76 offen offset:1024 nt lds
    v_mfma_f32_16x16x32_bf16 v[52:55], a[216:219], v[24:27], v[52:55]
    v_mfma_f32_16x16x32_bf16 v[152:155], a[196:199], v[4:7], v[152:155]
    ds_read_b128 v[32:35], v230 offset:37376
    v_mfma_f32_16x16x32_bf16 v[152:155], a[220:223], v[16:19], v[152:155]
    buffer_load_dwordx4 v234, s[20:23], s76 offen offset:2048 nt lds
    v_mfma_f32_16x16x32_bf16 v[176:179], a[196:199], v[8:11], v[176:179]
    v_mfma_f32_16x16x32_bf16 v[176:179], a[220:223], v[20:23], v[176:179]
    v_mfma_f32_16x16x32_bf16 v[56:59], a[196:199], v[12:15], v[56:59]
    ds_read_b128 v[36:39], v242 offset:25088
    v_mfma_f32_16x16x32_bf16 v[56:59], a[220:223], v[24:27], v[56:59]
    v_mfma_f32_16x16x32_bf16 v[156:159], a[200:203], v[4:7], v[156:159]
    v_mfma_f32_16x16x32_bf16 v[156:159], a[224:227], v[16:19], v[156:159]
    v_mfma_f32_16x16x32_bf16 v[180:183], a[200:203], v[8:11], v[180:183]
    ds_read_b128 v[40:43], v231 offset:25088
    v_mfma_f32_16x16x32_bf16 v[180:183], a[224:227], v[20:23], v[180:183]
    v_mfma_f32_16x16x32_bf16 v[60:63], a[200:203], v[12:15], v[60:63]
    v_mfma_f32_16x16x32_bf16 v[60:63], a[224:227], v[24:27], v[60:63]
    v_mfma_f32_16x16x32_bf16 v[160:163], a[204:207], v[4:7], v[160:163]
    ds_read_b128 v[44:47], v231 offset:37376
    v_mfma_f32_16x16x32_bf16 v[160:163], a[228:231], v[16:19], v[160:163]
    v_mfma_f32_16x16x32_bf16 v[184:187], a[204:207], v[8:11], v[184:187]
    v_mfma_f32_16x16x32_bf16 v[184:187], a[228:231], v[20:23], v[184:187]
    v_mfma_f32_16x16x32_bf16 v[64:67], a[204:207], v[12:15], v[64:67]
    ds_read_b128 v[48:51], v243 offset:25088
    v_mfma_f32_16x16x32_bf16 v[64:67], a[228:231], v[24:27], v[64:67]
    v_mfma_f32_16x16x32_bf16 v[164:167], a[208:211], v[4:7], v[164:167]
    v_mfma_f32_16x16x32_bf16 v[164:167], a[232:235], v[16:19], v[164:167]
    v_mfma_f32_16x16x32_bf16 v[188:191], a[208:211], v[8:11], v[188:191]
    v_mfma_f32_16x16x32_bf16 v[188:191], a[232:235], v[20:23], v[188:191]
    v_mfma_f32_16x16x32_bf16 v[68:71], a[208:211], v[12:15], v[68:71]
    v_mfma_f32_16x16x32_bf16 v[68:71], a[232:235], v[24:27], v[68:71]
    v_mfma_f32_16x16x32_bf16 v[168:171], a[212:215], v[4:7], v[168:171]
    v_mfma_f32_16x16x32_bf16 v[168:171], a[236:239], v[16:19], v[168:171]
    v_mfma_f32_16x16x32_bf16 v[192:195], a[212:215], v[8:11], v[192:195]
    v_mfma_f32_16x16x32_bf16 v[192:195], a[236:239], v[20:23], v[192:195]
    v_mfma_f32_16x16x32_bf16 v[72:75], a[212:215], v[12:15], v[72:75]
    s_waitcnt lgkmcnt(0)
    s_cmp_ge_u32 s72, 24
    s_cbranch_scc0 L_nopfw
    s_mov_b32 exec_hi, 15
    buffer_load_dword v254, v253, s[40:43], 0 offen sc1
    s_mov_b64 exec, -1
L_nopfw:
    v_mfma_f32_16x16x32_bf16 v[72:75], a[236:239], v[24:27], v[72:75]
    s_waitcnt vmcnt(12) lgkmcnt(0)
    s_barrier
    v_mfma_f32_16x16x32_bf16 v[148:151], a[240:243], v[28:31], v[148:151]
    v_mfma_f32_16x16x32_bf16 v[148:151], v[204:207], v[40:43], v[148:151]
    v_mfma_f32_16x16x32_bf16 v[172:175], a[240:243], v[32:35], v[172:175]
    ds_read_b128 v[4:7], v240 offset:36864
    v_mfma_f32_16x16x32_bf16 v[172:175], v[204:207], v[44:47], v[172:175]
    v_mfma_f32_16x16x32_bf16 v[52:55], a[240:243], v[36:39], v[52:55]
    v_mfma_f32_16x16x32_bf16 v[52:55], v[204:207], v[48:51], v[52:55]
    v_mfma_f32_16x16x32_bf16 v[152:155], a[244:247], v[28:31], v[152:155]
    ds_read_b128 v[8:11], v240 offset:49152
    v_mfma_f32_16x16x32_bf16 v[152:155], v[208:211], v[40:43], v[152:155]
    v_mfma_f32_16x16x32_bf16 v[176:179], a[244:247], v[32:35], v[176:179]
    v_mfma_f32_16x16x32_bf16 v[176:179], v[208:211], v[44:47], v[176:179]
    v_mfma_f32_16x16x32_bf16 v[56:59], a[244:247], v[36:39], v[56:59]
    ds_read_b128 v[12:15], v240 offset:61440
    v_mfma_f32_16x16x32_bf16 v[56:59], v[208:211], v[48:51], v[56:59]
    v_mfma_f32_16x16x32_bf16 v[156:159], a[248:251], v[28:31], v[156:159]
    v_mfma_f32_16x16x32_bf16 v[156:159], v[212:215], v[40:43], v[156:159]
    v_mfma_f32_16x16x32_bf16 v[180:183], a[248:251], v[32:35], v[180:183]
    ds_read_b128 v[16:19], v241 offset:36864
    v_mfma_f32_16x16x32_bf16 v[180:183], v[212:215], v[44:47], v[180:183]
    v_mfma_f32_16x16x32_bf16 v[60:63], a[248:251], v[36:39], v[60:63]
    v_mfma_f32_16x16x32_bf16 v[60:63], v[212:215], v[48:51], v[60:63]
    v_mfma_f32_16x16x32_bf16 v[160:163], a[252:255], v[28:31], v[160:163]
    ds_read_b128 v[20:23], v241 offset:49152
    v_mfma_f32_16x16x32_bf16 v[160:163], v[216:219], v[40:43], v[160:163]
    v_mfma_f32_16x16x32_bf16 v[184:187], a[252:255], v[32:35], v[184:187]
    v_mfma_f32_16x16x32_bf16 v[184:187], v[216:219], v[44:47], v[184:187]
    v_mfma_f32_16x16x32_bf16 v[64:67], a[252:255], v[36:39], v[64:67]
    ds_read_b128 v[24:27], v241 offset:61440
    v_mfma_f32_16x16x32_bf16 v[64:67], v[216:219], v[48:51], v[64:67]
    v_mfma_f32_16x16x32_bf16 v[164:167], v[196:199], v[28:31], v[164:167]
    v_mfma_f32_16x16x32_bf16 v[164:167], v[220:223], v[40:43], v[164:167]
    v_mfma_f32_16x16x32_bf16 v[188:191], v[196:199], v[32:35], v[188:191]
    v_mfma_f32_16x16x32_bf16 v[188:191], v[220:223], v[44:47], v[188:191]
    v_mfma_f32_16x16x32_bf16 v[68:71], v[196:199], v[36:39], v[68:71]
    v_mfma_f32_16x16x32_bf16 v[68:71], v[220:223], v[48:51], v[68:71]
    v_mfma_f32_16x16x32_bf16 v[168:171], v[200:203], v[28:31], v[168:171]
    v_mfma_f32_16x16x32_bf16 v[168:171], v[224:227], v[40:43], v[168:171]
    v_mfma_f32_16x16x32_bf16 v[192:195], v[200:203], v[32:35], v[192:195]
    v_mfma_f32_16x16x32_bf16 v[192:195], v[224:227], v[44:47], v[192:195]
    v_mfma_f32_16x16x32_bf16 v[72:75], v[200:203], v[36:39], v[72:75]
    v_mfma_f32_16x16x32_bf16 v[72:75], v[224:227], v[48:51], v[72:75]
    s_branch L_p2done
L_pass2t:
    s_waitcnt lgkmcnt(0)
    v_cvt_pk_bf16_f32 v76, v148, v149
    v_cvt_pk_bf16_f32 v77, v150, v151
    v_mfma_f32_16x16x32_bf16 v[148:151], a[0:3], v[4:7], 0
    s_add_u32 s77, s2, 258
    s_and_b32 s77, s77, 255
    v_mfma_f32_16x16x32_bf16 v[148:151], a[24:27], v[16:19], v[148:151]
    v_cvt_pk_bf16_f32 v88, v172, v173
    v_cvt_pk_bf16_f32 v89, v174, v175
    s_add_u32 s77, s77, 1536
    s_mul_i32 s77, s77, 12288
    v_mfma_f32_16x16x32_bf16 v[172:175], a[0:3], v[8:11], 0
    ds_read_b128 v[28:31], v230 offset:24576
    s_add_u32 m0, s49, 110592
    v_mfma_f32_16x16x32_bf16 v[172:175], a[24:27], v[20:23], v[172:175]
    v_cvt_pk_bf16_f32 v100, v52, v53
    v_cvt_pk_bf16_f32 v101, v54, v55
    buffer_load_dwordx4 v244, s[24:27], s77 offen nt lds
    v_mfma_f32_16x16x32_bf16 v[52:55], a[0:3], v[12:15], 0
    v_mfma_f32_16x16x32_bf16 v[52:55], a[24:27], v[24:27], v[52:55]
    v_cvt_pk_bf16_f32 v78, v152, v153
    v_cvt_pk_bf16_f32 v79, v154, v155
    v_mfma_f32_16x16x32_bf16 v[152:155], a[4:7], v[4:7], 0
    ds_read_b128 v[32:35], v230 offset:36864
    buffer_load_dwordx4 v245, s[24:27], s77 offen offset:1024 nt lds
    v_mfma_f32_16x16x32_bf16 v[152:155], a[28:31], v[16:19], v[152:155]
    v_cvt_pk_bf16_f32 v90, v176, v177
    v_cvt_pk_bf16_f32 v91, v178, v179
    v_mfma_f32_16x16x32_bf16 v[176:179], a[4:7], v[8:11], 0
    v_mfma_f32_16x16x32_bf16 v[176:179], a[28:31], v[20:23], v[176:179]
    v_cvt_pk_bf16_f32 v102, v56, v57
    v_cvt_pk_bf16_f32 v103, v58, v59
    buffer_load_dwordx4 v246, s[24:27], s77 offen offset:2048 nt lds
    v_mfma_f32_16x16x32_bf16 v[56:59], a[4:7], v[12:15], 0
    ds_read_b128 v[36:39], v242 offset:24576
    v_mfma_f32_16x16x32_bf16 v[56:59], a[28:31], v[24:27], v[56:59]
    v_cvt_pk_bf16_f32 v80, v156, v157
    v_cvt_pk_bf16_f32 v81, v158, v159
    v_mfma_f32_16x16x32_bf16 v[156:159], a[8:11], v[4:7], 0
    v_mfma_f32_16x16x32_bf16 v[156:159], a[32:35], v[16:19], v[156:159]
    v_cvt_pk_bf16_f32 v92, v180, v181
    v_cvt_pk_bf16_f32 v93, v182, v183
    v_mfma_f32_16x16x32_bf16 v[180:183], a[8:11], v[8:11], 0
    ds_read_b128 v[40:43], v231 offset:24576
    v_mfma_f32_16x16x32_bf16 v[180:183], a[32:35], v[20:23], v[180:183]
    v_cvt_pk_bf16_f32 v104, v60, v61
    v_cvt_pk_bf16_f32 v105, v62, v63
    v_mfma_f32_16x16x32_bf16 v[60:63], a[8:11], v[12:15], 0
    v_mfma_f32_16x16x32_bf16 v[60:63], a[32:35], v[24:27], v[60:63]
    v_cvt_pk_bf16_f32 v82, v160, v161
    v_cvt_pk_bf16_f32 v83, v162, v163
    v_mfma_f32_16x16x32_bf16 v[160:163], a[12:15], v[4:7], 0
    ds_read_b128 v[44:47], v231 offset:36864
    v_mfma_f32_16x16x32_bf16 v[160:163], a[36:39], v[16:19], v[160:163]
    v_cvt_pk_bf16_f32 v94, v184, v185
    v_cvt_pk_bf16_f32 v95, v186, v187
    v_mfma_f32_16x16x32_bf16 v[184:187], a[12:15], v[8:11], 0
    s_add_u32 s74, s2, 301
    s_and_b32 s74, s74, 255
    v_mfma_f32_16x16x32_bf16 v[184:187], a[36:39], v[20:23], v[184:187]
    v_cvt_pk_bf16_f32 v106, v64, v65
    v_cvt_pk_bf16_f32 v107, v66, v67
    s_add_u32 s74, s74, 1792
    s_mul_i32 s74, s74, 12288
    v_mfma_f32_16x16x32_bf16 v[64:67], a[12:15], v[12:15], 0
    ds_read_b128 v[48:51], v243 offset:24576
    s_add_u32 m0, s49, 122880
    v_mfma_f32_16x16x32_bf16 v[64:67], a[36:39], v[24:27], v[64:67]
    v_cvt_pk_bf16_f32 v84, v164, v165
    v_cvt_pk_bf16_f32 v85, v166, v167
    buffer_load_dwordx4 v244, s[24:27], s74 offen nt lds
    v_mfma_f32_16x16x32_bf16 v[164:167], a[16:19], v[4:7], 0
    v_mfma_f32_16x16x32_bf16 v[164:167], a[40:43], v[16:19], v[164:167]
    v_cvt_pk_bf16_f32 v96, v188, v189
    v_cvt_pk_bf16_f32 v97, v190, v191
    v_mfma_f32_16x16x32_bf16 v[188:191], a[16:19], v[8:11], 0
    buffer_load_dwordx4 v245, s[24:27], s74 offen offset:1024 nt lds
    v_mfma_f32_16x16x32_bf16 v[188:191], a[40:43], v[20:23], v[188:191]
    v_cvt_pk_bf16_f32 v108, v68, v69
    v_cvt_pk_bf16_f32 v109, v70, v71
    v_mfma_f32_16x16x32_bf16 v[68:71], a[16:19], v[12:15], 0
    v_mfma_f32_16x16x32_bf16 v[68:71], a[40:43], v[24:27], v[68:71]
    v_cvt_pk_bf16_f32 v86, v168, v169
    v_cvt_pk_bf16_f32 v87, v170, v171
    buffer_load_dwordx4 v246, s[24:27], s74 offen offset:2048 nt lds
    v_mfma_f32_16x16x32_bf16 v[168:171], a[20:23], v[4:7], 0
    v_mfma_f32_16x16x32_bf16 v[168:171], a[44:47], v[16:19], v[168:171]
    v_cvt_pk_bf16_f32 v98, v192, v193
    v_cvt_pk_bf16_f32 v99, v194, v195
    v_mfma_f32_16x16x32_bf16 v[192:195], a[20:23], v[8:11], 0
    v_mfma_f32_16x16x32_bf16 v[192:195], a[44:47], v[20:23], v[192:195]
    v_cvt_pk_bf16_f32 v110, v72, v73
    v_cvt_pk_bf16_f32 v111, v74, v75
    v_mfma_f32_16x16x32_bf16 v[72:75], a[20:23], v[12:15], 0
    v_mfma_f32_16x16x32_bf16 v[72:75], a[44:47], v[24:27], v[72:75]
    s_waitcnt lgkmcnt(0)
    v_mfma_f32_16x16x32_bf16 v[148:151], a[48:51], v[28:31], v[148:151]
    v_mfma_f32_16x16x32_bf16 v[148:151], a[72:75], v[40:43], v[148:151]
    v_mfma_f32_16x16x32_bf16 v[172:175], a[48:51], v[32:35], v[172:175]
    ds_read_b128 v[4:7], v228 offset:24832
    v_mfma_f32_16x16x32_bf16 v[172:175], a[72:75], v[44:47], v[172:175]
    v_mfma_f32_16x16x32_bf16 v[52:55], a[48:51], v[36:39], v[52:55]
    s_add_u32 s75, s2, 344
    s_and_b32 s75, s75, 255
    v_mfma_f32_16x16x32_bf16 v[52:55], a[72:75], v[48:51], v[52:55]
    s_add_u32 s75, s75, 2048
    s_mul_i32 s75, s75, 12288
    v_mfma_f32_16x16x32_bf16 v[152:155], a[52:55], v[28:31], v[152:155]
    ds_read_b128 v[8:11], v228 offset:37120
    s_add_u32 m0, s49, 135168
    v_mfma_f32_16x16x32_bf16 v[152:155], a[76:79], v[40:43], v[152:155]
    buffer_load_dwordx4 v244, s[24:27], s75 offen nt lds
    v_mfma_f32_16x16x32_bf16 v[176:179], a[52:55], v[32:35], v[176:179]
    v_mfma_f32_16x16x32_bf16 v[176:179], a[76:79], v[44:47], v[176:179]
    v_mfma_f32_16x16x32_bf16 v[56:59], a[52:55], v[36:39], v[56:59]
    ds_read_b128 v[12:15], v240 offset:24832
    buffer_load_dwordx4 v245, s[24:27], s75 offen offset:1024 nt lds
    v_mfma_f32_16x16x32_bf16 v[56:59], a[76:79], v[48:51], v[56:59]
    v_mfma_f32_16x16x32_bf16 v[156:159], a[56:59], v[28:31], v[156:159]
    v_mfma_f32_16x16x32_bf16 v[156:159], a[80:83], v[40:43], v[156:159]
    buffer_load_dwordx4 v246, s[24:27], s75 offen offset:2048 nt lds
    v_mfma_f32_16x16x32_bf16 v[180:183], a[56:59], v[32:35], v[180:183]
    ds_read_b128 v[16:19], v229 offset:24832
    v_mfma_f32_16x16x32_bf16 v[180:183], a[80:83], v[44:47], v[180:183]
    v_mfma_f32_16x16x32_bf16 v[60:63], a[56:59], v[36:39], v[60:63]
    v_mfma_f32_16x16x32_bf16 v[60:63], a[80:83], v[48:51], v[60:63]
    v_mfma_f32_16x16x32_bf16 v[160:163], a[60:63], v[28:31], v[160:163]
    ds_read_b128 v[20:23], v229 offset:37120
    v_mfma_f32_16x16x32_bf16 v[160:163], a[84:87], v[40:43], v[160:163]
    v_mfma_f32_16x16x32_bf16 v[184:187], a[60:63], v[32:35], v[184:187]
    v_mfma_f32_16x16x32_bf16 v[184:187], a[84:87], v[44:47], v[184:187]
    v_mfma_f32_16x16x32_bf16 v[64:67], a[60:63], v[36:39], v[64:67]
    ds_read_b128 v[24:27], v241 offset:24832
    v_mfma_f32_16x16x32_bf16 v[64:67], a[84:87], v[48:51], v[64:67]
    v_mfma_f32_16x16x32_bf16 v[164:167], a[64:67], v[28:31], v[164:167]
    s_add_u32 s76, s78, 0
    s_add_u32 m0, s49, 0
    v_mfma_f32_16x16x32_bf16 v[164:167], a[88:91], v[40:43], v[164:167]
    buffer_load_dwordx4 v232, s[20:23], s76 offen nt lds
    v_mfma_f32_16x16x32_bf16 v[188:191], a[64:67], v[32:35], v[188:191]
    v_mfma_f32_16x16x32_bf16 v[188:191], a[88:91], v[44:47], v[188:191]
    v_mfma_f32_16x16x32_bf16 v[68:71], a[64:67], v[36:39], v[68:71]
    buffer_load_dwordx4 v233, s[20:23], s76 offen offset:1024 nt lds
    v_mfma_f32_16x16x32_bf16 v[68:71], a[88:91], v[48:51], v[68:71]
    v_mfma_f32_16x16x32_bf16 v[168:171], a[68:71], v[28:31], v[168:171]
    v_mfma_f32_16x16x32_bf16 v[168:171], a[92:95], v[40:43], v[168:171]
    buffer_load_dwordx4 v234, s[20:23], s76 offen offset:2048 nt lds
    v_mfma_f32_16x16x32_bf16 v[192:195], a[68:71], v[32:35], v[192:195]
    v_mfma_f32_16x16x32_bf16 v[192:195], a[92:95], v[44:47], v[192:195]
    v_mfma_f32_16x16x32_bf16 v[72:75], a[68:71], v[36:39], v[72:75]
    v_mfma_f32_16x16x32_bf16 v[72:75], a[92:95], v[48:51], v[72:75]
    s_waitcnt lgkmcnt(0)
    v_mfma_f32_16x16x32_bf16 v[148:151], a[96:99], v[4:7], v[148:151]
    v_mfma_f32_16x16x32_bf16 v[148:151], a[120:123], v[16:19], v[148:151]
    v_mfma_f32_16x16x32_bf16 v[172:175], a[96:99], v[8:11], v[172:175]
    ds_read_b128 v[28:31], v230 offset:24832
    v_mfma_f32_16x16x32_bf16 v[172:175], a[120:123], v[20:23], v[172:175]
    v_mfma_f32_16x16x32_bf16 v[52:55], a[96:99], v[12:15], v[52:55]
    v_mfma_f32_16x16x32_bf16 v[52:55], a[120:123], v[24:27], v[52:55]
    v_mfma_f32_16x16x32_bf16 v[152:155], a[100:103], v[4:7], v[152:155]
    ds_read_b128 v[32:35], v230 offset:37120
    v_mfma_f32_16x16x32_bf16 v[152:155], a[124:127], v[16:19], v[152:155]
    v_mfma_f32_16x16x32_bf16 v[176:179], a[100:103], v[8:11], v[176:179]
    s_add_u32 s77, s78, 768
    s_add_u32 m0, s49, 12288
    v_mfma_f32_16x16x32_bf16 v[176:179], a[124:127], v[20:23], v[176:179]
    buffer_load_dwordx4 v232, s[20:23], s77 offen nt lds
    v_mfma_f32_16x16x32_bf16 v[56:59], a[100:103], v[12:15], v[56:59]
    ds_read_b128 v[36:39], v242 offset:24832
    v_mfma_f32_16x16x32_bf16 v[56:59], a[124:127], v[24:27], v[56:59]
    v_mfma_f32_16x16x32_bf16 v[156:159], a[104:107], v[4:7], v[156:159]
    buffer_load_dwordx4 v233, s[20:23], s77 offen offset:1024 nt lds
    v_mfma_f32_16x16x32_bf16 v[156:159], a[128:131], v[16:19], v[156:159]
    v_mfma_f32_16x16x32_bf16 v[180:183], a[104:107], v[8:11], v[180:183]
    ds_read_b128 v[40:43], v231 offset:24832
    v_mfma_f32_16x16x32_bf16 v[180:183], a[128:131], v[20:23], v[180:183]
    buffer_load_dwordx4 v234, s[20:23], s77 offen offset:2048 nt lds
    v_mfma_f32_16x16x32_bf16 v[60:63], a[104:107], v[12:15], v[60:63]
    v_mfma_f32_16x16x32_bf16 v[60:63], a[128:131], v[24:27], v[60:63]
    v_mfma_f32_16x16x32_bf16 v[160:163], a[108:111], v[4:7], v[160:163]
    ds_read_b128 v[44:47], v231 offset:37120
    v_mfma_f32_16x16x32_bf16 v[160:163], a[132:135], v[16:19], v[160:163]
    v_mfma_f32_16x16x32_bf16 v[184:187], a[108:111], v[8:11], v[184:187]
    v_mfma_f32_16x16x32_bf16 v[184:187], a[132:135], v[20:23], v[184:187]
    v_mfma_f32_16x16x32_bf16 v[64:67], a[108:111], v[12:15], v[64:67]
    ds_read_b128 v[48:51], v243 offset:24832
    v_mfma_f32_16x16x32_bf16 v[64:67], a[132:135], v[24:27], v[64:67]
    v_mfma_f32_16x16x32_bf16 v[164:167], a[112:115], v[4:7], v[164:167]
    v_mfma_f32_16x16x32_bf16 v[164:167], a[136:139], v[16:19], v[164:167]
    v_mfma_f32_16x16x32_bf16 v[188:191], a[112:115], v[8:11], v[188:191]
    v_mfma_f32_16x16x32_bf16 v[188:191], a[136:139], v[20:23], v[188:191]
    v_mfma_f32_16x16x32_bf16 v[68:71], a[112:115], v[12:15], v[68:71]
    v_mfma_f32_16x16x32_bf16 v[68:71], a[136:139], v[24:27], v[68:71]
    v_mfma_f32_16x16x32_bf16 v[168:171], a[116:119], v[4:7], v[168:171]
    v_mfma_f32_16x16x32_bf16 v[168:171], a[140:143], v[16:19], v[168:171]
    v_mfma_f32_16x16x32_bf16 v[192:195], a[116:119], v[8:11], v[192:195]
    v_mfma_f32_16x16x32_bf16 v[192:195], a[140:143], v[20:23], v[192:195]
    v_mfma_f32_16x16x32_bf16 v[72:75], a[116:119], v[12:15], v[72:75]
    v_mfma_f32_16x16x32_bf16 v[72:75], a[140:143], v[24:27], v[72:75]
    s_waitcnt lgkmcnt(0)
    v_mfma_f32_16x16x32_bf16 v[148:151], a[144:147], v[28:31], v[148:151]
    v_mfma_f32_16x16x32_bf16 v[148:151], a[168:171], v[40:43], v[148:151]
    v_mfma_f32_16x16x32_bf16 v[172:175], a[144:147], v[32:35], v[172:175]
    ds_read_b128 v[4:7], v228 offset:25088
    v_mfma_f32_16x16x32_bf16 v[172:175], a[168:171], v[44:47], v[172:175]
    v_mfma_f32_16x16x32_bf16 v[52:55], a[144:147], v[36:39], v[52:55]
    v_mfma_f32_16x16x32_bf16 v[52:55], a[168:171], v[48:51], v[52:55]
    v_mfma_f32_16x16x32_bf16 v[152:155], a[148:151], v[28:31], v[152:155]
    ds_read_b128 v[8:11], v228 offset:37376
    v_mfma_f32_16x16x32_bf16 v[152:155], a[172:175], v[40:43], v[152:155]
    v_mfma_f32_16x16x32_bf16 v[176:179], a[148:151], v[32:35], v[176:179]
    v_mfma_f32_16x16x32_bf16 v[176:179], a[172:175], v[44:47], v[176:179]
    v_mfma_f32_16x16x32_bf16 v[56:59], a[148:151], v[36:39], v[56:59]
    ds_read_b128 v[12:15], v240 offset:25088
    v_mfma_f32_16x16x32_bf16 v[56:59], a[172:175], v[48:51], v[56:59]
    v_mfma_f32_16x16x32_bf16 v[156:159], a[152:155], v[28:31], v[156:159]
    v_mfma_f32_16x16x32_bf16 v[156:159], a[176:179], v[40:43], v[156:159]
    v_mfma_f32_16x16x32_bf16 v[180:183], a[152:155], v[32:35], v[180:183]
    ds_read_b128 v[16:19], v229 offset:25088
    v_mfma_f32_16x16x32_bf16 v[180:183], a[176:179], v[44:47], v[180:183]
    v_mfma_f32_16x16x32_bf16 v[60:63], a[152:155], v[36:39], v[60:63]
    v_mfma_f32_16x16x32_bf16 v[60:63], a[176:179], v[48:51], v[60:63]
    v_mfma_f32_16x16x32_bf16 v[160:163], a[156:159], v[28:31], v[160:163]
    ds_read_b128 v[20:23], v229 offset:37376
    v_mfma_f32_16x16x32_bf16 v[160:163], a[180:183], v[40:43], v[160:163]
    v_mfma_f32_16x16x32_bf16 v[184:187], a[156:159], v[32:35], v[184:187]
    v_mfma_f32_16x16x32_bf16 v[184:187], a[180:183], v[44:47], v[184:187]
    v_mfma_f32_16x16x32_bf16 v[64:67], a[156:159], v[36:39], v[64:67]
    ds_read_b128 v[24:27], v241 offset:25088
    v_mfma_f32_16x16x32_bf16 v[64:67], a[180:183], v[48:51], v[64:67]
    v_mfma_f32_16x16x32_bf16 v[164:167], a[160:163], v[28:31], v[164:167]
    v_mfma_f32_16x16x32_bf16 v[164:167], a[184:187], v[40:43], v[164:167]
    v_mfma_f32_16x16x32_bf16 v[188:191], a[160:163], v[32:35], v[188:191]
    v_mfma_f32_16x16x32_bf16 v[188:191], a[184:187], v[44:47], v[188:191]
    v_mfma_f32_16x16x32_bf16 v[68:71], a[160:163], v[36:39], v[68:71]
    v_mfma_f32_16x16x32_bf16 v[68:71], a[184:187], v[48:51], v[68:71]
    v_mfma_f32_16x16x32_bf16 v[168:171], a[164:167], v[28:31], v[168:171]
    v_mfma_f32_16x16x32_bf16 v[168:171], a[188:191], v[40:43], v[168:171]
    v_mfma_f32_16x16x32_bf16 v[192:195], a[164:167], v[32:35], v[192:195]
    v_mfma_f32_16x16x32_bf16 v[192:195], a[188:191], v[44:47], v[192:195]
    v_mfma_f32_16x16x32_bf16 v[72:75], a[164:167], v[36:39], v[72:75]
    v_mfma_f32_16x16x32_bf16 v[72:75], a[188:191], v[48:51], v[72:75]
    s_waitcnt lgkmcnt(0)
    v_mfma_f32_16x16x32_bf16 v[148:151], a[192:195], v[4:7], v[148:151]
    s_load_dword s72, s[14:15], 0
    v_mfma_f32_16x16x32_bf16 v[148:151], a[216:219], v[16:19], v[148:151]
    v_mfma_f32_16x16x32_bf16 v[172:175], a[192:195], v[8:11], v[172:175]
    ds_read_b128 v[28:31], v230 offset:25088
    v_mfma_f32_16x16x32_bf16 v[172:175], a[216:219], v[20:23], v[172:175]
    v_mfma_f32_16x16x32_bf16 v[52:55], a[192:195], v[12:15], v[52:55]
    v_mfma_f32_16x16x32_bf16 v[52:55], a[216:219], v[24:27], v[52:55]
    v_mfma_f32_16x16x32_bf16 v[152:155], a[196:199], v[4:7], v[152:155]
    ds_read_b128 v[32:35], v230 offset:37376
    v_mfma_f32_16x16x32_bf16 v[152:155], a[220:223], v[16:19], v[152:155]
    v_mfma_f32_16x16x32_bf16 v[176:179], a[196:199], v[8:11], v[176:179]
    v_mfma_f32_16x16x32_bf16 v[176:179], a[220:223], v[20:23], v[176:179]
    v_mfma_f32_16x16x32_bf16 v[56:59], a[196:199], v[12:15], v[56:59]
    ds_read_b128 v[36:39], v242 offset:25088
    v_mfma_f32_16x16x32_bf16 v[56:59], a[220:223], v[24:27], v[56:59]
    v_mfma_f32_16x16x32_bf16 v[156:159], a[200:203], v[4:7], v[156:159]
    v_mfma_f32_16x16x32_bf16 v[156:159], a[224:227], v[16:19], v[156:159]
    v_mfma_f32_16x16x32_bf16 v[180:183], a[200:203], v[8:11], v[180:183]
    ds_read_b128 v[40:43], v231 offset:25088
    v_mfma_f32_16x16x32_bf16 v[180:183], a[224:227], v[20:23], v[180:183]
    v_mfma_f32_16x16x32_bf16 v[60:63], a[200:203], v[12:15], v[60:63]
    v_mfma_f32_16x16x32_bf16 v[60:63], a[224:227], v[24:27], v[60:63]
    v_mfma_f32_16x16x32_bf16 v[160:163], a[204:207], v[4:7], v[160:163]
    ds_read_b128 v[44:47], v231 offset:37376
    v_mfma_f32_16x16x32_bf16 v[160:163], a[228:231], v[16:19], v[160:163]
    v_mfma_f32_16x16x32_bf16 v[184:187], a[204:207], v[8:11], v[184:187]
    v_mfma_f32_16x16x32_bf16 v[184:187], a[228:231], v[20:23], v[184:187]
    v_mfma_f32_16x16x32_bf16 v[64:67], a[204:207], v[12:15], v[64:67]
    ds_read_b128 v[48:51], v243 offset:25088
    v_mfma_f32_16x16x32_bf16 v[64:67], a[228:231], v[24:27], v[64:67]
    v_mfma_f32_16x16x32_bf16 v[164:167], a[208:211], v[4:7], v[164:167]
    v_mfma_f32_16x16x32_bf16 v[164:167], a[232:235], v[16:19], v[164:167]
    v_mfma_f32_16x16x32_bf16 v[188:191], a[208:211], v[8:11], v[188:191]
    v_mfma_f32_16x16x32_bf16 v[188:191], a[232:235], v[20:23], v[188:191]
    v_mfma_f32_16x16x32_bf16 v[68:71], a[208:211], v[12:15], v[68:71]
    v_mfma_f32_16x16x32_bf16 v[68:71], a[232:235], v[24:27], v[68:71]
    v_mfma_f32_16x16x32_bf16 v[168:171], a[212:215], v[4:7], v[168:171]
    v_mfma_f32_16x16x32_bf16 v[168:171], a[236:239], v[16:19], v[168:171]
    v_mfma_f32_16x16x32_bf16 v[192:195], a[212:215], v[8:11], v[192:195]
    v_mfma_f32_16x16x32_bf16 v[192:195], a[236:239], v[20:23], v[192:195]
    v_mfma_f32_16x16x32_bf16 v[72:75], a[212:215], v[12:15], v[72:75]
    s_waitcnt lgkmcnt(0)
    s_cmp_ge_u32 s72, 24
    s_cbranch_scc0 L_nopft
    s_mov_b32 exec_hi, 15
    buffer_load_dword v254, v253, s[40:43], 0 offen sc1
    s_mov_b64 exec, -1
L_nopft:
    v_mfma_f32_16x16x32_bf16 v[72:75], a[236:239], v[24:27], v[72:75]
    s_waitcnt vmcnt(6) lgkmcnt(0)
    s_barrier
    v_mfma_f32_16x16x32_bf16 v[148:151], a[240:243], v[28:31], v[148:151]
    v_mfma_f32_16x16x32_bf16 v[148:151], v[204:207], v[40:43], v[148:151]
    v_mfma_f32_16x16x32_bf16 v[172:175], a[240:243], v[32:35], v[172:175]
    ds_read_b128 v[4:7], v240 offset:36864
    v_mfma_f32_16x16x32_bf16 v[172:175], v[204:207], v[44:47], v[172:175]
    v_mfma_f32_16x16x32_bf16 v[52:55], a[240:243], v[36:39], v[52:55]
    v_mfma_f32_16x16x32_bf16 v[52:55], v[204:207], v[48:51], v[52:55]
    v_mfma_f32_16x16x32_bf16 v[152:155], a[244:247], v[28:31], v[152:155]
    ds_read_b128 v[8:11], v240 offset:49152
    v_mfma_f32_16x16x32_bf16 v[152:155], v[208:211], v[40:43], v[152:155]
    v_mfma_f32_16x16x32_bf16 v[176:179], a[244:247], v[32:35], v[176:179]
    v_mfma_f32_16x16x32_bf16 v[176:179], v[208:211], v[44:47], v[176:179]
    v_mfma_f32_16x16x32_bf16 v[56:59], a[244:247], v[36:39], v[56:59]
    ds_read_b128 v[12:15], v240 offset:61440
    v_mfma_f32_16x16x32_bf16 v[56:59], v[208:211], v[48:51], v[56:59]
    v_mfma_f32_16x16x32_bf16 v[156:159], a[248:251], v[28:31], v[156:159]
    v_mfma_f32_16x16x32_bf16 v[156:159], v[212:215], v[40:43], v[156:159]
    v_mfma_f32_16x16x32_bf16 v[180:183], a[248:251], v[32:35], v[180:183]
    ds_read_b128 v[16:19], v241 offset:36864
    v_mfma_f32_16x16x32_bf16 v[180:183], v[212:215], v[44:47], v[180:183]
    v_mfma_f32_16x16x32_bf16 v[60:63], a[248:251], v[36:39], v[60:63]
    v_mfma_f32_16x16x32_bf16 v[60:63], v[212:215], v[48:51], v[60:63]
    v_mfma_f32_16x16x32_bf16 v[160:163], a[252:255], v[28:31], v[160:163]
    ds_read_b128 v[20:23], v241 offset:49152
    v_mfma_f32_16x16x32_bf16 v[160:163], v[216:219], v[40:43], v[160:163]
    v_mfma_f32_16x16x32_bf16 v[184:187], a[252:255], v[32:35], v[184:187]
    v_mfma_f32_16x16x32_bf16 v[184:187], v[216:219], v[44:47], v[184:187]
    v_mfma_f32_16x16x32_bf16 v[64:67], a[252:255], v[36:39], v[64:67]
    ds_read_b128 v[24:27], v241 offset:61440
    v_mfma_f32_16x16x32_bf16 v[64:67], v[216:219], v[48:51], v[64:67]
    v_mfma_f32_16x16x32_bf16 v[164:167], v[196:199], v[28:31], v[164:167]
    v_mfma_f32_16x16x32_bf16 v[164:167], v[220:223], v[40:43], v[164:167]
    v_mfma_f32_16x16x32_bf16 v[188:191], v[196:199], v[32:35], v[188:191]
    v_mfma_f32_16x16x32_bf16 v[188:191], v[220:223], v[44:47], v[188:191]
    v_mfma_f32_16x16x32_bf16 v[68:71], v[196:199], v[36:39], v[68:71]
    v_mfma_f32_16x16x32_bf16 v[68:71], v[220:223], v[48:51], v[68:71]
    v_mfma_f32_16x16x32_bf16 v[168:171], v[200:203], v[28:31], v[168:171]
    v_mfma_f32_16x16x32_bf16 v[168:171], v[224:227], v[40:43], v[168:171]
    v_mfma_f32_16x16x32_bf16 v[192:195], v[200:203], v[32:35], v[192:195]
    v_mfma_f32_16x16x32_bf16 v[192:195], v[224:227], v[44:47], v[192:195]
    v_mfma_f32_16x16x32_bf16 v[72:75], v[200:203], v[36:39], v[72:75]
    v_mfma_f32_16x16x32_bf16 v[72:75], v[224:227], v[48:51], v[72:75]
L_p2done:
    s_cmp_ge_u32 s72, 24
    s_cbranch_scc0 L_poll
L_ready:
    s_waitcnt lgkmcnt(0)
    v_cvt_pk_bf16_f32 v112, v148, v149
    v_cvt_pk_bf16_f32 v113, v150, v151
    v_mfma_f32_16x16x32_bf16 v[148:151], a[0:3], v[4:7], 0
    v_mfma_f32_16x16x32_bf16 v[148:151], a[24:27], v[16:19], v[148:151]
    v_cvt_pk_bf16_f32 v124, v172, v173
    v_cvt_pk_bf16_f32 v125, v174, v175
    v_mfma_f32_16x16x32_bf16 v[172:175], a[0:3], v[8:11], 0
    ds_read_b128 v[28:31], v242 offset:36864
    s_mov_b32 s74, 0
    v_mfma_f32_16x16x32_bf16 v[172:175], a[24:27], v[20:23], v[172:175]
    v_cvt_pk_bf16_f32 v136, v52, v53
    v_cvt_pk_bf16_f32 v137, v54, v55
    v_mfma_f32_16x16x32_bf16 v[52:55], a[0:3], v[12:15], 0
    buffer_load_dwordx4 a[0:3], v252, s[40:43], s74 offen sc1
    v_mfma_f32_16x16x32_bf16 v[52:55], a[24:27], v[24:27], v[52:55]
    v_cvt_pk_bf16_f32 v114, v152, v153
    v_cvt_pk_bf16_f32 v115, v154, v155
    v_mfma_f32_16x16x32_bf16 v[152:155], a[4:7], v[4:7], 0
    ds_read_b128 v[32:35], v242 offset:49152
    v_mfma_f32_16x16x32_bf16 v[152:155], a[28:31], v[16:19], v[152:155]
    v_cvt_pk_bf16_f32 v126, v176, v177
    v_cvt_pk_bf16_f32 v127, v178, v179
    buffer_load_dwordx4 a[24:27], v252, s[40:43], s74 offen offset:1024 sc1
    v_mfma_f32_16x16x32_bf16 v[176:179], a[4:7], v[8:11], 0
    v_mfma_f32_16x16x32_bf16 v[176:179], a[28:31], v[20:23], v[176:179]
    v_cvt_pk_bf16_f32 v138, v56, v57
    v_cvt_pk_bf16_f32 v139, v58, v59
    v_mfma_f32_16x16x32_bf16 v[56:59], a[4:7], v[12:15], 0
    ds_read_b128 v[36:39], v242 offset:61440
    buffer_load_dwordx4 a[4:7], v252, s[40:43], s74 offen offset:2048 sc1
    v_mfma_f32_16x16x32_bf16 v[56:59], a[28:31], v[24:27], v[56:59]
    v_cvt_pk_bf16_f32 v116, v156, v157
    v_cvt_pk_bf16_f32 v117, v158, v159
    v_mfma_f32_16x16x32_bf16 v[156:159], a[8:11], v[4:7], 0
    v_mfma_f32_16x16x32_bf16 v[156:159], a[32:35], v[16:19], v[156:159]
    v_cvt_pk_bf16_f32 v128, v180, v181
    v_cvt_pk_bf16_f32 v129, v182, v183
    buffer_load_dwordx4 a[28:31], v252, s[40:43], s74 offen offset:3072 sc1
    v_mfma_f32_16x16x32_bf16 v[180:183], a[8:11], v[8:11], 0
    ds_read_b128 v[40:43], v243 offset:36864
    s_mov_b32 s75, 4096
    v_mfma_f32_16x16x32_bf16 v[180:183], a[32:35], v[20:23], v[180:183]
    v_cvt_pk_bf16_f32 v140, v60, v61
    v_cvt_pk_bf16_f32 v141, v62, v63
    v_mfma_f32_16x16x32_bf16 v[60:63], a[8:11], v[12:15], 0
    buffer_load_dwordx4 a[8:11], v252, s[40:43], s75 offen sc1
    v_mfma_f32_16x16x32_bf16 v[60:63], a[32:35], v[24:27], v[60:63]
    v_cvt_pk_bf16_f32 v118, v160, v161
    v_cvt_pk_bf16_f32 v119, v162, v163
    v_mfma_f32_16x16x32_bf16 v[160:163], a[12:15], v[4:7], 0
    ds_read_b128 v[44:47], v243 offset:49152
    v_mfma_f32_16x16x32_bf16 v[160:163], a[36:39], v[16:19], v[160:163]
    v_cvt_pk_bf16_f32 v130, v184, v185
    v_cvt_pk_bf16_f32 v131, v186, v187
    buffer_load_dwordx4 a[32:35], v252, s[40:43], s75 offen offset:1024 sc1
    v_mfma_f32_16x16x32_bf16 v[184:187], a[12:15], v[8:11], 0
    v_mfma_f32_16x16x32_bf16 v[184:187], a[36:39], v[20:23], v[184:187]
    v_cvt_pk_bf16_f32 v142, v64, v65
    v_cvt_pk_bf16_f32 v143, v66, v67
    v_mfma_f32_16x16x32_bf16 v[64:67], a[12:15], v[12:15], 0
    ds_read_b128 v[48:51], v243 offset:61440
    buffer_load_dwordx4 a[12:15], v252, s[40:43], s75 offen offset:2048 sc1
    v_mfma_f32_16x16x32_bf16 v[64:67], a[36:39], v[24:27], v[64:67]
    v_cvt_pk_bf16_f32 v120, v164, v165
    v_cvt_pk_bf16_f32 v121, v166, v167
    v_mfma_f32_16x16x32_bf16 v[164:167], a[16:19], v[4:7], 0
    v_mfma_f32_16x16x32_bf16 v[164:167], a[40:43], v[16:19], v[164:167]
    v_cvt_pk_bf16_f32 v132, v188, v189
    v_cvt_pk_bf16_f32 v133, v190, v191
    buffer_load_dwordx4 a[36:39], v252, s[40:43], s75 offen offset:3072 sc1
    v_mfma_f32_16x16x32_bf16 v[188:191], a[16:19], v[8:11], 0
    s_mov_b32 s76, 8192
    v_mfma_f32_16x16x32_bf16 v[188:191], a[40:43], v[20:23], v[188:191]
    v_cvt_pk_bf16_f32 v144, v68, v69
    v_cvt_pk_bf16_f32 v145, v70, v71
    v_mfma_f32_16x16x32_bf16 v[68:71], a[16:19], v[12:15], 0
    buffer_load_dwordx4 a[16:19], v252, s[40:43], s76 offen sc1
    v_mfma_f32_16x16x32_bf16 v[68:71], a[40:43], v[24:27], v[68:71]
    v_cvt_pk_bf16_f32 v122, v168, v169
    v_cvt_pk_bf16_f32 v123, v170, v171
    v_mfma_f32_16x16x32_bf16 v[168:171], a[20:23], v[4:7], 0
    v_mfma_f32_16x16x32_bf16 v[168:171], a[44:47], v[16:19], v[168:171]
    v_cvt_pk_bf16_f32 v134, v192, v193
    v_cvt_pk_bf16_f32 v135, v194, v195
    buffer_load_dwordx4 a[40:43], v252, s[40:43], s76 offen offset:1024 sc1
    v_mfma_f32_16x16x32_bf16 v[192:195], a[20:23], v[8:11], 0
    v_mfma_f32_16x16x32_bf16 v[192:195], a[44:47], v[20:23], v[192:195]
    v_cvt_pk_bf16_f32 v146, v72, v73
    v_cvt_pk_bf16_f32 v147, v74, v75
    v_mfma_f32_16x16x32_bf16 v[72:75], a[20:23], v[12:15], 0
    buffer_load_dwordx4 a[20:23], v252, s[40:43], s76 offen offset:2048 sc1
    v_mfma_f32_16x16x32_bf16 v[72:75], a[44:47], v[24:27], v[72:75]
    s_waitcnt lgkmcnt(0)
    v_mfma_f32_16x16x32_bf16 v[148:151], a[48:51], v[28:31], v[148:151]
    v_mfma_f32_16x16x32_bf16 v[148:151], a[72:75], v[40:43], v[148:151]
    buffer_load_dwordx4 a[44:47], v252, s[40:43], s76 offen offset:3072 sc1
    v_mfma_f32_16x16x32_bf16 v[172:175], a[48:51], v[32:35], v[172:175]
    ds_read_b128 v[4:7], v240 offset:37120
    s_mov_b32 s77, 12288
    v_mfma_f32_16x16x32_bf16 v[172:175], a[72:75], v[44:47], v[172:175]
    v_mfma_f32_16x16x32_bf16 v[52:55], a[48:51], v[36:39], v[52:55]
    buffer_load_dwordx4 a[48:51], v252, s[40:43], s77 offen sc1
    v_mfma_f32_16x16x32_bf16 v[52:55], a[72:75], v[48:51], v[52:55]
    v_mfma_f32_16x16x32_bf16 v[152:155], a[52:55], v[28:31], v[152:155]
    ds_read_b128 v[8:11], v240 offset:49408
    v_mfma_f32_16x16x32_bf16 v[152:155], a[76:79], v[40:43], v[152:155]
    buffer_load_dwordx4 a[72:75], v252, s[40:43], s77 offen offset:1024 sc1
    v_mfma_f32_16x16x32_bf16 v[176:179], a[52:55], v[32:35], v[176:179]
    v_mfma_f32_16x16x32_bf16 v[176:179], a[76:79], v[44:47], v[176:179]
    v_mfma_f32_16x16x32_bf16 v[56:59], a[52:55], v[36:39], v[56:59]
    ds_read_b128 v[12:15], v240 offset:61696
    buffer_load_dwordx4 a[52:55], v252, s[40:43], s77 offen offset:2048 sc1
    v_mfma_f32_16x16x32_bf16 v[56:59], a[76:79], v[48:51], v[56:59]
    v_mfma_f32_16x16x32_bf16 v[156:159], a[56:59], v[28:31], v[156:159]
    v_mfma_f32_16x16x32_bf16 v[156:159], a[80:83], v[40:43], v[156:159]
    buffer_load_dwordx4 a[76:79], v252, s[40:43], s77 offen offset:3072 sc1
    v_mfma_f32_16x16x32_bf16 v[180:183], a[56:59], v[32:35], v[180:183]
    ds_read_b128 v[16:19], v241 offset:37120
    s_mov_b32 s74, 16384
    v_mfma_f32_16x16x32_bf16 v[180:183], a[80:83], v[44:47], v[180:183]
    v_mfma_f32_16x16x32_bf16 v[60:63], a[56:59], v[36:39], v[60:63]
    buffer_load_dwordx4 a[56:59], v252, s[40:43], s74 offen sc1
    v_mfma_f32_16x16x32_bf16 v[60:63], a[80:83], v[48:51], v[60:63]
    v_mfma_f32_16x16x32_bf16 v[160:163], a[60:63], v[28:31], v[160:163]
    ds_read_b128 v[20:23], v241 offset:49408
    v_mfma_f32_16x16x32_bf16 v[160:163], a[84:87], v[40:43], v[160:163]
    buffer_load_dwordx4 a[80:83], v252, s[40:43], s74 offen offset:1024 sc1
    v_mfma_f32_16x16x32_bf16 v[184:187], a[60:63], v[32:35], v[184:187]
    v_mfma_f32_16x16x32_bf16 v[184:187], a[84:87], v[44:47], v[184:187]
    v_mfma_f32_16x16x32_bf16 v[64:67], a[60:63], v[36:39], v[64:67]
    ds_read_b128 v[24:27], v241 offset:61696
    buffer_load_dwordx4 a[60:63], v252, s[40:43], s74 offen offset:2048 sc1
    v_mfma_f32_16x16x32_bf16 v[64:67], a[84:87], v[48:51], v[64:67]
    v_mfma_f32_16x16x32_bf16 v[164:167], a[64:67], v[28:31], v[164:167]
    v_mfma_f32_16x16x32_bf16 v[164:167], a[88:91], v[40:43], v[164:167]
    buffer_load_dwordx4 a[84:87], v252, s[40:43], s74 offen offset:3072 sc1
    v_mfma_f32_16x16x32_bf16 v[188:191], a[64:67], v[32:35], v[188:191]
    s_mov_b32 s75, 20480
    v_mfma_f32_16x16x32_bf16 v[188:191], a[88:91], v[44:47], v[188:191]
    v_mfma_f32_16x16x32_bf16 v[68:71], a[64:67], v[36:39], v[68:71]
    buffer_load_dwordx4 a[64:67], v252, s[40:43], s75 offen sc1
    v_mfma_f32_16x16x32_bf16 v[68:71], a[88:91], v[48:51], v[68:71]
    v_mfma_f32_16x16x32_bf16 v[168:171], a[68:71], v[28:31], v[168:171]
    v_mfma_f32_16x16x32_bf16 v[168:171], a[92:95], v[40:43], v[168:171]
    buffer_load_dwordx4 a[88:91], v252, s[40:43], s75 offen offset:1024 sc1
    v_mfma_f32_16x16x32_bf16 v[192:195], a[68:71], v[32:35], v[192:195]
    v_mfma_f32_16x16x32_bf16 v[192:195], a[92:95], v[44:47], v[192:195]
    v_mfma_f32_16x16x32_bf16 v[72:75], a[68:71], v[36:39], v[72:75]
    buffer_load_dwordx4 a[68:71], v252, s[40:43], s75 offen offset:2048 sc1
    v_mfma_f32_16x16x32_bf16 v[72:75], a[92:95], v[48:51], v[72:75]
    s_waitcnt lgkmcnt(0)
    v_mfma_f32_16x16x32_bf16 v[148:151], a[96:99], v[4:7], v[148:151]
    v_mfma_f32_16x16x32_bf16 v[148:151], a[120:123], v[16:19], v[148:151]
    buffer_load_dwordx4 a[92:95], v252, s[40:43], s75 offen offset:3072 sc1
    v_mfma_f32_16x16x32_bf16 v[172:175], a[96:99], v[8:11], v[172:175]
    ds_read_b128 v[28:31], v242 offset:37120
    s_mov_b32 s76, 24576
    v_mfma_f32_16x16x32_bf16 v[172:175], a[120:123], v[20:23], v[172:175]
    v_mfma_f32_16x16x32_bf16 v[52:55], a[96:99], v[12:15], v[52:55]
    buffer_load_dwordx4 a[96:99], v252, s[40:43], s76 offen sc1
    v_mfma_f32_16x16x32_bf16 v[52:55], a[120:123], v[24:27], v[52:55]
    v_mfma_f32_16x16x32_bf16 v[152:155], a[100:103], v[4:7], v[152:155]
    ds_read_b128 v[32:35], v242 offset:49408
    v_mfma_f32_16x16x32_bf16 v[152:155], a[124:127], v[16:19], v[152:155]
    buffer_load_dwordx4 a[120:123], v252, s[40:43], s76 offen offset:1024 sc1
    v_mfma_f32_16x16x32_bf16 v[176:179], a[100:103], v[8:11], v[176:179]
    v_mfma_f32_16x16x32_bf16 v[176:179], a[124:127], v[20:23], v[176:179]
    v_mfma_f32_16x16x32_bf16 v[56:59], a[100:103], v[12:15], v[56:59]
    ds_read_b128 v[36:39], v242 offset:61696
    buffer_load_dwordx4 a[100:103], v252, s[40:43], s76 offen offset:2048 sc1
    v_mfma_f32_16x16x32_bf16 v[56:59], a[124:127], v[24:27], v[56:59]
    v_mfma_f32_16x16x32_bf16 v[156:159], a[104:107], v[4:7], v[156:159]
    v_mfma_f32_16x16x32_bf16 v[156:159], a[128:131], v[16:19], v[156:159]
    buffer_load_dwordx4 a[124:127], v252, s[40:43], s76 offen offset:3072 sc1
    v_mfma_f32_16x16x32_bf16 v[180:183], a[104:107], v[8:11], v[180:183]
    ds_read_b128 v[40:43], v243 offset:37120
    s_mov_b32 s77, 28672
    v_mfma_f32_16x16x32_bf16 v[180:183], a[128:131], v[20:23], v[180:183]
    v_mfma_f32_16x16x32_bf16 v[60:63], a[104:107], v[12:15], v[60:63]
    buffer_load_dwordx4 a[104:107], v252, s[40:43], s77 offen sc1
    v_mfma_f32_16x16x32_bf16 v[60:63], a[128:131], v[24:27], v[60:63]
    v_mfma_f32_16x16x32_bf16 v[160:163], a[108:111], v[4:7], v[160:163]
    ds_read_b128 v[44:47], v243 offset:49408
    v_mfma_f32_16x16x32_bf16 v[160:163], a[132:135], v[16:19], v[160:163]
    buffer_load_dwordx4 a[128:131], v252, s[40:43], s77 offen offset:1024 sc1
    v_mfma_f32_16x16x32_bf16 v[184:187], a[108:111], v[8:11], v[184:187]
    v_mfma_f32_16x16x32_bf16 v[184:187], a[132:135], v[20:23], v[184:187]
    v_mfma_f32_16x16x32_bf16 v[64:67], a[108:111], v[12:15], v[64:67]
    ds_read_b128 v[48:51], v243 offset:61696
    buffer_load_dwordx4 a[108:111], v252, s[40:43], s77 offen offset:2048 sc1
    v_mfma_f32_16x16x32_bf16 v[64:67], a[132:135], v[24:27], v[64:67]
    v_mfma_f32_16x16x32_bf16 v[164:167], a[112:115], v[4:7], v[164:167]
    v_mfma_f32_16x16x32_bf16 v[164:167], a[136:139], v[16:19], v[164:167]
    buffer_load_dwordx4 a[132:135], v252, s[40:43], s77 offen offset:3072 sc1
    v_mfma_f32_16x16x32_bf16 v[188:191], a[112:115], v[8:11], v[188:191]
    s_mov_b32 s74, 32768
    v_mfma_f32_16x16x32_bf16 v[188:191], a[136:139], v[20:23], v[188:191]
    v_mfma_f32_16x16x32_bf16 v[68:71], a[112:115], v[12:15], v[68:71]
    buffer_load_dwordx4 a[112:115], v252, s[40:43], s74 offen sc1
    v_mfma_f32_16x16x32_bf16 v[68:71], a[136:139], v[24:27], v[68:71]
    v_mfma_f32_16x16x32_bf16 v[168:171], a[116:119], v[4:7], v[168:171]
    v_mfma_f32_16x16x32_bf16 v[168:171], a[140:143], v[16:19], v[168:171]
    buffer_load_dwordx4 a[136:139], v252, s[40:43], s74 offen offset:1024 sc1
    v_mfma_f32_16x16x32_bf16 v[192:195], a[116:119], v[8:11], v[192:195]
    v_mfma_f32_16x16x32_bf16 v[192:195], a[140:143], v[20:23], v[192:195]
    v_mfma_f32_16x16x32_bf16 v[72:75], a[116:119], v[12:15], v[72:75]
    buffer_load_dwordx4 a[116:119], v252, s[40:43], s74 offen offset:2048 sc1
    v_mfma_f32_16x16x32_bf16 v[72:75], a[140:143], v[24:27], v[72:75]
    s_waitcnt lgkmcnt(0)
    v_mfma_f32_16x16x32_bf16 v[148:151], a[144:147], v[28:31], v[148:151]
    v_mfma_f32_16x16x32_bf16 v[148:151], a[168:171], v[40:43], v[148:151]
    buffer_load_dwordx4 a[140:143], v252, s[40:43], s74 offen offset:3072 sc1
    v_mfma_f32_16x16x32_bf16 v[172:175], a[144:147], v[32:35], v[172:175]
    ds_read_b128 v[4:7], v240 offset:37376
    s_mov_b32 s75, 36864
    v_mfma_f32_16x16x32_bf16 v[172:175], a[168:171], v[44:47], v[172:175]
    v_mfma_f32_16x16x32_bf16 v[52:55], a[144:147], v[36:39], v[52:55]
    buffer_load_dwordx4 a[144:147], v252, s[40:43], s75 offen sc1
    v_mfma_f32_16x16x32_bf16 v[52:55], a[168:171], v[48:51], v[52:55]
    v_mfma_f32_16x16x32_bf16 v[152:155], a[148:151], v[28:31], v[152:155]
    ds_read_b128 v[8:11], v240 offset:49664
    v_mfma_f32_16x16x32_bf16 v[152:155], a[172:175], v[40:43], v[152:155]
    buffer_load_dwordx4 a[168:171], v252, s[40:43], s75 offen offset:1024 sc1
    v_mfma_f32_16x16x32_bf16 v[176:179], a[148:151], v[32:35], v[176:179]
    v_mfma_f32_16x16x32_bf16 v[176:179], a[172:175], v[44:47], v[176:179]
    v_mfma_f32_16x16x32_bf16 v[56:59], a[148:151], v[36:39], v[56:59]
    ds_read_b128 v[12:15], v240 offset:61952
    buffer_load_dwordx4 a[148:151], v252, s[40:43], s75 offen offset:2048 sc1
    v_mfma_f32_16x16x32_bf16 v[56:59], a[172:175], v[48:51], v[56:59]
    v_mfma_f32_16x16x32_bf16 v[156:159], a[152:155], v[28:31], v[156:159]
    v_mfma_f32_16x16x32_bf16 v[156:159], a[176:179], v[40:43], v[156:159]
    buffer_load_dwordx4 a[172:175], v252, s[40:43], s75 offen offset:3072 sc1
    v_mfma_f32_16x16x32_bf16 v[180:183], a[152:155], v[32:35], v[180:183]
    ds_read_b128 v[16:19], v241 offset:37376
    s_mov_b32 s76, 40960
    v_mfma_f32_16x16x32_bf16 v[180:183], a[176:179], v[44:47], v[180:183]
    v_mfma_f32_16x16x32_bf16 v[60:63], a[152:155], v[36:39], v[60:63]
    buffer_load_dwordx4 a[152:155], v252, s[40:43], s76 offen sc1
    v_mfma_f32_16x16x32_bf16 v[60:63], a[176:179], v[48:51], v[60:63]
    v_mfma_f32_16x16x32_bf16 v[160:163], a[156:159], v[28:31], v[160:163]
    ds_read_b128 v[20:23], v241 offset:49664
    v_mfma_f32_16x16x32_bf16 v[160:163], a[180:183], v[40:43], v[160:163]
    buffer_load_dwordx4 a[176:179], v252, s[40:43], s76 offen offset:1024 sc1
    v_mfma_f32_16x16x32_bf16 v[184:187], a[156:159], v[32:35], v[184:187]
    v_mfma_f32_16x16x32_bf16 v[184:187], a[180:183], v[44:47], v[184:187]
    v_mfma_f32_16x16x32_bf16 v[64:67], a[156:159], v[36:39], v[64:67]
    ds_read_b128 v[24:27], v241 offset:61952
    buffer_load_dwordx4 a[156:159], v252, s[40:43], s76 offen offset:2048 sc1
    v_mfma_f32_16x16x32_bf16 v[64:67], a[180:183], v[48:51], v[64:67]
    v_mfma_f32_16x16x32_bf16 v[164:167], a[160:163], v[28:31], v[164:167]
    v_mfma_f32_16x16x32_bf16 v[164:167], a[184:187], v[40:43], v[164:167]
    buffer_load_dwordx4 a[180:183], v252, s[40:43], s76 offen offset:3072 sc1
    v_mfma_f32_16x16x32_bf16 v[188:191], a[160:163], v[32:35], v[188:191]
    s_mov_b32 s77, 45056
    v_mfma_f32_16x16x32_bf16 v[188:191], a[184:187], v[44:47], v[188:191]
    v_mfma_f32_16x16x32_bf16 v[68:71], a[160:163], v[36:39], v[68:71]
    buffer_load_dwordx4 a[160:163], v252, s[40:43], s77 offen sc1
    v_mfma_f32_16x16x32_bf16 v[68:71], a[184:187], v[48:51], v[68:71]
    v_mfma_f32_16x16x32_bf16 v[168:171], a[164:167], v[28:31], v[168:171]
    v_mfma_f32_16x16x32_bf16 v[168:171], a[188:191], v[40:43], v[168:171]
    buffer_load_dwordx4 a[184:187], v252, s[40:43], s77 offen offset:1024 sc1
    v_mfma_f32_16x16x32_bf16 v[192:195], a[164:167], v[32:35], v[192:195]
    v_mfma_f32_16x16x32_bf16 v[192:195], a[188:191], v[44:47], v[192:195]
    v_mfma_f32_16x16x32_bf16 v[72:75], a[164:167], v[36:39], v[72:75]
    buffer_load_dwordx4 a[164:167], v252, s[40:43], s77 offen offset:2048 sc1
    v_mfma_f32_16x16x32_bf16 v[72:75], a[188:191], v[48:51], v[72:75]
    s_waitcnt lgkmcnt(0)
    v_mfma_f32_16x16x32_bf16 v[148:151], a[192:195], v[4:7], v[148:151]
    v_mfma_f32_16x16x32_bf16 v[148:151], a[216:219], v[16:19], v[148:151]
    buffer_load_dwordx4 a[188:191], v252, s[40:43], s77 offen offset:3072 sc1
    v_mfma_f32_16x16x32_bf16 v[172:175], a[192:195], v[8:11], v[172:175]
    ds_read_b128 v[28:31], v242 offset:37376
    s_mov_b32 s74, 49152
    v_mfma_f32_16x16x32_bf16 v[172:175], a[216:219], v[20:23], v[172:175]
    v_mfma_f32_16x16x32_bf16 v[52:55], a[192:195], v[12:15], v[52:55]
    buffer_load_dwordx4 a[192:195], v252, s[40:43], s74 offen sc1
    v_mfma_f32_16x16x32_bf16 v[52:55], a[216:219], v[24:27], v[52:55]
    v_mfma_f32_16x16x32_bf16 v[152:155], a[196:199], v[4:7], v[152:155]
    ds_read_b128 v[32:35], v242 offset:49664
    v_mfma_f32_16x16x32_bf16 v[152:155], a[220:223], v[16:19], v[152:155]
    buffer_load_dwordx4 a[216:219], v252, s[40:43], s74 offen offset:1024 sc1
    v_mfma_f32_16x16x32_bf16 v[176:179], a[196:199], v[8:11], v[176:179]
    v_mfma_f32_16x16x32_bf16 v[176:179], a[220:223], v[20:23], v[176:179]
    v_mfma_f32_16x16x32_bf16 v[56:59], a[196:199], v[12:15], v[56:59]
    ds_read_b128 v[36:39], v242 offset:61952
    buffer_load_dwordx4 a[196:199], v252, s[40:43], s74 offen offset:2048 sc1
    v_mfma_f32_16x16x32_bf16 v[56:59], a[220:223], v[24:27], v[56:59]
    v_mfma_f32_16x16x32_bf16 v[156:159], a[200:203], v[4:7], v[156:159]
    v_mfma_f32_16x16x32_bf16 v[156:159], a[224:227], v[16:19], v[156:159]
    buffer_load_dwordx4 a[220:223], v252, s[40:43], s74 offen offset:3072 sc1
    v_mfma_f32_16x16x32_bf16 v[180:183], a[200:203], v[8:11], v[180:183]
    ds_read_b128 v[40:43], v243 offset:37376
    s_mov_b32 s75, 53248
    v_mfma_f32_16x16x32_bf16 v[180:183], a[224:227], v[20:23], v[180:183]
    v_mfma_f32_16x16x32_bf16 v[60:63], a[200:203], v[12:15], v[60:63]
    buffer_load_dwordx4 a[200:203], v252, s[40:43], s75 offen sc1
    v_mfma_f32_16x16x32_bf16 v[60:63], a[224:227], v[24:27], v[60:63]
    v_mfma_f32_16x16x32_bf16 v[160:163], a[204:207], v[4:7], v[160:163]
    ds_read_b128 v[44:47], v243 offset:49664
    v_mfma_f32_16x16x32_bf16 v[160:163], a[228:231], v[16:19], v[160:163]
    buffer_load_dwordx4 a[224:227], v252, s[40:43], s75 offen offset:1024 sc1
    v_mfma_f32_16x16x32_bf16 v[184:187], a[204:207], v[8:11], v[184:187]
    v_mfma_f32_16x16x32_bf16 v[184:187], a[228:231], v[20:23], v[184:187]
    v_mfma_f32_16x16x32_bf16 v[64:67], a[204:207], v[12:15], v[64:67]
    ds_read_b128 v[48:51], v243 offset:61952
    buffer_load_dwordx4 a[204:207], v252, s[40:43], s75 offen offset:2048 sc1
    v_mfma_f32_16x16x32_bf16 v[64:67], a[228:231], v[24:27], v[64:67]
    v_mfma_f32_16x16x32_bf16 v[164:167], a[208:211], v[4:7], v[164:167]
    v_mfma_f32_16x16x32_bf16 v[164:167], a[232:235], v[16:19], v[164:167]
    buffer_load_dwordx4 a[228:231], v252, s[40:43], s75 offen offset:3072 sc1
    v_mfma_f32_16x16x32_bf16 v[188:191], a[208:211], v[8:11], v[188:191]
    s_mov_b32 s76, 57344
    v_mfma_f32_16x16x32_bf16 v[188:191], a[232:235], v[20:23], v[188:191]
    v_mfma_f32_16x16x32_bf16 v[68:71], a[208:211], v[12:15], v[68:71]
    buffer_load_dwordx4 a[208:211], v252, s[40:43], s76 offen sc1
    v_mfma_f32_16x16x32_bf16 v[68:71], a[232:235], v[24:27], v[68:71]
    v_mfma_f32_16x16x32_bf16 v[168:171], a[212:215], v[4:7], v[168:171]
    v_mfma_f32_16x16x32_bf16 v[168:171], a[236:239], v[16:19], v[168:171]
    buffer_load_dwordx4 a[232:235], v252, s[40:43], s76 offen offset:1024 sc1
    v_mfma_f32_16x16x32_bf16 v[192:195], a[212:215], v[8:11], v[192:195]
    v_mfma_f32_16x16x32_bf16 v[192:195], a[236:239], v[20:23], v[192:195]
    v_mfma_f32_16x16x32_bf16 v[72:75], a[212:215], v[12:15], v[72:75]
    buffer_load_dwordx4 a[212:215], v252, s[40:43], s76 offen offset:2048 sc1
    v_mfma_f32_16x16x32_bf16 v[72:75], a[236:239], v[24:27], v[72:75]
    s_waitcnt vmcnt(59) lgkmcnt(0)
    s_barrier
    v_mfma_f32_16x16x32_bf16 v[148:151], a[240:243], v[28:31], v[148:151]
    v_mfma_f32_16x16x32_bf16 v[148:151], v[204:207], v[40:43], v[148:151]
    buffer_load_dwordx4 a[236:239], v252, s[40:43], s76 offen offset:3072 sc1
    v_mfma_f32_16x16x32_bf16 v[172:175], a[240:243], v[32:35], v[172:175]
    s_mov_b32 s77, 61440
    v_mfma_f32_16x16x32_bf16 v[172:175], v[204:207], v[44:47], v[172:175]
    v_mfma_f32_16x16x32_bf16 v[52:55], a[240:243], v[36:39], v[52:55]
    buffer_load_dwordx4 a[240:243], v252, s[40:43], s77 offen sc1
    v_mfma_f32_16x16x32_bf16 v[52:55], v[204:207], v[48:51], v[52:55]
    v_mfma_f32_16x16x32_bf16 v[152:155], a[244:247], v[28:31], v[152:155]
    v_mfma_f32_16x16x32_bf16 v[152:155], v[208:211], v[40:43], v[152:155]
    buffer_load_dwordx4 v[204:207], v252, s[40:43], s77 offen offset:1024 sc1
    v_mfma_f32_16x16x32_bf16 v[176:179], a[244:247], v[32:35], v[176:179]
    v_mfma_f32_16x16x32_bf16 v[176:179], v[208:211], v[44:47], v[176:179]
    v_mfma_f32_16x16x32_bf16 v[56:59], a[244:247], v[36:39], v[56:59]
    buffer_load_dwordx4 a[244:247], v252, s[40:43], s77 offen offset:2048 sc1
    v_mfma_f32_16x16x32_bf16 v[56:59], v[208:211], v[48:51], v[56:59]
    v_mfma_f32_16x16x32_bf16 v[156:159], a[248:251], v[28:31], v[156:159]
    v_mfma_f32_16x16x32_bf16 v[156:159], v[212:215], v[40:43], v[156:159]
    buffer_load_dwordx4 v[208:211], v252, s[40:43], s77 offen offset:3072 sc1
    v_mfma_f32_16x16x32_bf16 v[180:183], a[248:251], v[32:35], v[180:183]
    s_mov_b32 s74, 65536
    v_mfma_f32_16x16x32_bf16 v[180:183], v[212:215], v[44:47], v[180:183]
    v_mfma_f32_16x16x32_bf16 v[60:63], a[248:251], v[36:39], v[60:63]
    buffer_load_dwordx4 a[248:251], v252, s[40:43], s74 offen sc1
    v_mfma_f32_16x16x32_bf16 v[60:63], v[212:215], v[48:51], v[60:63]
    v_mfma_f32_16x16x32_bf16 v[160:163], a[252:255], v[28:31], v[160:163]
    v_mfma_f32_16x16x32_bf16 v[160:163], v[216:219], v[40:43], v[160:163]
    buffer_load_dwordx4 v[212:215], v252, s[40:43], s74 offen offset:1024 sc1
    v_mfma_f32_16x16x32_bf16 v[184:187], a[252:255], v[32:35], v[184:187]
    v_mfma_f32_16x16x32_bf16 v[184:187], v[216:219], v[44:47], v[184:187]
    v_mfma_f32_16x16x32_bf16 v[64:67], a[252:255], v[36:39], v[64:67]
    buffer_load_dwordx4 a[252:255], v252, s[40:43], s74 offen offset:2048 sc1
    v_mfma_f32_16x16x32_bf16 v[64:67], v[216:219], v[48:51], v[64:67]
    v_mfma_f32_16x16x32_bf16 v[164:167], v[196:199], v[28:31], v[164:167]
    v_mfma_f32_16x16x32_bf16 v[164:167], v[220:223], v[40:43], v[164:167]
    buffer_load_dwordx4 v[216:219], v252, s[40:43], s74 offen offset:3072 sc1
    v_mfma_f32_16x16x32_bf16 v[188:191], v[196:199], v[32:35], v[188:191]
    s_mov_b32 s75, 69632
    v_mfma_f32_16x16x32_bf16 v[188:191], v[220:223], v[44:47], v[188:191]
    v_mfma_f32_16x16x32_bf16 v[68:71], v[196:199], v[36:39], v[68:71]
    buffer_load_dwordx4 v[196:199], v252, s[40:43], s75 offen sc1
    v_mfma_f32_16x16x32_bf16 v[68:71], v[220:223], v[48:51], v[68:71]
    v_mfma_f32_16x16x32_bf16 v[168:171], v[200:203], v[28:31], v[168:171]
    v_mfma_f32_16x16x32_bf16 v[168:171], v[224:227], v[40:43], v[168:171]
    buffer_load_dwordx4 v[220:223], v252, s[40:43], s75 offen offset:1024 sc1
    v_mfma_f32_16x16x32_bf16 v[192:195], v[200:203], v[32:35], v[192:195]
    v_mfma_f32_16x16x32_bf16 v[192:195], v[224:227], v[44:47], v[192:195]
    v_mfma_f32_16x16x32_bf16 v[72:75], v[200:203], v[36:39], v[72:75]
    buffer_load_dwordx4 v[200:203], v252, s[40:43], s75 offen offset:2048 sc1
    v_mfma_f32_16x16x32_bf16 v[72:75], v[224:227], v[48:51], v[72:75]
    buffer_load_dwordx4 v[224:227], v252, s[40:43], s75 offen offset:3072 sc1
L_postd:
    ds_read_b128 v[4:7], v228 offset:0
    ds_read_b128 v[8:11], v229 offset:0
    ds_read_b128 v[12:15], v230 offset:0
    ds_read_b128 v[16:19], v231 offset:0
    ds_read_b128 v[20:23], v228 offset:256
    ds_read_b128 v[24:27], v229 offset:256
    ds_read_b128 v[28:31], v230 offset:256
    ds_read_b128 v[32:35], v231 offset:256
    ds_read_b128 v[36:39], v228 offset:512
    ds_read_b128 v[40:43], v229 offset:512
    ds_read_b128 v[44:47], v230 offset:512
    ds_read_b128 v[48:51], v231 offset:512
    v_cvt_pk_bf16_f32 v148, v148, v149
    v_cvt_pk_bf16_f32 v149, v150, v151
    v_cvt_pk_bf16_f32 v150, v152, v153
    v_cvt_pk_bf16_f32 v151, v154, v155
    v_cvt_pk_bf16_f32 v152, v156, v157
    v_cvt_pk_bf16_f32 v153, v158, v159
    v_cvt_pk_bf16_f32 v154, v160, v161
    v_cvt_pk_bf16_f32 v155, v162, v163
    v_cvt_pk_bf16_f32 v156, v164, v165
    v_cvt_pk_bf16_f32 v157, v166, v167
    v_cvt_pk_bf16_f32 v158, v168, v169
    v_cvt_pk_bf16_f32 v159, v170, v171
    v_cvt_pk_bf16_f32 v160, v172, v173
    v_cvt_pk_bf16_f32 v161, v174, v175
    v_cvt_pk_bf16_f32 v162, v176, v177
    v_cvt_pk_bf16_f32 v163, v178, v179
    v_cvt_pk_bf16_f32 v164, v180, v181
    v_cvt_pk_bf16_f32 v165, v182, v183
    v_cvt_pk_bf16_f32 v166, v184, v185
    v_cvt_pk_bf16_f32 v167, v186, v187
    v_cvt_pk_bf16_f32 v168, v188, v189
    v_cvt_pk_bf16_f32 v169, v190, v191
    v_cvt_pk_bf16_f32 v170, v192, v193
    v_cvt_pk_bf16_f32 v171, v194, v195
    v_cvt_pk_bf16_f32 v172, v52, v53
    v_cvt_pk_bf16_f32 v173, v54, v55
    v_cvt_pk_bf16_f32 v174, v56, v57
    v_cvt_pk_bf16_f32 v175, v58, v59
    v_cvt_pk_bf16_f32 v176, v60, v61
    v_cvt_pk_bf16_f32 v177, v62, v63
    v_cvt_pk_bf16_f32 v178, v64, v65
    v_cvt_pk_bf16_f32 v179, v66, v67
    v_cvt_pk_bf16_f32 v180, v68, v69
    v_cvt_pk_bf16_f32 v181, v70, v71
    v_cvt_pk_bf16_f32 v182, v72, v73
    v_cvt_pk_bf16_f32 v183, v74, v75
    v_lshlrev_b32 v184, 16, v76
    v_and_b32 v185, s59, v76
    v_lshlrev_b32 v186, 16, v77
    v_and_b32 v187, s59, v77
    v_lshlrev_b32 v188, 16, v78
    v_and_b32 v189, s59, v78
    v_lshlrev_b32 v190, 16, v79
    v_and_b32 v191, s59, v79
    v_lshlrev_b32 v192, 16, v80
    v_and_b32 v193, s59, v80
    v_lshlrev_b32 v194, 16, v81
    v_and_b32 v195, s59, v81
    v_lshlrev_b32 v76, 16, v82
    v_and_b32 v77, s59, v82
    v_lshlrev_b32 v78, 16, v83
    v_and_b32 v79, s59, v83
    s_waitcnt vmcnt(0)
    v_readfirstlane_b32 s73, v239
    s_waitcnt lgkmcnt(0)
.p2align 6
L_p2:
    s_waitcnt lgkmcnt(10)
    v_mfma_f32_16x16x32_bf16 v[52:55], a[0:3], v[4:7], v[184:187]
    v_mfma_f32_16x16x32_bf16 v[52:55], a[24:27], v[8:11], v[52:55]
    v_mfma_f32_16x16x32_bf16 v[52:55], a[48:51], v[12:15], v[52:55]
    s_waitcnt lgkmcnt(6)
    v_mfma_f32_16x16x32_bf16 v[52:55], a[72:75], v[16:19], v[52:55]
    v_cvt_pk_bf16_f32 v0, v68, v69
    v_cvt_pk_bf16_f32 v1, v70, v71
    v_mfma_f32_16x16x32_bf16 v[52:55], a[96:99], v[20:23], v[52:55]
    v_mfma_f32_16x16x32_bf16 v[52:55], a[120:123], v[24:27], v[52:55]
    s_waitcnt lgkmcnt(3)
    v_mfma_f32_16x16x32_bf16 v[52:55], a[144:147], v[28:31], v[52:55]
    v_mfma_f32_16x16x32_bf16 v[52:55], a[168:171], v[32:35], v[52:55]
    v_mfma_f32_16x16x32_bf16 v[52:55], a[192:195], v[36:39], v[52:55]
    s_waitcnt lgkmcnt(0)
    v_mfma_f32_16x16x32_bf16 v[52:55], a[216:219], v[40:43], v[52:55]
    v_cvt_pk_bf16_f32 v2, v72, v73
    v_cvt_pk_bf16_f32 v3, v74, v75
    v_mfma_f32_16x16x32_bf16 v[52:55], a[240:243], v[44:47], v[52:55]
    ds_write_b128 v237, v[0:3] offset:36864
    v_mfma_f32_16x16x32_bf16 v[52:55], v[204:207], v[48:51], v[52:55]
    v_mfma_f32_16x16x32_bf16 v[56:59], a[4:7], v[4:7], v[188:191]
    s_add_u32 s55, s81, 294912
    v_mfma_f32_16x16x32_bf16 v[56:59], a[28:31], v[8:11], v[56:59]
    s_add_u32 m0, s82, 24576
    v_mfma_f32_16x16x32_bf16 v[56:59], a[52:55], v[12:15], v[56:59]
    buffer_load_dwordx4 v232, s[20:23], s55 offen nt lds
    v_mfma_f32_16x16x32_bf16 v[56:59], a[76:79], v[16:19], v[56:59]
    v_mfma_f32_16x16x32_bf16 v[56:59], a[100:103], v[20:23], v[56:59]
    v_mfma_f32_16x16x32_bf16 v[56:59], a[124:127], v[24:27], v[56:59]
    buffer_load_dwordx4 v233, s[20:23], s55 offen offset:1024 nt lds
    v_mfma_f32_16x16x32_bf16 v[56:59], a[148:151], v[28:31], v[56:59]
    v_mfma_f32_16x16x32_bf16 v[56:59], a[172:175], v[32:35], v[56:59]
    v_mfma_f32_16x16x32_bf16 v[56:59], a[196:199], v[36:39], v[56:59]
    buffer_load_dwordx4 v234, s[20:23], s55 offen offset:2048 nt lds
    v_mfma_f32_16x16x32_bf16 v[56:59], a[220:223], v[40:43], v[56:59]
    s_cbranch_vccz L_lo0
    s_waitcnt vmcnt(6)
L_lo0:
    v_cvt_pk_bf16_f32 v0, v52, v53
    v_cvt_pk_bf16_f32 v1, v54, v55
    v_mfma_f32_16x16x32_bf16 v[56:59], a[244:247], v[44:47], v[56:59]
    s_set_gpr_idx_on s54, gpr_idx(SRC0)
    v_mov_b64 v[252:253], v[84:85]
    v_mov_b64 v[254:255], v[86:87]
    s_set_gpr_idx_off
    v_mfma_f32_16x16x32_bf16 v[56:59], v[208:211], v[48:51], v[56:59]
    v_lshlrev_b32 v80, 16, v252
    v_and_b32 v81, s59, v252
    v_mfma_f32_16x16x32_bf16 v[60:63], a[8:11], v[4:7], v[192:195]
    v_lshlrev_b32 v82, 16, v253
    v_and_b32 v83, s59, v253
    v_mfma_f32_16x16x32_bf16 v[60:63], a[32:35], v[8:11], v[60:63]
    v_lshlrev_b32 v84, 16, v254
    v_and_b32 v85, s59, v254
    v_mfma_f32_16x16x32_bf16 v[60:63], a[56:59], v[12:15], v[60:63]
    v_lshlrev_b32 v86, 16, v255
    v_and_b32 v87, s59, v255
    v_mfma_f32_16x16x32_bf16 v[60:63], a[80:83], v[16:19], v[60:63]
    v_mfma_f32_16x16x32_bf16 v[60:63], a[104:107], v[20:23], v[60:63]
    v_mfma_f32_16x16x32_bf16 v[60:63], a[128:131], v[24:27], v[60:63]
    s_mov_b64 exec, 1
    v_mov_b32 v239, 1
    buffer_atomic_add v239, off, s[40:43], s66 sc0
    s_mov_b64 exec, -1
    v_mfma_f32_16x16x32_bf16 v[60:63], a[152:155], v[28:31], v[60:63]
    v_mfma_f32_16x16x32_bf16 v[60:63], a[176:179], v[32:35], v[60:63]
    s_cmp_eq_u32 s65, 0
    s_cbranch_scc1 L_md0
    s_waitcnt vmcnt(7)
L_md0:
    v_mfma_f32_16x16x32_bf16 v[60:63], a[200:203], v[36:39], v[60:63]
    v_cvt_pk_bf16_f32 v2, v56, v57
    v_cvt_pk_bf16_f32 v3, v58, v59
    v_mfma_f32_16x16x32_bf16 v[60:63], a[224:227], v[40:43], v[60:63]
    ds_write_b128 v235, v[0:3] offset:0
    v_mfma_f32_16x16x32_bf16 v[60:63], a[248:251], v[44:47], v[60:63]
    v_mfma_f32_16x16x32_bf16 v[60:63], v[212:215], v[48:51], v[60:63]
    v_mfma_f32_16x16x32_bf16 v[64:67], a[12:15], v[4:7], v[76:79]
    v_mfma_f32_16x16x32_bf16 v[64:67], a[36:39], v[8:11], v[64:67]
    v_mfma_f32_16x16x32_bf16 v[64:67], a[60:63], v[12:15], v[64:67]
    v_mfma_f32_16x16x32_bf16 v[64:67], a[84:87], v[16:19], v[64:67]
    v_mfma_f32_16x16x32_bf16 v[64:67], a[108:111], v[20:23], v[64:67]
    v_mfma_f32_16x16x32_bf16 v[64:67], a[132:135], v[24:27], v[64:67]
    v_mfma_f32_16x16x32_bf16 v[64:67], a[156:159], v[28:31], v[64:67]
    v_mfma_f32_16x16x32_bf16 v[64:67], a[180:183], v[32:35], v[64:67]
    v_mfma_f32_16x16x32_bf16 v[64:67], a[204:207], v[36:39], v[64:67]
    v_cvt_pk_bf16_f32 v0, v60, v61
    v_cvt_pk_bf16_f32 v1, v62, v63
    v_mfma_f32_16x16x32_bf16 v[64:67], a[228:231], v[40:43], v[64:67]
    v_mfma_f32_16x16x32_bf16 v[64:67], a[252:255], v[44:47], v[64:67]
    v_mfma_f32_16x16x32_bf16 v[64:67], v[216:219], v[48:51], v[64:67]
    v_mfma_f32_16x16x32_bf16 v[68:71], a[16:19], v[4:7], v[80:83]
    v_mfma_f32_16x16x32_bf16 v[68:71], a[40:43], v[8:11], v[68:71]
    s_waitcnt vmcnt(7) lgkmcnt(1)
    s_barrier
    v_mfma_f32_16x16x32_bf16 v[68:71], a[64:67], v[12:15], v[68:71]
    ds_read_b128 v[240:243], v238 offset:36864
    v_mfma_f32_16x16x32_bf16 v[68:71], a[88:91], v[16:19], v[68:71]
    ds_read_b128 v[244:247], v238 offset:37888
    v_mfma_f32_16x16x32_bf16 v[68:71], a[112:115], v[20:23], v[68:71]
    v_mfma_f32_16x16x32_bf16 v[68:71], a[136:139], v[24:27], v[68:71]
    v_mfma_f32_16x16x32_bf16 v[72:75], a[20:23], v[4:7], v[84:87]
    ds_read_b128 v[4:7], v228 offset:12288
    v_mfma_f32_16x16x32_bf16 v[72:75], a[44:47], v[8:11], v[72:75]
    ds_read_b128 v[248:251], v238 offset:38912
    v_mfma_f32_16x16x32_bf16 v[72:75], a[68:71], v[12:15], v[72:75]
    ds_read_b128 v[8:11], v229 offset:12288
    v_mfma_f32_16x16x32_bf16 v[72:75], a[92:95], v[16:19], v[72:75]
    v_cvt_pk_bf16_f32 v2, v64, v65
    v_cvt_pk_bf16_f32 v3, v66, v67
    v_mfma_f32_16x16x32_bf16 v[72:75], a[116:119], v[20:23], v[72:75]
    ds_read_b128 v[12:15], v230 offset:12288
    v_mfma_f32_16x16x32_bf16 v[72:75], a[140:143], v[24:27], v[72:75]
    ds_write_b128 v236, v[0:3] offset:0
    v_mfma_f32_16x16x32_bf16 v[68:71], a[160:163], v[28:31], v[68:71]
    ds_read_b128 v[16:19], v231 offset:12288
    v_mfma_f32_16x16x32_bf16 v[68:71], a[184:187], v[32:35], v[68:71]
    v_mfma_f32_16x16x32_bf16 v[68:71], a[208:211], v[36:39], v[68:71]
    s_waitcnt lgkmcnt(7)
    buffer_store_dwordx4 v[240:243], v232, s[36:39], s56 offen sc1
    ds_read_b128 v[20:23], v228 offset:12544
    v_mfma_f32_16x16x32_bf16 v[68:71], a[232:235], v[40:43], v[68:71]
    v_mfma_f32_16x16x32_bf16 v[68:71], v[196:199], v[44:47], v[68:71]
    ds_read_b128 v[24:27], v229 offset:12544
    v_mfma_f32_16x16x32_bf16 v[68:71], v[220:223], v[48:51], v[68:71]
    v_mfma_f32_16x16x32_bf16 v[72:75], a[164:167], v[28:31], v[72:75]
    s_waitcnt lgkmcnt(8)
    buffer_store_dwordx4 v[244:247], v233, s[36:39], s56 offen offset:1024 sc1
    ds_read_b128 v[28:31], v230 offset:12544
    v_mfma_f32_16x16x32_bf16 v[72:75], a[188:191], v[32:35], v[72:75]
    ds_read_b128 v[32:35], v231 offset:12544
    v_mfma_f32_16x16x32_bf16 v[72:75], a[212:215], v[36:39], v[72:75]
    ds_read_b128 v[36:39], v228 offset:12800
    v_mfma_f32_16x16x32_bf16 v[72:75], a[236:239], v[40:43], v[72:75]
    ds_read_b128 v[40:43], v229 offset:12800
    v_mfma_f32_16x16x32_bf16 v[72:75], v[200:203], v[44:47], v[72:75]
    s_waitcnt lgkmcnt(10)
    buffer_store_dwordx4 v[248:251], v234, s[36:39], s56 offen offset:2048 sc1
    s_add_u32 s56, s78, 0
    ds_read_b128 v[44:47], v230 offset:12800
    v_mfma_f32_16x16x32_bf16 v[72:75], v[224:227], v[48:51], v[72:75]
    ds_read_b128 v[48:51], v231 offset:12800
    s_waitcnt lgkmcnt(10)
    v_mfma_f32_16x16x32_bf16 v[52:55], a[0:3], v[4:7], v[184:187]
    v_mfma_f32_16x16x32_bf16 v[52:55], a[24:27], v[8:11], v[52:55]
    v_mfma_f32_16x16x32_bf16 v[52:55], a[48:51], v[12:15], v[52:55]
    s_waitcnt lgkmcnt(6)
    v_mfma_f32_16x16x32_bf16 v[52:55], a[72:75], v[16:19], v[52:55]
    v_cvt_pk_bf16_f32 v0, v68, v69
    v_cvt_pk_bf16_f32 v1, v70, v71
    v_mfma_f32_16x16x32_bf16 v[52:55], a[96:99], v[20:23], v[52:55]
    v_mfma_f32_16x16x32_bf16 v[52:55], a[120:123], v[24:27], v[52:55]
    s_waitcnt lgkmcnt(3)
    v_mfma_f32_16x16x32_bf16 v[52:55], a[144:147], v[28:31], v[52:55]
    v_mfma_f32_16x16x32_bf16 v[52:55], a[168:171], v[32:35], v[52:55]
    v_mfma_f32_16x16x32_bf16 v[52:55], a[192:195], v[36:39], v[52:55]
    s_waitcnt lgkmcnt(0)
    v_mfma_f32_16x16x32_bf16 v[52:55], a[216:219], v[40:43], v[52:55]
    v_cvt_pk_bf16_f32 v2, v72, v73
    v_cvt_pk_bf16_f32 v3, v74, v75
    v_mfma_f32_16x16x32_bf16 v[52:55], a[240:243], v[44:47], v[52:55]
    ds_write_b128 v237, v[0:3] offset:0
    v_mfma_f32_16x16x32_bf16 v[52:55], v[204:207], v[48:51], v[52:55]
    v_mfma_f32_16x16x32_bf16 v[56:59], a[4:7], v[4:7], v[188:191]
    s_add_u32 s55, s81, 295680
    v_mfma_f32_16x16x32_bf16 v[56:59], a[28:31], v[8:11], v[56:59]
    s_add_u32 m0, s82, 36864
    v_mfma_f32_16x16x32_bf16 v[56:59], a[52:55], v[12:15], v[56:59]
    buffer_load_dwordx4 v232, s[20:23], s55 offen nt lds
    v_mfma_f32_16x16x32_bf16 v[56:59], a[76:79], v[16:19], v[56:59]
    v_mfma_f32_16x16x32_bf16 v[56:59], a[100:103], v[20:23], v[56:59]
    v_mfma_f32_16x16x32_bf16 v[56:59], a[124:127], v[24:27], v[56:59]
    buffer_load_dwordx4 v233, s[20:23], s55 offen offset:1024 nt lds
    v_mfma_f32_16x16x32_bf16 v[56:59], a[148:151], v[28:31], v[56:59]
    v_mfma_f32_16x16x32_bf16 v[56:59], a[172:175], v[32:35], v[56:59]
    v_mfma_f32_16x16x32_bf16 v[56:59], a[196:199], v[36:39], v[56:59]
    buffer_load_dwordx4 v234, s[20:23], s55 offen offset:2048 nt lds
    v_mfma_f32_16x16x32_bf16 v[56:59], a[220:223], v[40:43], v[56:59]
    s_cbranch_vccz L_lo1
    s_waitcnt vmcnt(7)
L_lo1:
    v_cvt_pk_bf16_f32 v0, v52, v53
    v_cvt_pk_bf16_f32 v1, v54, v55
    v_mfma_f32_16x16x32_bf16 v[56:59], a[244:247], v[44:47], v[56:59]
    v_mfma_f32_16x16x32_bf16 v[56:59], v[208:211], v[48:51], v[56:59]
    s_add_u32 s54, s54, 12
    v_mfma_f32_16x16x32_bf16 v[60:63], a[8:11], v[4:7], v[192:195]
    v_mfma_f32_16x16x32_bf16 v[60:63], a[32:35], v[8:11], v[60:63]
    v_mfma_f32_16x16x32_bf16 v[60:63], a[56:59], v[12:15], v[60:63]
    v_mfma_f32_16x16x32_bf16 v[60:63], a[80:83], v[16:19], v[60:63]
    v_mfma_f32_16x16x32_bf16 v[60:63], a[104:107], v[20:23], v[60:63]
    v_mfma_f32_16x16x32_bf16 v[60:63], a[128:131], v[24:27], v[60:63]
    v_mfma_f32_16x16x32_bf16 v[60:63], a[152:155], v[28:31], v[60:63]
    v_mfma_f32_16x16x32_bf16 v[60:63], a[176:179], v[32:35], v[60:63]
    s_cmp_eq_u32 s65, 0
    s_cbranch_scc1 L_md1
    s_waitcnt vmcnt(7)
L_md1:
    v_mfma_f32_16x16x32_bf16 v[60:63], a[200:203], v[36:39], v[60:63]
    v_cvt_pk_bf16_f32 v2, v56, v57
    v_cvt_pk_bf16_f32 v3, v58, v59
    v_mfma_f32_16x16x32_bf16 v[60:63], a[224:227], v[40:43], v[60:63]
    ds_write_b128 v235, v[0:3] offset:12288
    v_mfma_f32_16x16x32_bf16 v[60:63], a[248:251], v[44:47], v[60:63]
    v_mfma_f32_16x16x32_bf16 v[60:63], v[212:215], v[48:51], v[60:63]
    v_mfma_f32_16x16x32_bf16 v[64:67], a[12:15], v[4:7], v[76:79]
    s_cmp_eq_u32 s19, s85
    s_cselect_b32 s57, 99, s19
    v_mfma_f32_16x16x32_bf16 v[64:67], a[36:39], v[8:11], v[64:67]
    s_cmp_lt_u32 s57, 9
    s_cselect_b32 s81, s79, 2147483648
    s_cselect_b32 s82, s49, 163840
    v_mfma_f32_16x16x32_bf16 v[64:67], a[60:63], v[12:15], v[64:67]
    v_mfma_f32_16x16x32_bf16 v[64:67], a[84:87], v[16:19], v[64:67]
    v_mfma_f32_16x16x32_bf16 v[64:67], a[108:111], v[20:23], v[64:67]
    v_mfma_f32_16x16x32_bf16 v[64:67], a[132:135], v[24:27], v[64:67]
    v_mfma_f32_16x16x32_bf16 v[64:67], a[156:159], v[28:31], v[64:67]
    v_mfma_f32_16x16x32_bf16 v[64:67], a[180:183], v[32:35], v[64:67]
    v_mfma_f32_16x16x32_bf16 v[64:67], a[204:207], v[36:39], v[64:67]
    v_cvt_pk_bf16_f32 v0, v60, v61
    v_cvt_pk_bf16_f32 v1, v62, v63
    v_mfma_f32_16x16x32_bf16 v[64:67], a[228:231], v[40:43], v[64:67]
    v_mfma_f32_16x16x32_bf16 v[64:67], a[252:255], v[44:47], v[64:67]
    v_mfma_f32_16x16x32_bf16 v[64:67], v[216:219], v[48:51], v[64:67]
    v_mfma_f32_16x16x32_bf16 v[68:71], a[16:19], v[4:7], v[80:83]
    v_mfma_f32_16x16x32_bf16 v[68:71], a[40:43], v[8:11], v[68:71]
    s_waitcnt vmcnt(7) lgkmcnt(1)
    s_barrier
    v_mfma_f32_16x16x32_bf16 v[68:71], a[64:67], v[12:15], v[68:71]
    ds_read_b128 v[240:243], v238 offset:0
    v_mfma_f32_16x16x32_bf16 v[68:71], a[88:91], v[16:19], v[68:71]
    ds_read_b128 v[244:247], v238 offset:1024
    v_mfma_f32_16x16x32_bf16 v[68:71], a[112:115], v[20:23], v[68:71]
    v_mfma_f32_16x16x32_bf16 v[68:71], a[136:139], v[24:27], v[68:71]
    v_mfma_f32_16x16x32_bf16 v[72:75], a[20:23], v[4:7], v[84:87]
    ds_read_b128 v[4:7], v228 offset:24576
    v_mfma_f32_16x16x32_bf16 v[72:75], a[44:47], v[8:11], v[72:75]
    ds_read_b128 v[248:251], v238 offset:2048
    v_mfma_f32_16x16x32_bf16 v[72:75], a[68:71], v[12:15], v[72:75]
    ds_read_b128 v[8:11], v229 offset:24576
    v_mfma_f32_16x16x32_bf16 v[72:75], a[92:95], v[16:19], v[72:75]
    v_cvt_pk_bf16_f32 v2, v64, v65
    v_cvt_pk_bf16_f32 v3, v66, v67
    v_mfma_f32_16x16x32_bf16 v[72:75], a[116:119], v[20:23], v[72:75]
    ds_read_b128 v[12:15], v230 offset:24576
    v_mfma_f32_16x16x32_bf16 v[72:75], a[140:143], v[24:27], v[72:75]
    ds_write_b128 v236, v[0:3] offset:12288
    v_mfma_f32_16x16x32_bf16 v[68:71], a[160:163], v[28:31], v[68:71]
    ds_read_b128 v[16:19], v231 offset:24576
    v_mfma_f32_16x16x32_bf16 v[68:71], a[184:187], v[32:35], v[68:71]
    v_mfma_f32_16x16x32_bf16 v[68:71], a[208:211], v[36:39], v[68:71]
    s_waitcnt lgkmcnt(7)
    buffer_store_dwordx4 v[240:243], v232, s[36:39], s56 offen sc1
    ds_read_b128 v[20:23], v228 offset:24832
    v_mfma_f32_16x16x32_bf16 v[68:71], a[232:235], v[40:43], v[68:71]
    v_mfma_f32_16x16x32_bf16 v[68:71], v[196:199], v[44:47], v[68:71]
    ds_read_b128 v[24:27], v229 offset:24832
    v_mfma_f32_16x16x32_bf16 v[68:71], v[220:223], v[48:51], v[68:71]
    v_mfma_f32_16x16x32_bf16 v[72:75], a[164:167], v[28:31], v[72:75]
    s_waitcnt lgkmcnt(8)
    buffer_store_dwordx4 v[244:247], v233, s[36:39], s56 offen offset:1024 sc1
    ds_read_b128 v[28:31], v230 offset:24832
    v_mfma_f32_16x16x32_bf16 v[72:75], a[188:191], v[32:35], v[72:75]
    ds_read_b128 v[32:35], v231 offset:24832
    v_mfma_f32_16x16x32_bf16 v[72:75], a[212:215], v[36:39], v[72:75]
    ds_read_b128 v[36:39], v228 offset:25088
    v_mfma_f32_16x16x32_bf16 v[72:75], a[236:239], v[40:43], v[72:75]
    ds_read_b128 v[40:43], v229 offset:25088
    v_mfma_f32_16x16x32_bf16 v[72:75], v[200:203], v[44:47], v[72:75]
    s_waitcnt lgkmcnt(10)
    buffer_store_dwordx4 v[248:251], v234, s[36:39], s56 offen offset:2048 sc1
    s_add_u32 s56, s78, 768
    ds_read_b128 v[44:47], v230 offset:25088
    v_mfma_f32_16x16x32_bf16 v[72:75], v[224:227], v[48:51], v[72:75]
    ds_read_b128 v[48:51], v231 offset:25088
    s_waitcnt lgkmcnt(10)
    v_mfma_f32_16x16x32_bf16 v[52:55], a[0:3], v[4:7], v[184:187]
    v_mfma_f32_16x16x32_bf16 v[52:55], a[24:27], v[8:11], v[52:55]
    v_mfma_f32_16x16x32_bf16 v[52:55], a[48:51], v[12:15], v[52:55]
    s_waitcnt lgkmcnt(6)
    v_mfma_f32_16x16x32_bf16 v[52:55], a[72:75], v[16:19], v[52:55]
    v_cvt_pk_bf16_f32 v0, v68, v69
    v_cvt_pk_bf16_f32 v1, v70, v71
    v_mfma_f32_16x16x32_bf16 v[52:55], a[96:99], v[20:23], v[52:55]
    v_mfma_f32_16x16x32_bf16 v[52:55], a[120:123], v[24:27], v[52:55]
    s_waitcnt lgkmcnt(3)
    v_mfma_f32_16x16x32_bf16 v[52:55], a[144:147], v[28:31], v[52:55]
    v_mfma_f32_16x16x32_bf16 v[52:55], a[168:171], v[32:35], v[52:55]
    v_mfma_f32_16x16x32_bf16 v[52:55], a[192:195], v[36:39], v[52:55]
    s_waitcnt lgkmcnt(0)
    v_mfma_f32_16x16x32_bf16 v[52:55], a[216:219], v[40:43], v[52:55]
    v_cvt_pk_bf16_f32 v2, v72, v73
    v_cvt_pk_bf16_f32 v3, v74, v75
    v_mfma_f32_16x16x32_bf16 v[52:55], a[240:243], v[44:47], v[52:55]
    ds_write_b128 v237, v[0:3] offset:12288
    v_mfma_f32_16x16x32_bf16 v[52:55], v[204:207], v[48:51], v[52:55]
    v_mfma_f32_16x16x32_bf16 v[56:59], a[4:7], v[4:7], v[188:191]
    s_add_u32 s55, s81, 0
    v_mfma_f32_16x16x32_bf16 v[56:59], a[28:31], v[8:11], v[56:59]
    s_add_u32 m0, s82, 0
    v_mfma_f32_16x16x32_bf16 v[56:59], a[52:55], v[12:15], v[56:59]
    buffer_load_dwordx4 v232, s[20:23], s55 offen nt lds
    v_mfma_f32_16x16x32_bf16 v[56:59], a[76:79], v[16:19], v[56:59]
    v_mfma_f32_16x16x32_bf16 v[56:59], a[100:103], v[20:23], v[56:59]
    v_mfma_f32_16x16x32_bf16 v[56:59], a[124:127], v[24:27], v[56:59]
    buffer_load_dwordx4 v233, s[20:23], s55 offen offset:1024 nt lds
    v_mfma_f32_16x16x32_bf16 v[56:59], a[148:151], v[28:31], v[56:59]
    v_mfma_f32_16x16x32_bf16 v[56:59], a[172:175], v[32:35], v[56:59]
    v_mfma_f32_16x16x32_bf16 v[56:59], a[196:199], v[36:39], v[56:59]
    buffer_load_dwordx4 v234, s[20:23], s55 offen offset:2048 nt lds
    v_mfma_f32_16x16x32_bf16 v[56:59], a[220:223], v[40:43], v[56:59]
    s_cbranch_vccz L_lo2
    s_waitcnt vmcnt(6)
L_lo2:
    v_cvt_pk_bf16_f32 v0, v52, v53
    v_cvt_pk_bf16_f32 v1, v54, v55
    v_mfma_f32_16x16x32_bf16 v[56:59], a[244:247], v[44:47], v[56:59]
    v_mfma_f32_16x16x32_bf16 v[56:59], v[208:211], v[48:51], v[56:59]
    v_mfma_f32_16x16x32_bf16 v[60:63], a[8:11], v[4:7], v[192:195]
    v_mfma_f32_16x16x32_bf16 v[60:63], a[32:35], v[8:11], v[60:63]
    v_mfma_f32_16x16x32_bf16 v[60:63], a[56:59], v[12:15], v[60:63]
    v_mfma_f32_16x16x32_bf16 v[60:63], a[80:83], v[16:19], v[60:63]
    v_mfma_f32_16x16x32_bf16 v[60:63], a[104:107], v[20:23], v[60:63]
    v_mfma_f32_16x16x32_bf16 v[60:63], a[128:131], v[24:27], v[60:63]
    v_mfma_f32_16x16x32_bf16 v[60:63], a[152:155], v[28:31], v[60:63]
    v_mfma_f32_16x16x32_bf16 v[60:63], a[176:179], v[32:35], v[60:63]
    s_cmp_eq_u32 s65, 0
    s_cbranch_scc1 L_md2
    s_waitcnt vmcnt(6)
L_md2:
    v_mfma_f32_16x16x32_bf16 v[60:63], a[200:203], v[36:39], v[60:63]
    v_cvt_pk_bf16_f32 v2, v56, v57
    v_cvt_pk_bf16_f32 v3, v58, v59
    v_mfma_f32_16x16x32_bf16 v[60:63], a[224:227], v[40:43], v[60:63]
    ds_write_b128 v235, v[0:3] offset:24576
    v_mfma_f32_16x16x32_bf16 v[60:63], a[248:251], v[44:47], v[60:63]
    v_mfma_f32_16x16x32_bf16 v[60:63], v[212:215], v[48:51], v[60:63]
    v_mfma_f32_16x16x32_bf16 v[64:67], a[12:15], v[4:7], v[76:79]
    s_add_u32 s67, s67, 43
    s_and_b32 s67, s67, 255
    v_mfma_f32_16x16x32_bf16 v[64:67], a[36:39], v[8:11], v[64:67]
    s_add_u32 s19, s19, 1
    s_lshl_b32 s87, s19, 8
    v_mfma_f32_16x16x32_bf16 v[64:67], a[60:63], v[12:15], v[64:67]
    s_add_u32 s87, s87, s67
    s_mul_hi_u32 s57, s87, 0x15555556
    v_mfma_f32_16x16x32_bf16 v[64:67], a[84:87], v[16:19], v[64:67]
    s_mul_i32 s57, s57, 294912
    s_mul_i32 s58, s87, 24576
    v_mfma_f32_16x16x32_bf16 v[64:67], a[108:111], v[20:23], v[64:67]
    s_add_u32 s80, s57, s58
    v_mfma_f32_16x16x32_bf16 v[64:67], a[132:135], v[24:27], v[64:67]
    v_mfma_f32_16x16x32_bf16 v[64:67], a[156:159], v[28:31], v[64:67]
    v_mfma_f32_16x16x32_bf16 v[64:67], a[180:183], v[32:35], v[64:67]
    v_mfma_f32_16x16x32_bf16 v[64:67], a[204:207], v[36:39], v[64:67]
    v_cvt_pk_bf16_f32 v0, v60, v61
    v_cvt_pk_bf16_f32 v1, v62, v63
    v_mfma_f32_16x16x32_bf16 v[64:67], a[228:231], v[40:43], v[64:67]
    v_mfma_f32_16x16x32_bf16 v[64:67], a[252:255], v[44:47], v[64:67]
    v_mfma_f32_16x16x32_bf16 v[64:67], v[216:219], v[48:51], v[64:67]
    v_mfma_f32_16x16x32_bf16 v[68:71], a[16:19], v[4:7], v[80:83]
    v_mfma_f32_16x16x32_bf16 v[68:71], a[40:43], v[8:11], v[68:71]
    s_waitcnt vmcnt(6) lgkmcnt(1)
    s_barrier
    v_mfma_f32_16x16x32_bf16 v[68:71], a[64:67], v[12:15], v[68:71]
    ds_read_b128 v[240:243], v238 offset:12288
    v_mfma_f32_16x16x32_bf16 v[68:71], a[88:91], v[16:19], v[68:71]
    ds_read_b128 v[244:247], v238 offset:13312
    v_readlane_b32 s52, v239, 0
    v_mfma_f32_16x16x32_bf16 v[68:71], a[112:115], v[20:23], v[68:71]
    v_mfma_f32_16x16x32_bf16 v[68:71], a[136:139], v[24:27], v[68:71]
    v_mfma_f32_16x16x32_bf16 v[72:75], a[20:23], v[4:7], v[84:87]
    ds_read_b128 v[4:7], v228 offset:36864
    s_sub_u32 s52, s52, s73
    s_cmp_ge_i32 s52, 52
    s_cselect_b32 s65, 0, 1
    s_cselect_b64 vcc, 0, s[98:99]
    v_mfma_f32_16x16x32_bf16 v[72:75], a[44:47], v[8:11], v[72:75]
    ds_read_b128 v[248:251], v238 offset:14336
    s_cmp_lt_u32 s83, 1
    s_cselect_b32 s65, 1, s65
    s_cselect_b64 vcc, -1, vcc
    v_mfma_f32_16x16x32_bf16 v[72:75], a[68:71], v[12:15], v[72:75]
    ds_read_b128 v[8:11], v229 offset:36864
    s_add_u32 s73, s73, 64
    v_mfma_f32_16x16x32_bf16 v[72:75], a[92:95], v[16:19], v[72:75]
    v_cvt_pk_bf16_f32 v2, v64, v65
    v_cvt_pk_bf16_f32 v3, v66, v67
    v_mfma_f32_16x16x32_bf16 v[72:75], a[116:119], v[20:23], v[72:75]
    ds_read_b128 v[12:15], v230 offset:36864
    v_mfma_f32_16x16x32_bf16 v[72:75], a[140:143], v[24:27], v[72:75]
    ds_write_b128 v236, v[0:3] offset:24576
    v_mfma_f32_16x16x32_bf16 v[68:71], a[160:163], v[28:31], v[68:71]
    ds_read_b128 v[16:19], v231 offset:36864
    v_mfma_f32_16x16x32_bf16 v[68:71], a[184:187], v[32:35], v[68:71]
    v_mfma_f32_16x16x32_bf16 v[68:71], a[208:211], v[36:39], v[68:71]
    s_waitcnt lgkmcnt(7)
    buffer_store_dwordx4 v[240:243], v232, s[36:39], s56 offen sc1
    ds_read_b128 v[20:23], v228 offset:37120
    v_mfma_f32_16x16x32_bf16 v[68:71], a[232:235], v[40:43], v[68:71]
    v_mfma_f32_16x16x32_bf16 v[68:71], v[196:199], v[44:47], v[68:71]
    ds_read_b128 v[24:27], v229 offset:37120
    v_mfma_f32_16x16x32_bf16 v[68:71], v[220:223], v[48:51], v[68:71]
    v_mfma_f32_16x16x32_bf16 v[72:75], a[164:167], v[28:31], v[72:75]
    s_waitcnt lgkmcnt(8)
    buffer_store_dwordx4 v[244:247], v233, s[36:39], s56 offen offset:1024 sc1
    ds_read_b128 v[28:31], v230 offset:37120
    v_mfma_f32_16x16x32_bf16 v[72:75], a[188:191], v[32:35], v[72:75]
    ds_read_b128 v[32:35], v231 offset:37120
    v_mfma_f32_16x16x32_bf16 v[72:75], a[212:215], v[36:39], v[72:75]
    ds_read_b128 v[36:39], v228 offset:37376
    v_mfma_f32_16x16x32_bf16 v[72:75], a[236:239], v[40:43], v[72:75]
    ds_read_b128 v[40:43], v229 offset:37376
    v_mfma_f32_16x16x32_bf16 v[72:75], v[200:203], v[44:47], v[72:75]
    s_waitcnt lgkmcnt(10)
    buffer_store_dwordx4 v[248:251], v234, s[36:39], s56 offen offset:2048 sc1
    s_add_u32 s56, s78, 294912
    ds_read_b128 v[44:47], v230 offset:37376
    v_mfma_f32_16x16x32_bf16 v[72:75], v[224:227], v[48:51], v[72:75]
    ds_read_b128 v[48:51], v231 offset:37376
    s_waitcnt lgkmcnt(10)
    v_mfma_f32_16x16x32_bf16 v[52:55], a[0:3], v[4:7], v[184:187]
    s_cmp_eq_u32 s83, s85
    s_cselect_b32 s53, -49152, 0
    v_mfma_f32_16x16x32_bf16 v[52:55], a[24:27], v[8:11], v[52:55]
    s_add_u32 s83, s83, 1
    v_mfma_f32_16x16x32_bf16 v[52:55], a[48:51], v[12:15], v[52:55]
    s_waitcnt lgkmcnt(6)
    v_mfma_f32_16x16x32_bf16 v[52:55], a[72:75], v[16:19], v[52:55]
    v_cvt_pk_bf16_f32 v0, v68, v69
    v_cvt_pk_bf16_f32 v1, v70, v71
    v_mfma_f32_16x16x32_bf16 v[52:55], a[96:99], v[20:23], v[52:55]
    s_cmp_eq_u32 s83, s85
    s_cselect_b32 s53, 49152, s53
    v_mfma_f32_16x16x32_bf16 v[52:55], a[120:123], v[24:27], v[52:55]
    s_waitcnt lgkmcnt(3)
    v_mfma_f32_16x16x32_bf16 v[52:55], a[144:147], v[28:31], v[52:55]
    v_mfma_f32_16x16x32_bf16 v[52:55], a[168:171], v[32:35], v[52:55]
    v_mfma_f32_16x16x32_bf16 v[52:55], a[192:195], v[36:39], v[52:55]
    s_waitcnt lgkmcnt(0)
    v_mfma_f32_16x16x32_bf16 v[52:55], a[216:219], v[40:43], v[52:55]
    v_cvt_pk_bf16_f32 v2, v72, v73
    v_cvt_pk_bf16_f32 v3, v74, v75
    v_mfma_f32_16x16x32_bf16 v[52:55], a[240:243], v[44:47], v[52:55]
    ds_write_b128 v237, v[0:3] offset:24576
    v_mfma_f32_16x16x32_bf16 v[52:55], v[204:207], v[48:51], v[52:55]
    v_mfma_f32_16x16x32_bf16 v[56:59], a[4:7], v[4:7], v[188:191]
    s_add_u32 s55, s81, 768
    v_mfma_f32_16x16x32_bf16 v[56:59], a[28:31], v[8:11], v[56:59]
    s_add_u32 m0, s82, 12288
    v_mfma_f32_16x16x32_bf16 v[56:59], a[52:55], v[12:15], v[56:59]
    buffer_load_dwordx4 v232, s[20:23], s55 offen nt lds
    v_mfma_f32_16x16x32_bf16 v[56:59], a[76:79], v[16:19], v[56:59]
    v_mfma_f32_16x16x32_bf16 v[56:59], a[100:103], v[20:23], v[56:59]
    v_mfma_f32_16x16x32_bf16 v[56:59], a[124:127], v[24:27], v[56:59]
    buffer_load_dwordx4 v233, s[20:23], s55 offen offset:1024 nt lds
    v_mfma_f32_16x16x32_bf16 v[56:59], a[148:151], v[28:31], v[56:59]
    v_mfma_f32_16x16x32_bf16 v[56:59], a[172:175], v[32:35], v[56:59]
    v_mfma_f32_16x16x32_bf16 v[56:59], a[196:199], v[36:39], v[56:59]
    buffer_load_dwordx4 v234, s[20:23], s55 offen offset:2048 nt lds
    v_mfma_f32_16x16x32_bf16 v[56:59], a[220:223], v[40:43], v[56:59]
    s_cbranch_vccz L_lo3
    s_waitcnt vmcnt(6)
L_lo3:
    v_cvt_pk_bf16_f32 v0, v52, v53
    v_cvt_pk_bf16_f32 v1, v54, v55
    v_mfma_f32_16x16x32_bf16 v[56:59], a[244:247], v[44:47], v[56:59]
    s_set_gpr_idx_on s54, gpr_idx(SRC0)
    v_mov_b64 v[252:253], v[76:77]
    v_mov_b64 v[254:255], v[78:79]
    s_set_gpr_idx_off
    v_mfma_f32_16x16x32_bf16 v[56:59], v[208:211], v[48:51], v[56:59]
    v_lshlrev_b32 v184, 16, v252
    v_and_b32 v185, s59, v252
    v_mfma_f32_16x16x32_bf16 v[60:63], a[8:11], v[4:7], v[192:195]
    v_lshlrev_b32 v186, 16, v253
    v_and_b32 v187, s59, v253
    v_mfma_f32_16x16x32_bf16 v[60:63], a[32:35], v[8:11], v[60:63]
    v_lshlrev_b32 v188, 16, v254
    v_and_b32 v189, s59, v254
    v_mfma_f32_16x16x32_bf16 v[60:63], a[56:59], v[12:15], v[60:63]
    v_lshlrev_b32 v190, 16, v255
    v_and_b32 v191, s59, v255
    v_mfma_f32_16x16x32_bf16 v[60:63], a[80:83], v[16:19], v[60:63]
    v_mfma_f32_16x16x32_bf16 v[60:63], a[104:107], v[20:23], v[60:63]
    v_mfma_f32_16x16x32_bf16 v[60:63], a[128:131], v[24:27], v[60:63]
    v_mfma_f32_16x16x32_bf16 v[60:63], a[152:155], v[28:31], v[60:63]
    v_mfma_f32_16x16x32_bf16 v[60:63], a[176:179], v[32:35], v[60:63]
    s_cmp_eq_u32 s65, 0
    s_cbranch_scc1 L_md3
    s_waitcnt vmcnt(6)
L_md3:
    v_mfma_f32_16x16x32_bf16 v[60:63], a[200:203], v[36:39], v[60:63]
    v_cvt_pk_bf16_f32 v2, v56, v57
    v_cvt_pk_bf16_f32 v3, v58, v59
    v_mfma_f32_16x16x32_bf16 v[60:63], a[224:227], v[40:43], v[60:63]
    ds_write_b128 v235, v[0:3] offset:36864
    v_mfma_f32_16x16x32_bf16 v[60:63], a[248:251], v[44:47], v[60:63]
    v_mfma_f32_16x16x32_bf16 v[60:63], v[212:215], v[48:51], v[60:63]
    v_mfma_f32_16x16x32_bf16 v[64:67], a[12:15], v[4:7], v[76:79]
    v_add_u32 v228, s53, v228
    v_add_u32 v229, s53, v229
    v_mfma_f32_16x16x32_bf16 v[64:67], a[36:39], v[8:11], v[64:67]
    v_add_u32 v230, s53, v230
    v_add_u32 v231, s53, v231
    v_mfma_f32_16x16x32_bf16 v[64:67], a[60:63], v[12:15], v[64:67]
    v_mfma_f32_16x16x32_bf16 v[64:67], a[84:87], v[16:19], v[64:67]
    v_mfma_f32_16x16x32_bf16 v[64:67], a[108:111], v[20:23], v[64:67]
    v_mfma_f32_16x16x32_bf16 v[64:67], a[132:135], v[24:27], v[64:67]
    v_mfma_f32_16x16x32_bf16 v[64:67], a[156:159], v[28:31], v[64:67]
    v_mfma_f32_16x16x32_bf16 v[64:67], a[180:183], v[32:35], v[64:67]
    v_mfma_f32_16x16x32_bf16 v[64:67], a[204:207], v[36:39], v[64:67]
    v_cvt_pk_bf16_f32 v0, v60, v61
    v_cvt_pk_bf16_f32 v1, v62, v63
    v_mfma_f32_16x16x32_bf16 v[64:67], a[228:231], v[40:43], v[64:67]
    s_set_gpr_idx_on s54, gpr_idx(SRC0)
    v_mov_b64 v[252:253], v[80:81]
    v_mov_b64 v[254:255], v[82:83]
    s_set_gpr_idx_off
    v_mfma_f32_16x16x32_bf16 v[64:67], a[252:255], v[44:47], v[64:67]
    v_lshlrev_b32 v192, 16, v252
    v_and_b32 v193, s59, v252
    v_mfma_f32_16x16x32_bf16 v[64:67], v[216:219], v[48:51], v[64:67]
    v_lshlrev_b32 v194, 16, v253
    v_and_b32 v195, s59, v253
    v_mfma_f32_16x16x32_bf16 v[68:71], a[16:19], v[4:7], v[80:83]
    v_lshlrev_b32 v76, 16, v254
    v_and_b32 v77, s59, v254
    v_mfma_f32_16x16x32_bf16 v[68:71], a[40:43], v[8:11], v[68:71]
    s_waitcnt vmcnt(6) lgkmcnt(1)
    s_barrier
    v_lshlrev_b32 v78, 16, v255
    v_and_b32 v79, s59, v255
    v_mfma_f32_16x16x32_bf16 v[68:71], a[64:67], v[12:15], v[68:71]
    ds_read_b128 v[240:243], v238 offset:24576
    v_mfma_f32_16x16x32_bf16 v[68:71], a[88:91], v[16:19], v[68:71]
    ds_read_b128 v[244:247], v238 offset:25600
    v_mfma_f32_16x16x32_bf16 v[68:71], a[112:115], v[20:23], v[68:71]
    v_mfma_f32_16x16x32_bf16 v[68:71], a[136:139], v[24:27], v[68:71]
    v_mfma_f32_16x16x32_bf16 v[72:75], a[20:23], v[4:7], v[84:87]
    ds_read_b128 v[4:7], v228 offset:0
    v_mfma_f32_16x16x32_bf16 v[72:75], a[44:47], v[8:11], v[72:75]
    ds_read_b128 v[248:251], v238 offset:26624
    v_mfma_f32_16x16x32_bf16 v[72:75], a[68:71], v[12:15], v[72:75]
    ds_read_b128 v[8:11], v229 offset:0
    v_mfma_f32_16x16x32_bf16 v[72:75], a[92:95], v[16:19], v[72:75]
    v_cvt_pk_bf16_f32 v2, v64, v65
    v_cvt_pk_bf16_f32 v3, v66, v67
    v_mfma_f32_16x16x32_bf16 v[72:75], a[116:119], v[20:23], v[72:75]
    ds_read_b128 v[12:15], v230 offset:0
    v_mfma_f32_16x16x32_bf16 v[72:75], a[140:143], v[24:27], v[72:75]
    ds_write_b128 v236, v[0:3] offset:36864
    v_mfma_f32_16x16x32_bf16 v[68:71], a[160:163], v[28:31], v[68:71]
    ds_read_b128 v[16:19], v231 offset:0
    v_mfma_f32_16x16x32_bf16 v[68:71], a[184:187], v[32:35], v[68:71]
    v_mfma_f32_16x16x32_bf16 v[68:71], a[208:211], v[36:39], v[68:71]
    s_waitcnt lgkmcnt(7)
    buffer_store_dwordx4 v[240:243], v232, s[36:39], s56 offen sc1
    ds_read_b128 v[20:23], v228 offset:256
    v_mfma_f32_16x16x32_bf16 v[68:71], a[232:235], v[40:43], v[68:71]
    v_mfma_f32_16x16x32_bf16 v[68:71], v[196:199], v[44:47], v[68:71]
    ds_read_b128 v[24:27], v229 offset:256
    v_mfma_f32_16x16x32_bf16 v[68:71], v[220:223], v[48:51], v[68:71]
    v_mfma_f32_16x16x32_bf16 v[72:75], a[164:167], v[28:31], v[72:75]
    s_waitcnt lgkmcnt(8)
    buffer_store_dwordx4 v[244:247], v233, s[36:39], s56 offen offset:1024 sc1
    ds_read_b128 v[28:31], v230 offset:256
    v_mfma_f32_16x16x32_bf16 v[72:75], a[188:191], v[32:35], v[72:75]
    ds_read_b128 v[32:35], v231 offset:256
    v_mfma_f32_16x16x32_bf16 v[72:75], a[212:215], v[36:39], v[72:75]
    ds_read_b128 v[36:39], v228 offset:512
    v_mfma_f32_16x16x32_bf16 v[72:75], a[236:239], v[40:43], v[72:75]
    ds_read_b128 v[40:43], v229 offset:512
    v_mfma_f32_16x16x32_bf16 v[72:75], v[200:203], v[44:47], v[72:75]
    s_waitcnt lgkmcnt(10)
    buffer_store_dwordx4 v[248:251], v234, s[36:39], s56 offen offset:2048 sc1
    s_add_u32 s56, s78, 295680
    ds_read_b128 v[44:47], v230 offset:512
    v_mfma_f32_16x16x32_bf16 v[72:75], v[224:227], v[48:51], v[72:75]
    ds_read_b128 v[48:51], v231 offset:512
    s_mov_b32 s78, s79
    s_mov_b32 s79, s80
    s_cmp_lg_u32 s83, 8
    s_cbranch_scc1 L_p2
    s_waitcnt lgkmcnt(10)
    v_mfma_f32_16x16x32_bf16 v[52:55], a[0:3], v[4:7], v[184:187]
    v_mfma_f32_16x16x32_bf16 v[52:55], a[24:27], v[8:11], v[52:55]
    v_mfma_f32_16x16x32_bf16 v[52:55], a[48:51], v[12:15], v[52:55]
    s_waitcnt lgkmcnt(6)
    v_mfma_f32_16x16x32_bf16 v[52:55], a[72:75], v[16:19], v[52:55]
    v_cvt_pk_bf16_f32 v0, v68, v69
    v_cvt_pk_bf16_f32 v1, v70, v71
    v_mfma_f32_16x16x32_bf16 v[52:55], a[96:99], v[20:23], v[52:55]
    v_mfma_f32_16x16x32_bf16 v[52:55], a[120:123], v[24:27], v[52:55]
    s_waitcnt lgkmcnt(3)
    v_mfma_f32_16x16x32_bf16 v[52:55], a[144:147], v[28:31], v[52:55]
    v_mfma_f32_16x16x32_bf16 v[52:55], a[168:171], v[32:35], v[52:55]
    v_mfma_f32_16x16x32_bf16 v[52:55], a[192:195], v[36:39], v[52:55]
    s_waitcnt lgkmcnt(0)
    v_mfma_f32_16x16x32_bf16 v[52:55], a[216:219], v[40:43], v[52:55]
    v_cvt_pk_bf16_f32 v2, v72, v73
    v_cvt_pk_bf16_f32 v3, v74, v75
    v_mfma_f32_16x16x32_bf16 v[52:55], a[240:243], v[44:47], v[52:55]
    ds_write_b128 v237, v[0:3] offset:36864
    v_mfma_f32_16x16x32_bf16 v[52:55], v[204:207], v[48:51], v[52:55]
    v_mfma_f32_16x16x32_bf16 v[56:59], a[4:7], v[4:7], v[188:191]
    s_add_u32 s55, s81, 294912
    v_mfma_f32_16x16x32_bf16 v[56:59], a[28:31], v[8:11], v[56:59]
    s_add_u32 m0, s82, 24576
    v_mfma_f32_16x16x32_bf16 v[56:59], a[52:55], v[12:15], v[56:59]
    buffer_load_dwordx4 v232, s[20:23], s55 offen nt lds
    v_mfma_f32_16x16x32_bf16 v[56:59], a[76:79], v[16:19], v[56:59]
    v_mfma_f32_16x16x32_bf16 v[56:59], a[100:103], v[20:23], v[56:59]
    v_mfma_f32_16x16x32_bf16 v[56:59], a[124:127], v[24:27], v[56:59]
    buffer_load_dwordx4 v233, s[20:23], s55 offen offset:1024 nt lds
    v_mfma_f32_16x16x32_bf16 v[56:59], a[148:151], v[28:31], v[56:59]
    v_mfma_f32_16x16x32_bf16 v[56:59], a[172:175], v[32:35], v[56:59]
    v_mfma_f32_16x16x32_bf16 v[56:59], a[196:199], v[36:39], v[56:59]
    buffer_load_dwordx4 v234, s[20:23], s55 offen offset:2048 nt lds
    v_mfma_f32_16x16x32_bf16 v[56:59], a[220:223], v[40:43], v[56:59]
    v_cvt_pk_bf16_f32 v0, v52, v53
    v_cvt_pk_bf16_f32 v1, v54, v55
    v_mfma_f32_16x16x32_bf16 v[56:59], a[244:247], v[44:47], v[56:59]
    s_set_gpr_idx_on s54, gpr_idx(SRC0)
    v_mov_b64 v[252:253], v[84:85]
    v_mov_b64 v[254:255], v[86:87]
    s_set_gpr_idx_off
    v_mfma_f32_16x16x32_bf16 v[56:59], v[208:211], v[48:51], v[56:59]
    v_lshlrev_b32 v80, 16, v252
    v_and_b32 v81, s59, v252
    v_mfma_f32_16x16x32_bf16 v[60:63], a[8:11], v[4:7], v[192:195]
    v_lshlrev_b32 v82, 16, v253
    v_and_b32 v83, s59, v253
    v_mfma_f32_16x16x32_bf16 v[60:63], a[32:35], v[8:11], v[60:63]
    v_lshlrev_b32 v84, 16, v254
    v_and_b32 v85, s59, v254
    v_mfma_f32_16x16x32_bf16 v[60:63], a[56:59], v[12:15], v[60:63]
    v_lshlrev_b32 v86, 16, v255
    v_and_b32 v87, s59, v255
    v_mfma_f32_16x16x32_bf16 v[60:63], a[80:83], v[16:19], v[60:63]
    v_mfma_f32_16x16x32_bf16 v[60:63], a[104:107], v[20:23], v[60:63]
    v_mfma_f32_16x16x32_bf16 v[60:63], a[128:131], v[24:27], v[60:63]
    v_mfma_f32_16x16x32_bf16 v[60:63], a[152:155], v[28:31], v[60:63]
    v_mfma_f32_16x16x32_bf16 v[60:63], a[176:179], v[32:35], v[60:63]
    v_mfma_f32_16x16x32_bf16 v[60:63], a[200:203], v[36:39], v[60:63]
    v_cvt_pk_bf16_f32 v2, v56, v57
    v_cvt_pk_bf16_f32 v3, v58, v59
    v_mfma_f32_16x16x32_bf16 v[60:63], a[224:227], v[40:43], v[60:63]
    ds_write_b128 v235, v[0:3] offset:0
    v_mfma_f32_16x16x32_bf16 v[60:63], a[248:251], v[44:47], v[60:63]
    v_mfma_f32_16x16x32_bf16 v[60:63], v[212:215], v[48:51], v[60:63]
    v_mfma_f32_16x16x32_bf16 v[64:67], a[12:15], v[4:7], v[76:79]
    v_mfma_f32_16x16x32_bf16 v[64:67], a[36:39], v[8:11], v[64:67]
    v_mfma_f32_16x16x32_bf16 v[64:67], a[60:63], v[12:15], v[64:67]
    v_mfma_f32_16x16x32_bf16 v[64:67], a[84:87], v[16:19], v[64:67]
    v_mfma_f32_16x16x32_bf16 v[64:67], a[108:111], v[20:23], v[64:67]
    v_mfma_f32_16x16x32_bf16 v[64:67], a[132:135], v[24:27], v[64:67]
    v_mfma_f32_16x16x32_bf16 v[64:67], a[156:159], v[28:31], v[64:67]
    v_mfma_f32_16x16x32_bf16 v[64:67], a[180:183], v[32:35], v[64:67]
    v_mfma_f32_16x16x32_bf16 v[64:67], a[204:207], v[36:39], v[64:67]
    v_cvt_pk_bf16_f32 v0, v60, v61
    v_cvt_pk_bf16_f32 v1, v62, v63
    v_mfma_f32_16x16x32_bf16 v[64:67], a[228:231], v[40:43], v[64:67]
    v_mfma_f32_16x16x32_bf16 v[64:67], a[252:255], v[44:47], v[64:67]
    v_mfma_f32_16x16x32_bf16 v[64:67], v[216:219], v[48:51], v[64:67]
    v_mfma_f32_16x16x32_bf16 v[68:71], a[16:19], v[4:7], v[80:83]
    v_mfma_f32_16x16x32_bf16 v[68:71], a[40:43], v[8:11], v[68:71]
    s_waitcnt vmcnt(6) lgkmcnt(1)
    s_barrier
    v_mfma_f32_16x16x32_bf16 v[68:71], a[64:67], v[12:15], v[68:71]
    ds_read_b128 v[240:243], v238 offset:36864
    v_mfma_f32_16x16x32_bf16 v[68:71], a[88:91], v[16:19], v[68:71]
    ds_read_b128 v[244:247], v238 offset:37888
    v_mfma_f32_16x16x32_bf16 v[68:71], a[112:115], v[20:23], v[68:71]
    v_mfma_f32_16x16x32_bf16 v[68:71], a[136:139], v[24:27], v[68:71]
    v_mfma_f32_16x16x32_bf16 v[72:75], a[20:23], v[4:7], v[84:87]
    ds_read_b128 v[4:7], v228 offset:12288
    v_mfma_f32_16x16x32_bf16 v[72:75], a[44:47], v[8:11], v[72:75]
    ds_read_b128 v[248:251], v238 offset:38912
    v_mfma_f32_16x16x32_bf16 v[72:75], a[68:71], v[12:15], v[72:75]
    ds_read_b128 v[8:11], v229 offset:12288
    v_mfma_f32_16x16x32_bf16 v[72:75], a[92:95], v[16:19], v[72:75]
    v_cvt_pk_bf16_f32 v2, v64, v65
    v_cvt_pk_bf16_f32 v3, v66, v67
    v_mfma_f32_16x16x32_bf16 v[72:75], a[116:119], v[20:23], v[72:75]
    ds_read_b128 v[12:15], v230 offset:12288
    v_mfma_f32_16x16x32_bf16 v[72:75], a[140:143], v[24:27], v[72:75]
    ds_write_b128 v236, v[0:3] offset:0
    v_mfma_f32_16x16x32_bf16 v[68:71], a[160:163], v[28:31], v[68:71]
    ds_read_b128 v[16:19], v231 offset:12288
    v_mfma_f32_16x16x32_bf16 v[68:71], a[184:187], v[32:35], v[68:71]
    v_mfma_f32_16x16x32_bf16 v[68:71], a[208:211], v[36:39], v[68:71]
    s_waitcnt lgkmcnt(7)
    buffer_store_dwordx4 v[240:243], v232, s[36:39], s56 offen sc1
    ds_read_b128 v[20:23], v228 offset:12544
    v_mfma_f32_16x16x32_bf16 v[68:71], a[232:235], v[40:43], v[68:71]
    v_mfma_f32_16x16x32_bf16 v[68:71], v[196:199], v[44:47], v[68:71]
    ds_read_b128 v[24:27], v229 offset:12544
    v_mfma_f32_16x16x32_bf16 v[68:71], v[220:223], v[48:51], v[68:71]
    v_mfma_f32_16x16x32_bf16 v[72:75], a[164:167], v[28:31], v[72:75]
    s_waitcnt lgkmcnt(8)
    buffer_store_dwordx4 v[244:247], v233, s[36:39], s56 offen offset:1024 sc1
    ds_read_b128 v[28:31], v230 offset:12544
    v_mfma_f32_16x16x32_bf16 v[72:75], a[188:191], v[32:35], v[72:75]
    ds_read_b128 v[32:35], v231 offset:12544
    v_mfma_f32_16x16x32_bf16 v[72:75], a[212:215], v[36:39], v[72:75]
    ds_read_b128 v[36:39], v228 offset:12800
    v_mfma_f32_16x16x32_bf16 v[72:75], a[236:239], v[40:43], v[72:75]
    ds_read_b128 v[40:43], v229 offset:12800
    v_mfma_f32_16x16x32_bf16 v[72:75], v[200:203], v[44:47], v[72:75]
    s_waitcnt lgkmcnt(10)
    buffer_store_dwordx4 v[248:251], v234, s[36:39], s56 offen offset:2048 sc1
    s_add_u32 s56, s78, 0
    ds_read_b128 v[44:47], v230 offset:12800
    v_mfma_f32_16x16x32_bf16 v[72:75], v[224:227], v[48:51], v[72:75]
    ds_read_b128 v[48:51], v231 offset:12800
    s_waitcnt lgkmcnt(10)
    v_mfma_f32_16x16x32_bf16 v[52:55], a[0:3], v[4:7], v[184:187]
    v_mfma_f32_16x16x32_bf16 v[52:55], a[24:27], v[8:11], v[52:55]
    v_mfma_f32_16x16x32_bf16 v[52:55], a[48:51], v[12:15], v[52:55]
    s_waitcnt lgkmcnt(6)
    v_mfma_f32_16x16x32_bf16 v[52:55], a[72:75], v[16:19], v[52:55]
    v_cvt_pk_bf16_f32 v0, v68, v69
    v_cvt_pk_bf16_f32 v1, v70, v71
    v_mfma_f32_16x16x32_bf16 v[52:55], a[96:99], v[20:23], v[52:55]
    v_mfma_f32_16x16x32_bf16 v[52:55], a[120:123], v[24:27], v[52:55]
    s_waitcnt lgkmcnt(3)
    v_mfma_f32_16x16x32_bf16 v[52:55], a[144:147], v[28:31], v[52:55]
    v_mfma_f32_16x16x32_bf16 v[52:55], a[168:171], v[32:35], v[52:55]
    v_mfma_f32_16x16x32_bf16 v[52:55], a[192:195], v[36:39], v[52:55]
    s_waitcnt lgkmcnt(0)
    v_mfma_f32_16x16x32_bf16 v[52:55], a[216:219], v[40:43], v[52:55]
    v_cvt_pk_bf16_f32 v2, v72, v73
    v_cvt_pk_bf16_f32 v3, v74, v75
    v_mfma_f32_16x16x32_bf16 v[52:55], a[240:243], v[44:47], v[52:55]
    ds_write_b128 v237, v[0:3] offset:0
    v_mfma_f32_16x16x32_bf16 v[52:55], v[204:207], v[48:51], v[52:55]
    v_mfma_f32_16x16x32_bf16 v[56:59], a[4:7], v[4:7], v[188:191]
    s_add_u32 s55, s81, 295680
    v_mfma_f32_16x16x32_bf16 v[56:59], a[28:31], v[8:11], v[56:59]
    s_add_u32 m0, s82, 36864
    v_mfma_f32_16x16x32_bf16 v[56:59], a[52:55], v[12:15], v[56:59]
    buffer_load_dwordx4 v232, s[20:23], s55 offen nt lds
    v_mfma_f32_16x16x32_bf16 v[56:59], a[76:79], v[16:19], v[56:59]
    v_mfma_f32_16x16x32_bf16 v[56:59], a[100:103], v[20:23], v[56:59]
    v_mfma_f32_16x16x32_bf16 v[56:59], a[124:127], v[24:27], v[56:59]
    buffer_load_dwordx4 v233, s[20:23], s55 offen offset:1024 nt lds
    v_mfma_f32_16x16x32_bf16 v[56:59], a[148:151], v[28:31], v[56:59]
    v_mfma_f32_16x16x32_bf16 v[56:59], a[172:175], v[32:35], v[56:59]
    v_mfma_f32_16x16x32_bf16 v[56:59], a[196:199], v[36:39], v[56:59]
    buffer_load_dwordx4 v234, s[20:23], s55 offen offset:2048 nt lds
    v_mfma_f32_16x16x32_bf16 v[56:59], a[220:223], v[40:43], v[56:59]
    v_cvt_pk_bf16_f32 v0, v52, v53
    v_cvt_pk_bf16_f32 v1, v54, v55
    v_mfma_f32_16x16x32_bf16 v[56:59], a[244:247], v[44:47], v[56:59]
    v_mfma_f32_16x16x32_bf16 v[56:59], v[208:211], v[48:51], v[56:59]
    s_add_u32 s54, s54, 12
    v_mfma_f32_16x16x32_bf16 v[60:63], a[8:11], v[4:7], v[192:195]
    v_mfma_f32_16x16x32_bf16 v[60:63], a[32:35], v[8:11], v[60:63]
    v_mfma_f32_16x16x32_bf16 v[60:63], a[56:59], v[12:15], v[60:63]
    v_mfma_f32_16x16x32_bf16 v[60:63], a[80:83], v[16:19], v[60:63]
    v_mfma_f32_16x16x32_bf16 v[60:63], a[104:107], v[20:23], v[60:63]
    v_mfma_f32_16x16x32_bf16 v[60:63], a[128:131], v[24:27], v[60:63]
    v_mfma_f32_16x16x32_bf16 v[60:63], a[152:155], v[28:31], v[60:63]
    v_mfma_f32_16x16x32_bf16 v[60:63], a[176:179], v[32:35], v[60:63]
    v_mfma_f32_16x16x32_bf16 v[60:63], a[200:203], v[36:39], v[60:63]
    v_cvt_pk_bf16_f32 v2, v56, v57
    v_cvt_pk_bf16_f32 v3, v58, v59
    v_mfma_f32_16x16x32_bf16 v[60:63], a[224:227], v[40:43], v[60:63]
    ds_write_b128 v235, v[0:3] offset:12288
    v_mfma_f32_16x16x32_bf16 v[60:63], a[248:251], v[44:47], v[60:63]
    v_mfma_f32_16x16x32_bf16 v[60:63], v[212:215], v[48:51], v[60:63]
    v_mfma_f32_16x16x32_bf16 v[64:67], a[12:15], v[4:7], v[76:79]
    v_mfma_f32_16x16x32_bf16 v[64:67], a[36:39], v[8:11], v[64:67]
    v_mfma_f32_16x16x32_bf16 v[64:67], a[60:63], v[12:15], v[64:67]
    v_mfma_f32_16x16x32_bf16 v[64:67], a[84:87], v[16:19], v[64:67]
    v_mfma_f32_16x16x32_bf16 v[64:67], a[108:111], v[20:23], v[64:67]
    v_mfma_f32_16x16x32_bf16 v[64:67], a[132:135], v[24:27], v[64:67]
    v_mfma_f32_16x16x32_bf16 v[64:67], a[156:159], v[28:31], v[64:67]
    v_mfma_f32_16x16x32_bf16 v[64:67], a[180:183], v[32:35], v[64:67]
    v_mfma_f32_16x16x32_bf16 v[64:67], a[204:207], v[36:39], v[64:67]
    v_cvt_pk_bf16_f32 v0, v60, v61
    v_cvt_pk_bf16_f32 v1, v62, v63
    v_mfma_f32_16x16x32_bf16 v[64:67], a[228:231], v[40:43], v[64:67]
    v_mfma_f32_16x16x32_bf16 v[64:67], a[252:255], v[44:47], v[64:67]
    v_mfma_f32_16x16x32_bf16 v[64:67], v[216:219], v[48:51], v[64:67]
    v_mfma_f32_16x16x32_bf16 v[68:71], a[16:19], v[4:7], v[80:83]
    v_mfma_f32_16x16x32_bf16 v[68:71], a[40:43], v[8:11], v[68:71]
    s_waitcnt vmcnt(6) lgkmcnt(1)
    s_barrier
    v_mfma_f32_16x16x32_bf16 v[68:71], a[64:67], v[12:15], v[68:71]
    ds_read_b128 v[240:243], v238 offset:0
    v_mfma_f32_16x16x32_bf16 v[68:71], a[88:91], v[16:19], v[68:71]
    ds_read_b128 v[244:247], v238 offset:1024
    v_mfma_f32_16x16x32_bf16 v[68:71], a[112:115], v[20:23], v[68:71]
    v_mfma_f32_16x16x32_bf16 v[68:71], a[136:139], v[24:27], v[68:71]
    v_mfma_f32_16x16x32_bf16 v[72:75], a[20:23], v[4:7], v[84:87]
    ds_read_b128 v[4:7], v228 offset:24576
    v_mfma_f32_16x16x32_bf16 v[72:75], a[44:47], v[8:11], v[72:75]
    ds_read_b128 v[248:251], v238 offset:2048
    v_mfma_f32_16x16x32_bf16 v[72:75], a[68:71], v[12:15], v[72:75]
    ds_read_b128 v[8:11], v229 offset:24576
    v_mfma_f32_16x16x32_bf16 v[72:75], a[92:95], v[16:19], v[72:75]
    v_cvt_pk_bf16_f32 v2, v64, v65
    v_cvt_pk_bf16_f32 v3, v66, v67
    v_mfma_f32_16x16x32_bf16 v[72:75], a[116:119], v[20:23], v[72:75]
    ds_read_b128 v[12:15], v230 offset:24576
    v_mfma_f32_16x16x32_bf16 v[72:75], a[140:143], v[24:27], v[72:75]
    ds_write_b128 v236, v[0:3] offset:12288
    v_mfma_f32_16x16x32_bf16 v[68:71], a[160:163], v[28:31], v[68:71]
    ds_read_b128 v[16:19], v231 offset:24576
    v_mfma_f32_16x16x32_bf16 v[68:71], a[184:187], v[32:35], v[68:71]
    v_mfma_f32_16x16x32_bf16 v[68:71], a[208:211], v[36:39], v[68:71]
    s_waitcnt lgkmcnt(7)
    buffer_store_dwordx4 v[240:243], v232, s[36:39], s56 offen sc1
    ds_read_b128 v[20:23], v228 offset:24832
    v_mfma_f32_16x16x32_bf16 v[68:71], a[232:235], v[40:43], v[68:71]
    v_mfma_f32_16x16x32_bf16 v[68:71], v[196:199], v[44:47], v[68:71]
    ds_read_b128 v[24:27], v229 offset:24832
    v_mfma_f32_16x16x32_bf16 v[68:71], v[220:223], v[48:51], v[68:71]
    v_mfma_f32_16x16x32_bf16 v[72:75], a[164:167], v[28:31], v[72:75]
    s_waitcnt lgkmcnt(8)
    buffer_store_dwordx4 v[244:247], v233, s[36:39], s56 offen offset:1024 sc1
    ds_read_b128 v[28:31], v230 offset:24832
    v_mfma_f32_16x16x32_bf16 v[72:75], a[188:191], v[32:35], v[72:75]
    ds_read_b128 v[32:35], v231 offset:24832
    v_mfma_f32_16x16x32_bf16 v[72:75], a[212:215], v[36:39], v[72:75]
    ds_read_b128 v[36:39], v228 offset:25088
    v_mfma_f32_16x16x32_bf16 v[72:75], a[236:239], v[40:43], v[72:75]
    ds_read_b128 v[40:43], v229 offset:25088
    v_mfma_f32_16x16x32_bf16 v[72:75], v[200:203], v[44:47], v[72:75]
    s_waitcnt lgkmcnt(10)
    buffer_store_dwordx4 v[248:251], v234, s[36:39], s56 offen offset:2048 sc1
    s_add_u32 s56, s78, 768
    ds_read_b128 v[44:47], v230 offset:25088
    v_mfma_f32_16x16x32_bf16 v[72:75], v[224:227], v[48:51], v[72:75]
    ds_read_b128 v[48:51], v231 offset:25088
    s_waitcnt lgkmcnt(10)
    v_mfma_f32_16x16x32_bf16 v[52:55], a[0:3], v[4:7], v[184:187]
    v_mfma_f32_16x16x32_bf16 v[52:55], a[24:27], v[8:11], v[52:55]
    v_mfma_f32_16x16x32_bf16 v[52:55], a[48:51], v[12:15], v[52:55]
    s_waitcnt lgkmcnt(6)
    v_mfma_f32_16x16x32_bf16 v[52:55], a[72:75], v[16:19], v[52:55]
    v_cvt_pk_bf16_f32 v0, v68, v69
    v_cvt_pk_bf16_f32 v1, v70, v71
    v_mfma_f32_16x16x32_bf16 v[52:55], a[96:99], v[20:23], v[52:55]
    v_mfma_f32_16x16x32_bf16 v[52:55], a[120:123], v[24:27], v[52:55]
    s_waitcnt lgkmcnt(3)
    v_mfma_f32_16x16x32_bf16 v[52:55], a[144:147], v[28:31], v[52:55]
    v_mfma_f32_16x16x32_bf16 v[52:55], a[168:171], v[32:35], v[52:55]
    v_mfma_f32_16x16x32_bf16 v[52:55], a[192:195], v[36:39], v[52:55]
    s_waitcnt lgkmcnt(0)
    v_mfma_f32_16x16x32_bf16 v[52:55], a[216:219], v[40:43], v[52:55]
    v_cvt_pk_bf16_f32 v2, v72, v73
    v_cvt_pk_bf16_f32 v3, v74, v75
    v_mfma_f32_16x16x32_bf16 v[52:55], a[240:243], v[44:47], v[52:55]
    ds_write_b128 v237, v[0:3] offset:12288
    v_mfma_f32_16x16x32_bf16 v[52:55], v[204:207], v[48:51], v[52:55]
    v_mfma_f32_16x16x32_bf16 v[56:59], a[4:7], v[4:7], v[188:191]
    s_add_u32 s55, s97, 0
    v_mfma_f32_16x16x32_bf16 v[56:59], a[28:31], v[8:11], v[56:59]
    s_add_u32 m0, s49, 147456
    v_mfma_f32_16x16x32_bf16 v[56:59], a[52:55], v[12:15], v[56:59]
    buffer_load_dwordx4 v232, s[20:23], s55 offen nt lds
    v_mfma_f32_16x16x32_bf16 v[56:59], a[76:79], v[16:19], v[56:59]
    v_mfma_f32_16x16x32_bf16 v[56:59], a[100:103], v[20:23], v[56:59]
    v_mfma_f32_16x16x32_bf16 v[56:59], a[124:127], v[24:27], v[56:59]
    buffer_load_dwordx4 v233, s[20:23], s55 offen offset:1024 nt lds
    v_mfma_f32_16x16x32_bf16 v[56:59], a[148:151], v[28:31], v[56:59]
    v_mfma_f32_16x16x32_bf16 v[56:59], a[172:175], v[32:35], v[56:59]
    v_mfma_f32_16x16x32_bf16 v[56:59], a[196:199], v[36:39], v[56:59]
    v_mfma_f32_16x16x32_bf16 v[56:59], a[220:223], v[40:43], v[56:59]
    v_cvt_pk_bf16_f32 v0, v52, v53
    v_cvt_pk_bf16_f32 v1, v54, v55
    v_mfma_f32_16x16x32_bf16 v[56:59], a[244:247], v[44:47], v[56:59]
    v_mfma_f32_16x16x32_bf16 v[56:59], v[208:211], v[48:51], v[56:59]
    v_mfma_f32_16x16x32_bf16 v[60:63], a[8:11], v[4:7], v[192:195]
    v_mfma_f32_16x16x32_bf16 v[60:63], a[32:35], v[8:11], v[60:63]
    v_mfma_f32_16x16x32_bf16 v[60:63], a[56:59], v[12:15], v[60:63]
    v_mfma_f32_16x16x32_bf16 v[60:63], a[80:83], v[16:19], v[60:63]
    v_mfma_f32_16x16x32_bf16 v[60:63], a[104:107], v[20:23], v[60:63]
    v_mfma_f32_16x16x32_bf16 v[60:63], a[128:131], v[24:27], v[60:63]
    v_mfma_f32_16x16x32_bf16 v[60:63], a[152:155], v[28:31], v[60:63]
    v_mfma_f32_16x16x32_bf16 v[60:63], a[176:179], v[32:35], v[60:63]
    v_mfma_f32_16x16x32_bf16 v[60:63], a[200:203], v[36:39], v[60:63]
    v_cvt_pk_bf16_f32 v2, v56, v57
    v_cvt_pk_bf16_f32 v3, v58, v59
    v_mfma_f32_16x16x32_bf16 v[60:63], a[224:227], v[40:43], v[60:63]
    ds_write_b128 v235, v[0:3] offset:24576
    v_mfma_f32_16x16x32_bf16 v[60:63], a[248:251], v[44:47], v[60:63]
    v_mfma_f32_16x16x32_bf16 v[60:63], v[212:215], v[48:51], v[60:63]
    v_mfma_f32_16x16x32_bf16 v[64:67], a[12:15], v[4:7], v[76:79]
    v_mfma_f32_16x16x32_bf16 v[64:67], a[36:39], v[8:11], v[64:67]
    v_mfma_f32_16x16x32_bf16 v[64:67], a[60:63], v[12:15], v[64:67]
    v_mfma_f32_16x16x32_bf16 v[64:67], a[84:87], v[16:19], v[64:67]
    v_mfma_f32_16x16x32_bf16 v[64:67], a[108:111], v[20:23], v[64:67]
    v_mfma_f32_16x16x32_bf16 v[64:67], a[132:135], v[24:27], v[64:67]
    v_mfma_f32_16x16x32_bf16 v[64:67], a[156:159], v[28:31], v[64:67]
    v_mfma_f32_16x16x32_bf16 v[64:67], a[180:183], v[32:35], v[64:67]
    v_mfma_f32_16x16x32_bf16 v[64:67], a[204:207], v[36:39], v[64:67]
    v_cvt_pk_bf16_f32 v0, v60, v61
    v_cvt_pk_bf16_f32 v1, v62, v63
    v_mfma_f32_16x16x32_bf16 v[64:67], a[228:231], v[40:43], v[64:67]
    v_mfma_f32_16x16x32_bf16 v[64:67], a[252:255], v[44:47], v[64:67]
    v_mfma_f32_16x16x32_bf16 v[64:67], v[216:219], v[48:51], v[64:67]
    v_mfma_f32_16x16x32_bf16 v[68:71], a[16:19], v[4:7], v[80:83]
    v_mfma_f32_16x16x32_bf16 v[68:71], a[40:43], v[8:11], v[68:71]
    s_waitcnt vmcnt(5) lgkmcnt(1)
    s_barrier
    v_mfma_f32_16x16x32_bf16 v[68:71], a[64:67], v[12:15], v[68:71]
    ds_read_b128 v[240:243], v238 offset:12288
    v_mfma_f32_16x16x32_bf16 v[68:71], a[88:91], v[16:19], v[68:71]
    ds_read_b128 v[244:247], v238 offset:13312
    v_mfma_f32_16x16x32_bf16 v[68:71], a[112:115], v[20:23], v[68:71]
    v_mfma_f32_16x16x32_bf16 v[68:71], a[136:139], v[24:27], v[68:71]
    v_mfma_f32_16x16x32_bf16 v[72:75], a[20:23], v[4:7], v[84:87]
    ds_read_b128 v[4:7], v228 offset:36864
    v_mfma_f32_16x16x32_bf16 v[72:75], a[44:47], v[8:11], v[72:75]
    ds_read_b128 v[248:251], v238 offset:14336
    v_mfma_f32_16x16x32_bf16 v[72:75], a[68:71], v[12:15], v[72:75]
    ds_read_b128 v[8:11], v229 offset:36864
    v_mfma_f32_16x16x32_bf16 v[72:75], a[92:95], v[16:19], v[72:75]
    v_cvt_pk_bf16_f32 v2, v64, v65
    v_cvt_pk_bf16_f32 v3, v66, v67
    v_mfma_f32_16x16x32_bf16 v[72:75], a[116:119], v[20:23], v[72:75]
    ds_read_b128 v[12:15], v230 offset:36864
    v_mfma_f32_16x16x32_bf16 v[72:75], a[140:143], v[24:27], v[72:75]
    ds_write_b128 v236, v[0:3] offset:24576
    v_mfma_f32_16x16x32_bf16 v[68:71], a[160:163], v[28:31], v[68:71]
    ds_read_b128 v[16:19], v231 offset:36864
    v_mfma_f32_16x16x32_bf16 v[68:71], a[184:187], v[32:35], v[68:71]
    v_mfma_f32_16x16x32_bf16 v[68:71], a[208:211], v[36:39], v[68:71]
    s_waitcnt lgkmcnt(7)
    buffer_store_dwordx4 v[240:243], v232, s[36:39], s56 offen sc1
    ds_read_b128 v[20:23], v228 offset:37120
    v_mfma_f32_16x16x32_bf16 v[68:71], a[232:235], v[40:43], v[68:71]
    v_mfma_f32_16x16x32_bf16 v[68:71], v[196:199], v[44:47], v[68:71]
    ds_read_b128 v[24:27], v229 offset:37120
    v_mfma_f32_16x16x32_bf16 v[68:71], v[220:223], v[48:51], v[68:71]
    v_mfma_f32_16x16x32_bf16 v[72:75], a[164:167], v[28:31], v[72:75]
    s_waitcnt lgkmcnt(8)
    buffer_store_dwordx4 v[244:247], v233, s[36:39], s56 offen offset:1024 sc1
    ds_read_b128 v[28:31], v230 offset:37120
    v_mfma_f32_16x16x32_bf16 v[72:75], a[188:191], v[32:35], v[72:75]
    ds_read_b128 v[32:35], v231 offset:37120
    v_mfma_f32_16x16x32_bf16 v[72:75], a[212:215], v[36:39], v[72:75]
    ds_read_b128 v[36:39], v228 offset:37376
    v_mfma_f32_16x16x32_bf16 v[72:75], a[236:239], v[40:43], v[72:75]
    ds_read_b128 v[40:43], v229 offset:37376
    v_mfma_f32_16x16x32_bf16 v[72:75], v[200:203], v[44:47], v[72:75]
    s_waitcnt lgkmcnt(10)
    buffer_store_dwordx4 v[248:251], v234, s[36:39], s56 offen offset:2048 sc1
    s_add_u32 s56, s78, 294912
    ds_read_b128 v[44:47], v230 offset:37376
    v_mfma_f32_16x16x32_bf16 v[72:75], v[224:227], v[48:51], v[72:75]
    ds_read_b128 v[48:51], v231 offset:37376
    s_waitcnt lgkmcnt(10)
    v_mfma_f32_16x16x32_bf16 v[52:55], a[0:3], v[4:7], v[184:187]
    v_mfma_f32_16x16x32_bf16 v[52:55], a[24:27], v[8:11], v[52:55]
    s_add_u32 s83, s83, 1
    v_mfma_f32_16x16x32_bf16 v[52:55], a[48:51], v[12:15], v[52:55]
    s_waitcnt lgkmcnt(6)
    v_mfma_f32_16x16x32_bf16 v[52:55], a[72:75], v[16:19], v[52:55]
    v_cvt_pk_bf16_f32 v0, v68, v69
    v_cvt_pk_bf16_f32 v1, v70, v71
    v_mfma_f32_16x16x32_bf16 v[52:55], a[96:99], v[20:23], v[52:55]
    v_mfma_f32_16x16x32_bf16 v[52:55], a[120:123], v[24:27], v[52:55]
    s_waitcnt lgkmcnt(3)
    v_mfma_f32_16x16x32_bf16 v[52:55], a[144:147], v[28:31], v[52:55]
    v_mfma_f32_16x16x32_bf16 v[52:55], a[168:171], v[32:35], v[52:55]
    v_mfma_f32_16x16x32_bf16 v[52:55], a[192:195], v[36:39], v[52:55]
    s_waitcnt lgkmcnt(0)
    v_mfma_f32_16x16x32_bf16 v[52:55], a[216:219], v[40:43], v[52:55]
    v_cvt_pk_bf16_f32 v2, v72, v73
    v_cvt_pk_bf16_f32 v3, v74, v75
    v_mfma_f32_16x16x32_bf16 v[52:55], a[240:243], v[44:47], v[52:55]
    ds_write_b128 v237, v[0:3] offset:24576
    v_mfma_f32_16x16x32_bf16 v[52:55], v[204:207], v[48:51], v[52:55]
    v_mfma_f32_16x16x32_bf16 v[56:59], a[4:7], v[4:7], v[188:191]
    s_add_u32 s55, s97, 768
    v_mfma_f32_16x16x32_bf16 v[56:59], a[28:31], v[8:11], v[56:59]
    s_add_u32 m0, s49, 147456
    v_mfma_f32_16x16x32_bf16 v[56:59], a[52:55], v[12:15], v[56:59]
    buffer_load_dwordx4 v232, s[20:23], s55 offen nt lds
    v_mfma_f32_16x16x32_bf16 v[56:59], a[76:79], v[16:19], v[56:59]
    v_mfma_f32_16x16x32_bf16 v[56:59], a[100:103], v[20:23], v[56:59]
    v_mfma_f32_16x16x32_bf16 v[56:59], a[124:127], v[24:27], v[56:59]
    buffer_load_dwordx4 v233, s[20:23], s55 offen offset:1024 nt lds
    v_mfma_f32_16x16x32_bf16 v[56:59], a[148:151], v[28:31], v[56:59]
    v_mfma_f32_16x16x32_bf16 v[56:59], a[172:175], v[32:35], v[56:59]
    v_mfma_f32_16x16x32_bf16 v[56:59], a[196:199], v[36:39], v[56:59]
    v_mfma_f32_16x16x32_bf16 v[56:59], a[220:223], v[40:43], v[56:59]
    v_cvt_pk_bf16_f32 v0, v52, v53
    v_cvt_pk_bf16_f32 v1, v54, v55
    v_mfma_f32_16x16x32_bf16 v[56:59], a[244:247], v[44:47], v[56:59]
    v_mfma_f32_16x16x32_bf16 v[56:59], v[208:211], v[48:51], v[56:59]
    v_mfma_f32_16x16x32_bf16 v[60:63], a[8:11], v[4:7], v[192:195]
    v_mfma_f32_16x16x32_bf16 v[60:63], a[32:35], v[8:11], v[60:63]
    v_mfma_f32_16x16x32_bf16 v[60:63], a[56:59], v[12:15], v[60:63]
    v_mfma_f32_16x16x32_bf16 v[60:63], a[80:83], v[16:19], v[60:63]
    v_mfma_f32_16x16x32_bf16 v[60:63], a[104:107], v[20:23], v[60:63]
    v_mfma_f32_16x16x32_bf16 v[60:63], a[128:131], v[24:27], v[60:63]
    v_mfma_f32_16x16x32_bf16 v[60:63], a[152:155], v[28:31], v[60:63]
    v_mfma_f32_16x16x32_bf16 v[60:63], a[176:179], v[32:35], v[60:63]
    v_mfma_f32_16x16x32_bf16 v[60:63], a[200:203], v[36:39], v[60:63]
    v_cvt_pk_bf16_f32 v2, v56, v57
    v_cvt_pk_bf16_f32 v3, v58, v59
    v_mfma_f32_16x16x32_bf16 v[60:63], a[224:227], v[40:43], v[60:63]
    ds_write_b128 v235, v[0:3] offset:36864
    v_mfma_f32_16x16x32_bf16 v[60:63], a[248:251], v[44:47], v[60:63]
    v_mfma_f32_16x16x32_bf16 v[60:63], v[212:215], v[48:51], v[60:63]
    v_mfma_f32_16x16x32_bf16 v[64:67], a[12:15], v[4:7], v[76:79]
    v_mfma_f32_16x16x32_bf16 v[64:67], a[36:39], v[8:11], v[64:67]
    v_mfma_f32_16x16x32_bf16 v[64:67], a[60:63], v[12:15], v[64:67]
    v_mfma_f32_16x16x32_bf16 v[64:67], a[84:87], v[16:19], v[64:67]
    v_mfma_f32_16x16x32_bf16 v[64:67], a[108:111], v[20:23], v[64:67]
    v_mfma_f32_16x16x32_bf16 v[64:67], a[132:135], v[24:27], v[64:67]
    v_mfma_f32_16x16x32_bf16 v[64:67], a[156:159], v[28:31], v[64:67]
    v_mfma_f32_16x16x32_bf16 v[64:67], a[180:183], v[32:35], v[64:67]
    v_mfma_f32_16x16x32_bf16 v[64:67], a[204:207], v[36:39], v[64:67]
    v_cvt_pk_bf16_f32 v0, v60, v61
    v_cvt_pk_bf16_f32 v1, v62, v63
    v_mfma_f32_16x16x32_bf16 v[64:67], a[228:231], v[40:43], v[64:67]
    v_mfma_f32_16x16x32_bf16 v[64:67], a[252:255], v[44:47], v[64:67]
    v_mfma_f32_16x16x32_bf16 v[64:67], v[216:219], v[48:51], v[64:67]
    v_mfma_f32_16x16x32_bf16 v[68:71], a[16:19], v[4:7], v[80:83]
    v_mfma_f32_16x16x32_bf16 v[68:71], a[40:43], v[8:11], v[68:71]
    s_waitcnt lgkmcnt(1)
    s_barrier
    v_mfma_f32_16x16x32_bf16 v[68:71], a[64:67], v[12:15], v[68:71]
    ds_read_b128 v[240:243], v238 offset:24576
    v_mfma_f32_16x16x32_bf16 v[68:71], a[88:91], v[16:19], v[68:71]
    ds_read_b128 v[244:247], v238 offset:25600
    v_mfma_f32_16x16x32_bf16 v[68:71], a[112:115], v[20:23], v[68:71]
    v_mfma_f32_16x16x32_bf16 v[68:71], a[136:139], v[24:27], v[68:71]
    v_mfma_f32_16x16x32_bf16 v[72:75], a[20:23], v[4:7], v[84:87]
    v_mfma_f32_16x16x32_bf16 v[72:75], a[44:47], v[8:11], v[72:75]
    ds_read_b128 v[248:251], v238 offset:26624
    v_mfma_f32_16x16x32_bf16 v[72:75], a[68:71], v[12:15], v[72:75]
    v_mfma_f32_16x16x32_bf16 v[72:75], a[92:95], v[16:19], v[72:75]
    v_cvt_pk_bf16_f32 v2, v64, v65
    v_cvt_pk_bf16_f32 v3, v66, v67
    v_mfma_f32_16x16x32_bf16 v[72:75], a[116:119], v[20:23], v[72:75]
    v_mfma_f32_16x16x32_bf16 v[72:75], a[140:143], v[24:27], v[72:75]
    ds_write_b128 v236, v[0:3] offset:36864
    v_mfma_f32_16x16x32_bf16 v[68:71], a[160:163], v[28:31], v[68:71]
    v_mfma_f32_16x16x32_bf16 v[68:71], a[184:187], v[32:35], v[68:71]
    v_mfma_f32_16x16x32_bf16 v[68:71], a[208:211], v[36:39], v[68:71]
    s_waitcnt lgkmcnt(3)
    buffer_store_dwordx4 v[240:243], v232, s[36:39], s56 offen sc1
    v_mfma_f32_16x16x32_bf16 v[68:71], a[232:235], v[40:43], v[68:71]
    v_mfma_f32_16x16x32_bf16 v[68:71], v[196:199], v[44:47], v[68:71]
    v_mfma_f32_16x16x32_bf16 v[68:71], v[220:223], v[48:51], v[68:71]
    v_mfma_f32_16x16x32_bf16 v[72:75], a[164:167], v[28:31], v[72:75]
    s_waitcnt lgkmcnt(2)
    buffer_store_dwordx4 v[244:247], v233, s[36:39], s56 offen offset:1024 sc1
    v_mfma_f32_16x16x32_bf16 v[72:75], a[188:191], v[32:35], v[72:75]
    v_mfma_f32_16x16x32_bf16 v[72:75], a[212:215], v[36:39], v[72:75]
    v_mfma_f32_16x16x32_bf16 v[72:75], a[236:239], v[40:43], v[72:75]
    v_mfma_f32_16x16x32_bf16 v[72:75], v[200:203], v[44:47], v[72:75]
    s_waitcnt lgkmcnt(1)
    buffer_store_dwordx4 v[248:251], v234, s[36:39], s56 offen offset:2048 sc1
    s_add_u32 s56, s78, 295680
    v_mfma_f32_16x16x32_bf16 v[72:75], v[224:227], v[48:51], v[72:75]
    s_nop 3
    v_cvt_pk_bf16_f32 v0, v68, v69
    v_cvt_pk_bf16_f32 v1, v70, v71
    s_nop 4
    v_cvt_pk_bf16_f32 v2, v72, v73
    v_cvt_pk_bf16_f32 v3, v74, v75
    ds_write_b128 v237, v[0:3] offset:36864
    s_waitcnt lgkmcnt(0)
    s_barrier
    ds_read_b128 v[240:243], v238 offset:36864
    ds_read_b128 v[244:247], v238 offset:37888
    ds_read_b128 v[248:251], v238 offset:38912
    s_waitcnt lgkmcnt(2)
    buffer_store_dwordx4 v[240:243], v232, s[36:39], s56 offen sc1
    s_waitcnt lgkmcnt(1)
    buffer_store_dwordx4 v[244:247], v233, s[36:39], s56 offen offset:1024 sc1
    s_waitcnt lgkmcnt(0)
    buffer_store_dwordx4 v[248:251], v234, s[36:39], s56 offen offset:2048 sc1
    s_endpgm
L_prod:
    v_mul_u32_u24 v136, 192, v2
    v_lshl_add_u32 v136, v3, 4, v136
    v_add_u32 v136, s71, v136
    v_and_b32 v137, 1, v3
    v_lshrrev_b32 v138, 1, v3
    v_bfe_u32 v139, v0, 2, 2
    v_lshl_add_u32 v139, v137, 3, v139
    v_mul_u32_u24 v139, 192, v139
    v_and_b32 v1, 3, v0
    v_lshl_add_u32 v139, v1, 4, v139
    v_lshl_add_u32 v139, v138, 3, v139
    v_add_u32 v139, s71, v139
    v_cvt_pk_bf16_f32 v112, v148, v149
    v_cvt_pk_bf16_f32 v113, v150, v151
    v_cvt_pk_bf16_f32 v114, v152, v153
    v_cvt_pk_bf16_f32 v115, v154, v155
    v_cvt_pk_bf16_f32 v116, v156, v157
    v_cvt_pk_bf16_f32 v117, v158, v159
    v_cvt_pk_bf16_f32 v118, v160, v161
    v_cvt_pk_bf16_f32 v119, v162, v163
    v_cvt_pk_bf16_f32 v120, v164, v165
    v_cvt_pk_bf16_f32 v121, v166, v167
    v_cvt_pk_bf16_f32 v122, v168, v169
    v_cvt_pk_bf16_f32 v123, v170, v171
    ds_write_b128 v136, v[112:115] offset:0
    ds_write_b128 v136, v[116:119] offset:64
    ds_write_b128 v136, v[120:123] offset:128
    ds_read_b64_tr_b16 v[124:125], v139 offset:0
    ds_read_b64_tr_b16 v[126:127], v139 offset:768
    ds_read_b64_tr_b16 v[128:129], v139 offset:64
    ds_read_b64_tr_b16 v[130:131], v139 offset:832
    ds_read_b64_tr_b16 v[132:133], v139 offset:128
    ds_read_b64_tr_b16 v[134:135], v139 offset:896
    v_lshl_add_u32 v1, v137, 4, v2
    v_lshlrev_b32 v1, 4, v1
    v_lshl_add_u32 v1, v138, 11, v1
    s_mul_i32 s57, s48, 73728
    v_add_u32 v1, s57, v1
    s_lshr_b32 s57, s60, 2
    s_mul_i32 s57, s57, 12288
    s_and_b32 s58, s60, 3
    s_lshl_b32 s58, s58, 9
    s_add_u32 s57, s57, s58
    s_add_u32 s58, s57, 4096
    s_add_u32 s68, s57, 8192
    s_waitcnt lgkmcnt(0)
    buffer_store_dwordx4 v[124:127], v1, s[40:43], s57 offen sc0 sc1
    buffer_store_dwordx4 v[128:131], v1, s[40:43], s58 offen sc0 sc1
    buffer_store_dwordx4 v[132:135], v1, s[40:43], s68 offen sc0 sc1
    s_waitcnt vmcnt(12)
    s_branch L_prod_ret
L_poll:
    s_load_dword s72, s[14:15], 64
    s_waitcnt lgkmcnt(0)
    s_cmp_ge_u32 s72, 24
    s_cbranch_scc1 L_got
    s_sleep 8
    s_load_dword s72, s[14:15], 128
    s_waitcnt lgkmcnt(0)
    s_cmp_ge_u32 s72, 24
    s_cbranch_scc1 L_got
    s_sleep 8
    s_load_dword s72, s[14:15], 192
    s_waitcnt lgkmcnt(0)
    s_cmp_ge_u32 s72, 24
    s_cbranch_scc1 L_got
    s_mov_b32 s58, 0
L_poll2:
    buffer_load_dword v254, off, s[44:47], 0 sc1
    s_waitcnt vmcnt(0)
    v_readfirstlane_b32 s72, v254
    s_nop 3
    s_cmp_ge_u32 s72, 24
    s_cbranch_scc1 L_got
    s_sleep 4
    s_add_u32 s58, s58, 1
    s_cmp_lt_u32 s58, 0x40000
    s_cbranch_scc1 L_poll2
L_got:
    s_mov_b32 exec_hi, 15
    buffer_load_dword v254, v253, s[40:43], 0 offen sc1
    s_mov_b64 exec, -1
    s_branch L_ready
L_end:
    s_endpgm
.section .rodata,"a"
.p2align 6
.amdhsa_kernel standalone__detection_seg_fpn_lateral__vision_kernel
  .amdhsa_next_free_vgpr 512
  .amdhsa_next_free_sgpr 102
  .amdhsa_accum_offset 256
  .amdhsa_group_segment_fixed_size 0
  .amdhsa_kernarg_size 56
  .amdhsa_user_sgpr_count 2
  .amdhsa_user_sgpr_kernarg_segment_ptr 1
  .amdhsa_system_sgpr_workgroup_id_x 1
.end_amdhsa_kernel
```
